```python
import torch

def _softmax(x, axis=-1):
    return torch.softmax(x, dim=axis)
def _gelu(x):
    return torch.nn.functional.gelu(x, approximate="tanh")
def _silu(x):
    return torch.nn.functional.silu(x)
def _sigmoid(x):
    return torch.sigmoid(x)
def _layernorm(x, axis=-1, eps=1e-5):
    m = x.mean(dim=axis, keepdim=True)
    v = x.var(dim=axis, keepdim=True, unbiased=False)
    return (x - m) / torch.sqrt(v + eps)
def _scatter_add(tgt, idx, src, axis=0):
    return tgt.clone().index_add_(axis, idx, src)
def _segment_sum(src, seg, n):
    out = torch.zeros((n,) + src.shape[1:], dtype=src.dtype)
    return out.index_add_(0, seg, src)
def _pad(x, pw):
    flat = tuple(v for pair in reversed(pw) for v in pair)
    return torch.nn.functional.pad(x, flat)

kernel_name = 'standalone__gqa_block_cached__sampling'

def setup_inputs():

    _w = (lambda a: (lambda t: t.to(torch.bfloat16) if t.is_floating_point() else t)(torch.as_tensor(a)))
    B, Sq, D = 8, 16, 576
    Hq, Hkv, Sk, Dh = 32, 16, 8192, 128
    assert Hq % Hkv == 0, (Hq, Hkv)
    return {
        "x": _w((lambda *s: torch.randn(*s, dtype=torch.bfloat16) * 0.8)(B, Sq, D)),
        "k_cache": _w((lambda *s: torch.randn(*s, dtype=torch.bfloat16) * 0.8)(B, Hkv, Sk, Dh)),
        "v_cache": _w((lambda *s: torch.randn(*s, dtype=torch.bfloat16) * 0.05)(B, Hkv, Sk, Dh)),
        "wq": _w((lambda *s: torch.randn(*s, dtype=torch.bfloat16) * 0.8)(D, Hq * Dh) * (D ** -0.5)),
        "wo": _w((lambda *s: torch.randn(*s, dtype=torch.bfloat16) * 0.05)(Hq * Dh, D) * ((Hq * Dh) ** -0.5)),
    }

def reference(x, k_cache, v_cache, wq, wo):
    B, Sq, D = x.shape
    Hq, Dh = 32, 128
    Hkv = k_cache.shape[1]
    rep = Hq // Hkv
    q = (lambda x, *d: x.permute(*d))((x @ wq).reshape(B, Sq, Hq, Dh), 0, 2, 1, 3)
    k = (lambda x, n, axis: torch.repeat_interleave(x, n, dim=axis))(k_cache, rep, axis=1)
    v = (lambda x, n, axis: torch.repeat_interleave(x, n, dim=axis))(v_cache, rep, axis=1)
    scores = torch.einsum("bhqd,bhkd->bhqk", q, k) * (Dh ** -0.5)
    p = _softmax(scores, axis=-1)
    o = torch.einsum("bhqk,bhkd->bhqd", p, v)
    return (lambda x, *d: x.permute(*d))(o, 0, 2, 1, 3).reshape(B, Sq, Hq * Dh) @ wo
```

```asm
; @launch grid=(256,1,1) block=(256,1,1) lds=163840
.amdgcn_target "amdgcn-amd-amdhsa--gfx950"
.text
.globl standalone__gqa_block_cached__sampling_kernel
.p2align 12
.p2align 8
.type standalone__gqa_block_cached__sampling_kernel,@function
standalone__gqa_block_cached__sampling_kernel:
  s_load_dwordx16 s[4:19], s[0:1], 0
  s_cmpk_ge_u32 s2, 0x100
  s_cbranch_scc1 L_end
  v_lshrrev_b32 v1, 6, v0
  v_and_b32 v0, 63, v0
  v_readfirstlane_b32 s3, v1
  v_lshlrev_b32 v241, 4, v0
  v_and_b32 v31, 48, v0
  v_and_b32 v5, 56, v0
  v_add_lshl_u32 v5, v5, v0, 4
  v_xor_b32 v1, v5, v31
  v_xor_b32 v2, 64, v1
  s_lshr_b32 s94, s2, 3
  s_and_b32 s95, s2, 7
  s_and_b32 s60, s94, 1
  s_lshl1_add_u32 s48, s95, s60
  s_lshr_b32 s49, s2, 5
  s_lshl4_add_u32 s51, s49, s48
  s_and_b32 s59, s3, 2
  s_lshl_b32 s51, s51, 7
  s_and_b32 s60, s94, 2
  s_add_u32 s51, s51, s60
  s_lshl2_add_u32 s51, s51, s3
  s_lshl_b32 s51, s51, 12
  s_bfe_u32 s60, s2, 0x10005
  s_lshl_b32 s60, s60, 14
  s_xor_b32 s51, s51, s60
  s_mov_b32 s52, s51
  s_lshl_b32 s53, s3, 15
  s_brev_b32 s22, 8
  s_mov_b32 s23, 0x20000
  v_min_u32 v250, 35, v0
  v_lshrrev_b32 v26, 2, v250
  v_lshlrev_b32 v250, 7, v250
  s_movk_i32 s60, 7680
  v_mad_u32_u24 v26, v26, s60, v250
  s_lshr_b32 s90, s2, 4
  s_lshl2_add_u32 s90, s90, s3
  s_mul_i32 s61, s90, 144
  s_add_u32 s61, s61, s48
  s_lshl_b32 s61, s61, 9
  s_mov_b32 s30, 4718592
  s_mov_b32 s31, s23
  s_mul_i32 s67, s3, 5120
  s_mul_i32 s68, s49, 18432
  s_add_u32 s68, s68, s67
  s_add_u32 s67, s67, s23
  s_mov_b32 s34, 147456
  s_mov_b32 s35, s23
  s_bitcmp1_b32 0x88a88a88, s94
  s_cselect_b32 s89, 2, 1
  s_bitcmp1_b32 0x15115115, s94
  s_cselect_b32 s89, 0, s89
  s_mov_b32 m0, s53
  s_mov_b32 s64, 2
  s_bitcmp1_b32 s2, 3
  s_waitcnt lgkmcnt(0)
  s_mov_b64 s[28:29], s[10:11]
  s_mov_b64 s[20:21], s[6:7]
  s_mov_b64 s[32:33], s[4:5]
  s_load_dword s100, s[4:5], s68
  s_cbranch_scc1 L_burst
  buffer_load_dword v252, v26, s[28:31], s61 offen
  s_cmp_lg_u32 s89, 0
  s_cbranch_scc1 L_burst
  s_mov_b32 m0, s67
  s_nop 0
  buffer_load_dwordx4 v241, s[32:35], s68 offen lds
  buffer_load_dwordx4 v241, s[32:35], s68 offen offset:1024 lds
  buffer_load_dwordx4 v241, s[32:35], s68 offen offset:2048 lds
  buffer_load_dwordx4 v241, s[32:35], s68 offen offset:3072 lds
  s_addk_i32 m0, 4096
  s_addk_i32 s68, 4096
  buffer_load_dwordx4 v241, s[32:35], s68 offen lds
  s_branch L_wq
L_burst:
  s_mov_b32 s99, 0x14000
1:
  s_waitcnt vmcnt(7)
  buffer_load_dwordx4 v1, s[20:23], s51 offen nt lds
  s_waitcnt vmcnt(7)
  buffer_load_dwordx4 v2, s[20:23], s51 offen offset:2048 nt lds
  s_addk_i32 m0, 896
  s_waitcnt vmcnt(7)
  buffer_load_dwordx4 v1, s[20:23], s51 offen offset:128 nt lds
  s_waitcnt vmcnt(7)
  buffer_load_dwordx4 v2, s[20:23], s51 offen offset:2176 nt lds
  s_addk_i32 m0, 3200
  s_xor_b32 s51, s51, 16384
  s_waitcnt vmcnt(7)
  buffer_load_dwordx4 v1, s[20:23], s51 offen nt lds
  s_waitcnt vmcnt(7)
  buffer_load_dwordx4 v2, s[20:23], s51 offen offset:2048 nt lds
  s_addk_i32 m0, 896
  s_waitcnt vmcnt(7)
  buffer_load_dwordx4 v1, s[20:23], s51 offen offset:128 nt lds
  s_waitcnt vmcnt(7)
  buffer_load_dwordx4 v2, s[20:23], s51 offen offset:2176 nt lds
  s_addk_i32 m0, 3200
  s_xor_b32 s51, s51, s99
  s_mov_b32 s99, 0x54000
  s_sub_u32 s64, s64, 1
  s_cmp_lg_u32 s64, 0
  s_cbranch_scc1 1b
  s_mul_i32 s60, s48, 294912
  s_load_dword s100, s[12:13], s60
  s_add_u32 s60, s60, 294784
  s_load_dword s100, s[12:13], s60
  s_bitcmp1_b32 s2, 3
  s_cbranch_scc0 1f
  buffer_load_dword v252, v26, s[28:31], s61 offen
  s_getpc_b64 s[70:71]
L_pc:
  v_min_u32 v26, 11, v0
  v_lshl_add_u32 v26, v26, 6, s90
  v_lshlrev_b32 v26, 7, v26
  v_min_u32 v26, L_end-L_pc, v26
  global_load_dword v252, v26, s[70:71]
1:
  s_mov_b32 s64, s89
  s_mov_b32 s99, 0x14000
1:
  s_waitcnt vmcnt(11)
  buffer_load_dwordx4 v1, s[20:23], s51 offen nt lds
  s_waitcnt vmcnt(11)
  buffer_load_dwordx4 v2, s[20:23], s51 offen offset:2048 nt lds
  s_addk_i32 m0, 896
  s_waitcnt vmcnt(11)
  buffer_load_dwordx4 v1, s[20:23], s51 offen offset:128 nt lds
  s_waitcnt vmcnt(11)
  buffer_load_dwordx4 v2, s[20:23], s51 offen offset:2176 nt lds
  s_addk_i32 m0, 3200
  s_xor_b32 s51, s51, 16384
  s_waitcnt vmcnt(11)
  buffer_load_dwordx4 v1, s[20:23], s51 offen nt lds
  s_waitcnt vmcnt(11)
  buffer_load_dwordx4 v2, s[20:23], s51 offen offset:2048 nt lds
  s_addk_i32 m0, 896
  s_waitcnt vmcnt(11)
  buffer_load_dwordx4 v1, s[20:23], s51 offen offset:128 nt lds
  s_waitcnt vmcnt(11)
  buffer_load_dwordx4 v2, s[20:23], s51 offen offset:2176 nt lds
  s_addk_i32 m0, 3200
  s_xor_b32 s51, s51, s99
  s_mov_b32 s99, 0xd4000
  s_sub_u32 s64, s64, 1
  s_cmp_lg_u32 s64, 0
  s_cbranch_scc1 1b
  s_cmp_eq_u32 s89, 2
  s_cbranch_scc1 L_more
L_back:
  s_mov_b64 s[36:37], s[12:13]
  s_mov_b64 s[38:39], s[30:31]
  s_lshl_b32 s60, s48, 6
  s_add_u32 s60, s60, s90
  s_mul_i32 s60, s60, 4608
  buffer_load_dword v252, v250, s[36:39], s60 offen
  s_mov_b32 m0, s67
  s_nop 0
  buffer_load_dwordx4 v241, s[32:35], s68 offen lds
  buffer_load_dwordx4 v241, s[32:35], s68 offen offset:1024 lds
  buffer_load_dwordx4 v241, s[32:35], s68 offen offset:2048 lds
  buffer_load_dwordx4 v241, s[32:35], s68 offen offset:3072 lds
  s_addk_i32 m0, 4096
  s_addk_i32 s68, 4096
  buffer_load_dwordx4 v241, s[32:35], s68 offen lds
L_wq:
  v_lshrrev_b32 v27, 4, v0
  v_and_b32 v28, 15, v0
  v_xor_b32 v240, s59, v28
  v_lshlrev_b32 v240, 4, v240
  v_lshl_add_u32 v240, v27, 16, v240
  s_and_b32 s60, s3, 1
  s_lshl1_add_u32 s60, s48, s60
  s_mul_i32 s58, s59, 4608
  s_add_u32 s58, s58, s60
  s_lshl_b32 s58, s58, 8
  buffer_load_dwordx4 v[64:67], v240, s[28:31], s58 offen
  s_addk_i32 s58, 8192
  buffer_load_dwordx4 v[68:71], v240, s[28:31], s58 offen
  s_addk_i32 s58, 8192
  buffer_load_dwordx4 v[72:75], v240, s[28:31], s58 offen
  s_addk_i32 s58, 8192
  buffer_load_dwordx4 v[76:79], v240, s[28:31], s58 offen
  s_addk_i32 s58, 8192
  buffer_load_dwordx4 v[80:83], v240, s[28:31], s58 offen
  s_addk_i32 s58, 8192
  buffer_load_dwordx4 v[84:87], v240, s[28:31], s58 offen
  s_addk_i32 s58, 8192
  buffer_load_dwordx4 v[88:91], v240, s[28:31], s58 offen
  s_addk_i32 s58, 8192
  buffer_load_dwordx4 v[92:95], v240, s[28:31], s58 offen
  s_add_u32 s58, s58, 204800
  s_bfe_u32 s60, s2, 0x10004
  s_lshl1_add_u32 s50, s48, s60
  s_lshl_b32 s60, s49, 5
  v_mov_b32 v254, s60
  s_add_u32 s60, s60, s50
  s_lshl_b32 s65, s60, 9
  s_add_u32 s65, s65, 5242880
  s_lshl_b32 s54, s3, 13
  s_add_u32 s54, s54, s23
  s_mov_b32 s56, 0x05040100
  s_mov_b32 s57, 0x07060302
  s_mov_b32 s55, 0x3e0293ee
  s_mov_b64 s[24:25], s[8:9]
  s_mov_b64 s[26:27], s[22:23]
  s_mov_b64 s[36:37], s[12:13]
  s_mov_b64 s[38:39], s[30:31]
  s_mov_b64 s[40:41], s[18:19]
  s_mov_b32 s42, 5373952
  s_mov_b32 s43, s23
  s_mov_b64 s[44:45], s[14:15]
  s_mov_b64 s[46:47], s[34:35]
  v_mov_b32 v228, v241
  v_lshlrev_b32 v31, 2, v31
  v_xor_b32 v18, v241, v31
  v_and_b32 v31, 64, v31
  v_xor_b32 v5, v5, v31
  v_mul_u32_u24 v251, 1152, v28
  v_lshl_add_u32 v251, v27, 4, v251
  s_mul_i32 s60, s59, 288
  s_add_u32 s60, s60, s23
  v_add_u32 v251, s60, v251
  s_lshr_b32 s60, s89, 1
  s_lshl_b32 s60, s60, 14
  s_add_u32 s60, s60, s53
  v_lshrrev_b32 v30, 5, v0
  v_bfe_u32 v29, v0, 1, 3
  v_xor_b32 v6, v30, v29
  v_lshl_add_u32 v6, v6, 4, s60
  v_and_b32 v29, 24, v0
  v_lshl_add_u32 v6, v29, 7, v6
  v_and_b32 v29, 31, v0
  v_lshl_add_u32 v6, v29, 7, v6
  v_xor_b32 v7, 32, v6
  v_xor_b32 v8, 64, v6
  v_xor_b32 v9, 96, v6
  v_lshlrev_b32 v230, 2, v29
  v_add_u32 v231, s54, v230
  v_bfe_u32 v29, v0, 2, 2
  v_lshl_add_u32 v30, v30, 2, v29
  v_and_b32 v29, 8, v0
  v_lshlrev_b32 v29, 3, v29
  v_lshl_add_u32 v14, v30, 7, v29
  v_and_b32 v29, 16, v0
  v_lshl_add_u32 v14, v29, 1, v14
  v_and_b32 v29, 3, v0
  v_lshl_add_u32 v14, v29, 3, v14
  s_and_b32 s60, s3, 1
  s_lshl3_add_u32 s60, s59, s60
  s_lshl_b32 s60, s60, 6
  s_add_u32 s60, s60, s53
  v_xor_b32 v14, s60, v14
  v_xor_b32 v15, 64, v14
  v_xor_b32 v16, 1024, v14
  v_xor_b32 v17, 1088, v14
  v_lshrrev_b32 v30, 2, v0
  v_lshlrev_b32 v30, 8, v30
  v_lshl_add_u32 v20, v29, 3, v30
  s_add_u32 s60, s53, 24576
  v_add_u32 v20, s60, v20
  v_and_b32 v30, 12, v0
  v_lshl_add_u32 v20, v30, 4, v20
  v_xor_b32 v243, 64, v20
  v_xor_b32 v244, 128, v20
  v_xor_b32 v245, 192, v20
  v_lshl_add_u32 v21, v0, 3, s54
  v_mul_u32_u24 v30, 896, v27
  v_add_u32 v18, v18, v30
  s_lshl_b32 s60, s3, 8
  v_add_u32 v18, s60, v18
  v_lshrrev_b32 v29, 3, v0
  v_add_u32 v29, 1, v29
  v_lshl_add_u32 v19, v29, 10, v241
  s_mul_i32 s66, s48, 294912
  v_and_b32 v29, 7, v0
  v_lshlrev_b32 v29, 5, v29
  v_cmp_eq_u32 vcc, 0, v0
  s_mov_b32 s91, 0
  s_lshl_b32 s95, s95, 14
  v_cndmask_b32 v254, v29, v254, vcc
  s_add_u32 s95, s95, 5243008
  s_lshl2_add_u32 s94, s94, s95
  v_mov_b32 v253, 1
  v_mov_b32 v255, 0
  s_and_b32 s60, s50, 1
  s_add_u32 s60, s60, 9
  s_cmp_eq_u32 s3, 0
  s_cselect_b32 s63, s60, 0
  s_lshl2_add_u32 s60, s50, s3
  s_lshl4_add_u32 s61, s49, 1
  s_and_b32 s64, s49, 1
  s_add_u32 s64, s64, 3
  s_cmp_eq_u32 s60, s61
  s_cselect_b32 s63, s64, s63
  s_sub_u32 s60, s63, 3
  s_cmp_lt_u32 s60, 2
  s_cbranch_scc0 1f
  v_mov_b32 v26, -1
  v_mov_b32 v27, -1
  v_mov_b32 v28, -1
  v_mov_b32 v29, -1
  s_lshl_b32 s60, s49, 14
  s_add_u32 s60, s60, 5242880
  buffer_store_dwordx4 v[26:29], v228, s[40:43], s60 offen sc1
  buffer_store_dwordx4 v[26:29], v228, s[40:43], s60 offen offset:1024 sc1
  buffer_store_dwordx4 v[26:29], v228, s[40:43], s60 offen offset:2048 sc1
  buffer_store_dwordx4 v[26:29], v228, s[40:43], s60 offen offset:3072 sc1
  s_addk_i32 s60, 4096
  buffer_store_dwordx4 v[26:29], v228, s[40:43], s60 offen sc1
  buffer_store_dwordx4 v[26:29], v228, s[40:43], s60 offen offset:1024 sc1
  buffer_store_dwordx4 v[26:29], v228, s[40:43], s60 offen offset:2048 sc1
  buffer_store_dwordx4 v[26:29], v228, s[40:43], s60 offen offset:3072 sc1
  s_nop 1
1:
  s_sub_u32 s60, s63, 3
  s_cmp_lt_u32 s60, 2
  s_cbranch_scc0 1f
  v_mov_b32 v26, -1
  v_mov_b32 v27, -1
  v_mov_b32 v28, -1
  v_mov_b32 v29, -1
  s_lshl_b32 s60, s49, 14
  s_add_u32 s60, s60, 5251072
  buffer_store_dwordx4 v[26:29], v228, s[40:43], s60 offen sc1
  buffer_store_dwordx4 v[26:29], v228, s[40:43], s60 offen offset:1024 sc1
  buffer_store_dwordx4 v[26:29], v228, s[40:43], s60 offen offset:2048 sc1
  buffer_store_dwordx4 v[26:29], v228, s[40:43], s60 offen offset:3072 sc1
  s_addk_i32 s60, 4096
  buffer_store_dwordx4 v[26:29], v228, s[40:43], s60 offen sc1
  buffer_store_dwordx4 v[26:29], v228, s[40:43], s60 offen offset:1024 sc1
  buffer_store_dwordx4 v[26:29], v228, s[40:43], s60 offen offset:2048 sc1
  buffer_store_dwordx4 v[26:29], v228, s[40:43], s60 offen offset:3072 sc1
  s_nop 1
1:
  buffer_load_dwordx4 v[96:99], v240, s[28:31], s58 offen
  s_addk_i32 s58, 8192
  buffer_load_dwordx4 v[100:103], v240, s[28:31], s58 offen
  s_addk_i32 s58, 8192
  buffer_load_dwordx4 v[104:107], v240, s[28:31], s58 offen
  s_addk_i32 s58, 8192
  buffer_load_dwordx4 v[108:111], v240, s[28:31], s58 offen
  s_addk_i32 s58, 8192
  buffer_load_dwordx4 v[112:115], v240, s[28:31], s58 offen
  s_addk_i32 s58, 8192
  buffer_load_dwordx4 v[116:119], v240, s[28:31], s58 offen
  s_addk_i32 s58, 8192
  buffer_load_dwordx4 v[120:123], v240, s[28:31], s58 offen
  s_addk_i32 s58, 8192
  buffer_load_dwordx4 v[124:127], v240, s[28:31], s58 offen
  s_add_u32 s58, s58, 204800
  buffer_load_dwordx4 v[128:131], v240, s[28:31], s58 offen
  s_addk_i32 s58, 8192
  buffer_load_dwordx4 v[132:135], v240, s[28:31], s58 offen
  s_addk_i32 s58, 8192
  buffer_load_dwordx4 v[136:139], v240, s[28:31], s58 offen
  s_addk_i32 s58, 8192
  buffer_load_dwordx4 v[140:143], v240, s[28:31], s58 offen
  s_addk_i32 s58, 8192
  buffer_load_dwordx4 v[144:147], v240, s[28:31], s58 offen
  s_addk_i32 s58, 8192
  buffer_load_dwordx4 v[148:151], v240, s[28:31], s58 offen
  s_addk_i32 s58, 8192
  buffer_load_dwordx4 v[152:155], v240, s[28:31], s58 offen
  s_addk_i32 s58, 8192
  buffer_load_dwordx4 v[156:159], v240, s[28:31], s58 offen
  s_add_u32 s58, s58, 204800
  s_waitcnt lgkmcnt(0)
  s_waitcnt vmcnt(24)
  s_barrier
  ds_read_b128 a[192:195], v251
  ds_read_b128 a[196:199], v251 offset:64
  ds_read_b128 a[200:203], v251 offset:128
  ds_read_b128 a[204:207], v251 offset:192
  ds_read_b128 a[208:211], v251 offset:256
  ds_read_b128 a[212:215], v251 offset:320
  ds_read_b128 a[216:219], v251 offset:384
  ds_read_b128 a[220:223], v251 offset:448
  ds_read_b128 a[224:227], v251 offset:512
  s_waitcnt vmcnt(16)
  buffer_load_dwordx4 v[160:163], v240, s[28:31], s58 offen
  s_addk_i32 s58, 8192
  buffer_load_dwordx4 v[164:167], v240, s[28:31], s58 offen
  s_addk_i32 s58, 8192
  v_perm_b32 v192, v68, v64, s56
  v_perm_b32 v193, v76, v72, s56
  v_perm_b32 v194, v84, v80, s56
  v_perm_b32 v195, v92, v88, s56
  v_perm_b32 v196, v68, v64, s57
  v_perm_b32 v197, v76, v72, s57
  s_waitcnt lgkmcnt(8)
  v_mfma_f32_16x16x32_bf16 v[32:35], v[192:195], a[192:195], 0
  v_perm_b32 v198, v84, v80, s57
  v_perm_b32 v199, v92, v88, s57
  buffer_load_dwordx4 v[168:171], v240, s[28:31], s58 offen
  s_addk_i32 s58, 8192
  buffer_load_dwordx4 v[172:175], v240, s[28:31], s58 offen
  s_addk_i32 s58, 8192
  v_perm_b32 v200, v69, v65, s56
  v_perm_b32 v201, v77, v73, s56
  v_mfma_f32_16x16x32_bf16 v[36:39], v[196:199], a[192:195], 0
  v_perm_b32 v202, v85, v81, s56
  v_perm_b32 v203, v93, v89, s56
  v_perm_b32 v204, v69, v65, s57
  v_perm_b32 v205, v77, v73, s57
  v_mfma_f32_16x16x32_bf16 v[40:43], v[200:203], a[192:195], 0
  v_perm_b32 v206, v85, v81, s57
  v_perm_b32 v207, v93, v89, s57
  buffer_load_dwordx4 v[176:179], v240, s[28:31], s58 offen
  s_addk_i32 s58, 8192
  buffer_load_dwordx4 v[180:183], v240, s[28:31], s58 offen
  s_addk_i32 s58, 8192
  v_perm_b32 v192, v70, v66, s56
  v_perm_b32 v193, v78, v74, s56
  v_mfma_f32_16x16x32_bf16 v[44:47], v[204:207], a[192:195], 0
  v_perm_b32 v194, v86, v82, s56
  v_perm_b32 v195, v94, v90, s56
  v_perm_b32 v196, v70, v66, s57
  v_perm_b32 v197, v78, v74, s57
  v_mfma_f32_16x16x32_bf16 v[48:51], v[192:195], a[192:195], 0
  v_perm_b32 v198, v86, v82, s57
  v_perm_b32 v199, v94, v90, s57
  buffer_load_dwordx4 v[184:187], v240, s[28:31], s58 offen
  s_addk_i32 s58, 8192
  buffer_load_dwordx4 v[188:191], v240, s[28:31], s58 offen
  s_add_u32 s58, s58, 204800
  v_perm_b32 v200, v71, v67, s56
  v_perm_b32 v201, v79, v75, s56
  v_mfma_f32_16x16x32_bf16 v[52:55], v[196:199], a[192:195], 0
  v_perm_b32 v202, v87, v83, s56
  v_perm_b32 v203, v95, v91, s56
  v_perm_b32 v204, v71, v67, s57
  v_perm_b32 v205, v79, v75, s57
  v_mfma_f32_16x16x32_bf16 v[56:59], v[200:203], a[192:195], 0
  v_perm_b32 v206, v87, v83, s57
  v_perm_b32 v207, v95, v91, s57
  s_nop 1
  v_mfma_f32_16x16x32_bf16 v[60:63], v[204:207], a[192:195], 0
  s_waitcnt vmcnt(16)
  buffer_load_dwordx4 v[64:67], v240, s[28:31], s58 offen
  s_addk_i32 s58, 8192
  buffer_load_dwordx4 v[68:71], v240, s[28:31], s58 offen
  s_addk_i32 s58, 8192
  v_perm_b32 v192, v100, v96, s56
  v_perm_b32 v193, v108, v104, s56
  v_perm_b32 v194, v116, v112, s56
  v_perm_b32 v195, v124, v120, s56
  v_perm_b32 v196, v100, v96, s57
  v_perm_b32 v197, v108, v104, s57
  s_waitcnt lgkmcnt(7)
  v_mfma_f32_16x16x32_bf16 v[32:35], v[192:195], a[196:199], v[32:35]
  v_perm_b32 v198, v116, v112, s57
  v_perm_b32 v199, v124, v120, s57
  ds_read_b128 a[64:67], v6
  ds_read_b128 a[68:71], v7
  buffer_load_dwordx4 v[72:75], v240, s[28:31], s58 offen
  s_addk_i32 s58, 8192
  buffer_load_dwordx4 v[76:79], v240, s[28:31], s58 offen
  s_addk_i32 s58, 8192
  v_perm_b32 v200, v101, v97, s56
  v_perm_b32 v201, v109, v105, s56
  v_mfma_f32_16x16x32_bf16 v[36:39], v[196:199], a[196:199], v[36:39]
  v_perm_b32 v202, v117, v113, s56
  v_perm_b32 v203, v125, v121, s56
  v_perm_b32 v204, v101, v97, s57
  v_perm_b32 v205, v109, v105, s57
  v_mfma_f32_16x16x32_bf16 v[40:43], v[200:203], a[196:199], v[40:43]
  v_perm_b32 v206, v117, v113, s57
  v_perm_b32 v207, v125, v121, s57
  ds_read_b128 a[72:75], v8
  ds_read_b128 a[76:79], v9
  buffer_load_dwordx4 v[80:83], v240, s[28:31], s58 offen
  s_addk_i32 s58, 8192
  buffer_load_dwordx4 v[84:87], v240, s[28:31], s58 offen
  s_addk_i32 s58, 8192
  v_perm_b32 v192, v102, v98, s56
  v_perm_b32 v193, v110, v106, s56
  v_mfma_f32_16x16x32_bf16 v[44:47], v[204:207], a[196:199], v[44:47]
  v_perm_b32 v194, v118, v114, s56
  v_perm_b32 v195, v126, v122, s56
  v_perm_b32 v196, v102, v98, s57
  v_perm_b32 v197, v110, v106, s57
  v_mfma_f32_16x16x32_bf16 v[48:51], v[192:195], a[196:199], v[48:51]
  v_perm_b32 v198, v118, v114, s57
  v_perm_b32 v199, v126, v122, s57
  ds_read_b128 a[80:83], v6 offset:1024
  ds_read_b128 a[84:87], v7 offset:1024
  buffer_load_dwordx4 v[88:91], v240, s[28:31], s58 offen
  s_addk_i32 s58, 8192
  buffer_load_dwordx4 v[92:95], v240, s[28:31], s58 offen
  s_add_u32 s58, s58, 204800
  v_perm_b32 v200, v103, v99, s56
  v_perm_b32 v201, v111, v107, s56
  v_mfma_f32_16x16x32_bf16 v[52:55], v[196:199], a[196:199], v[52:55]
  v_perm_b32 v202, v119, v115, s56
  v_perm_b32 v203, v127, v123, s56
  v_perm_b32 v204, v103, v99, s57
  v_perm_b32 v205, v111, v107, s57
  v_mfma_f32_16x16x32_bf16 v[56:59], v[200:203], a[196:199], v[56:59]
  v_perm_b32 v206, v119, v115, s57
  v_perm_b32 v207, v127, v123, s57
  s_nop 1
  v_mfma_f32_16x16x32_bf16 v[60:63], v[204:207], a[196:199], v[60:63]
  ds_read_b128 a[88:91], v8 offset:1024
  ds_read_b128 a[92:95], v9 offset:1024
  s_waitcnt vmcnt(16)
  buffer_load_dwordx4 v[96:99], v240, s[28:31], s58 offen
  s_addk_i32 s58, 8192
  buffer_load_dwordx4 v[100:103], v240, s[28:31], s58 offen
  s_addk_i32 s58, 8192
  v_perm_b32 v192, v132, v128, s56
  v_perm_b32 v193, v140, v136, s56
  v_perm_b32 v194, v148, v144, s56
  v_perm_b32 v195, v156, v152, s56
  v_perm_b32 v196, v132, v128, s57
  v_perm_b32 v197, v140, v136, s57
  s_waitcnt lgkmcnt(14)
  v_mfma_f32_16x16x32_bf16 v[32:35], v[192:195], a[200:203], v[32:35]
  v_perm_b32 v198, v148, v144, s57
  v_perm_b32 v199, v156, v152, s57
  ds_read_b128 a[96:99], v6 offset:8192
  s_waitcnt lgkmcnt(14)
  ds_read_b128 a[100:103], v7 offset:8192
  buffer_load_dwordx4 v[104:107], v240, s[28:31], s58 offen
  s_addk_i32 s58, 8192
  buffer_load_dwordx4 v[108:111], v240, s[28:31], s58 offen
  s_addk_i32 s58, 8192
  v_perm_b32 v200, v133, v129, s56
  v_perm_b32 v201, v141, v137, s56
  v_mfma_f32_16x16x32_bf16 v[36:39], v[196:199], a[200:203], v[36:39]
  v_perm_b32 v202, v149, v145, s56
  v_perm_b32 v203, v157, v153, s56
  v_perm_b32 v204, v133, v129, s57
  v_perm_b32 v205, v141, v137, s57
  v_mfma_f32_16x16x32_bf16 v[40:43], v[200:203], a[200:203], v[40:43]
  v_perm_b32 v206, v149, v145, s57
  v_perm_b32 v207, v157, v153, s57
  s_waitcnt lgkmcnt(14)
  ds_read_b128 a[104:107], v8 offset:8192
  s_waitcnt lgkmcnt(14)
  ds_read_b128 a[108:111], v9 offset:8192
  buffer_load_dwordx4 v[112:115], v240, s[28:31], s58 offen
  s_addk_i32 s58, 8192
  buffer_load_dwordx4 v[116:119], v240, s[28:31], s58 offen
  s_addk_i32 s58, 8192
  v_perm_b32 v192, v134, v130, s56
  v_perm_b32 v193, v142, v138, s56
  v_mfma_f32_16x16x32_bf16 v[44:47], v[204:207], a[200:203], v[44:47]
  v_perm_b32 v194, v150, v146, s56
  v_perm_b32 v195, v158, v154, s56
  v_perm_b32 v196, v134, v130, s57
  v_perm_b32 v197, v142, v138, s57
  v_mfma_f32_16x16x32_bf16 v[48:51], v[192:195], a[200:203], v[48:51]
  v_perm_b32 v198, v150, v146, s57
  v_perm_b32 v199, v158, v154, s57
  s_waitcnt lgkmcnt(14)
  ds_read_b128 a[112:115], v6 offset:9216
  s_waitcnt lgkmcnt(14)
  ds_read_b128 a[116:119], v7 offset:9216
  buffer_load_dwordx4 v[120:123], v240, s[28:31], s58 offen
  s_addk_i32 s58, 8192
  buffer_load_dwordx4 v[124:127], v240, s[28:31], s58 offen
  s_add_u32 s58, s58, 204800
  v_perm_b32 v200, v135, v131, s56
  v_perm_b32 v201, v143, v139, s56
  v_mfma_f32_16x16x32_bf16 v[52:55], v[196:199], a[200:203], v[52:55]
  v_perm_b32 v202, v151, v147, s56
  v_perm_b32 v203, v159, v155, s56
  v_perm_b32 v204, v135, v131, s57
  v_perm_b32 v205, v143, v139, s57
  v_mfma_f32_16x16x32_bf16 v[56:59], v[200:203], a[200:203], v[56:59]
  v_perm_b32 v206, v151, v147, s57
  v_perm_b32 v207, v159, v155, s57
  s_nop 1
  v_mfma_f32_16x16x32_bf16 v[60:63], v[204:207], a[200:203], v[60:63]
  s_waitcnt lgkmcnt(14)
  ds_read_b128 a[120:123], v8 offset:9216
  s_waitcnt lgkmcnt(14)
  ds_read_b128 a[124:127], v9 offset:9216
  s_waitcnt vmcnt(16)
  buffer_load_dwordx4 v[128:131], v240, s[28:31], s58 offen
  s_addk_i32 s58, 8192
  buffer_load_dwordx4 v[132:135], v240, s[28:31], s58 offen
  s_addk_i32 s58, 8192
  v_perm_b32 v192, v164, v160, s56
  v_perm_b32 v193, v172, v168, s56
  v_perm_b32 v194, v180, v176, s56
  v_perm_b32 v195, v188, v184, s56
  v_perm_b32 v196, v164, v160, s57
  v_perm_b32 v197, v172, v168, s57
  v_mfma_f32_16x16x32_bf16 v[32:35], v[192:195], a[204:207], v[32:35]
  v_perm_b32 v198, v180, v176, s57
  v_perm_b32 v199, v188, v184, s57
  buffer_load_dwordx4 v[136:139], v240, s[28:31], s58 offen
  s_addk_i32 s58, 8192
  buffer_load_dwordx4 v[140:143], v240, s[28:31], s58 offen
  s_addk_i32 s58, 8192
  v_perm_b32 v200, v165, v161, s56
  v_perm_b32 v201, v173, v169, s56
  v_mfma_f32_16x16x32_bf16 v[36:39], v[196:199], a[204:207], v[36:39]
  v_perm_b32 v202, v181, v177, s56
  v_perm_b32 v203, v189, v185, s56
  v_perm_b32 v204, v165, v161, s57
  v_perm_b32 v205, v173, v169, s57
  v_mfma_f32_16x16x32_bf16 v[40:43], v[200:203], a[204:207], v[40:43]
  v_perm_b32 v206, v181, v177, s57
  v_perm_b32 v207, v189, v185, s57
  buffer_load_dwordx4 v[144:147], v240, s[28:31], s58 offen
  s_addk_i32 s58, 8192
  buffer_load_dwordx4 v[148:151], v240, s[28:31], s58 offen
  s_addk_i32 s58, 8192
  v_perm_b32 v192, v166, v162, s56
  v_perm_b32 v193, v174, v170, s56
  v_mfma_f32_16x16x32_bf16 v[44:47], v[204:207], a[204:207], v[44:47]
  v_perm_b32 v194, v182, v178, s56
  v_perm_b32 v195, v190, v186, s56
  v_perm_b32 v196, v166, v162, s57
  v_perm_b32 v197, v174, v170, s57
  v_mfma_f32_16x16x32_bf16 v[48:51], v[192:195], a[204:207], v[48:51]
  v_perm_b32 v198, v182, v178, s57
  v_perm_b32 v199, v190, v186, s57
  buffer_load_dwordx4 v[152:155], v240, s[28:31], s58 offen
  s_addk_i32 s58, 8192
  buffer_load_dwordx4 v[156:159], v240, s[28:31], s58 offen
  s_add_u32 s58, s58, 204800
  v_perm_b32 v200, v167, v163, s56
  v_perm_b32 v201, v175, v171, s56
  v_mfma_f32_16x16x32_bf16 v[52:55], v[196:199], a[204:207], v[52:55]
  v_perm_b32 v202, v183, v179, s56
  v_perm_b32 v203, v191, v187, s56
  v_perm_b32 v204, v167, v163, s57
  v_perm_b32 v205, v175, v171, s57
  v_mfma_f32_16x16x32_bf16 v[56:59], v[200:203], a[204:207], v[56:59]
  v_perm_b32 v206, v183, v179, s57
  v_perm_b32 v207, v191, v187, s57
  s_nop 1
  v_mfma_f32_16x16x32_bf16 v[60:63], v[204:207], a[204:207], v[60:63]
  s_waitcnt lgkmcnt(0)
  s_barrier
  s_waitcnt vmcnt(16)
  buffer_load_dwordx4 v[160:163], v240, s[28:31], s58 offen
  s_addk_i32 s58, 8192
  buffer_load_dwordx4 v[164:167], v240, s[28:31], s58 offen
  s_addk_i32 s58, 8192
  v_perm_b32 v192, v68, v64, s56
  v_perm_b32 v193, v76, v72, s56
  v_perm_b32 v194, v84, v80, s56
  v_perm_b32 v195, v92, v88, s56
  v_perm_b32 v196, v68, v64, s57
  v_perm_b32 v197, v76, v72, s57
  v_mfma_f32_16x16x32_bf16 v[32:35], v[192:195], a[208:211], v[32:35]
  v_perm_b32 v198, v84, v80, s57
  v_perm_b32 v199, v92, v88, s57
  buffer_load_dwordx4 v[168:171], v240, s[28:31], s58 offen
  s_addk_i32 s58, 8192
  buffer_load_dwordx4 v[172:175], v240, s[28:31], s58 offen
  s_addk_i32 s58, 8192
  v_perm_b32 v200, v69, v65, s56
  v_perm_b32 v201, v77, v73, s56
  v_mfma_f32_16x16x32_bf16 v[36:39], v[196:199], a[208:211], v[36:39]
  v_perm_b32 v202, v85, v81, s56
  v_perm_b32 v203, v93, v89, s56
  v_perm_b32 v204, v69, v65, s57
  v_perm_b32 v205, v77, v73, s57
  v_mfma_f32_16x16x32_bf16 v[40:43], v[200:203], a[208:211], v[40:43]
  v_perm_b32 v206, v85, v81, s57
  v_perm_b32 v207, v93, v89, s57
  buffer_load_dwordx4 v[176:179], v240, s[28:31], s58 offen
  s_addk_i32 s58, 8192
  buffer_load_dwordx4 v[180:183], v240, s[28:31], s58 offen
  s_addk_i32 s58, 8192
  v_perm_b32 v192, v70, v66, s56
  v_perm_b32 v193, v78, v74, s56
  v_mfma_f32_16x16x32_bf16 v[44:47], v[204:207], a[208:211], v[44:47]
  v_perm_b32 v194, v86, v82, s56
  v_perm_b32 v195, v94, v90, s56
  v_perm_b32 v196, v70, v66, s57
  v_perm_b32 v197, v78, v74, s57
  v_mfma_f32_16x16x32_bf16 v[48:51], v[192:195], a[208:211], v[48:51]
  v_perm_b32 v198, v86, v82, s57
  v_perm_b32 v199, v94, v90, s57
  buffer_load_dwordx4 v[184:187], v240, s[28:31], s58 offen
  s_addk_i32 s58, 8192
  buffer_load_dwordx4 v[188:191], v240, s[28:31], s58 offen
  s_add_u32 s58, s58, 204800
  v_perm_b32 v200, v71, v67, s56
  v_perm_b32 v201, v79, v75, s56
  v_mfma_f32_16x16x32_bf16 v[52:55], v[196:199], a[208:211], v[52:55]
  v_perm_b32 v202, v87, v83, s56
  v_perm_b32 v203, v95, v91, s56
  v_perm_b32 v204, v71, v67, s57
  v_perm_b32 v205, v79, v75, s57
  v_mfma_f32_16x16x32_bf16 v[56:59], v[200:203], a[208:211], v[56:59]
  v_perm_b32 v206, v87, v83, s57
  v_perm_b32 v207, v95, v91, s57
  s_nop 1
  v_mfma_f32_16x16x32_bf16 v[60:63], v[204:207], a[208:211], v[60:63]
  s_waitcnt vmcnt(16)
  buffer_load_dwordx4 v[64:67], v240, s[28:31], s58 offen
  s_addk_i32 s58, 8192
  buffer_load_dwordx4 v[68:71], v240, s[28:31], s58 offen
  s_addk_i32 s58, 8192
  v_perm_b32 v192, v100, v96, s56
  v_perm_b32 v193, v108, v104, s56
  v_perm_b32 v194, v116, v112, s56
  v_perm_b32 v195, v124, v120, s56
  v_perm_b32 v196, v100, v96, s57
  v_perm_b32 v197, v108, v104, s57
  v_mfma_f32_16x16x32_bf16 v[32:35], v[192:195], a[212:215], v[32:35]
  v_perm_b32 v198, v116, v112, s57
  v_perm_b32 v199, v124, v120, s57
  buffer_load_dwordx4 v[72:75], v240, s[28:31], s58 offen
  s_addk_i32 s58, 8192
  buffer_load_dwordx4 v[76:79], v240, s[28:31], s58 offen
  s_addk_i32 s58, 8192
  v_perm_b32 v200, v101, v97, s56
  v_perm_b32 v201, v109, v105, s56
  v_mfma_f32_16x16x32_bf16 v[36:39], v[196:199], a[212:215], v[36:39]
  v_perm_b32 v202, v117, v113, s56
  v_perm_b32 v203, v125, v121, s56
  v_perm_b32 v204, v101, v97, s57
  v_perm_b32 v205, v109, v105, s57
  v_mfma_f32_16x16x32_bf16 v[40:43], v[200:203], a[212:215], v[40:43]
  v_perm_b32 v206, v117, v113, s57
  v_perm_b32 v207, v125, v121, s57
  buffer_load_dwordx4 v[80:83], v240, s[28:31], s58 offen
  s_addk_i32 s58, 8192
  buffer_load_dwordx4 v[84:87], v240, s[28:31], s58 offen
  s_addk_i32 s58, 8192
  v_perm_b32 v192, v102, v98, s56
  v_perm_b32 v193, v110, v106, s56
  v_mfma_f32_16x16x32_bf16 v[44:47], v[204:207], a[212:215], v[44:47]
  v_perm_b32 v194, v118, v114, s56
  v_perm_b32 v195, v126, v122, s56
  v_perm_b32 v196, v102, v98, s57
  v_perm_b32 v197, v110, v106, s57
  v_mfma_f32_16x16x32_bf16 v[48:51], v[192:195], a[212:215], v[48:51]
  v_perm_b32 v198, v118, v114, s57
  v_perm_b32 v199, v126, v122, s57
  buffer_load_dwordx4 v[88:91], v240, s[28:31], s58 offen
  s_addk_i32 s58, 8192
  buffer_load_dwordx4 v[92:95], v240, s[28:31], s58 offen
  v_perm_b32 v200, v103, v99, s56
  v_perm_b32 v201, v111, v107, s56
  v_mfma_f32_16x16x32_bf16 v[52:55], v[196:199], a[212:215], v[52:55]
  v_perm_b32 v202, v119, v115, s56
  v_perm_b32 v203, v127, v123, s56
  v_perm_b32 v204, v103, v99, s57
  v_perm_b32 v205, v111, v107, s57
  v_mfma_f32_16x16x32_bf16 v[56:59], v[200:203], a[212:215], v[56:59]
  v_perm_b32 v206, v119, v115, s57
  v_perm_b32 v207, v127, v123, s57
  s_nop 1
  v_mfma_f32_16x16x32_bf16 v[60:63], v[204:207], a[212:215], v[60:63]
  s_cmp_eq_u32 s89, 1
  s_cbranch_scc1 L_B
  s_cmp_eq_u32 s89, 2
  s_cbranch_scc1 L_C
  s_mul_i32 s60, s90, 4608
  s_add_u32 s60, s60, s66
  buffer_load_dword v252, v250, s[36:39], s60 offen
  s_mov_b32 m0, s53
  s_nop 0
  buffer_load_dwordx4 v1, s[20:23], s51 offen nt lds
  s_waitcnt vmcnt(18)
  v_perm_b32 v192, v132, v128, s56
  v_perm_b32 v193, v140, v136, s56
  v_perm_b32 v194, v148, v144, s56
  v_perm_b32 v195, v156, v152, s56
  v_perm_b32 v196, v132, v128, s57
  v_perm_b32 v197, v140, v136, s57
  v_mfma_f32_16x16x32_bf16 v[32:35], v[192:195], a[216:219], v[32:35]
  v_perm_b32 v198, v148, v144, s57
  v_perm_b32 v199, v156, v152, s57
  buffer_load_dwordx4 v2, s[20:23], s51 offen offset:2048 nt lds
  v_perm_b32 v200, v133, v129, s56
  v_perm_b32 v201, v141, v137, s56
  v_mfma_f32_16x16x32_bf16 v[36:39], v[196:199], a[216:219], v[36:39]
  v_perm_b32 v202, v149, v145, s56
  v_perm_b32 v203, v157, v153, s56
  v_perm_b32 v204, v133, v129, s57
  v_perm_b32 v205, v141, v137, s57
  v_mfma_f32_16x16x32_bf16 v[40:43], v[200:203], a[216:219], v[40:43]
  v_perm_b32 v206, v149, v145, s57
  v_perm_b32 v207, v157, v153, s57
  s_add_u32 m0, s53, 896
  s_nop 0
  buffer_load_dwordx4 v1, s[20:23], s51 offen offset:128 nt lds
  v_perm_b32 v192, v134, v130, s56
  v_perm_b32 v193, v142, v138, s56
  v_mfma_f32_16x16x32_bf16 v[44:47], v[204:207], a[216:219], v[44:47]
  v_perm_b32 v194, v150, v146, s56
  v_perm_b32 v195, v158, v154, s56
  v_perm_b32 v196, v134, v130, s57
  v_perm_b32 v197, v142, v138, s57
  v_mfma_f32_16x16x32_bf16 v[48:51], v[192:195], a[216:219], v[48:51]
  v_perm_b32 v198, v150, v146, s57
  v_perm_b32 v199, v158, v154, s57
  buffer_load_dwordx4 v2, s[20:23], s51 offen offset:2176 nt lds
  s_xor_b32 s51, s51, 16384
  v_perm_b32 v200, v135, v131, s56
  v_perm_b32 v201, v143, v139, s56
  v_mfma_f32_16x16x32_bf16 v[52:55], v[196:199], a[216:219], v[52:55]
  v_perm_b32 v202, v151, v147, s56
  v_perm_b32 v203, v159, v155, s56
  v_perm_b32 v204, v135, v131, s57
  v_perm_b32 v205, v143, v139, s57
  v_mfma_f32_16x16x32_bf16 v[56:59], v[200:203], a[216:219], v[56:59]
  v_perm_b32 v206, v151, v147, s57
  v_perm_b32 v207, v159, v155, s57
  s_nop 1
  v_mfma_f32_16x16x32_bf16 v[60:63], v[204:207], a[216:219], v[60:63]
  s_add_u32 m0, s53, 4096
  s_nop 0
  buffer_load_dwordx4 v1, s[20:23], s51 offen nt lds
  s_waitcnt vmcnt(14)
  v_perm_b32 v192, v164, v160, s56
  v_perm_b32 v193, v172, v168, s56
  v_perm_b32 v194, v180, v176, s56
  v_perm_b32 v195, v188, v184, s56
  v_perm_b32 v196, v164, v160, s57
  v_perm_b32 v197, v172, v168, s57
  v_mfma_f32_16x16x32_bf16 v[32:35], v[192:195], a[220:223], v[32:35]
  v_perm_b32 v198, v180, v176, s57
  v_perm_b32 v199, v188, v184, s57
  buffer_load_dwordx4 v2, s[20:23], s51 offen offset:2048 nt lds
  v_perm_b32 v200, v165, v161, s56
  v_perm_b32 v201, v173, v169, s56
  v_mfma_f32_16x16x32_bf16 v[36:39], v[196:199], a[220:223], v[36:39]
  v_perm_b32 v202, v181, v177, s56
  v_perm_b32 v203, v189, v185, s56
  v_perm_b32 v204, v165, v161, s57
  v_perm_b32 v205, v173, v169, s57
  v_mfma_f32_16x16x32_bf16 v[40:43], v[200:203], a[220:223], v[40:43]
  v_perm_b32 v206, v181, v177, s57
  v_perm_b32 v207, v189, v185, s57
  s_add_u32 m0, s53, 4992
  s_nop 0
  buffer_load_dwordx4 v1, s[20:23], s51 offen offset:128 nt lds
  v_perm_b32 v192, v166, v162, s56
  v_perm_b32 v193, v174, v170, s56
  v_mfma_f32_16x16x32_bf16 v[44:47], v[204:207], a[220:223], v[44:47]
  v_perm_b32 v194, v182, v178, s56
  v_perm_b32 v195, v190, v186, s56
  v_perm_b32 v196, v166, v162, s57
  v_perm_b32 v197, v174, v170, s57
  v_mfma_f32_16x16x32_bf16 v[48:51], v[192:195], a[220:223], v[48:51]
  v_perm_b32 v198, v182, v178, s57
  v_perm_b32 v199, v190, v186, s57
  buffer_load_dwordx4 v2, s[20:23], s51 offen offset:2176 nt lds
  s_xor_b32 s51, s51, 0x14000
  v_perm_b32 v200, v167, v163, s56
  v_perm_b32 v201, v175, v171, s56
  v_mfma_f32_16x16x32_bf16 v[52:55], v[196:199], a[220:223], v[52:55]
  v_perm_b32 v202, v183, v179, s56
  v_perm_b32 v203, v191, v187, s56
  v_perm_b32 v204, v167, v163, s57
  v_perm_b32 v205, v175, v171, s57
  v_mfma_f32_16x16x32_bf16 v[56:59], v[200:203], a[220:223], v[56:59]
  v_perm_b32 v206, v183, v179, s57
  v_perm_b32 v207, v191, v187, s57
  s_nop 1
  v_mfma_f32_16x16x32_bf16 v[60:63], v[204:207], a[220:223], v[60:63]
  s_add_u32 m0, s53, 8192
  s_nop 0
  buffer_load_dwordx4 v1, s[20:23], s51 offen nt lds
  s_waitcnt vmcnt(10)
  v_perm_b32 v192, v68, v64, s56
  v_perm_b32 v193, v76, v72, s56
  v_perm_b32 v194, v84, v80, s56
  v_perm_b32 v195, v92, v88, s56
  v_perm_b32 v196, v68, v64, s57
  v_perm_b32 v197, v76, v72, s57
  v_mfma_f32_16x16x32_bf16 v[32:35], v[192:195], a[224:227], v[32:35]
  v_perm_b32 v198, v84, v80, s57
  v_perm_b32 v199, v92, v88, s57
  buffer_load_dwordx4 v2, s[20:23], s51 offen offset:2048 nt lds
  v_perm_b32 v200, v69, v65, s56
  v_perm_b32 v201, v77, v73, s56
  v_mfma_f32_16x16x32_bf16 v[36:39], v[196:199], a[224:227], v[36:39]
  v_perm_b32 v202, v85, v81, s56
  v_perm_b32 v203, v93, v89, s56
  v_perm_b32 v204, v69, v65, s57
  v_perm_b32 v205, v77, v73, s57
  v_mfma_f32_16x16x32_bf16 v[40:43], v[200:203], a[224:227], v[40:43]
  v_perm_b32 v206, v85, v81, s57
  v_perm_b32 v207, v93, v89, s57
  s_add_u32 m0, s53, 9088
  s_nop 0
  buffer_load_dwordx4 v1, s[20:23], s51 offen offset:128 nt lds
  v_perm_b32 v192, v70, v66, s56
  v_perm_b32 v193, v78, v74, s56
  v_mfma_f32_16x16x32_bf16 v[44:47], v[204:207], a[224:227], v[44:47]
  v_perm_b32 v194, v86, v82, s56
  v_perm_b32 v195, v94, v90, s56
  v_perm_b32 v196, v70, v66, s57
  v_perm_b32 v197, v78, v74, s57
  v_mfma_f32_16x16x32_bf16 v[48:51], v[192:195], a[224:227], v[48:51]
  v_perm_b32 v198, v86, v82, s57
  v_perm_b32 v199, v94, v90, s57
  buffer_load_dwordx4 v2, s[20:23], s51 offen offset:2176 nt lds
  s_xor_b32 s51, s51, 16384
  v_perm_b32 v200, v71, v67, s56
  v_perm_b32 v201, v79, v75, s56
  v_mfma_f32_16x16x32_bf16 v[52:55], v[196:199], a[224:227], v[52:55]
  v_perm_b32 v202, v87, v83, s56
  v_perm_b32 v203, v95, v91, s56
  v_perm_b32 v204, v71, v67, s57
  v_perm_b32 v205, v79, v75, s57
  v_mfma_f32_16x16x32_bf16 v[56:59], v[200:203], a[224:227], v[56:59]
  v_perm_b32 v206, v87, v83, s57
  v_perm_b32 v207, v95, v91, s57
  s_nop 1
  v_mfma_f32_16x16x32_bf16 v[60:63], v[204:207], a[224:227], v[60:63]
  s_add_u32 m0, s53, 12288
  s_waitcnt vmcnt(11)
  buffer_load_dwordx4 v1, s[20:23], s51 offen nt lds
  s_waitcnt vmcnt(11)
  buffer_load_dwordx4 v2, s[20:23], s51 offen offset:2048 nt lds
  v_xor_b32 v26, 16384, v21
  s_nop 6
  ds_write_b64 v21, v[34:35]
  ds_write_b64 v21, v[38:39] offset:512
  ds_write_b64 v21, v[42:43] offset:1024
  ds_write_b64 v21, v[46:47] offset:1536
  ds_write_b64 v21, v[50:51] offset:2048
  ds_write_b64 v21, v[54:55] offset:2560
  ds_write_b64 v21, v[58:59] offset:3072
  ds_write_b64 v21, v[62:63] offset:3584
  v_and_b32 v27, 15, v0
  v_lshrrev_b32 v28, 4, v0
  v_lshlrev_b32 v28, 2, v28
  v_xor_b32 v28, s59, v28
  v_xor_b32 v28, v28, v27
  v_lshlrev_b32 v28, 4, v28
  v_lshl_add_u32 v28, v27, 8, v28
  s_and_b32 s60, s3, 1
  s_lshl_b32 s60, s60, 13
  s_add_u32 s60, s60, 135168
  v_add_u32 v28, s60, v28
  v_xor_b32 v29, 16, v28
  s_waitcnt lgkmcnt(0)
  s_barrier
  ds_read_b64 v[64:65], v26
  ds_read_b64 v[66:67], v26 offset:512
  ds_read_b64 v[68:69], v26 offset:1024
  ds_read_b64 v[70:71], v26 offset:1536
  ds_read_b64 v[72:73], v26 offset:2048
  ds_read_b64 v[74:75], v26 offset:2560
  ds_read_b64 v[76:77], v26 offset:3072
  ds_read_b64 v[78:79], v26 offset:3584
  s_add_u32 m0, s53, 13184
  s_waitcnt vmcnt(11)
  buffer_load_dwordx4 v1, s[20:23], s51 offen offset:128 nt lds
  s_waitcnt vmcnt(11)
  buffer_load_dwordx4 v2, s[20:23], s51 offen offset:2176 nt lds
  s_xor_b32 s51, s51, 0x54000
  s_add_u32 m0, s53, 16384
  s_waitcnt vmcnt(11)
  buffer_load_dwordx4 v1, s[20:23], s51 offen nt lds
  s_waitcnt lgkmcnt(7)
  v_add_f32 v64, v64, v32
  v_add_f32 v65, v65, v33
  s_waitcnt lgkmcnt(6)
  v_add_f32 v66, v66, v36
  v_add_f32 v67, v67, v37
  s_waitcnt lgkmcnt(5)
  v_add_f32 v68, v68, v40
  v_add_f32 v69, v69, v41
  s_waitcnt lgkmcnt(4)
  v_add_f32 v70, v70, v44
  v_add_f32 v71, v71, v45
  s_waitcnt lgkmcnt(3)
  v_add_f32 v72, v72, v48
  v_add_f32 v73, v73, v49
  s_waitcnt lgkmcnt(2)
  v_add_f32 v74, v74, v52
  v_add_f32 v75, v75, v53
  s_waitcnt lgkmcnt(1)
  v_add_f32 v76, v76, v56
  v_add_f32 v77, v77, v57
  s_waitcnt lgkmcnt(0)
  v_add_f32 v78, v78, v60
  v_add_f32 v79, v79, v61
  v_cvt_pk_bf16_f32 v80, v64, v66
  v_cvt_pk_bf16_f32 v81, v68, v70
  v_cvt_pk_bf16_f32 v82, v72, v74
  v_cvt_pk_bf16_f32 v83, v76, v78
  ds_write_b128 v28, v[80:83]
  v_cvt_pk_bf16_f32 v84, v65, v67
  v_cvt_pk_bf16_f32 v85, v69, v71
  v_cvt_pk_bf16_f32 v86, v73, v75
  v_cvt_pk_bf16_f32 v87, v77, v79
  ds_write_b128 v29, v[84:87]
  v_lshrrev_b32 v26, 5, v0
  v_xor_b32 v26, v26, v27
  v_lshlrev_b32 v26, 4, v26
  v_lshl_add_u32 v26, v27, 8, v26
  v_and_b32 v27, 16, v0
  v_lshl_add_u32 v26, v27, 9, v26
  v_add_u32 v96, 135168, v26
  v_xor_b32 v97, 32, v96
  v_xor_b32 v98, 64, v96
  v_xor_b32 v99, 96, v96
  v_xor_b32 v100, 128, v96
  v_xor_b32 v101, 160, v96
  v_xor_b32 v102, 192, v96
  v_xor_b32 v103, 224, v96
  s_waitcnt lgkmcnt(0)
  s_barrier
  ds_read_b128 v[32:35], v96
  ds_read_b128 v[36:39], v97
  ds_read_b128 v[40:43], v98
  ds_read_b128 v[44:47], v99
  ds_read_b128 v[48:51], v100
  ds_read_b128 v[52:55], v101
  ds_read_b128 v[56:59], v102
  ds_read_b128 v[60:63], v103
  s_waitcnt lgkmcnt(0)
  s_waitcnt vmcnt(11)
  buffer_load_dwordx4 v2, s[20:23], s51 offen offset:2048 nt lds
  s_add_u32 m0, s53, 17280
  s_waitcnt vmcnt(11)
  buffer_load_dwordx4 v1, s[20:23], s51 offen offset:128 nt lds
  s_waitcnt vmcnt(11)
  buffer_load_dwordx4 v2, s[20:23], s51 offen offset:2176 nt lds
  s_xor_b32 s51, s51, 16384
  ds_read_b128 v[144:147], v6
  ds_read_b128 v[148:151], v7
  ds_read_b128 v[152:155], v8
  ds_read_b128 v[156:159], v9
  ds_read_b128 v[160:163], v6 offset:1024
  ds_read_b128 v[164:167], v7 offset:1024
  ds_read_b128 v[168:171], v8 offset:1024
  ds_read_b128 v[172:175], v9 offset:1024
  s_waitcnt lgkmcnt(4)
  v_mfma_f32_32x32x16_bf16 v[128:143], v[144:147], v[32:35], 0
  v_mfma_f32_32x32x16_bf16 v[128:143], v[148:151], v[36:39], v[128:143]
  v_mfma_f32_32x32x16_bf16 v[128:143], v[152:155], v[40:43], v[128:143]
  v_mfma_f32_32x32x16_bf16 v[128:143], v[156:159], v[44:47], v[128:143]
  s_add_u32 m0, s53, 20480
  s_waitcnt vmcnt(11)
  buffer_load_dwordx4 v1, s[20:23], s51 offen nt lds
  s_cmp_eq_u32 s63, 3
  s_cbranch_scc0 1f
  s_waitcnt vmcnt(0)
  s_mov_b64 exec, 1
  global_store_dword v254, v253, s[16:17] sc1
  s_mov_b64 exec, -1
1:
  s_waitcnt lgkmcnt(0)
  v_mfma_f32_32x32x16_bf16 v[128:143], v[160:163], v[48:51], v[128:143]
  v_mfma_f32_32x32x16_bf16 v[128:143], v[164:167], v[52:55], v[128:143]
  v_mfma_f32_32x32x16_bf16 v[128:143], v[168:171], v[56:59], v[128:143]
  v_mfma_f32_32x32x16_bf16 v[128:143], v[172:175], v[60:63], v[128:143]
  s_waitcnt vmcnt(11)
  buffer_load_dwordx4 v2, s[20:23], s51 offen offset:2048 nt lds
  s_nop 9
  v_max3_f32 v26, v128, v129, v130
  v_max3_f32 v27, v131, v132, v133
  v_max3_f32 v28, v134, v135, v136
  v_max3_f32 v29, v137, v138, v139
  v_max3_f32 v30, v140, v141, v142
  v_max3_f32 v26, v26, v27, v28
  v_max3_f32 v29, v29, v30, v143
  v_max_f32 v27, v26, v29
  v_max_f32 v26, v26, v29
  s_nop 1
  v_permlane32_swap_b32 v26, v27
  v_max_f32 v23, v26, v27
  v_mul_f32 v24, s55, v23
  v_fma_f32 v128, v128, s55, -v24
  v_fma_f32 v129, v129, s55, -v24
  v_fma_f32 v130, v130, s55, -v24
  v_fma_f32 v131, v131, s55, -v24
  s_add_u32 m0, s53, 21376
  s_waitcnt vmcnt(11)
  buffer_load_dwordx4 v1, s[20:23], s51 offen offset:128 nt lds
  v_fma_f32 v132, v132, s55, -v24
  v_fma_f32 v133, v133, s55, -v24
  v_exp_f32 v128, v128
  v_fma_f32 v134, v134, s55, -v24
  v_fma_f32 v135, v135, s55, -v24
  v_exp_f32 v129, v129
  v_fma_f32 v136, v136, s55, -v24
  v_fma_f32 v137, v137, s55, -v24
  v_exp_f32 v130, v130
  v_fma_f32 v138, v138, s55, -v24
  v_fma_f32 v139, v139, s55, -v24
  v_exp_f32 v131, v131
  v_fma_f32 v140, v140, s55, -v24
  v_fma_f32 v141, v141, s55, -v24
  v_exp_f32 v132, v132
  v_fma_f32 v142, v142, s55, -v24
  v_fma_f32 v143, v143, s55, -v24
  v_exp_f32 v133, v133
  s_waitcnt vmcnt(11)
  buffer_load_dwordx4 v2, s[20:23], s51 offen offset:2176 nt lds
  s_xor_b32 s51, s51, 0x14000
  v_exp_f32 v134, v134
  v_exp_f32 v135, v135
  v_exp_f32 v136, v136
  v_exp_f32 v137, v137
  v_exp_f32 v138, v138
  v_exp_f32 v139, v139
  v_cvt_pk_bf16_f32 v176, v128, v129
  v_exp_f32 v140, v140
  v_cvt_pk_bf16_f32 v177, v130, v131
  v_exp_f32 v141, v141
  v_cvt_pk_bf16_f32 v178, v132, v133
  v_exp_f32 v142, v142
  v_cvt_pk_bf16_f32 v179, v134, v135
  v_exp_f32 v143, v143
  v_cvt_pk_bf16_f32 v180, v136, v137
  s_add_u32 m0, s53, 24576
  s_waitcnt vmcnt(11)
  buffer_load_dwordx4 v1, s[20:23], s51 offen nt lds
  v_add_f32 v26, v128, v129
  v_add_f32 v27, v130, v131
  v_add_f32 v28, v132, v133
  v_add_f32 v29, v134, v135
  v_cvt_pk_bf16_f32 v181, v138, v139
  v_cvt_pk_bf16_f32 v182, v140, v141
  v_cvt_pk_bf16_f32 v183, v142, v143
  v_add_f32 v26, v26, v136
  v_accvgpr_write_b32 a0, v176
  v_add_f32 v27, v27, v137
  v_accvgpr_write_b32 a1, v177
  v_add_f32 v28, v28, v138
  v_accvgpr_write_b32 a2, v178
  v_add_f32 v29, v29, v139
  v_accvgpr_write_b32 a3, v179
  v_add_f32 v26, v26, v140
  v_accvgpr_write_b32 a4, v180
  v_add_f32 v27, v27, v141
  v_accvgpr_write_b32 a5, v181
  v_add_f32 v28, v28, v142
  v_accvgpr_write_b32 a6, v182
  v_add_f32 v29, v29, v143
  v_accvgpr_write_b32 a7, v183
  v_add_f32 v26, v26, v27
  v_add_f32 v28, v28, v29
  v_add_f32 v25, v26, v28
  s_waitcnt vmcnt(11)
  buffer_load_dwordx4 v2, s[20:23], s51 offen offset:2048 nt lds
  s_add_u32 m0, s53, 25472
  s_waitcnt vmcnt(11)
  buffer_load_dwordx4 v1, s[20:23], s51 offen offset:128 nt lds
  s_waitcnt vmcnt(11)
  buffer_load_dwordx4 v2, s[20:23], s51 offen offset:2176 nt lds
  s_xor_b32 s51, s51, 16384
  ds_read_b128 v[144:147], v6 offset:8192
  ds_read_b128 v[148:151], v7 offset:8192
  ds_read_b128 v[152:155], v8 offset:8192
  ds_read_b128 v[156:159], v9 offset:8192
  ds_read_b128 v[160:163], v6 offset:9216
  ds_read_b128 v[164:167], v7 offset:9216
  ds_read_b128 v[168:171], v8 offset:9216
  ds_read_b128 v[172:175], v9 offset:9216
  s_add_u32 m0, s53, 28672
  s_waitcnt vmcnt(11)
  buffer_load_dwordx4 v1, s[20:23], s51 offen nt lds
  s_waitcnt lgkmcnt(4)
  v_mfma_f32_32x32x16_bf16 v[128:143], v[144:147], v[32:35], 0
  v_mfma_f32_32x32x16_bf16 v[128:143], v[148:151], v[36:39], v[128:143]
  v_mfma_f32_32x32x16_bf16 v[128:143], v[152:155], v[40:43], v[128:143]
  v_mfma_f32_32x32x16_bf16 v[128:143], v[156:159], v[44:47], v[128:143]
  s_waitcnt vmcnt(11)
  buffer_load_dwordx4 v2, s[20:23], s51 offen offset:2048 nt lds
  s_cmp_eq_u32 s63, 4
  s_cbranch_scc0 1f
  s_waitcnt vmcnt(0)
  s_mov_b64 exec, 1
  global_store_dword v254, v253, s[16:17] sc1
  s_mov_b64 exec, -1
1:
  s_waitcnt lgkmcnt(0)
  v_mfma_f32_32x32x16_bf16 v[128:143], v[160:163], v[48:51], v[128:143]
  v_mfma_f32_32x32x16_bf16 v[128:143], v[164:167], v[52:55], v[128:143]
  v_mfma_f32_32x32x16_bf16 v[128:143], v[168:171], v[56:59], v[128:143]
  v_mfma_f32_32x32x16_bf16 v[128:143], v[172:175], v[60:63], v[128:143]
  v_mov_b32 v31, v24
  s_nop 10
  v_max3_f32 v26, v128, v129, v130
  v_max3_f32 v27, v131, v132, v133
  v_max3_f32 v28, v134, v135, v136
  v_max3_f32 v29, v137, v138, v139
  v_max3_f32 v30, v140, v141, v142
  v_max3_f32 v26, v26, v27, v28
  v_max3_f32 v29, v29, v30, v143
  v_max_f32 v27, v26, v29
  v_max_f32 v26, v26, v29
  s_nop 1
  v_permlane32_swap_b32 v26, v27
  v_max3_f32 v23, v26, v27, v23
  v_mul_f32 v24, s55, v23
  v_sub_f32 v31, v31, v24
  v_exp_f32 v22, v31
  v_fma_f32 v128, v128, s55, -v24
  v_fma_f32 v129, v129, s55, -v24
  v_fma_f32 v130, v130, s55, -v24
  v_fma_f32 v131, v131, s55, -v24
  ds_write_b32 v231, v22 offset:128
  s_add_u32 m0, s53, 29568
  s_waitcnt vmcnt(11)
  buffer_load_dwordx4 v1, s[20:23], s51 offen offset:128 nt lds
  v_fma_f32 v132, v132, s55, -v24
  v_fma_f32 v133, v133, s55, -v24
  v_exp_f32 v128, v128
  v_fma_f32 v134, v134, s55, -v24
  v_fma_f32 v135, v135, s55, -v24
  v_exp_f32 v129, v129
  v_fma_f32 v136, v136, s55, -v24
  v_fma_f32 v137, v137, s55, -v24
  v_exp_f32 v130, v130
  v_fma_f32 v138, v138, s55, -v24
  v_fma_f32 v139, v139, s55, -v24
  v_exp_f32 v131, v131
  v_fma_f32 v140, v140, s55, -v24
  v_fma_f32 v141, v141, s55, -v24
  v_exp_f32 v132, v132
  v_fma_f32 v142, v142, s55, -v24
  v_fma_f32 v143, v143, s55, -v24
  v_exp_f32 v133, v133
  s_waitcnt vmcnt(11)
  buffer_load_dwordx4 v2, s[20:23], s51 offen offset:2176 nt lds
  s_xor_b32 s51, s51, 0xd4000
  v_exp_f32 v134, v134
  v_exp_f32 v135, v135
  v_exp_f32 v136, v136
  v_exp_f32 v137, v137
  v_exp_f32 v138, v138
  v_exp_f32 v139, v139
  v_cvt_pk_bf16_f32 v176, v128, v129
  v_exp_f32 v140, v140
  v_cvt_pk_bf16_f32 v177, v130, v131
  v_exp_f32 v141, v141
  v_cvt_pk_bf16_f32 v178, v132, v133
  v_exp_f32 v142, v142
  v_cvt_pk_bf16_f32 v179, v134, v135
  v_exp_f32 v143, v143
  v_cvt_pk_bf16_f32 v180, v136, v137
  s_mov_b32 m0, s53
  s_waitcnt vmcnt(11)
  buffer_load_dwordx4 v1, s[20:23], s51 offen nt lds
  v_fma_f32 v26, v25, v22, v128
  v_add_f32 v27, v130, v131
  v_add_f32 v28, v132, v133
  v_add_f32 v29, v134, v135
  v_add_f32 v26, v26, v129
  v_cvt_pk_bf16_f32 v181, v138, v139
  v_cvt_pk_bf16_f32 v182, v140, v141
  v_cvt_pk_bf16_f32 v183, v142, v143
  v_add_f32 v26, v26, v136
  v_accvgpr_write_b32 a8, v176
  v_add_f32 v27, v27, v137
  v_accvgpr_write_b32 a9, v177
  v_add_f32 v28, v28, v138
  v_accvgpr_write_b32 a10, v178
  v_add_f32 v29, v29, v139
  v_accvgpr_write_b32 a11, v179
  v_add_f32 v26, v26, v140
  v_accvgpr_write_b32 a12, v180
  v_add_f32 v27, v27, v141
  v_accvgpr_write_b32 a13, v181
  v_add_f32 v28, v28, v142
  v_accvgpr_write_b32 a14, v182
  v_add_f32 v29, v29, v143
  v_accvgpr_write_b32 a15, v183
  v_add_f32 v26, v26, v27
  v_add_f32 v28, v28, v29
  v_add_f32 v25, v26, v28
  s_waitcnt vmcnt(11)
  buffer_load_dwordx4 v2, s[20:23], s51 offen offset:2048 nt lds
  s_add_u32 m0, s53, 896
  s_waitcnt vmcnt(11)
  buffer_load_dwordx4 v1, s[20:23], s51 offen offset:128 nt lds
  s_waitcnt vmcnt(11)
  buffer_load_dwordx4 v2, s[20:23], s51 offen offset:2176 nt lds
  s_xor_b32 s51, s51, 16384
  ds_read_b128 v[144:147], v6 offset:16384
  ds_read_b128 v[148:151], v7 offset:16384
  ds_read_b128 v[152:155], v8 offset:16384
  ds_read_b128 v[156:159], v9 offset:16384
  ds_read_b128 v[160:163], v6 offset:17408
  ds_read_b128 v[164:167], v7 offset:17408
  ds_read_b128 v[168:171], v8 offset:17408
  ds_read_b128 v[172:175], v9 offset:17408
  s_add_u32 m0, s53, 4096
  s_waitcnt vmcnt(11)
  buffer_load_dwordx4 v1, s[20:23], s51 offen nt lds
  s_waitcnt lgkmcnt(4)
  v_mfma_f32_32x32x16_bf16 v[128:143], v[144:147], v[32:35], 0
  v_mfma_f32_32x32x16_bf16 v[128:143], v[148:151], v[36:39], v[128:143]
  v_mfma_f32_32x32x16_bf16 v[128:143], v[152:155], v[40:43], v[128:143]
  v_mfma_f32_32x32x16_bf16 v[128:143], v[156:159], v[44:47], v[128:143]
  s_waitcnt vmcnt(11)
  buffer_load_dwordx4 v2, s[20:23], s51 offen offset:2048 nt lds
  s_waitcnt lgkmcnt(0)
  v_mfma_f32_32x32x16_bf16 v[128:143], v[160:163], v[48:51], v[128:143]
  v_mfma_f32_32x32x16_bf16 v[128:143], v[164:167], v[52:55], v[128:143]
  v_mfma_f32_32x32x16_bf16 v[128:143], v[168:171], v[56:59], v[128:143]
  v_mfma_f32_32x32x16_bf16 v[128:143], v[172:175], v[60:63], v[128:143]
  s_add_u32 m0, s53, 4992
  s_waitcnt vmcnt(11)
  buffer_load_dwordx4 v1, s[20:23], s51 offen offset:128 nt lds
  v_mov_b32 v31, v24
  s_nop 7
  v_max3_f32 v26, v128, v129, v130
  v_max3_f32 v27, v131, v132, v133
  v_max3_f32 v28, v134, v135, v136
  v_max3_f32 v29, v137, v138, v139
  v_max3_f32 v30, v140, v141, v142
  v_max3_f32 v26, v26, v27, v28
  v_max3_f32 v29, v29, v30, v143
  v_max_f32 v27, v26, v29
  v_max_f32 v26, v26, v29
  s_nop 1
  v_permlane32_swap_b32 v26, v27
  v_max3_f32 v23, v26, v27, v23
  v_mul_f32 v24, s55, v23
  v_sub_f32 v31, v31, v24
  v_exp_f32 v22, v31
  v_fma_f32 v128, v128, s55, -v24
  v_fma_f32 v129, v129, s55, -v24
  v_fma_f32 v130, v130, s55, -v24
  v_fma_f32 v131, v131, s55, -v24
  ds_write_b32 v231, v22 offset:256
  s_waitcnt vmcnt(11)
  buffer_load_dwordx4 v2, s[20:23], s51 offen offset:2176 nt lds
  s_xor_b32 s51, s51, 0x14000
  v_fma_f32 v132, v132, s55, -v24
  v_fma_f32 v133, v133, s55, -v24
  v_exp_f32 v128, v128
  v_fma_f32 v134, v134, s55, -v24
  v_fma_f32 v135, v135, s55, -v24
  v_exp_f32 v129, v129
  v_fma_f32 v136, v136, s55, -v24
  v_fma_f32 v137, v137, s55, -v24
  v_exp_f32 v130, v130
  v_fma_f32 v138, v138, s55, -v24
  v_fma_f32 v139, v139, s55, -v24
  v_exp_f32 v131, v131
  v_fma_f32 v140, v140, s55, -v24
  v_fma_f32 v141, v141, s55, -v24
  v_exp_f32 v132, v132
  v_fma_f32 v142, v142, s55, -v24
  v_fma_f32 v143, v143, s55, -v24
  v_exp_f32 v133, v133
  v_exp_f32 v134, v134
  v_exp_f32 v135, v135
  v_exp_f32 v136, v136
  v_exp_f32 v137, v137
  v_exp_f32 v138, v138
  v_exp_f32 v139, v139
  v_cvt_pk_bf16_f32 v176, v128, v129
  v_exp_f32 v140, v140
  v_cvt_pk_bf16_f32 v177, v130, v131
  v_exp_f32 v141, v141
  v_cvt_pk_bf16_f32 v178, v132, v133
  v_exp_f32 v142, v142
  v_cvt_pk_bf16_f32 v179, v134, v135
  v_exp_f32 v143, v143
  v_cvt_pk_bf16_f32 v180, v136, v137
  s_add_u32 m0, s53, 8192
  s_waitcnt vmcnt(11)
  buffer_load_dwordx4 v1, s[20:23], s51 offen nt lds
  v_fma_f32 v26, v25, v22, v128
  v_add_f32 v27, v130, v131
  v_add_f32 v28, v132, v133
  v_add_f32 v29, v134, v135
  v_add_f32 v26, v26, v129
  v_cvt_pk_bf16_f32 v181, v138, v139
  v_cvt_pk_bf16_f32 v182, v140, v141
  v_cvt_pk_bf16_f32 v183, v142, v143
  v_add_f32 v26, v26, v136
  v_accvgpr_write_b32 a16, v176
  v_add_f32 v27, v27, v137
  v_accvgpr_write_b32 a17, v177
  v_add_f32 v28, v28, v138
  v_accvgpr_write_b32 a18, v178
  v_add_f32 v29, v29, v139
  v_accvgpr_write_b32 a19, v179
  v_add_f32 v26, v26, v140
  v_accvgpr_write_b32 a20, v180
  v_add_f32 v27, v27, v141
  v_accvgpr_write_b32 a21, v181
  v_add_f32 v28, v28, v142
  v_accvgpr_write_b32 a22, v182
  v_add_f32 v29, v29, v143
  v_accvgpr_write_b32 a23, v183
  v_add_f32 v26, v26, v27
  v_add_f32 v28, v28, v29
  v_add_f32 v25, v26, v28
  s_waitcnt vmcnt(11)
  buffer_load_dwordx4 v2, s[20:23], s51 offen offset:2048 nt lds
  s_add_u32 m0, s53, 9088
  s_waitcnt vmcnt(11)
  buffer_load_dwordx4 v1, s[20:23], s51 offen offset:128 nt lds
  s_waitcnt vmcnt(11)
  buffer_load_dwordx4 v2, s[20:23], s51 offen offset:2176 nt lds
  s_xor_b32 s51, s51, 16384
  ds_read_b128 v[144:147], v6 offset:24576
  ds_read_b128 v[148:151], v7 offset:24576
  ds_read_b128 v[152:155], v8 offset:24576
  ds_read_b128 v[156:159], v9 offset:24576
  ds_read_b128 v[160:163], v6 offset:25600
  ds_read_b128 v[164:167], v7 offset:25600
  ds_read_b128 v[168:171], v8 offset:25600
  ds_read_b128 v[172:175], v9 offset:25600
  s_add_u32 m0, s53, 12288
  s_waitcnt vmcnt(11)
  buffer_load_dwordx4 v1, s[20:23], s51 offen nt lds
  s_waitcnt lgkmcnt(4)
  v_mfma_f32_32x32x16_bf16 v[128:143], v[144:147], v[32:35], 0
  v_mfma_f32_32x32x16_bf16 v[128:143], v[148:151], v[36:39], v[128:143]
  v_mfma_f32_32x32x16_bf16 v[128:143], v[152:155], v[40:43], v[128:143]
  v_mfma_f32_32x32x16_bf16 v[128:143], v[156:159], v[44:47], v[128:143]
  s_waitcnt lgkmcnt(0)
  v_mfma_f32_32x32x16_bf16 v[128:143], v[160:163], v[48:51], v[128:143]
  v_mfma_f32_32x32x16_bf16 v[128:143], v[164:167], v[52:55], v[128:143]
  v_mfma_f32_32x32x16_bf16 v[128:143], v[168:171], v[56:59], v[128:143]
  v_mfma_f32_32x32x16_bf16 v[128:143], v[172:175], v[60:63], v[128:143]
  s_waitcnt vmcnt(11)
  buffer_load_dwordx4 v2, s[20:23], s51 offen offset:2048 nt lds
  v_mov_b32 v31, v24
  s_nop 8
  v_max3_f32 v26, v128, v129, v130
  v_max3_f32 v27, v131, v132, v133
  v_max3_f32 v28, v134, v135, v136
  v_max3_f32 v29, v137, v138, v139
  v_max3_f32 v30, v140, v141, v142
  v_max3_f32 v26, v26, v27, v28
  v_max3_f32 v29, v29, v30, v143
  v_max_f32 v27, v26, v29
  v_max_f32 v26, v26, v29
  s_nop 1
  v_permlane32_swap_b32 v26, v27
  v_max3_f32 v23, v26, v27, v23
  v_mul_f32 v24, s55, v23
  v_sub_f32 v31, v31, v24
  v_exp_f32 v22, v31
  v_fma_f32 v128, v128, s55, -v24
  v_fma_f32 v129, v129, s55, -v24
  v_fma_f32 v130, v130, s55, -v24
  v_fma_f32 v131, v131, s55, -v24
  ds_write_b32 v231, v22 offset:384
  s_add_u32 m0, s53, 13184
  s_waitcnt vmcnt(11)
  buffer_load_dwordx4 v1, s[20:23], s51 offen offset:128 nt lds
  v_fma_f32 v132, v132, s55, -v24
  v_fma_f32 v133, v133, s55, -v24
  v_exp_f32 v128, v128
  v_fma_f32 v134, v134, s55, -v24
  v_fma_f32 v135, v135, s55, -v24
  v_exp_f32 v129, v129
  v_fma_f32 v136, v136, s55, -v24
  v_fma_f32 v137, v137, s55, -v24
  v_exp_f32 v130, v130
  v_fma_f32 v138, v138, s55, -v24
  v_fma_f32 v139, v139, s55, -v24
  v_exp_f32 v131, v131
  v_fma_f32 v140, v140, s55, -v24
  v_fma_f32 v141, v141, s55, -v24
  v_exp_f32 v132, v132
  v_fma_f32 v142, v142, s55, -v24
  v_fma_f32 v143, v143, s55, -v24
  v_exp_f32 v133, v133
  s_waitcnt vmcnt(11)
  buffer_load_dwordx4 v2, s[20:23], s51 offen offset:2176 nt lds
  s_xor_b32 s51, s51, 0x54000
  v_exp_f32 v134, v134
  v_exp_f32 v135, v135
  v_exp_f32 v136, v136
  v_exp_f32 v137, v137
  v_exp_f32 v138, v138
  v_exp_f32 v139, v139
  v_cvt_pk_bf16_f32 v176, v128, v129
  v_exp_f32 v140, v140
  v_cvt_pk_bf16_f32 v177, v130, v131
  v_exp_f32 v141, v141
  v_cvt_pk_bf16_f32 v178, v132, v133
  v_exp_f32 v142, v142
  v_cvt_pk_bf16_f32 v179, v134, v135
  v_exp_f32 v143, v143
  v_cvt_pk_bf16_f32 v180, v136, v137
  s_add_u32 m0, s53, 16384
  s_waitcnt vmcnt(11)
  buffer_load_dwordx4 v1, s[20:23], s51 offen nt lds
  v_fma_f32 v26, v25, v22, v128
  v_add_f32 v27, v130, v131
  v_add_f32 v28, v132, v133
  v_add_f32 v29, v134, v135
  v_add_f32 v26, v26, v129
  v_cvt_pk_bf16_f32 v181, v138, v139
  v_cvt_pk_bf16_f32 v182, v140, v141
  v_cvt_pk_bf16_f32 v183, v142, v143
  v_add_f32 v26, v26, v136
  v_accvgpr_write_b32 a24, v176
  v_add_f32 v27, v27, v137
  v_accvgpr_write_b32 a25, v177
  v_add_f32 v28, v28, v138
  v_accvgpr_write_b32 a26, v178
  v_add_f32 v29, v29, v139
  v_accvgpr_write_b32 a27, v179
  v_add_f32 v26, v26, v140
  v_accvgpr_write_b32 a28, v180
  v_add_f32 v27, v27, v141
  v_accvgpr_write_b32 a29, v181
  v_add_f32 v28, v28, v142
  v_accvgpr_write_b32 a30, v182
  v_add_f32 v29, v29, v143
  v_accvgpr_write_b32 a31, v183
  v_add_f32 v26, v26, v27
  v_add_f32 v28, v28, v29
  v_add_f32 v25, v26, v28
  s_waitcnt vmcnt(11)
  buffer_load_dwordx4 v2, s[20:23], s51 offen offset:2048 nt lds
  s_add_u32 m0, s53, 17280
  s_waitcnt vmcnt(11)
  buffer_load_dwordx4 v1, s[20:23], s51 offen offset:128 nt lds
  s_waitcnt vmcnt(11)
  buffer_load_dwordx4 v2, s[20:23], s51 offen offset:2176 nt lds
  s_xor_b32 s51, s51, 16384
  ds_read_b128 v[144:147], v6
  ds_read_b128 v[148:151], v7
  ds_read_b128 v[152:155], v8
  ds_read_b128 v[156:159], v9
  ds_read_b128 v[160:163], v6 offset:1024
  ds_read_b128 v[164:167], v7 offset:1024
  ds_read_b128 v[168:171], v8 offset:1024
  ds_read_b128 v[172:175], v9 offset:1024
  s_add_u32 m0, s53, 20480
  s_waitcnt vmcnt(4)
  buffer_load_dwordx4 v1, s[20:23], s51 offen nt lds
  s_waitcnt lgkmcnt(4)
  v_mfma_f32_32x32x16_bf16 v[128:143], v[144:147], v[32:35], 0
  v_mfma_f32_32x32x16_bf16 v[128:143], v[148:151], v[36:39], v[128:143]
  v_mfma_f32_32x32x16_bf16 v[128:143], v[152:155], v[40:43], v[128:143]
  v_mfma_f32_32x32x16_bf16 v[128:143], v[156:159], v[44:47], v[128:143]
  s_waitcnt vmcnt(4)
  buffer_load_dwordx4 v2, s[20:23], s51 offen offset:2048 nt lds
  s_waitcnt lgkmcnt(0)
  v_mfma_f32_32x32x16_bf16 v[128:143], v[160:163], v[48:51], v[128:143]
  v_mfma_f32_32x32x16_bf16 v[128:143], v[164:167], v[52:55], v[128:143]
  v_mfma_f32_32x32x16_bf16 v[128:143], v[168:171], v[56:59], v[128:143]
  v_mfma_f32_32x32x16_bf16 v[128:143], v[172:175], v[60:63], v[128:143]
  s_add_u32 m0, s53, 21376
  s_waitcnt vmcnt(4)
  buffer_load_dwordx4 v1, s[20:23], s51 offen offset:128 nt lds
  v_mov_b32 v31, v24
  s_nop 7
  v_max3_f32 v26, v128, v129, v130
  v_max3_f32 v27, v131, v132, v133
  v_max3_f32 v28, v134, v135, v136
  v_max3_f32 v29, v137, v138, v139
  v_max3_f32 v30, v140, v141, v142
  v_max3_f32 v26, v26, v27, v28
  v_max3_f32 v29, v29, v30, v143
  v_max_f32 v27, v26, v29
  v_max_f32 v26, v26, v29
  s_nop 1
  v_permlane32_swap_b32 v26, v27
  v_max3_f32 v23, v26, v27, v23
  v_mul_f32 v24, s55, v23
  v_sub_f32 v31, v31, v24
  v_exp_f32 v22, v31
  v_fma_f32 v128, v128, s55, -v24
  v_fma_f32 v129, v129, s55, -v24
  v_fma_f32 v130, v130, s55, -v24
  v_fma_f32 v131, v131, s55, -v24
  ds_write_b32 v231, v22 offset:512
  v_fma_f32 v132, v132, s55, -v24
  v_fma_f32 v133, v133, s55, -v24
  v_exp_f32 v128, v128
  v_fma_f32 v134, v134, s55, -v24
  v_fma_f32 v135, v135, s55, -v24
  v_exp_f32 v129, v129
  v_fma_f32 v136, v136, s55, -v24
  v_fma_f32 v137, v137, s55, -v24
  v_exp_f32 v130, v130
  v_fma_f32 v138, v138, s55, -v24
  v_fma_f32 v139, v139, s55, -v24
  v_exp_f32 v131, v131
  v_fma_f32 v140, v140, s55, -v24
  v_fma_f32 v141, v141, s55, -v24
  v_exp_f32 v132, v132
  v_fma_f32 v142, v142, s55, -v24
  v_fma_f32 v143, v143, s55, -v24
  v_exp_f32 v133, v133
  s_waitcnt vmcnt(4)
  buffer_load_dwordx4 v2, s[20:23], s51 offen offset:2176 nt lds
  s_xor_b32 s51, s51, 0x14000
  v_exp_f32 v134, v134
  v_exp_f32 v135, v135
  v_exp_f32 v136, v136
  v_exp_f32 v137, v137
  v_exp_f32 v138, v138
  v_exp_f32 v139, v139
  v_cvt_pk_bf16_f32 v176, v128, v129
  v_exp_f32 v140, v140
  v_cvt_pk_bf16_f32 v177, v130, v131
  v_exp_f32 v141, v141
  v_cvt_pk_bf16_f32 v178, v132, v133
  v_exp_f32 v142, v142
  v_cvt_pk_bf16_f32 v179, v134, v135
  v_exp_f32 v143, v143
  v_cvt_pk_bf16_f32 v180, v136, v137
  s_add_u32 m0, s53, 24576
  s_waitcnt vmcnt(4)
  buffer_load_dwordx4 v1, s[20:23], s51 offen nt lds
  v_fma_f32 v26, v25, v22, v128
  v_add_f32 v27, v130, v131
  v_add_f32 v28, v132, v133
  v_add_f32 v29, v134, v135
  v_add_f32 v26, v26, v129
  v_cvt_pk_bf16_f32 v181, v138, v139
  v_cvt_pk_bf16_f32 v182, v140, v141
  v_cvt_pk_bf16_f32 v183, v142, v143
  v_add_f32 v26, v26, v136
  v_accvgpr_write_b32 a32, v176
  v_add_f32 v27, v27, v137
  v_accvgpr_write_b32 a33, v177
  v_add_f32 v28, v28, v138
  v_accvgpr_write_b32 a34, v178
  v_add_f32 v29, v29, v139
  v_accvgpr_write_b32 a35, v179
  v_add_f32 v26, v26, v140
  v_accvgpr_write_b32 a36, v180
  v_add_f32 v27, v27, v141
  v_accvgpr_write_b32 a37, v181
  v_add_f32 v28, v28, v142
  v_accvgpr_write_b32 a38, v182
  v_add_f32 v29, v29, v143
  v_accvgpr_write_b32 a39, v183
  v_add_f32 v26, v26, v27
  v_add_f32 v28, v28, v29
  v_add_f32 v25, v26, v28
  s_waitcnt vmcnt(4)
  buffer_load_dwordx4 v2, s[20:23], s51 offen offset:2048 nt lds
  ds_read_b128 v[144:147], v6 offset:8192
  ds_read_b128 v[148:151], v7 offset:8192
  ds_read_b128 v[152:155], v8 offset:8192
  ds_read_b128 v[156:159], v9 offset:8192
  ds_read_b128 v[160:163], v6 offset:9216
  ds_read_b128 v[164:167], v7 offset:9216
  ds_read_b128 v[168:171], v8 offset:9216
  ds_read_b128 v[172:175], v9 offset:9216
  s_add_u32 m0, s53, 25472
  s_waitcnt vmcnt(4)
  buffer_load_dwordx4 v1, s[20:23], s51 offen offset:128 nt lds
  s_waitcnt lgkmcnt(4)
  v_mfma_f32_32x32x16_bf16 v[128:143], v[144:147], v[32:35], 0
  v_mfma_f32_32x32x16_bf16 v[128:143], v[148:151], v[36:39], v[128:143]
  v_mfma_f32_32x32x16_bf16 v[128:143], v[152:155], v[40:43], v[128:143]
  v_mfma_f32_32x32x16_bf16 v[128:143], v[156:159], v[44:47], v[128:143]
  s_waitcnt vmcnt(4)
  buffer_load_dwordx4 v2, s[20:23], s51 offen offset:2176 nt lds
  s_xor_b32 s51, s51, 16384
  s_waitcnt lgkmcnt(0)
  v_mfma_f32_32x32x16_bf16 v[128:143], v[160:163], v[48:51], v[128:143]
  v_mfma_f32_32x32x16_bf16 v[128:143], v[164:167], v[52:55], v[128:143]
  v_mfma_f32_32x32x16_bf16 v[128:143], v[168:171], v[56:59], v[128:143]
  v_mfma_f32_32x32x16_bf16 v[128:143], v[172:175], v[60:63], v[128:143]
  v_mov_b32 v31, v24
  s_nop 10
  v_max3_f32 v26, v128, v129, v130
  v_max3_f32 v27, v131, v132, v133
  v_max3_f32 v28, v134, v135, v136
  v_max3_f32 v29, v137, v138, v139
  v_max3_f32 v30, v140, v141, v142
  v_max3_f32 v26, v26, v27, v28
  v_max3_f32 v29, v29, v30, v143
  v_max_f32 v27, v26, v29
  v_max_f32 v26, v26, v29
  s_nop 1
  v_permlane32_swap_b32 v26, v27
  v_max3_f32 v23, v26, v27, v23
  v_mul_f32 v24, s55, v23
  v_sub_f32 v31, v31, v24
  v_exp_f32 v22, v31
  v_fma_f32 v128, v128, s55, -v24
  v_fma_f32 v129, v129, s55, -v24
  v_fma_f32 v130, v130, s55, -v24
  v_fma_f32 v131, v131, s55, -v24
  ds_write_b32 v231, v22 offset:640
  s_add_u32 m0, s53, 28672
  s_waitcnt vmcnt(4)
  buffer_load_dwordx4 v1, s[20:23], s51 offen nt lds
  v_fma_f32 v132, v132, s55, -v24
  v_fma_f32 v133, v133, s55, -v24
  v_exp_f32 v128, v128
  v_fma_f32 v134, v134, s55, -v24
  v_fma_f32 v135, v135, s55, -v24
  v_exp_f32 v129, v129
  v_fma_f32 v136, v136, s55, -v24
  v_fma_f32 v137, v137, s55, -v24
  v_exp_f32 v130, v130
  v_fma_f32 v138, v138, s55, -v24
  v_fma_f32 v139, v139, s55, -v24
  v_exp_f32 v131, v131
  v_fma_f32 v140, v140, s55, -v24
  v_fma_f32 v141, v141, s55, -v24
  v_exp_f32 v132, v132
  v_fma_f32 v142, v142, s55, -v24
  v_fma_f32 v143, v143, s55, -v24
  v_exp_f32 v133, v133
  s_waitcnt vmcnt(4)
  buffer_load_dwordx4 v2, s[20:23], s51 offen offset:2048 nt lds
  v_exp_f32 v134, v134
  v_exp_f32 v135, v135
  v_exp_f32 v136, v136
  v_exp_f32 v137, v137
  v_exp_f32 v138, v138
  v_exp_f32 v139, v139
  v_cvt_pk_bf16_f32 v176, v128, v129
  v_exp_f32 v140, v140
  v_cvt_pk_bf16_f32 v177, v130, v131
  v_exp_f32 v141, v141
  v_cvt_pk_bf16_f32 v178, v132, v133
  v_exp_f32 v142, v142
  v_cvt_pk_bf16_f32 v179, v134, v135
  v_exp_f32 v143, v143
  v_cvt_pk_bf16_f32 v180, v136, v137
  s_add_u32 m0, s53, 29568
  s_waitcnt vmcnt(4)
  buffer_load_dwordx4 v1, s[20:23], s51 offen offset:128 nt lds
  v_fma_f32 v26, v25, v22, v128
  v_add_f32 v27, v130, v131
  v_add_f32 v28, v132, v133
  v_add_f32 v29, v134, v135
  v_add_f32 v26, v26, v129
  v_cvt_pk_bf16_f32 v181, v138, v139
  v_cvt_pk_bf16_f32 v182, v140, v141
  v_cvt_pk_bf16_f32 v183, v142, v143
  v_add_f32 v26, v26, v136
  v_accvgpr_write_b32 a40, v176
  v_add_f32 v27, v27, v137
  v_accvgpr_write_b32 a41, v177
  v_add_f32 v28, v28, v138
  v_accvgpr_write_b32 a42, v178
  v_add_f32 v29, v29, v139
  v_accvgpr_write_b32 a43, v179
  v_add_f32 v26, v26, v140
  v_accvgpr_write_b32 a44, v180
  v_add_f32 v27, v27, v141
  v_accvgpr_write_b32 a45, v181
  v_add_f32 v28, v28, v142
  v_accvgpr_write_b32 a46, v182
  v_add_f32 v29, v29, v143
  v_accvgpr_write_b32 a47, v183
  v_add_f32 v26, v26, v27
  v_add_f32 v28, v28, v29
  v_add_f32 v25, v26, v28
  s_waitcnt vmcnt(4)
  buffer_load_dwordx4 v2, s[20:23], s51 offen offset:2176 nt lds
  s_xor_b32 s51, s51, 0x1d4000
  ds_read_b128 v[144:147], v6 offset:16384
  ds_read_b128 v[148:151], v7 offset:16384
  ds_read_b128 v[152:155], v8 offset:16384
  ds_read_b128 v[156:159], v9 offset:16384
  ds_read_b128 v[160:163], v6 offset:17408
  ds_read_b128 v[164:167], v7 offset:17408
  ds_read_b128 v[168:171], v8 offset:17408
  ds_read_b128 v[172:175], v9 offset:17408
  s_mov_b32 m0, s53
  s_waitcnt vmcnt(4)
  buffer_load_dwordx4 v1, s[20:23], s51 offen nt lds
  s_waitcnt lgkmcnt(4)
  v_mfma_f32_32x32x16_bf16 v[128:143], v[144:147], v[32:35], 0
  v_mfma_f32_32x32x16_bf16 v[128:143], v[148:151], v[36:39], v[128:143]
  v_mfma_f32_32x32x16_bf16 v[128:143], v[152:155], v[40:43], v[128:143]
  v_mfma_f32_32x32x16_bf16 v[128:143], v[156:159], v[44:47], v[128:143]
  s_waitcnt lgkmcnt(0)
  v_mfma_f32_32x32x16_bf16 v[128:143], v[160:163], v[48:51], v[128:143]
  v_mfma_f32_32x32x16_bf16 v[128:143], v[164:167], v[52:55], v[128:143]
  v_mfma_f32_32x32x16_bf16 v[128:143], v[168:171], v[56:59], v[128:143]
  v_mfma_f32_32x32x16_bf16 v[128:143], v[172:175], v[60:63], v[128:143]
  s_waitcnt vmcnt(4)
  buffer_load_dwordx4 v2, s[20:23], s51 offen offset:2048 nt lds
  v_mov_b32 v31, v24
  s_nop 8
  v_max3_f32 v26, v128, v129, v130
  v_max3_f32 v27, v131, v132, v133
  v_max3_f32 v28, v134, v135, v136
  v_max3_f32 v29, v137, v138, v139
  v_max3_f32 v30, v140, v141, v142
  v_max3_f32 v26, v26, v27, v28
  v_max3_f32 v29, v29, v30, v143
  v_max_f32 v27, v26, v29
  v_max_f32 v26, v26, v29
  s_nop 1
  v_permlane32_swap_b32 v26, v27
  v_max3_f32 v23, v26, v27, v23
  v_mul_f32 v24, s55, v23
  v_sub_f32 v31, v31, v24
  v_exp_f32 v22, v31
  v_fma_f32 v128, v128, s55, -v24
  v_fma_f32 v129, v129, s55, -v24
  v_fma_f32 v130, v130, s55, -v24
  v_fma_f32 v131, v131, s55, -v24
  ds_write_b32 v231, v22 offset:768
  s_add_u32 m0, s53, 896
  s_waitcnt vmcnt(4)
  buffer_load_dwordx4 v1, s[20:23], s51 offen offset:128 nt lds
  v_fma_f32 v132, v132, s55, -v24
  v_fma_f32 v133, v133, s55, -v24
  v_exp_f32 v128, v128
  v_fma_f32 v134, v134, s55, -v24
  v_fma_f32 v135, v135, s55, -v24
  v_exp_f32 v129, v129
  v_fma_f32 v136, v136, s55, -v24
  v_fma_f32 v137, v137, s55, -v24
  v_exp_f32 v130, v130
  v_fma_f32 v138, v138, s55, -v24
  v_fma_f32 v139, v139, s55, -v24
  v_exp_f32 v131, v131
  v_fma_f32 v140, v140, s55, -v24
  v_fma_f32 v141, v141, s55, -v24
  v_exp_f32 v132, v132
  v_fma_f32 v142, v142, s55, -v24
  v_fma_f32 v143, v143, s55, -v24
  v_exp_f32 v133, v133
  s_waitcnt vmcnt(4)
  buffer_load_dwordx4 v2, s[20:23], s51 offen offset:2176 nt lds
  s_xor_b32 s51, s51, 16384
  v_exp_f32 v134, v134
  v_exp_f32 v135, v135
  v_exp_f32 v136, v136
  v_exp_f32 v137, v137
  v_exp_f32 v138, v138
  v_exp_f32 v139, v139
  v_cvt_pk_bf16_f32 v176, v128, v129
  v_exp_f32 v140, v140
  v_cvt_pk_bf16_f32 v177, v130, v131
  v_exp_f32 v141, v141
  v_cvt_pk_bf16_f32 v178, v132, v133
  v_exp_f32 v142, v142
  v_cvt_pk_bf16_f32 v179, v134, v135
  v_exp_f32 v143, v143
  v_cvt_pk_bf16_f32 v180, v136, v137
  s_add_u32 m0, s53, 4096
  s_waitcnt vmcnt(4)
  buffer_load_dwordx4 v1, s[20:23], s51 offen nt lds
  v_fma_f32 v26, v25, v22, v128
  v_add_f32 v27, v130, v131
  v_add_f32 v28, v132, v133
  v_add_f32 v29, v134, v135
  v_add_f32 v26, v26, v129
  v_cvt_pk_bf16_f32 v181, v138, v139
  v_cvt_pk_bf16_f32 v182, v140, v141
  v_cvt_pk_bf16_f32 v183, v142, v143
  v_add_f32 v26, v26, v136
  v_accvgpr_write_b32 a48, v176
  v_add_f32 v27, v27, v137
  v_accvgpr_write_b32 a49, v177
  v_add_f32 v28, v28, v138
  v_accvgpr_write_b32 a50, v178
  v_add_f32 v29, v29, v139
  v_accvgpr_write_b32 a51, v179
  v_add_f32 v26, v26, v140
  v_accvgpr_write_b32 a52, v180
  v_add_f32 v27, v27, v141
  v_accvgpr_write_b32 a53, v181
  v_add_f32 v28, v28, v142
  v_accvgpr_write_b32 a54, v182
  v_add_f32 v29, v29, v143
  v_accvgpr_write_b32 a55, v183
  v_add_f32 v26, v26, v27
  v_add_f32 v28, v28, v29
  v_add_f32 v25, v26, v28
  s_waitcnt vmcnt(4)
  buffer_load_dwordx4 v2, s[20:23], s51 offen offset:2048 nt lds
  ds_read_b128 v[144:147], v6 offset:24576
  ds_read_b128 v[148:151], v7 offset:24576
  ds_read_b128 v[152:155], v8 offset:24576
  ds_read_b128 v[156:159], v9 offset:24576
  ds_read_b128 v[160:163], v6 offset:25600
  ds_read_b128 v[164:167], v7 offset:25600
  ds_read_b128 v[168:171], v8 offset:25600
  ds_read_b128 v[172:175], v9 offset:25600
  s_waitcnt lgkmcnt(4)
  v_mfma_f32_32x32x16_bf16 v[128:143], v[144:147], v[32:35], 0
  v_mfma_f32_32x32x16_bf16 v[128:143], v[148:151], v[36:39], v[128:143]
  v_mfma_f32_32x32x16_bf16 v[128:143], v[152:155], v[40:43], v[128:143]
  v_mfma_f32_32x32x16_bf16 v[128:143], v[156:159], v[44:47], v[128:143]
  s_add_u32 m0, s53, 4992
  s_waitcnt vmcnt(4)
  buffer_load_dwordx4 v1, s[20:23], s51 offen offset:128 nt lds
  s_waitcnt lgkmcnt(0)
  v_mfma_f32_32x32x16_bf16 v[128:143], v[160:163], v[48:51], v[128:143]
  v_mfma_f32_32x32x16_bf16 v[128:143], v[164:167], v[52:55], v[128:143]
  v_mfma_f32_32x32x16_bf16 v[128:143], v[168:171], v[56:59], v[128:143]
  v_mfma_f32_32x32x16_bf16 v[128:143], v[172:175], v[60:63], v[128:143]
  s_waitcnt vmcnt(4)
  buffer_load_dwordx4 v2, s[20:23], s51 offen offset:2176 nt lds
  s_xor_b32 s51, s51, 0x14000
  v_mov_b32 v31, v24
  s_nop 7
  v_max3_f32 v26, v128, v129, v130
  v_max3_f32 v27, v131, v132, v133
  v_max3_f32 v28, v134, v135, v136
  v_max3_f32 v29, v137, v138, v139
  v_max3_f32 v30, v140, v141, v142
  v_max3_f32 v26, v26, v27, v28
  v_max3_f32 v29, v29, v30, v143
  v_max_f32 v27, v26, v29
  v_max_f32 v26, v26, v29
  s_nop 1
  v_permlane32_swap_b32 v26, v27
  v_max3_f32 v23, v26, v27, v23
  v_mul_f32 v24, s55, v23
  v_sub_f32 v31, v31, v24
  v_exp_f32 v22, v31
  v_fma_f32 v128, v128, s55, -v24
  v_fma_f32 v129, v129, s55, -v24
  v_fma_f32 v130, v130, s55, -v24
  v_fma_f32 v131, v131, s55, -v24
  ds_write_b32 v231, v22 offset:896
  s_add_u32 m0, s53, 8192
  s_waitcnt vmcnt(4)
  buffer_load_dwordx4 v1, s[20:23], s51 offen nt lds
  v_fma_f32 v132, v132, s55, -v24
  v_fma_f32 v133, v133, s55, -v24
  v_exp_f32 v128, v128
  v_fma_f32 v134, v134, s55, -v24
  v_fma_f32 v135, v135, s55, -v24
  v_exp_f32 v129, v129
  v_fma_f32 v136, v136, s55, -v24
  v_fma_f32 v137, v137, s55, -v24
  v_exp_f32 v130, v130
  v_fma_f32 v138, v138, s55, -v24
  v_fma_f32 v139, v139, s55, -v24
  v_exp_f32 v131, v131
  v_fma_f32 v140, v140, s55, -v24
  v_fma_f32 v141, v141, s55, -v24
  v_exp_f32 v132, v132
  v_fma_f32 v142, v142, s55, -v24
  v_fma_f32 v143, v143, s55, -v24
  v_exp_f32 v133, v133
  s_waitcnt vmcnt(4)
  buffer_load_dwordx4 v2, s[20:23], s51 offen offset:2048 nt lds
  v_exp_f32 v134, v134
  v_exp_f32 v135, v135
  v_exp_f32 v136, v136
  v_exp_f32 v137, v137
  v_exp_f32 v138, v138
  v_exp_f32 v139, v139
  v_cvt_pk_bf16_f32 v176, v128, v129
  v_exp_f32 v140, v140
  v_cvt_pk_bf16_f32 v177, v130, v131
  v_exp_f32 v141, v141
  v_cvt_pk_bf16_f32 v178, v132, v133
  v_exp_f32 v142, v142
  v_cvt_pk_bf16_f32 v179, v134, v135
  v_exp_f32 v143, v143
  v_cvt_pk_bf16_f32 v180, v136, v137
  s_add_u32 m0, s53, 9088
  s_waitcnt vmcnt(4)
  buffer_load_dwordx4 v1, s[20:23], s51 offen offset:128 nt lds
  v_fma_f32 v26, v25, v22, v128
  v_add_f32 v27, v130, v131
  v_add_f32 v28, v132, v133
  v_add_f32 v29, v134, v135
  v_add_f32 v26, v26, v129
  v_cvt_pk_bf16_f32 v181, v138, v139
  v_cvt_pk_bf16_f32 v182, v140, v141
  v_cvt_pk_bf16_f32 v183, v142, v143
  v_add_f32 v26, v26, v136
  v_accvgpr_write_b32 a56, v176
  v_add_f32 v27, v27, v137
  v_accvgpr_write_b32 a57, v177
  v_add_f32 v28, v28, v138
  v_accvgpr_write_b32 a58, v178
  v_add_f32 v29, v29, v139
  v_accvgpr_write_b32 a59, v179
  v_add_f32 v26, v26, v140
  v_accvgpr_write_b32 a60, v180
  v_add_f32 v27, v27, v141
  v_accvgpr_write_b32 a61, v181
  v_add_f32 v28, v28, v142
  v_accvgpr_write_b32 a62, v182
  v_add_f32 v29, v29, v143
  v_accvgpr_write_b32 a63, v183
  v_add_f32 v26, v26, v27
  v_add_f32 v28, v28, v29
  v_add_f32 v25, v26, v28
  s_waitcnt vmcnt(4)
  buffer_load_dwordx4 v2, s[20:23], s51 offen offset:2176 nt lds
  s_xor_b32 s51, s51, 16384
  s_add_u32 m0, s53, 12288
  s_waitcnt vmcnt(4)
  buffer_load_dwordx4 v1, s[20:23], s51 offen nt lds
  ds_read_b128 v[144:147], v6
  ds_read_b128 v[148:151], v7
  ds_read_b128 v[152:155], v8
  ds_read_b128 v[156:159], v9
  ds_read_b128 v[160:163], v6 offset:1024
  ds_read_b128 v[164:167], v7 offset:1024
  ds_read_b128 v[168:171], v8 offset:1024
  ds_read_b128 v[172:175], v9 offset:1024
  s_waitcnt vmcnt(4)
  buffer_load_dwordx4 v2, s[20:23], s51 offen offset:2048 nt lds
  s_waitcnt lgkmcnt(4)
  v_mfma_f32_32x32x16_bf16 v[128:143], v[144:147], v[32:35], 0
  v_mfma_f32_32x32x16_bf16 v[128:143], v[148:151], v[36:39], v[128:143]
  v_mfma_f32_32x32x16_bf16 v[128:143], v[152:155], v[40:43], v[128:143]
  v_mfma_f32_32x32x16_bf16 v[128:143], v[156:159], v[44:47], v[128:143]
  s_add_u32 m0, s53, 13184
  s_waitcnt vmcnt(4)
  buffer_load_dwordx4 v1, s[20:23], s51 offen offset:128 nt lds
  s_waitcnt lgkmcnt(0)
  v_mfma_f32_32x32x16_bf16 v[128:143], v[160:163], v[48:51], v[128:143]
  v_mfma_f32_32x32x16_bf16 v[128:143], v[164:167], v[52:55], v[128:143]
  v_mfma_f32_32x32x16_bf16 v[128:143], v[168:171], v[56:59], v[128:143]
  v_mfma_f32_32x32x16_bf16 v[128:143], v[172:175], v[60:63], v[128:143]
  s_waitcnt vmcnt(4)
  buffer_load_dwordx4 v2, s[20:23], s51 offen offset:2176 nt lds
  s_xor_b32 s51, s51, 0x54000
  v_mov_b32 v31, v24
  s_nop 7
  v_max3_f32 v26, v128, v129, v130
  v_max3_f32 v27, v131, v132, v133
  v_max3_f32 v28, v134, v135, v136
  v_max3_f32 v29, v137, v138, v139
  v_max3_f32 v30, v140, v141, v142
  v_max3_f32 v26, v26, v27, v28
  v_max3_f32 v29, v29, v30, v143
  v_max_f32 v27, v26, v29
  v_max_f32 v26, v26, v29
  s_nop 1
  v_permlane32_swap_b32 v26, v27
  v_max3_f32 v23, v26, v27, v23
  v_mul_f32 v24, s55, v23
  v_sub_f32 v31, v31, v24
  v_exp_f32 v22, v31
  v_fma_f32 v128, v128, s55, -v24
  v_fma_f32 v129, v129, s55, -v24
  v_fma_f32 v130, v130, s55, -v24
  v_fma_f32 v131, v131, s55, -v24
  ds_write_b32 v231, v22 offset:1024
  v_fma_f32 v132, v132, s55, -v24
  v_fma_f32 v133, v133, s55, -v24
  v_exp_f32 v128, v128
  v_fma_f32 v134, v134, s55, -v24
  v_fma_f32 v135, v135, s55, -v24
  v_exp_f32 v129, v129
  v_fma_f32 v136, v136, s55, -v24
  v_fma_f32 v137, v137, s55, -v24
  v_exp_f32 v130, v130
  v_fma_f32 v138, v138, s55, -v24
  v_fma_f32 v139, v139, s55, -v24
  v_exp_f32 v131, v131
  v_fma_f32 v140, v140, s55, -v24
  v_fma_f32 v141, v141, s55, -v24
  v_exp_f32 v132, v132
  v_fma_f32 v142, v142, s55, -v24
  v_fma_f32 v143, v143, s55, -v24
  v_exp_f32 v133, v133
  s_add_u32 m0, s53, 16384
  s_waitcnt vmcnt(4)
  buffer_load_dwordx4 v1, s[20:23], s51 offen nt lds
  v_exp_f32 v134, v134
  v_exp_f32 v135, v135
  v_exp_f32 v136, v136
  v_exp_f32 v137, v137
  v_exp_f32 v138, v138
  v_exp_f32 v139, v139
  v_cvt_pk_bf16_f32 v176, v128, v129
  v_exp_f32 v140, v140
  v_cvt_pk_bf16_f32 v177, v130, v131
  v_exp_f32 v141, v141
  v_cvt_pk_bf16_f32 v178, v132, v133
  v_exp_f32 v142, v142
  v_cvt_pk_bf16_f32 v179, v134, v135
  v_exp_f32 v143, v143
  v_cvt_pk_bf16_f32 v180, v136, v137
  s_waitcnt vmcnt(4)
  buffer_load_dwordx4 v2, s[20:23], s51 offen offset:2048 nt lds
  v_fma_f32 v26, v25, v22, v128
  v_add_f32 v27, v130, v131
  v_add_f32 v28, v132, v133
  v_add_f32 v29, v134, v135
  v_add_f32 v26, v26, v129
  v_cvt_pk_bf16_f32 v181, v138, v139
  v_cvt_pk_bf16_f32 v182, v140, v141
  v_cvt_pk_bf16_f32 v183, v142, v143
  v_add_f32 v26, v26, v136
  v_accvgpr_write_b32 a64, v176
  v_add_f32 v27, v27, v137
  v_accvgpr_write_b32 a65, v177
  v_add_f32 v28, v28, v138
  v_accvgpr_write_b32 a66, v178
  v_add_f32 v29, v29, v139
  v_accvgpr_write_b32 a67, v179
  v_add_f32 v26, v26, v140
  v_accvgpr_write_b32 a68, v180
  v_add_f32 v27, v27, v141
  v_accvgpr_write_b32 a69, v181
  v_add_f32 v28, v28, v142
  v_accvgpr_write_b32 a70, v182
  v_add_f32 v29, v29, v143
  v_accvgpr_write_b32 a71, v183
  v_add_f32 v26, v26, v27
  v_add_f32 v28, v28, v29
  v_add_f32 v25, v26, v28
  s_add_u32 m0, s53, 17280
  s_waitcnt vmcnt(4)
  buffer_load_dwordx4 v1, s[20:23], s51 offen offset:128 nt lds
  s_waitcnt vmcnt(4)
  buffer_load_dwordx4 v2, s[20:23], s51 offen offset:2176 nt lds
  s_xor_b32 s51, s51, 16384
  s_add_u32 m0, s53, 20480
  s_waitcnt vmcnt(4)
  buffer_load_dwordx4 v1, s[20:23], s51 offen nt lds
  ds_read_b128 v[144:147], v6 offset:8192
  ds_read_b128 v[148:151], v7 offset:8192
  ds_read_b128 v[152:155], v8 offset:8192
  ds_read_b128 v[156:159], v9 offset:8192
  ds_read_b128 v[160:163], v6 offset:9216
  ds_read_b128 v[164:167], v7 offset:9216
  ds_read_b128 v[168:171], v8 offset:9216
  ds_read_b128 v[172:175], v9 offset:9216
  s_waitcnt lgkmcnt(4)
  v_mfma_f32_32x32x16_bf16 v[128:143], v[144:147], v[32:35], 0
  v_mfma_f32_32x32x16_bf16 v[128:143], v[148:151], v[36:39], v[128:143]
  v_mfma_f32_32x32x16_bf16 v[128:143], v[152:155], v[40:43], v[128:143]
  v_mfma_f32_32x32x16_bf16 v[128:143], v[156:159], v[44:47], v[128:143]
  s_waitcnt vmcnt(4)
  buffer_load_dwordx4 v2, s[20:23], s51 offen offset:2048 nt lds
  s_cmp_eq_u32 s63, 9
  s_cbranch_scc0 1f
  global_load_dword v255, v254, s[16:17] sc1
1:
  s_waitcnt lgkmcnt(0)
  v_mfma_f32_32x32x16_bf16 v[128:143], v[160:163], v[48:51], v[128:143]
  v_mfma_f32_32x32x16_bf16 v[128:143], v[164:167], v[52:55], v[128:143]
  v_mfma_f32_32x32x16_bf16 v[128:143], v[168:171], v[56:59], v[128:143]
  v_mfma_f32_32x32x16_bf16 v[128:143], v[172:175], v[60:63], v[128:143]
  s_add_u32 m0, s53, 21376
  s_waitcnt vmcnt(4)
  buffer_load_dwordx4 v1, s[20:23], s51 offen offset:128 nt lds
  v_mov_b32 v31, v24
  s_nop 7
  v_max3_f32 v26, v128, v129, v130
  v_max3_f32 v27, v131, v132, v133
  v_max3_f32 v28, v134, v135, v136
  v_max3_f32 v29, v137, v138, v139
  v_max3_f32 v30, v140, v141, v142
  v_max3_f32 v26, v26, v27, v28
  v_max3_f32 v29, v29, v30, v143
  v_max_f32 v27, v26, v29
  v_max_f32 v26, v26, v29
  s_nop 1
  v_permlane32_swap_b32 v26, v27
  v_max3_f32 v23, v26, v27, v23
  v_mul_f32 v24, s55, v23
  v_sub_f32 v31, v31, v24
  v_exp_f32 v22, v31
  v_fma_f32 v128, v128, s55, -v24
  v_fma_f32 v129, v129, s55, -v24
  v_fma_f32 v130, v130, s55, -v24
  v_fma_f32 v131, v131, s55, -v24
  ds_write_b32 v231, v22 offset:1152
  s_waitcnt vmcnt(4)
  buffer_load_dwordx4 v2, s[20:23], s51 offen offset:2176 nt lds
  s_xor_b32 s51, s51, 0x14000
  v_fma_f32 v132, v132, s55, -v24
  v_fma_f32 v133, v133, s55, -v24
  v_exp_f32 v128, v128
  v_fma_f32 v134, v134, s55, -v24
  v_fma_f32 v135, v135, s55, -v24
  v_exp_f32 v129, v129
  v_fma_f32 v136, v136, s55, -v24
  v_fma_f32 v137, v137, s55, -v24
  v_exp_f32 v130, v130
  v_fma_f32 v138, v138, s55, -v24
  v_fma_f32 v139, v139, s55, -v24
  v_exp_f32 v131, v131
  v_fma_f32 v140, v140, s55, -v24
  v_fma_f32 v141, v141, s55, -v24
  v_exp_f32 v132, v132
  v_fma_f32 v142, v142, s55, -v24
  v_fma_f32 v143, v143, s55, -v24
  v_exp_f32 v133, v133
  s_add_u32 m0, s53, 24576
  s_waitcnt vmcnt(4)
  buffer_load_dwordx4 v1, s[20:23], s51 offen nt lds
  v_exp_f32 v134, v134
  v_exp_f32 v135, v135
  v_exp_f32 v136, v136
  v_exp_f32 v137, v137
  v_exp_f32 v138, v138
  v_exp_f32 v139, v139
  v_cvt_pk_bf16_f32 v176, v128, v129
  v_exp_f32 v140, v140
  v_cvt_pk_bf16_f32 v177, v130, v131
  v_exp_f32 v141, v141
  v_cvt_pk_bf16_f32 v178, v132, v133
  v_exp_f32 v142, v142
  v_cvt_pk_bf16_f32 v179, v134, v135
  v_exp_f32 v143, v143
  v_cvt_pk_bf16_f32 v180, v136, v137
  s_waitcnt vmcnt(4)
  buffer_load_dwordx4 v2, s[20:23], s51 offen offset:2048 nt lds
  v_fma_f32 v26, v25, v22, v128
  v_add_f32 v27, v130, v131
  v_add_f32 v28, v132, v133
  v_add_f32 v29, v134, v135
  v_add_f32 v26, v26, v129
  v_cvt_pk_bf16_f32 v181, v138, v139
  v_cvt_pk_bf16_f32 v182, v140, v141
  v_cvt_pk_bf16_f32 v183, v142, v143
  v_add_f32 v26, v26, v136
  v_accvgpr_write_b32 a72, v176
  v_add_f32 v27, v27, v137
  v_accvgpr_write_b32 a73, v177
  v_add_f32 v28, v28, v138
  v_accvgpr_write_b32 a74, v178
  v_add_f32 v29, v29, v139
  v_accvgpr_write_b32 a75, v179
  v_add_f32 v26, v26, v140
  v_accvgpr_write_b32 a76, v180
  v_add_f32 v27, v27, v141
  v_accvgpr_write_b32 a77, v181
  v_add_f32 v28, v28, v142
  v_accvgpr_write_b32 a78, v182
  v_add_f32 v29, v29, v143
  v_accvgpr_write_b32 a79, v183
  v_add_f32 v26, v26, v27
  v_add_f32 v28, v28, v29
  v_add_f32 v25, v26, v28
  s_add_u32 m0, s53, 25472
  s_waitcnt vmcnt(4)
  buffer_load_dwordx4 v1, s[20:23], s51 offen offset:128 nt lds
  s_waitcnt vmcnt(4)
  buffer_load_dwordx4 v2, s[20:23], s51 offen offset:2176 nt lds
  s_xor_b32 s51, s51, 16384
  s_add_u32 m0, s53, 28672
  s_waitcnt vmcnt(4)
  buffer_load_dwordx4 v1, s[20:23], s51 offen nt lds
  ds_read_b128 v[144:147], v6 offset:16384
  ds_read_b128 v[148:151], v7 offset:16384
  ds_read_b128 v[152:155], v8 offset:16384
  ds_read_b128 v[156:159], v9 offset:16384
  ds_read_b128 v[160:163], v6 offset:17408
  ds_read_b128 v[164:167], v7 offset:17408
  ds_read_b128 v[168:171], v8 offset:17408
  ds_read_b128 v[172:175], v9 offset:17408
  s_waitcnt vmcnt(4)
  buffer_load_dwordx4 v2, s[20:23], s51 offen offset:2048 nt lds
  s_waitcnt lgkmcnt(4)
  v_mfma_f32_32x32x16_bf16 v[128:143], v[144:147], v[32:35], 0
  v_mfma_f32_32x32x16_bf16 v[128:143], v[148:151], v[36:39], v[128:143]
  v_mfma_f32_32x32x16_bf16 v[128:143], v[152:155], v[40:43], v[128:143]
  v_mfma_f32_32x32x16_bf16 v[128:143], v[156:159], v[44:47], v[128:143]
  s_add_u32 m0, s53, 29568
  s_waitcnt vmcnt(4)
  buffer_load_dwordx4 v1, s[20:23], s51 offen offset:128 nt lds
  s_cmp_eq_u32 s63, 10
  s_cbranch_scc0 1f
  global_load_dword v255, v254, s[16:17] sc1
1:
  s_waitcnt lgkmcnt(0)
  v_mfma_f32_32x32x16_bf16 v[128:143], v[160:163], v[48:51], v[128:143]
  v_mfma_f32_32x32x16_bf16 v[128:143], v[164:167], v[52:55], v[128:143]
  v_mfma_f32_32x32x16_bf16 v[128:143], v[168:171], v[56:59], v[128:143]
  v_mfma_f32_32x32x16_bf16 v[128:143], v[172:175], v[60:63], v[128:143]
  v_mov_b32 v31, v24
  s_nop 10
  v_max3_f32 v26, v128, v129, v130
  v_max3_f32 v27, v131, v132, v133
  v_max3_f32 v28, v134, v135, v136
  v_max3_f32 v29, v137, v138, v139
  v_max3_f32 v30, v140, v141, v142
  v_max3_f32 v26, v26, v27, v28
  v_max3_f32 v29, v29, v30, v143
  v_max_f32 v27, v26, v29
  v_max_f32 v26, v26, v29
  s_nop 1
  v_permlane32_swap_b32 v26, v27
  v_max3_f32 v23, v26, v27, v23
  v_mul_f32 v24, s55, v23
  v_sub_f32 v31, v31, v24
  v_exp_f32 v22, v31
  v_fma_f32 v128, v128, s55, -v24
  v_fma_f32 v129, v129, s55, -v24
  v_fma_f32 v130, v130, s55, -v24
  v_fma_f32 v131, v131, s55, -v24
  ds_write_b32 v231, v22 offset:1280
  s_waitcnt vmcnt(4)
  buffer_load_dwordx4 v2, s[20:23], s51 offen offset:2176 nt lds
  s_xor_b32 s51, s51, 0xd4000
  v_fma_f32 v132, v132, s55, -v24
  v_fma_f32 v133, v133, s55, -v24
  v_exp_f32 v128, v128
  v_fma_f32 v134, v134, s55, -v24
  v_fma_f32 v135, v135, s55, -v24
  v_exp_f32 v129, v129
  v_fma_f32 v136, v136, s55, -v24
  v_fma_f32 v137, v137, s55, -v24
  v_exp_f32 v130, v130
  v_fma_f32 v138, v138, s55, -v24
  v_fma_f32 v139, v139, s55, -v24
  v_exp_f32 v131, v131
  v_fma_f32 v140, v140, s55, -v24
  v_fma_f32 v141, v141, s55, -v24
  v_exp_f32 v132, v132
  v_fma_f32 v142, v142, s55, -v24
  v_fma_f32 v143, v143, s55, -v24
  v_exp_f32 v133, v133
  s_mov_b32 m0, s53
  s_waitcnt vmcnt(4)
  buffer_load_dwordx4 v1, s[20:23], s51 offen nt lds
  v_exp_f32 v134, v134
  v_exp_f32 v135, v135
  v_exp_f32 v136, v136
  v_exp_f32 v137, v137
  v_exp_f32 v138, v138
  v_exp_f32 v139, v139
  v_cvt_pk_bf16_f32 v176, v128, v129
  v_exp_f32 v140, v140
  v_cvt_pk_bf16_f32 v177, v130, v131
  v_exp_f32 v141, v141
  v_cvt_pk_bf16_f32 v178, v132, v133
  v_exp_f32 v142, v142
  v_cvt_pk_bf16_f32 v179, v134, v135
  v_exp_f32 v143, v143
  v_cvt_pk_bf16_f32 v180, v136, v137
  s_waitcnt vmcnt(4)
  buffer_load_dwordx4 v2, s[20:23], s51 offen offset:2048 nt lds
  v_fma_f32 v26, v25, v22, v128
  v_add_f32 v27, v130, v131
  v_add_f32 v28, v132, v133
  v_add_f32 v29, v134, v135
  v_add_f32 v26, v26, v129
  v_cvt_pk_bf16_f32 v181, v138, v139
  v_cvt_pk_bf16_f32 v182, v140, v141
  v_cvt_pk_bf16_f32 v183, v142, v143
  v_add_f32 v26, v26, v136
  v_accvgpr_write_b32 a80, v176
  v_add_f32 v27, v27, v137
  v_accvgpr_write_b32 a81, v177
  v_add_f32 v28, v28, v138
  v_accvgpr_write_b32 a82, v178
  v_add_f32 v29, v29, v139
  v_accvgpr_write_b32 a83, v179
  v_add_f32 v26, v26, v140
  v_accvgpr_write_b32 a84, v180
  v_add_f32 v27, v27, v141
  v_accvgpr_write_b32 a85, v181
  v_add_f32 v28, v28, v142
  v_accvgpr_write_b32 a86, v182
  v_add_f32 v29, v29, v143
  v_accvgpr_write_b32 a87, v183
  v_add_f32 v26, v26, v27
  v_add_f32 v28, v28, v29
  v_add_f32 v25, v26, v28
  s_add_u32 m0, s53, 896
  s_waitcnt vmcnt(4)
  buffer_load_dwordx4 v1, s[20:23], s51 offen offset:128 nt lds
  s_waitcnt vmcnt(4)
  buffer_load_dwordx4 v2, s[20:23], s51 offen offset:2176 nt lds
  s_xor_b32 s51, s51, 16384
  s_add_u32 m0, s53, 4096
  s_waitcnt vmcnt(4)
  buffer_load_dwordx4 v1, s[20:23], s51 offen nt lds
  ds_read_b128 v[144:147], v6 offset:24576
  ds_read_b128 v[148:151], v7 offset:24576
  ds_read_b128 v[152:155], v8 offset:24576
  ds_read_b128 v[156:159], v9 offset:24576
  ds_read_b128 v[160:163], v6 offset:25600
  ds_read_b128 v[164:167], v7 offset:25600
  ds_read_b128 v[168:171], v8 offset:25600
  ds_read_b128 v[172:175], v9 offset:25600
  s_waitcnt vmcnt(4)
  buffer_load_dwordx4 v2, s[20:23], s51 offen offset:2048 nt lds
  s_waitcnt lgkmcnt(4)
  v_mfma_f32_32x32x16_bf16 v[128:143], v[144:147], v[32:35], 0
  v_mfma_f32_32x32x16_bf16 v[128:143], v[148:151], v[36:39], v[128:143]
  v_mfma_f32_32x32x16_bf16 v[128:143], v[152:155], v[40:43], v[128:143]
  v_mfma_f32_32x32x16_bf16 v[128:143], v[156:159], v[44:47], v[128:143]
  s_add_u32 m0, s53, 4992
  s_waitcnt vmcnt(4)
  buffer_load_dwordx4 v1, s[20:23], s51 offen offset:128 nt lds
  s_waitcnt lgkmcnt(0)
  v_mfma_f32_32x32x16_bf16 v[128:143], v[160:163], v[48:51], v[128:143]
  v_mfma_f32_32x32x16_bf16 v[128:143], v[164:167], v[52:55], v[128:143]
  v_mfma_f32_32x32x16_bf16 v[128:143], v[168:171], v[56:59], v[128:143]
  v_mfma_f32_32x32x16_bf16 v[128:143], v[172:175], v[60:63], v[128:143]
  s_waitcnt vmcnt(4)
  buffer_load_dwordx4 v2, s[20:23], s51 offen offset:2176 nt lds
  s_xor_b32 s51, s51, 0x14000
  v_mov_b32 v31, v24
  s_nop 7
  v_max3_f32 v26, v128, v129, v130
  v_max3_f32 v27, v131, v132, v133
  v_max3_f32 v28, v134, v135, v136
  v_max3_f32 v29, v137, v138, v139
  v_max3_f32 v30, v140, v141, v142
  v_max3_f32 v26, v26, v27, v28
  v_max3_f32 v29, v29, v30, v143
  v_max_f32 v27, v26, v29
  v_max_f32 v26, v26, v29
  s_nop 1
  v_permlane32_swap_b32 v26, v27
  v_max3_f32 v23, v26, v27, v23
  v_mul_f32 v24, s55, v23
  v_sub_f32 v31, v31, v24
  v_exp_f32 v22, v31
  v_fma_f32 v128, v128, s55, -v24
  v_fma_f32 v129, v129, s55, -v24
  v_fma_f32 v130, v130, s55, -v24
  v_fma_f32 v131, v131, s55, -v24
  ds_write_b32 v231, v22 offset:1408
  s_add_u32 m0, s53, 8192
  s_waitcnt vmcnt(4)
  buffer_load_dwordx4 v1, s[20:23], s51 offen nt lds
  v_fma_f32 v132, v132, s55, -v24
  v_fma_f32 v133, v133, s55, -v24
  v_exp_f32 v128, v128
  v_fma_f32 v134, v134, s55, -v24
  v_fma_f32 v135, v135, s55, -v24
  v_exp_f32 v129, v129
  v_fma_f32 v136, v136, s55, -v24
  v_fma_f32 v137, v137, s55, -v24
  v_exp_f32 v130, v130
  v_fma_f32 v138, v138, s55, -v24
  v_fma_f32 v139, v139, s55, -v24
  v_exp_f32 v131, v131
  v_fma_f32 v140, v140, s55, -v24
  v_fma_f32 v141, v141, s55, -v24
  v_exp_f32 v132, v132
  v_fma_f32 v142, v142, s55, -v24
  v_fma_f32 v143, v143, s55, -v24
  v_exp_f32 v133, v133
  v_exp_f32 v134, v134
  v_exp_f32 v135, v135
  v_exp_f32 v136, v136
  v_exp_f32 v137, v137
  v_exp_f32 v138, v138
  v_exp_f32 v139, v139
  v_cvt_pk_bf16_f32 v176, v128, v129
  v_exp_f32 v140, v140
  v_cvt_pk_bf16_f32 v177, v130, v131
  v_exp_f32 v141, v141
  v_cvt_pk_bf16_f32 v178, v132, v133
  v_exp_f32 v142, v142
  v_cvt_pk_bf16_f32 v179, v134, v135
  v_exp_f32 v143, v143
  v_cvt_pk_bf16_f32 v180, v136, v137
  s_waitcnt vmcnt(4)
  buffer_load_dwordx4 v2, s[20:23], s51 offen offset:2048 nt lds
  v_fma_f32 v26, v25, v22, v128
  v_add_f32 v27, v130, v131
  v_add_f32 v28, v132, v133
  v_add_f32 v29, v134, v135
  v_add_f32 v26, v26, v129
  v_cvt_pk_bf16_f32 v181, v138, v139
  v_cvt_pk_bf16_f32 v182, v140, v141
  v_cvt_pk_bf16_f32 v183, v142, v143
  v_add_f32 v26, v26, v136
  v_accvgpr_write_b32 a88, v176
  v_add_f32 v27, v27, v137
  v_accvgpr_write_b32 a89, v177
  v_add_f32 v28, v28, v138
  v_accvgpr_write_b32 a90, v178
  v_add_f32 v29, v29, v139
  v_accvgpr_write_b32 a91, v179
  v_add_f32 v26, v26, v140
  v_accvgpr_write_b32 a92, v180
  v_add_f32 v27, v27, v141
  v_accvgpr_write_b32 a93, v181
  v_add_f32 v28, v28, v142
  v_accvgpr_write_b32 a94, v182
  v_add_f32 v29, v29, v143
  v_accvgpr_write_b32 a95, v183
  v_add_f32 v26, v26, v27
  v_add_f32 v28, v28, v29
  v_add_f32 v25, v26, v28
  s_add_u32 m0, s53, 9088
  s_waitcnt vmcnt(4)
  buffer_load_dwordx4 v1, s[20:23], s51 offen offset:128 nt lds
  s_waitcnt vmcnt(4)
  buffer_load_dwordx4 v2, s[20:23], s51 offen offset:2176 nt lds
  s_xor_b32 s51, s51, 16384
  s_add_u32 m0, s53, 12288
  s_waitcnt vmcnt(4)
  buffer_load_dwordx4 v1, s[20:23], s51 offen nt lds
  ds_read_b128 v[144:147], v6
  ds_read_b128 v[148:151], v7
  ds_read_b128 v[152:155], v8
  ds_read_b128 v[156:159], v9
  ds_read_b128 v[160:163], v6 offset:1024
  ds_read_b128 v[164:167], v7 offset:1024
  ds_read_b128 v[168:171], v8 offset:1024
  ds_read_b128 v[172:175], v9 offset:1024
  s_waitcnt vmcnt(4)
  buffer_load_dwordx4 v2, s[20:23], s51 offen offset:2048 nt lds
  s_waitcnt lgkmcnt(4)
  v_mfma_f32_32x32x16_bf16 v[128:143], v[144:147], v[32:35], 0
  v_mfma_f32_32x32x16_bf16 v[128:143], v[148:151], v[36:39], v[128:143]
  v_mfma_f32_32x32x16_bf16 v[128:143], v[152:155], v[40:43], v[128:143]
  v_mfma_f32_32x32x16_bf16 v[128:143], v[156:159], v[44:47], v[128:143]
  s_cmp_lt_u32 s63, 9
  s_cbranch_scc1 2f
  s_mov_b32 s69, 0x200000
1:
  v_cmp_ne_u32 vcc, 1, v255
  s_sub_u32 s69, s69, 1
  s_cbranch_vccz 2f
  s_cmp_eq_u32 s69, 0
  s_cbranch_scc1 2f
  global_load_dword v255, v254, s[16:17] sc1
  s_waitcnt vmcnt(0)
  s_branch 1b
2:
  v_cmp_gt_u32 s[92:93], 32, v0
  v_lshlrev_b32 v254, 2, v0
  v_mov_b32 v26, 512
  v_cndmask_b32 v254, v26, v254, s[92:93]
  v_cndmask_b32 v247, 0, 1, s[92:93]
  v_subrev_u32 v26, 32, v0
  v_mul_u32_u24 v26, 342, v26
  v_lshrrev_b32 v26, 10, v26
  v_add_u32 v26, 1, v26
  v_cndmask_b32 v248, v26, 0, s[92:93]
  s_and_b32 s60, s2, 7
  v_lshlrev_b32 v249, 14, v0
  v_add_u32 v249, 5243008, v249
  v_cmp_ne_u32 s[92:93], s60, v0
  v_mov_b32 v26, 0x40000000
  s_movk_i32 s97, 512
  v_cndmask_b32 v249, v26, v249, s[92:93]
  s_lshr_b32 s96, s2, 3
  s_cmp_eq_u32 s3, 3
  s_cselect_b32 s96, s96, 0x100
  s_mov_b64 vcc, 0
  s_barrier
  s_waitcnt lgkmcnt(0)
  v_mfma_f32_32x32x16_bf16 v[128:143], v[160:163], v[48:51], v[128:143]
  v_mfma_f32_32x32x16_bf16 v[128:143], v[164:167], v[52:55], v[128:143]
  v_mfma_f32_32x32x16_bf16 v[128:143], v[168:171], v[56:59], v[128:143]
  v_mfma_f32_32x32x16_bf16 v[128:143], v[172:175], v[60:63], v[128:143]
  s_add_u32 m0, s53, 13184
  s_waitcnt vmcnt(4)
  buffer_load_dwordx4 v1, s[20:23], s51 offen offset:128 nt lds
  v_mov_b32 v31, v24
  s_nop 7
  v_max3_f32 v26, v128, v129, v130
  v_max3_f32 v27, v131, v132, v133
  v_max3_f32 v28, v134, v135, v136
  v_max3_f32 v29, v137, v138, v139
  v_max3_f32 v30, v140, v141, v142
  v_max3_f32 v26, v26, v27, v28
  v_max3_f32 v29, v29, v30, v143
  v_max_f32 v27, v26, v29
  v_max_f32 v26, v26, v29
  s_nop 1
  v_permlane32_swap_b32 v26, v27
  v_max3_f32 v23, v26, v27, v23
  v_mul_f32 v24, s55, v23
  v_sub_f32 v31, v31, v24
  v_exp_f32 v22, v31
  v_fma_f32 v128, v128, s55, -v24
  v_fma_f32 v129, v129, s55, -v24
  v_fma_f32 v130, v130, s55, -v24
  v_fma_f32 v131, v131, s55, -v24
  ds_write_b32 v231, v22 offset:1536
  s_waitcnt vmcnt(4)
  buffer_load_dwordx4 v2, s[20:23], s51 offen offset:2176 nt lds
  s_xor_b32 s51, s51, 0x54000
  v_fma_f32 v132, v132, s55, -v24
  v_fma_f32 v133, v133, s55, -v24
  v_exp_f32 v128, v128
  v_fma_f32 v134, v134, s55, -v24
  v_fma_f32 v135, v135, s55, -v24
  v_exp_f32 v129, v129
  v_fma_f32 v136, v136, s55, -v24
  v_fma_f32 v137, v137, s55, -v24
  v_exp_f32 v130, v130
  v_fma_f32 v138, v138, s55, -v24
  v_fma_f32 v139, v139, s55, -v24
  v_exp_f32 v131, v131
  v_fma_f32 v140, v140, s55, -v24
  v_fma_f32 v141, v141, s55, -v24
  v_exp_f32 v132, v132
  v_fma_f32 v142, v142, s55, -v24
  v_fma_f32 v143, v143, s55, -v24
  v_exp_f32 v133, v133
  s_add_u32 m0, s53, 16384
  s_waitcnt vmcnt(4)
  buffer_load_dwordx4 v1, s[20:23], s51 offen nt lds
  v_exp_f32 v134, v134
  v_exp_f32 v135, v135
  v_exp_f32 v136, v136
  v_exp_f32 v137, v137
  v_exp_f32 v138, v138
  v_exp_f32 v139, v139
  v_cvt_pk_bf16_f32 v176, v128, v129
  v_exp_f32 v140, v140
  v_cvt_pk_bf16_f32 v177, v130, v131
  v_exp_f32 v141, v141
  v_cvt_pk_bf16_f32 v178, v132, v133
  v_exp_f32 v142, v142
  v_cvt_pk_bf16_f32 v179, v134, v135
  v_exp_f32 v143, v143
  v_cvt_pk_bf16_f32 v180, v136, v137
  s_waitcnt vmcnt(4)
  buffer_load_dwordx4 v2, s[20:23], s51 offen offset:2048 nt lds
  v_fma_f32 v26, v25, v22, v128
  v_add_f32 v27, v130, v131
  v_add_f32 v28, v132, v133
  v_add_f32 v29, v134, v135
  v_add_f32 v26, v26, v129
  v_cvt_pk_bf16_f32 v181, v138, v139
  v_cvt_pk_bf16_f32 v182, v140, v141
  v_cvt_pk_bf16_f32 v183, v142, v143
  v_add_f32 v26, v26, v136
  v_accvgpr_write_b32 a96, v176
  v_add_f32 v27, v27, v137
  v_accvgpr_write_b32 a97, v177
  v_add_f32 v28, v28, v138
  v_accvgpr_write_b32 a98, v178
  v_add_f32 v29, v29, v139
  v_accvgpr_write_b32 a99, v179
  v_add_f32 v26, v26, v140
  v_accvgpr_write_b32 a100, v180
  v_add_f32 v27, v27, v141
  v_accvgpr_write_b32 a101, v181
  v_add_f32 v28, v28, v142
  v_accvgpr_write_b32 a102, v182
  v_add_f32 v29, v29, v143
  v_accvgpr_write_b32 a103, v183
  v_add_f32 v26, v26, v27
  v_add_f32 v28, v28, v29
  v_add_f32 v25, v26, v28
  s_add_u32 m0, s53, 17280
  s_waitcnt vmcnt(4)
  buffer_load_dwordx4 v1, s[20:23], s51 offen offset:128 nt lds
  s_waitcnt vmcnt(4)
  buffer_load_dwordx4 v2, s[20:23], s51 offen offset:2176 nt lds
  s_xor_b32 s51, s51, 16384
  s_waitcnt lgkmcnt(0)
  s_branch L_join
L_more:
  v_lshrrev_b32 v30, 5, v0
  v_bfe_u32 v29, v0, 1, 3
  v_xor_b32 v6, v30, v29
  v_lshl_add_u32 v6, v6, 4, s53
  v_and_b32 v29, 24, v0
  v_lshl_add_u32 v6, v29, 7, v6
  v_and_b32 v29, 31, v0
  v_lshl_add_u32 v6, v29, 7, v6
  v_xor_b32 v7, 32, v6
  v_xor_b32 v8, 64, v6
  v_xor_b32 v9, 96, v6
  s_waitcnt lgkmcnt(0)
  ds_read_b128 a[128:131], v6
  ds_read_b128 a[132:135], v7
  ds_read_b128 a[136:139], v8
  ds_read_b128 a[140:143], v9
  ds_read_b128 a[144:147], v6 offset:1024
  ds_read_b128 a[148:151], v7 offset:1024
  ds_read_b128 a[152:155], v8 offset:1024
  ds_read_b128 a[156:159], v9 offset:1024
  ds_read_b128 a[160:163], v6 offset:8192
  ds_read_b128 a[164:167], v7 offset:8192
  ds_read_b128 a[168:171], v8 offset:8192
  ds_read_b128 a[172:175], v9 offset:8192
  ds_read_b128 a[176:179], v6 offset:9216
  ds_read_b128 a[180:183], v7 offset:9216
  s_waitcnt lgkmcnt(8)
  ds_read_b128 a[184:187], v8 offset:9216
  ds_read_b128 a[188:191], v9 offset:9216
  s_mov_b32 m0, s53
  s_mov_b32 s64, 2
  s_waitcnt lgkmcnt(0)
  s_mov_b32 s99, 0x14000
1:
  s_waitcnt vmcnt(11)
  buffer_load_dwordx4 v1, s[20:23], s51 offen nt lds
  s_waitcnt vmcnt(11)
  buffer_load_dwordx4 v2, s[20:23], s51 offen offset:2048 nt lds
  s_addk_i32 m0, 896
  s_waitcnt vmcnt(11)
  buffer_load_dwordx4 v1, s[20:23], s51 offen offset:128 nt lds
  s_waitcnt vmcnt(11)
  buffer_load_dwordx4 v2, s[20:23], s51 offen offset:2176 nt lds
  s_addk_i32 m0, 3200
  s_xor_b32 s51, s51, 16384
  s_waitcnt vmcnt(11)
  buffer_load_dwordx4 v1, s[20:23], s51 offen nt lds
  s_waitcnt vmcnt(11)
  buffer_load_dwordx4 v2, s[20:23], s51 offen offset:2048 nt lds
  s_addk_i32 m0, 896
  s_waitcnt vmcnt(11)
  buffer_load_dwordx4 v1, s[20:23], s51 offen offset:128 nt lds
  s_waitcnt vmcnt(11)
  buffer_load_dwordx4 v2, s[20:23], s51 offen offset:2176 nt lds
  s_addk_i32 m0, 3200
  s_xor_b32 s51, s51, s99
  s_mov_b32 s99, 0x54000
  s_sub_u32 s64, s64, 1
  s_cmp_lg_u32 s64, 0
  s_cbranch_scc1 1b
  s_branch L_back
L_C:
  v_xor_b32 v6, 16384, v6
  v_xor_b32 v7, 16384, v7
  v_xor_b32 v8, 16384, v8
  v_xor_b32 v9, 16384, v9
  s_add_u32 m0, s53, 16384
  s_nop 0
  buffer_load_dwordx4 v1, s[20:23], s51 offen nt lds
  s_waitcnt vmcnt(17)
  v_perm_b32 v192, v132, v128, s56
  v_perm_b32 v193, v140, v136, s56
  v_perm_b32 v194, v148, v144, s56
  v_perm_b32 v195, v156, v152, s56
  v_perm_b32 v196, v132, v128, s57
  v_perm_b32 v197, v140, v136, s57
  v_mfma_f32_16x16x32_bf16 v[32:35], v[192:195], a[216:219], v[32:35]
  v_perm_b32 v198, v148, v144, s57
  v_perm_b32 v199, v156, v152, s57
  v_perm_b32 v200, v133, v129, s56
  v_perm_b32 v201, v141, v137, s56
  v_mfma_f32_16x16x32_bf16 v[36:39], v[196:199], a[216:219], v[36:39]
  v_perm_b32 v202, v149, v145, s56
  v_perm_b32 v203, v157, v153, s56
  v_perm_b32 v204, v133, v129, s57
  v_perm_b32 v205, v141, v137, s57
  v_mfma_f32_16x16x32_bf16 v[40:43], v[200:203], a[216:219], v[40:43]
  v_perm_b32 v206, v149, v145, s57
  v_perm_b32 v207, v157, v153, s57
  buffer_load_dwordx4 v2, s[20:23], s51 offen offset:2048 nt lds
  v_perm_b32 v192, v134, v130, s56
  v_perm_b32 v193, v142, v138, s56
  v_mfma_f32_16x16x32_bf16 v[44:47], v[204:207], a[216:219], v[44:47]
  v_perm_b32 v194, v150, v146, s56
  v_perm_b32 v195, v158, v154, s56
  v_perm_b32 v196, v134, v130, s57
  v_perm_b32 v197, v142, v138, s57
  v_mfma_f32_16x16x32_bf16 v[48:51], v[192:195], a[216:219], v[48:51]
  v_perm_b32 v198, v150, v146, s57
  v_perm_b32 v199, v158, v154, s57
  v_perm_b32 v200, v135, v131, s56
  v_perm_b32 v201, v143, v139, s56
  v_mfma_f32_16x16x32_bf16 v[52:55], v[196:199], a[216:219], v[52:55]
  v_perm_b32 v202, v151, v147, s56
  v_perm_b32 v203, v159, v155, s56
  v_perm_b32 v204, v135, v131, s57
  v_perm_b32 v205, v143, v139, s57
  v_mfma_f32_16x16x32_bf16 v[56:59], v[200:203], a[216:219], v[56:59]
  v_perm_b32 v206, v151, v147, s57
  v_perm_b32 v207, v159, v155, s57
  s_nop 1
  v_mfma_f32_16x16x32_bf16 v[60:63], v[204:207], a[216:219], v[60:63]
  s_add_u32 m0, s53, 17280
  s_nop 0
  buffer_load_dwordx4 v1, s[20:23], s51 offen offset:128 nt lds
  s_waitcnt vmcnt(11)
  v_perm_b32 v192, v164, v160, s56
  v_perm_b32 v193, v172, v168, s56
  v_perm_b32 v194, v180, v176, s56
  v_perm_b32 v195, v188, v184, s56
  v_perm_b32 v196, v164, v160, s57
  v_perm_b32 v197, v172, v168, s57
  v_mfma_f32_16x16x32_bf16 v[32:35], v[192:195], a[220:223], v[32:35]
  v_perm_b32 v198, v180, v176, s57
  v_perm_b32 v199, v188, v184, s57
  v_perm_b32 v200, v165, v161, s56
  v_perm_b32 v201, v173, v169, s56
  v_mfma_f32_16x16x32_bf16 v[36:39], v[196:199], a[220:223], v[36:39]
  v_perm_b32 v202, v181, v177, s56
  v_perm_b32 v203, v189, v185, s56
  v_perm_b32 v204, v165, v161, s57
  v_perm_b32 v205, v173, v169, s57
  v_mfma_f32_16x16x32_bf16 v[40:43], v[200:203], a[220:223], v[40:43]
  v_perm_b32 v206, v181, v177, s57
  v_perm_b32 v207, v189, v185, s57
  buffer_load_dwordx4 v2, s[20:23], s51 offen offset:2176 nt lds
  s_xor_b32 s51, s51, 16384
  v_perm_b32 v192, v166, v162, s56
  v_perm_b32 v193, v174, v170, s56
  v_mfma_f32_16x16x32_bf16 v[44:47], v[204:207], a[220:223], v[44:47]
  v_perm_b32 v194, v182, v178, s56
  v_perm_b32 v195, v190, v186, s56
  v_perm_b32 v196, v166, v162, s57
  v_perm_b32 v197, v174, v170, s57
  v_mfma_f32_16x16x32_bf16 v[48:51], v[192:195], a[220:223], v[48:51]
  v_perm_b32 v198, v182, v178, s57
  v_perm_b32 v199, v190, v186, s57
  v_perm_b32 v200, v167, v163, s56
  v_perm_b32 v201, v175, v171, s56
  v_mfma_f32_16x16x32_bf16 v[52:55], v[196:199], a[220:223], v[52:55]
  v_perm_b32 v202, v183, v179, s56
  v_perm_b32 v203, v191, v187, s56
  v_perm_b32 v204, v167, v163, s57
  v_perm_b32 v205, v175, v171, s57
  v_mfma_f32_16x16x32_bf16 v[56:59], v[200:203], a[220:223], v[56:59]
  v_perm_b32 v206, v183, v179, s57
  v_perm_b32 v207, v191, v187, s57
  s_nop 1
  v_mfma_f32_16x16x32_bf16 v[60:63], v[204:207], a[220:223], v[60:63]
  s_add_u32 m0, s53, 20480
  s_nop 0
  buffer_load_dwordx4 v1, s[20:23], s51 offen nt lds
  s_waitcnt vmcnt(5)
  v_perm_b32 v192, v68, v64, s56
  v_perm_b32 v193, v76, v72, s56
  v_perm_b32 v194, v84, v80, s56
  v_perm_b32 v195, v92, v88, s56
  v_perm_b32 v196, v68, v64, s57
  v_perm_b32 v197, v76, v72, s57
  v_mfma_f32_16x16x32_bf16 v[32:35], v[192:195], a[224:227], v[32:35]
  v_perm_b32 v198, v84, v80, s57
  v_perm_b32 v199, v92, v88, s57
  v_perm_b32 v200, v69, v65, s56
  v_perm_b32 v201, v77, v73, s56
  v_mfma_f32_16x16x32_bf16 v[36:39], v[196:199], a[224:227], v[36:39]
  v_perm_b32 v202, v85, v81, s56
  v_perm_b32 v203, v93, v89, s56
  v_perm_b32 v204, v69, v65, s57
  v_perm_b32 v205, v77, v73, s57
  v_mfma_f32_16x16x32_bf16 v[40:43], v[200:203], a[224:227], v[40:43]
  v_perm_b32 v206, v85, v81, s57
  v_perm_b32 v207, v93, v89, s57
  buffer_load_dwordx4 v2, s[20:23], s51 offen offset:2048 nt lds
  v_perm_b32 v192, v70, v66, s56
  v_perm_b32 v193, v78, v74, s56
  v_mfma_f32_16x16x32_bf16 v[44:47], v[204:207], a[224:227], v[44:47]
  v_perm_b32 v194, v86, v82, s56
  v_perm_b32 v195, v94, v90, s56
  v_perm_b32 v196, v70, v66, s57
  v_perm_b32 v197, v78, v74, s57
  v_mfma_f32_16x16x32_bf16 v[48:51], v[192:195], a[224:227], v[48:51]
  v_perm_b32 v198, v86, v82, s57
  v_perm_b32 v199, v94, v90, s57
  v_perm_b32 v200, v71, v67, s56
  v_perm_b32 v201, v79, v75, s56
  v_mfma_f32_16x16x32_bf16 v[52:55], v[196:199], a[224:227], v[52:55]
  v_perm_b32 v202, v87, v83, s56
  v_perm_b32 v203, v95, v91, s56
  v_perm_b32 v204, v71, v67, s57
  v_perm_b32 v205, v79, v75, s57
  v_mfma_f32_16x16x32_bf16 v[56:59], v[200:203], a[224:227], v[56:59]
  v_perm_b32 v206, v87, v83, s57
  v_perm_b32 v207, v95, v91, s57
  s_nop 1
  v_mfma_f32_16x16x32_bf16 v[60:63], v[204:207], a[224:227], v[60:63]
  s_add_u32 m0, s53, 21376
  s_waitcnt vmcnt(5)
  buffer_load_dwordx4 v1, s[20:23], s51 offen offset:128 nt lds
  v_xor_b32 v26, 16384, v21
  s_nop 6
  ds_write_b64 v21, v[34:35]
  ds_write_b64 v21, v[38:39] offset:512
  ds_write_b64 v21, v[42:43] offset:1024
  ds_write_b64 v21, v[46:47] offset:1536
  ds_write_b64 v21, v[50:51] offset:2048
  ds_write_b64 v21, v[54:55] offset:2560
  ds_write_b64 v21, v[58:59] offset:3072
  ds_write_b64 v21, v[62:63] offset:3584
  v_and_b32 v27, 15, v0
  v_lshrrev_b32 v28, 4, v0
  v_lshlrev_b32 v28, 2, v28
  v_xor_b32 v28, s59, v28
  v_xor_b32 v28, v28, v27
  v_lshlrev_b32 v28, 4, v28
  v_lshl_add_u32 v28, v27, 8, v28
  s_and_b32 s60, s3, 1
  s_lshl_b32 s60, s60, 13
  s_add_u32 s60, s60, 135168
  v_add_u32 v28, s60, v28
  v_xor_b32 v29, 16, v28
  s_waitcnt lgkmcnt(0)
  s_barrier
  ds_read_b64 v[64:65], v26
  ds_read_b64 v[66:67], v26 offset:512
  ds_read_b64 v[68:69], v26 offset:1024
  ds_read_b64 v[70:71], v26 offset:1536
  ds_read_b64 v[72:73], v26 offset:2048
  ds_read_b64 v[74:75], v26 offset:2560
  ds_read_b64 v[76:77], v26 offset:3072
  ds_read_b64 v[78:79], v26 offset:3584
  s_waitcnt lgkmcnt(7)
  v_add_f32 v64, v64, v32
  v_add_f32 v65, v65, v33
  s_waitcnt lgkmcnt(6)
  v_add_f32 v66, v66, v36
  v_add_f32 v67, v67, v37
  s_waitcnt lgkmcnt(5)
  v_add_f32 v68, v68, v40
  v_add_f32 v69, v69, v41
  s_waitcnt lgkmcnt(4)
  v_add_f32 v70, v70, v44
  v_add_f32 v71, v71, v45
  s_waitcnt lgkmcnt(3)
  v_add_f32 v72, v72, v48
  v_add_f32 v73, v73, v49
  s_waitcnt lgkmcnt(2)
  v_add_f32 v74, v74, v52
  v_add_f32 v75, v75, v53
  s_waitcnt lgkmcnt(1)
  v_add_f32 v76, v76, v56
  v_add_f32 v77, v77, v57
  s_waitcnt lgkmcnt(0)
  v_add_f32 v78, v78, v60
  v_add_f32 v79, v79, v61
  v_cvt_pk_bf16_f32 v80, v64, v66
  v_cvt_pk_bf16_f32 v81, v68, v70
  v_cvt_pk_bf16_f32 v82, v72, v74
  v_cvt_pk_bf16_f32 v83, v76, v78
  ds_write_b128 v28, v[80:83]
  v_cvt_pk_bf16_f32 v84, v65, v67
  v_cvt_pk_bf16_f32 v85, v69, v71
  v_cvt_pk_bf16_f32 v86, v73, v75
  v_cvt_pk_bf16_f32 v87, v77, v79
  ds_write_b128 v29, v[84:87]
  v_lshrrev_b32 v26, 5, v0
  v_xor_b32 v26, v26, v27
  v_lshlrev_b32 v26, 4, v26
  v_lshl_add_u32 v26, v27, 8, v26
  v_and_b32 v27, 16, v0
  v_lshl_add_u32 v26, v27, 9, v26
  v_add_u32 v96, 135168, v26
  v_xor_b32 v97, 32, v96
  v_xor_b32 v98, 64, v96
  v_xor_b32 v99, 96, v96
  v_xor_b32 v100, 128, v96
  v_xor_b32 v101, 160, v96
  v_xor_b32 v102, 192, v96
  v_xor_b32 v103, 224, v96
  s_waitcnt lgkmcnt(0)
  s_barrier
  ds_read_b128 v[32:35], v96
  ds_read_b128 v[36:39], v97
  ds_read_b128 v[40:43], v98
  ds_read_b128 v[44:47], v99
  ds_read_b128 v[48:51], v100
  ds_read_b128 v[52:55], v101
  ds_read_b128 v[56:59], v102
  ds_read_b128 v[60:63], v103
  s_waitcnt lgkmcnt(0)
  s_waitcnt vmcnt(5)
  buffer_load_dwordx4 v2, s[20:23], s51 offen offset:2176 nt lds
  s_xor_b32 s51, s51, 0x14000
  ds_read_b128 v[144:147], v6
  ds_read_b128 v[148:151], v7
  ds_read_b128 v[152:155], v8
  ds_read_b128 v[156:159], v9
  ds_read_b128 v[160:163], v6 offset:1024
  ds_read_b128 v[164:167], v7 offset:1024
  ds_read_b128 v[168:171], v8 offset:1024
  ds_read_b128 v[172:175], v9 offset:1024
  v_mfma_f32_32x32x16_bf16 v[128:143], a[128:131], v[32:35], 0
  v_mfma_f32_32x32x16_bf16 v[128:143], a[132:135], v[36:39], v[128:143]
  v_mfma_f32_32x32x16_bf16 v[128:143], a[136:139], v[40:43], v[128:143]
  v_mfma_f32_32x32x16_bf16 v[128:143], a[140:143], v[44:47], v[128:143]
  s_add_u32 m0, s53, 24576
  s_waitcnt vmcnt(5)
  buffer_load_dwordx4 v1, s[20:23], s51 offen nt lds
  s_cmp_eq_u32 s63, 3
  s_cbranch_scc0 1f
  s_waitcnt vmcnt(0)
  s_mov_b64 exec, 1
  global_store_dword v254, v253, s[16:17] sc1
  s_mov_b64 exec, -1
1:
  v_mfma_f32_32x32x16_bf16 v[128:143], a[144:147], v[48:51], v[128:143]
  v_mfma_f32_32x32x16_bf16 v[128:143], a[148:151], v[52:55], v[128:143]
  v_mfma_f32_32x32x16_bf16 v[128:143], a[152:155], v[56:59], v[128:143]
  v_mfma_f32_32x32x16_bf16 v[128:143], a[156:159], v[60:63], v[128:143]
  s_nop 11
  v_max3_f32 v26, v128, v129, v130
  v_max3_f32 v27, v131, v132, v133
  v_max3_f32 v28, v134, v135, v136
  v_max3_f32 v29, v137, v138, v139
  v_max3_f32 v30, v140, v141, v142
  v_max3_f32 v26, v26, v27, v28
  v_max3_f32 v29, v29, v30, v143
  v_max_f32 v27, v26, v29
  v_max_f32 v26, v26, v29
  s_nop 1
  v_permlane32_swap_b32 v26, v27
  v_max_f32 v23, v26, v27
  v_mul_f32 v24, s55, v23
  v_fma_f32 v128, v128, s55, -v24
  v_fma_f32 v129, v129, s55, -v24
  v_fma_f32 v130, v130, s55, -v24
  v_fma_f32 v131, v131, s55, -v24
  s_waitcnt vmcnt(5)
  buffer_load_dwordx4 v2, s[20:23], s51 offen offset:2048 nt lds
  v_fma_f32 v132, v132, s55, -v24
  v_fma_f32 v133, v133, s55, -v24
  v_exp_f32 v128, v128
  v_fma_f32 v134, v134, s55, -v24
  v_fma_f32 v135, v135, s55, -v24
  v_exp_f32 v129, v129
  v_fma_f32 v136, v136, s55, -v24
  v_fma_f32 v137, v137, s55, -v24
  v_exp_f32 v130, v130
  v_fma_f32 v138, v138, s55, -v24
  v_fma_f32 v139, v139, s55, -v24
  v_exp_f32 v131, v131
  v_fma_f32 v140, v140, s55, -v24
  v_fma_f32 v141, v141, s55, -v24
  v_exp_f32 v132, v132
  v_fma_f32 v142, v142, s55, -v24
  v_fma_f32 v143, v143, s55, -v24
  v_exp_f32 v133, v133
  v_exp_f32 v134, v134
  v_exp_f32 v135, v135
  v_exp_f32 v136, v136
  v_exp_f32 v137, v137
  v_exp_f32 v138, v138
  v_exp_f32 v139, v139
  v_cvt_pk_bf16_f32 v176, v128, v129
  v_exp_f32 v140, v140
  v_cvt_pk_bf16_f32 v177, v130, v131
  v_exp_f32 v141, v141
  v_cvt_pk_bf16_f32 v178, v132, v133
  v_exp_f32 v142, v142
  v_cvt_pk_bf16_f32 v179, v134, v135
  v_exp_f32 v143, v143
  v_cvt_pk_bf16_f32 v180, v136, v137
  s_add_u32 m0, s53, 25472
  s_waitcnt vmcnt(5)
  buffer_load_dwordx4 v1, s[20:23], s51 offen offset:128 nt lds
  v_add_f32 v26, v128, v129
  v_add_f32 v27, v130, v131
  v_add_f32 v28, v132, v133
  v_add_f32 v29, v134, v135
  v_cvt_pk_bf16_f32 v181, v138, v139
  v_cvt_pk_bf16_f32 v182, v140, v141
  v_cvt_pk_bf16_f32 v183, v142, v143
  v_add_f32 v26, v26, v136
  v_accvgpr_write_b32 a0, v176
  v_add_f32 v27, v27, v137
  v_accvgpr_write_b32 a1, v177
  v_add_f32 v28, v28, v138
  v_accvgpr_write_b32 a2, v178
  v_add_f32 v29, v29, v139
  v_accvgpr_write_b32 a3, v179
  v_add_f32 v26, v26, v140
  v_accvgpr_write_b32 a4, v180
  v_add_f32 v27, v27, v141
  v_accvgpr_write_b32 a5, v181
  v_add_f32 v28, v28, v142
  v_accvgpr_write_b32 a6, v182
  v_add_f32 v29, v29, v143
  v_accvgpr_write_b32 a7, v183
  v_add_f32 v26, v26, v27
  v_add_f32 v28, v28, v29
  v_add_f32 v25, v26, v28
  s_waitcnt vmcnt(5)
  buffer_load_dwordx4 v2, s[20:23], s51 offen offset:2176 nt lds
  s_xor_b32 s51, s51, 16384
  v_mfma_f32_32x32x16_bf16 v[128:143], a[160:163], v[32:35], 0
  v_mfma_f32_32x32x16_bf16 v[128:143], a[164:167], v[36:39], v[128:143]
  v_mfma_f32_32x32x16_bf16 v[128:143], a[168:171], v[40:43], v[128:143]
  v_mfma_f32_32x32x16_bf16 v[128:143], a[172:175], v[44:47], v[128:143]
  s_cmp_eq_u32 s63, 4
  s_cbranch_scc0 1f
  s_waitcnt vmcnt(0)
  s_mov_b64 exec, 1
  global_store_dword v254, v253, s[16:17] sc1
  s_mov_b64 exec, -1
1:
  v_mfma_f32_32x32x16_bf16 v[128:143], a[176:179], v[48:51], v[128:143]
  v_mfma_f32_32x32x16_bf16 v[128:143], a[180:183], v[52:55], v[128:143]
  v_mfma_f32_32x32x16_bf16 v[128:143], a[184:187], v[56:59], v[128:143]
  v_mfma_f32_32x32x16_bf16 v[128:143], a[188:191], v[60:63], v[128:143]
  s_add_u32 m0, s53, 28672
  s_waitcnt vmcnt(5)
  buffer_load_dwordx4 v1, s[20:23], s51 offen nt lds
  v_mov_b32 v31, v24
  s_nop 7
  v_max3_f32 v26, v128, v129, v130
  v_max3_f32 v27, v131, v132, v133
  v_max3_f32 v28, v134, v135, v136
  v_max3_f32 v29, v137, v138, v139
  v_max3_f32 v30, v140, v141, v142
  v_max3_f32 v26, v26, v27, v28
  v_max3_f32 v29, v29, v30, v143
  v_max_f32 v27, v26, v29
  v_max_f32 v26, v26, v29
  s_nop 1
  v_permlane32_swap_b32 v26, v27
  v_max3_f32 v23, v26, v27, v23
  v_mul_f32 v24, s55, v23
  v_sub_f32 v31, v31, v24
  v_exp_f32 v22, v31
  v_fma_f32 v128, v128, s55, -v24
  v_fma_f32 v129, v129, s55, -v24
  v_fma_f32 v130, v130, s55, -v24
  v_fma_f32 v131, v131, s55, -v24
  ds_write_b32 v231, v22 offset:128
  v_fma_f32 v132, v132, s55, -v24
  v_fma_f32 v133, v133, s55, -v24
  v_exp_f32 v128, v128
  v_fma_f32 v134, v134, s55, -v24
  v_fma_f32 v135, v135, s55, -v24
  v_exp_f32 v129, v129
  v_fma_f32 v136, v136, s55, -v24
  v_fma_f32 v137, v137, s55, -v24
  v_exp_f32 v130, v130
  v_fma_f32 v138, v138, s55, -v24
  v_fma_f32 v139, v139, s55, -v24
  v_exp_f32 v131, v131
  v_fma_f32 v140, v140, s55, -v24
  v_fma_f32 v141, v141, s55, -v24
  v_exp_f32 v132, v132
  v_fma_f32 v142, v142, s55, -v24
  v_fma_f32 v143, v143, s55, -v24
  v_exp_f32 v133, v133
  s_waitcnt vmcnt(5)
  buffer_load_dwordx4 v2, s[20:23], s51 offen offset:2048 nt lds
  v_exp_f32 v134, v134
  v_exp_f32 v135, v135
  v_exp_f32 v136, v136
  v_exp_f32 v137, v137
  v_exp_f32 v138, v138
  v_exp_f32 v139, v139
  v_cvt_pk_bf16_f32 v176, v128, v129
  v_exp_f32 v140, v140
  v_cvt_pk_bf16_f32 v177, v130, v131
  v_exp_f32 v141, v141
  v_cvt_pk_bf16_f32 v178, v132, v133
  v_exp_f32 v142, v142
  v_cvt_pk_bf16_f32 v179, v134, v135
  v_exp_f32 v143, v143
  v_cvt_pk_bf16_f32 v180, v136, v137
  v_fma_f32 v26, v25, v22, v128
  v_add_f32 v27, v130, v131
  v_add_f32 v28, v132, v133
  v_add_f32 v29, v134, v135
  v_add_f32 v26, v26, v129
  v_cvt_pk_bf16_f32 v181, v138, v139
  v_cvt_pk_bf16_f32 v182, v140, v141
  v_cvt_pk_bf16_f32 v183, v142, v143
  v_add_f32 v26, v26, v136
  v_accvgpr_write_b32 a8, v176
  v_add_f32 v27, v27, v137
  v_accvgpr_write_b32 a9, v177
  v_add_f32 v28, v28, v138
  v_accvgpr_write_b32 a10, v178
  v_add_f32 v29, v29, v139
  v_accvgpr_write_b32 a11, v179
  v_add_f32 v26, v26, v140
  v_accvgpr_write_b32 a12, v180
  v_add_f32 v27, v27, v141
  v_accvgpr_write_b32 a13, v181
  v_add_f32 v28, v28, v142
  v_accvgpr_write_b32 a14, v182
  v_add_f32 v29, v29, v143
  v_accvgpr_write_b32 a15, v183
  v_add_f32 v26, v26, v27
  v_add_f32 v28, v28, v29
  v_add_f32 v25, v26, v28
  s_add_u32 m0, s53, 29568
  s_waitcnt vmcnt(5)
  buffer_load_dwordx4 v1, s[20:23], s51 offen offset:128 nt lds
  v_mfma_f32_32x32x16_bf16 v[128:143], a[64:67], v[32:35], 0
  v_mfma_f32_32x32x16_bf16 v[128:143], a[68:71], v[36:39], v[128:143]
  v_mfma_f32_32x32x16_bf16 v[128:143], a[72:75], v[40:43], v[128:143]
  v_mfma_f32_32x32x16_bf16 v[128:143], a[76:79], v[44:47], v[128:143]
  v_mfma_f32_32x32x16_bf16 v[128:143], a[80:83], v[48:51], v[128:143]
  v_mfma_f32_32x32x16_bf16 v[128:143], a[84:87], v[52:55], v[128:143]
  v_mfma_f32_32x32x16_bf16 v[128:143], a[88:91], v[56:59], v[128:143]
  v_mfma_f32_32x32x16_bf16 v[128:143], a[92:95], v[60:63], v[128:143]
  s_waitcnt vmcnt(5)
  buffer_load_dwordx4 v2, s[20:23], s51 offen offset:2176 nt lds
  s_xor_b32 s51, s51, 0x1d4000
  v_mov_b32 v31, v24
  s_nop 7
  v_max3_f32 v26, v128, v129, v130
  v_max3_f32 v27, v131, v132, v133
  v_max3_f32 v28, v134, v135, v136
  v_max3_f32 v29, v137, v138, v139
  v_max3_f32 v30, v140, v141, v142
  v_max3_f32 v26, v26, v27, v28
  v_max3_f32 v29, v29, v30, v143
  v_max_f32 v27, v26, v29
  v_max_f32 v26, v26, v29
  s_nop 1
  v_permlane32_swap_b32 v26, v27
  v_max3_f32 v23, v26, v27, v23
  v_mul_f32 v24, s55, v23
  v_sub_f32 v31, v31, v24
  v_exp_f32 v22, v31
  v_fma_f32 v128, v128, s55, -v24
  v_fma_f32 v129, v129, s55, -v24
  v_fma_f32 v130, v130, s55, -v24
  v_fma_f32 v131, v131, s55, -v24
  ds_write_b32 v231, v22 offset:256
  s_waitcnt lgkmcnt(2)
  s_mov_b32 m0, s53
  s_waitcnt vmcnt(5)
  buffer_load_dwordx4 v1, s[20:23], s51 offen nt lds
  v_fma_f32 v132, v132, s55, -v24
  v_fma_f32 v133, v133, s55, -v24
  v_exp_f32 v128, v128
  v_fma_f32 v134, v134, s55, -v24
  v_fma_f32 v135, v135, s55, -v24
  v_exp_f32 v129, v129
  v_fma_f32 v136, v136, s55, -v24
  v_fma_f32 v137, v137, s55, -v24
  v_exp_f32 v130, v130
  v_fma_f32 v138, v138, s55, -v24
  v_fma_f32 v139, v139, s55, -v24
  v_exp_f32 v131, v131
  v_fma_f32 v140, v140, s55, -v24
  v_fma_f32 v141, v141, s55, -v24
  v_exp_f32 v132, v132
  v_fma_f32 v142, v142, s55, -v24
  v_fma_f32 v143, v143, s55, -v24
  v_exp_f32 v133, v133
  v_exp_f32 v134, v134
  v_exp_f32 v135, v135
  v_exp_f32 v136, v136
  v_exp_f32 v137, v137
  v_exp_f32 v138, v138
  v_exp_f32 v139, v139
  v_cvt_pk_bf16_f32 v176, v128, v129
  v_exp_f32 v140, v140
  v_cvt_pk_bf16_f32 v177, v130, v131
  v_exp_f32 v141, v141
  v_cvt_pk_bf16_f32 v178, v132, v133
  v_exp_f32 v142, v142
  v_cvt_pk_bf16_f32 v179, v134, v135
  v_exp_f32 v143, v143
  v_cvt_pk_bf16_f32 v180, v136, v137
  s_waitcnt vmcnt(5)
  buffer_load_dwordx4 v2, s[20:23], s51 offen offset:2048 nt lds
  v_fma_f32 v26, v25, v22, v128
  v_add_f32 v27, v130, v131
  v_add_f32 v28, v132, v133
  v_add_f32 v29, v134, v135
  v_add_f32 v26, v26, v129
  v_cvt_pk_bf16_f32 v181, v138, v139
  v_cvt_pk_bf16_f32 v182, v140, v141
  v_cvt_pk_bf16_f32 v183, v142, v143
  v_add_f32 v26, v26, v136
  v_accvgpr_write_b32 a16, v176
  v_add_f32 v27, v27, v137
  v_accvgpr_write_b32 a17, v177
  v_add_f32 v28, v28, v138
  v_accvgpr_write_b32 a18, v178
  v_add_f32 v29, v29, v139
  v_accvgpr_write_b32 a19, v179
  v_add_f32 v26, v26, v140
  v_accvgpr_write_b32 a20, v180
  v_add_f32 v27, v27, v141
  v_accvgpr_write_b32 a21, v181
  v_add_f32 v28, v28, v142
  v_accvgpr_write_b32 a22, v182
  v_add_f32 v29, v29, v143
  v_accvgpr_write_b32 a23, v183
  v_add_f32 v26, v26, v27
  v_add_f32 v28, v28, v29
  v_add_f32 v25, v26, v28
  v_mfma_f32_32x32x16_bf16 v[128:143], a[96:99], v[32:35], 0
  v_mfma_f32_32x32x16_bf16 v[128:143], a[100:103], v[36:39], v[128:143]
  v_mfma_f32_32x32x16_bf16 v[128:143], a[104:107], v[40:43], v[128:143]
  v_mfma_f32_32x32x16_bf16 v[128:143], a[108:111], v[44:47], v[128:143]
  s_add_u32 m0, s53, 896
  s_waitcnt vmcnt(5)
  buffer_load_dwordx4 v1, s[20:23], s51 offen offset:128 nt lds
  v_mfma_f32_32x32x16_bf16 v[128:143], a[112:115], v[48:51], v[128:143]
  v_mfma_f32_32x32x16_bf16 v[128:143], a[116:119], v[52:55], v[128:143]
  v_mfma_f32_32x32x16_bf16 v[128:143], a[120:123], v[56:59], v[128:143]
  v_mfma_f32_32x32x16_bf16 v[128:143], a[124:127], v[60:63], v[128:143]
  v_mov_b32 v31, v24
  s_nop 10
  v_max3_f32 v26, v128, v129, v130
  v_max3_f32 v27, v131, v132, v133
  v_max3_f32 v28, v134, v135, v136
  v_max3_f32 v29, v137, v138, v139
  v_max3_f32 v30, v140, v141, v142
  v_max3_f32 v26, v26, v27, v28
  v_max3_f32 v29, v29, v30, v143
  v_max_f32 v27, v26, v29
  v_max_f32 v26, v26, v29
  s_nop 1
  v_permlane32_swap_b32 v26, v27
  v_max3_f32 v23, v26, v27, v23
  v_mul_f32 v24, s55, v23
  v_sub_f32 v31, v31, v24
  v_exp_f32 v22, v31
  v_fma_f32 v128, v128, s55, -v24
  v_fma_f32 v129, v129, s55, -v24
  v_fma_f32 v130, v130, s55, -v24
  v_fma_f32 v131, v131, s55, -v24
  ds_write_b32 v231, v22 offset:384
  s_waitcnt vmcnt(5)
  buffer_load_dwordx4 v2, s[20:23], s51 offen offset:2176 nt lds
  s_xor_b32 s51, s51, 16384
  v_fma_f32 v132, v132, s55, -v24
  v_fma_f32 v133, v133, s55, -v24
  v_exp_f32 v128, v128
  v_fma_f32 v134, v134, s55, -v24
  v_fma_f32 v135, v135, s55, -v24
  v_exp_f32 v129, v129
  v_fma_f32 v136, v136, s55, -v24
  v_fma_f32 v137, v137, s55, -v24
  v_exp_f32 v130, v130
  v_fma_f32 v138, v138, s55, -v24
  v_fma_f32 v139, v139, s55, -v24
  v_exp_f32 v131, v131
  v_fma_f32 v140, v140, s55, -v24
  v_fma_f32 v141, v141, s55, -v24
  v_exp_f32 v132, v132
  v_fma_f32 v142, v142, s55, -v24
  v_fma_f32 v143, v143, s55, -v24
  v_exp_f32 v133, v133
  v_exp_f32 v134, v134
  v_exp_f32 v135, v135
  v_exp_f32 v136, v136
  v_exp_f32 v137, v137
  v_exp_f32 v138, v138
  v_exp_f32 v139, v139
  v_cvt_pk_bf16_f32 v176, v128, v129
  v_exp_f32 v140, v140
  v_cvt_pk_bf16_f32 v177, v130, v131
  v_exp_f32 v141, v141
  v_cvt_pk_bf16_f32 v178, v132, v133
  v_exp_f32 v142, v142
  v_cvt_pk_bf16_f32 v179, v134, v135
  v_exp_f32 v143, v143
  v_cvt_pk_bf16_f32 v180, v136, v137
  s_add_u32 m0, s53, 4096
  s_waitcnt vmcnt(5)
  buffer_load_dwordx4 v1, s[20:23], s51 offen nt lds
  v_fma_f32 v26, v25, v22, v128
  v_add_f32 v27, v130, v131
  v_add_f32 v28, v132, v133
  v_add_f32 v29, v134, v135
  v_add_f32 v26, v26, v129
  v_cvt_pk_bf16_f32 v181, v138, v139
  v_cvt_pk_bf16_f32 v182, v140, v141
  v_cvt_pk_bf16_f32 v183, v142, v143
  v_add_f32 v26, v26, v136
  v_accvgpr_write_b32 a24, v176
  v_add_f32 v27, v27, v137
  v_accvgpr_write_b32 a25, v177
  v_add_f32 v28, v28, v138
  v_accvgpr_write_b32 a26, v178
  v_add_f32 v29, v29, v139
  v_accvgpr_write_b32 a27, v179
  v_add_f32 v26, v26, v140
  v_accvgpr_write_b32 a28, v180
  v_add_f32 v27, v27, v141
  v_accvgpr_write_b32 a29, v181
  v_add_f32 v28, v28, v142
  v_accvgpr_write_b32 a30, v182
  v_add_f32 v29, v29, v143
  v_accvgpr_write_b32 a31, v183
  v_add_f32 v26, v26, v27
  v_add_f32 v28, v28, v29
  v_add_f32 v25, v26, v28
  s_waitcnt vmcnt(5)
  buffer_load_dwordx4 v2, s[20:23], s51 offen offset:2048 nt lds
  v_mfma_f32_32x32x16_bf16 v[128:143], v[144:147], v[32:35], 0
  v_mfma_f32_32x32x16_bf16 v[128:143], v[148:151], v[36:39], v[128:143]
  v_mfma_f32_32x32x16_bf16 v[128:143], v[152:155], v[40:43], v[128:143]
  v_mfma_f32_32x32x16_bf16 v[128:143], v[156:159], v[44:47], v[128:143]
  v_mfma_f32_32x32x16_bf16 v[128:143], v[160:163], v[48:51], v[128:143]
  v_mfma_f32_32x32x16_bf16 v[128:143], v[164:167], v[52:55], v[128:143]
  v_mfma_f32_32x32x16_bf16 v[128:143], v[168:171], v[56:59], v[128:143]
  v_mfma_f32_32x32x16_bf16 v[128:143], v[172:175], v[60:63], v[128:143]
  s_add_u32 m0, s53, 4992
  s_waitcnt vmcnt(5)
  buffer_load_dwordx4 v1, s[20:23], s51 offen offset:128 nt lds
  v_mov_b32 v31, v24
  s_nop 7
  v_max3_f32 v26, v128, v129, v130
  v_max3_f32 v27, v131, v132, v133
  v_max3_f32 v28, v134, v135, v136
  v_max3_f32 v29, v137, v138, v139
  v_max3_f32 v30, v140, v141, v142
  v_max3_f32 v26, v26, v27, v28
  v_max3_f32 v29, v29, v30, v143
  v_max_f32 v27, v26, v29
  v_max_f32 v26, v26, v29
  s_nop 1
  v_permlane32_swap_b32 v26, v27
  v_max3_f32 v23, v26, v27, v23
  v_mul_f32 v24, s55, v23
  v_sub_f32 v31, v31, v24
  v_exp_f32 v22, v31
  v_fma_f32 v128, v128, s55, -v24
  v_fma_f32 v129, v129, s55, -v24
  v_fma_f32 v130, v130, s55, -v24
  v_fma_f32 v131, v131, s55, -v24
  ds_write_b32 v231, v22 offset:512
  v_fma_f32 v132, v132, s55, -v24
  v_fma_f32 v133, v133, s55, -v24
  v_exp_f32 v128, v128
  v_fma_f32 v134, v134, s55, -v24
  v_fma_f32 v135, v135, s55, -v24
  v_exp_f32 v129, v129
  v_fma_f32 v136, v136, s55, -v24
  v_fma_f32 v137, v137, s55, -v24
  v_exp_f32 v130, v130
  v_fma_f32 v138, v138, s55, -v24
  v_fma_f32 v139, v139, s55, -v24
  v_exp_f32 v131, v131
  v_fma_f32 v140, v140, s55, -v24
  v_fma_f32 v141, v141, s55, -v24
  v_exp_f32 v132, v132
  v_fma_f32 v142, v142, s55, -v24
  v_fma_f32 v143, v143, s55, -v24
  v_exp_f32 v133, v133
  s_waitcnt vmcnt(5)
  buffer_load_dwordx4 v2, s[20:23], s51 offen offset:2176 nt lds
  s_xor_b32 s51, s51, 0x14000
  v_exp_f32 v134, v134
  v_exp_f32 v135, v135
  v_exp_f32 v136, v136
  v_exp_f32 v137, v137
  v_exp_f32 v138, v138
  v_exp_f32 v139, v139
  v_cvt_pk_bf16_f32 v176, v128, v129
  v_exp_f32 v140, v140
  v_cvt_pk_bf16_f32 v177, v130, v131
  v_exp_f32 v141, v141
  v_cvt_pk_bf16_f32 v178, v132, v133
  v_exp_f32 v142, v142
  v_cvt_pk_bf16_f32 v179, v134, v135
  v_exp_f32 v143, v143
  v_cvt_pk_bf16_f32 v180, v136, v137
  v_fma_f32 v26, v25, v22, v128
  v_add_f32 v27, v130, v131
  v_add_f32 v28, v132, v133
  v_add_f32 v29, v134, v135
  v_add_f32 v26, v26, v129
  v_cvt_pk_bf16_f32 v181, v138, v139
  v_cvt_pk_bf16_f32 v182, v140, v141
  v_cvt_pk_bf16_f32 v183, v142, v143
  v_add_f32 v26, v26, v136
  v_accvgpr_write_b32 a32, v176
  v_add_f32 v27, v27, v137
  v_accvgpr_write_b32 a33, v177
  v_add_f32 v28, v28, v138
  v_accvgpr_write_b32 a34, v178
  v_add_f32 v29, v29, v139
  v_accvgpr_write_b32 a35, v179
  v_add_f32 v26, v26, v140
  v_accvgpr_write_b32 a36, v180
  v_add_f32 v27, v27, v141
  v_accvgpr_write_b32 a37, v181
  v_add_f32 v28, v28, v142
  v_accvgpr_write_b32 a38, v182
  v_add_f32 v29, v29, v143
  v_accvgpr_write_b32 a39, v183
  v_add_f32 v26, v26, v27
  v_add_f32 v28, v28, v29
  v_add_f32 v25, v26, v28
  ds_read_b128 v[144:147], v6 offset:8192
  ds_read_b128 v[148:151], v7 offset:8192
  ds_read_b128 v[152:155], v8 offset:8192
  ds_read_b128 v[156:159], v9 offset:8192
  ds_read_b128 v[160:163], v6 offset:9216
  ds_read_b128 v[164:167], v7 offset:9216
  ds_read_b128 v[168:171], v8 offset:9216
  ds_read_b128 v[172:175], v9 offset:9216
  s_waitcnt lgkmcnt(0)
  s_add_u32 m0, s53, 8192
  s_waitcnt vmcnt(5)
  buffer_load_dwordx4 v1, s[20:23], s51 offen nt lds
  v_mfma_f32_32x32x16_bf16 v[128:143], v[144:147], v[32:35], 0
  v_mfma_f32_32x32x16_bf16 v[128:143], v[148:151], v[36:39], v[128:143]
  v_mfma_f32_32x32x16_bf16 v[128:143], v[152:155], v[40:43], v[128:143]
  v_mfma_f32_32x32x16_bf16 v[128:143], v[156:159], v[44:47], v[128:143]
  v_mfma_f32_32x32x16_bf16 v[128:143], v[160:163], v[48:51], v[128:143]
  v_mfma_f32_32x32x16_bf16 v[128:143], v[164:167], v[52:55], v[128:143]
  v_mfma_f32_32x32x16_bf16 v[128:143], v[168:171], v[56:59], v[128:143]
  v_mfma_f32_32x32x16_bf16 v[128:143], v[172:175], v[60:63], v[128:143]
  s_waitcnt vmcnt(5)
  buffer_load_dwordx4 v2, s[20:23], s51 offen offset:2048 nt lds
  v_mov_b32 v31, v24
  s_nop 8
  v_max3_f32 v26, v128, v129, v130
  v_max3_f32 v27, v131, v132, v133
  v_max3_f32 v28, v134, v135, v136
  v_max3_f32 v29, v137, v138, v139
  v_max3_f32 v30, v140, v141, v142
  v_max3_f32 v26, v26, v27, v28
  v_max3_f32 v29, v29, v30, v143
  v_max_f32 v27, v26, v29
  v_max_f32 v26, v26, v29
  s_nop 1
  v_permlane32_swap_b32 v26, v27
  v_max3_f32 v23, v26, v27, v23
  v_mul_f32 v24, s55, v23
  v_sub_f32 v31, v31, v24
  v_exp_f32 v22, v31
  v_fma_f32 v128, v128, s55, -v24
  v_fma_f32 v129, v129, s55, -v24
  v_fma_f32 v130, v130, s55, -v24
  v_fma_f32 v131, v131, s55, -v24
  ds_write_b32 v231, v22 offset:640
  s_add_u32 m0, s53, 9088
  s_waitcnt vmcnt(5)
  buffer_load_dwordx4 v1, s[20:23], s51 offen offset:128 nt lds
  v_fma_f32 v132, v132, s55, -v24
  v_fma_f32 v133, v133, s55, -v24
  v_exp_f32 v128, v128
  v_fma_f32 v134, v134, s55, -v24
  v_fma_f32 v135, v135, s55, -v24
  v_exp_f32 v129, v129
  v_fma_f32 v136, v136, s55, -v24
  v_fma_f32 v137, v137, s55, -v24
  v_exp_f32 v130, v130
  v_fma_f32 v138, v138, s55, -v24
  v_fma_f32 v139, v139, s55, -v24
  v_exp_f32 v131, v131
  v_fma_f32 v140, v140, s55, -v24
  v_fma_f32 v141, v141, s55, -v24
  v_exp_f32 v132, v132
  v_fma_f32 v142, v142, s55, -v24
  v_fma_f32 v143, v143, s55, -v24
  v_exp_f32 v133, v133
  v_exp_f32 v134, v134
  v_exp_f32 v135, v135
  v_exp_f32 v136, v136
  v_exp_f32 v137, v137
  v_exp_f32 v138, v138
  v_exp_f32 v139, v139
  v_cvt_pk_bf16_f32 v176, v128, v129
  v_exp_f32 v140, v140
  v_cvt_pk_bf16_f32 v177, v130, v131
  v_exp_f32 v141, v141
  v_cvt_pk_bf16_f32 v178, v132, v133
  v_exp_f32 v142, v142
  v_cvt_pk_bf16_f32 v179, v134, v135
  v_exp_f32 v143, v143
  v_cvt_pk_bf16_f32 v180, v136, v137
  s_waitcnt vmcnt(5)
  buffer_load_dwordx4 v2, s[20:23], s51 offen offset:2176 nt lds
  s_xor_b32 s51, s51, 16384
  v_fma_f32 v26, v25, v22, v128
  v_add_f32 v27, v130, v131
  v_add_f32 v28, v132, v133
  v_add_f32 v29, v134, v135
  v_add_f32 v26, v26, v129
  v_cvt_pk_bf16_f32 v181, v138, v139
  v_cvt_pk_bf16_f32 v182, v140, v141
  v_cvt_pk_bf16_f32 v183, v142, v143
  v_add_f32 v26, v26, v136
  v_accvgpr_write_b32 a40, v176
  v_add_f32 v27, v27, v137
  v_accvgpr_write_b32 a41, v177
  v_add_f32 v28, v28, v138
  v_accvgpr_write_b32 a42, v178
  v_add_f32 v29, v29, v139
  v_accvgpr_write_b32 a43, v179
  v_add_f32 v26, v26, v140
  v_accvgpr_write_b32 a44, v180
  v_add_f32 v27, v27, v141
  v_accvgpr_write_b32 a45, v181
  v_add_f32 v28, v28, v142
  v_accvgpr_write_b32 a46, v182
  v_add_f32 v29, v29, v143
  v_accvgpr_write_b32 a47, v183
  v_add_f32 v26, v26, v27
  v_add_f32 v28, v28, v29
  v_add_f32 v25, v26, v28
  ds_read_b128 v[144:147], v6 offset:16384
  ds_read_b128 v[148:151], v7 offset:16384
  ds_read_b128 v[152:155], v8 offset:16384
  ds_read_b128 v[156:159], v9 offset:16384
  ds_read_b128 v[160:163], v6 offset:17408
  ds_read_b128 v[164:167], v7 offset:17408
  ds_read_b128 v[168:171], v8 offset:17408
  ds_read_b128 v[172:175], v9 offset:17408
  s_add_u32 m0, s53, 12288
  s_waitcnt vmcnt(5)
  buffer_load_dwordx4 v1, s[20:23], s51 offen nt lds
  s_waitcnt lgkmcnt(4)
  v_mfma_f32_32x32x16_bf16 v[128:143], v[144:147], v[32:35], 0
  v_mfma_f32_32x32x16_bf16 v[128:143], v[148:151], v[36:39], v[128:143]
  v_mfma_f32_32x32x16_bf16 v[128:143], v[152:155], v[40:43], v[128:143]
  v_mfma_f32_32x32x16_bf16 v[128:143], v[156:159], v[44:47], v[128:143]
  s_waitcnt lgkmcnt(0)
  v_mfma_f32_32x32x16_bf16 v[128:143], v[160:163], v[48:51], v[128:143]
  v_mfma_f32_32x32x16_bf16 v[128:143], v[164:167], v[52:55], v[128:143]
  v_mfma_f32_32x32x16_bf16 v[128:143], v[168:171], v[56:59], v[128:143]
  v_mfma_f32_32x32x16_bf16 v[128:143], v[172:175], v[60:63], v[128:143]
  s_waitcnt vmcnt(5)
  buffer_load_dwordx4 v2, s[20:23], s51 offen offset:2048 nt lds
  v_mov_b32 v31, v24
  s_nop 8
  v_max3_f32 v26, v128, v129, v130
  v_max3_f32 v27, v131, v132, v133
  v_max3_f32 v28, v134, v135, v136
  v_max3_f32 v29, v137, v138, v139
  v_max3_f32 v30, v140, v141, v142
  v_max3_f32 v26, v26, v27, v28
  v_max3_f32 v29, v29, v30, v143
  v_max_f32 v27, v26, v29
  v_max_f32 v26, v26, v29
  s_nop 1
  v_permlane32_swap_b32 v26, v27
  v_max3_f32 v23, v26, v27, v23
  v_mul_f32 v24, s55, v23
  v_sub_f32 v31, v31, v24
  v_exp_f32 v22, v31
  v_fma_f32 v128, v128, s55, -v24
  v_fma_f32 v129, v129, s55, -v24
  v_fma_f32 v130, v130, s55, -v24
  v_fma_f32 v131, v131, s55, -v24
  ds_write_b32 v231, v22 offset:768
  v_fma_f32 v132, v132, s55, -v24
  v_fma_f32 v133, v133, s55, -v24
  v_exp_f32 v128, v128
  v_fma_f32 v134, v134, s55, -v24
  v_fma_f32 v135, v135, s55, -v24
  v_exp_f32 v129, v129
  v_fma_f32 v136, v136, s55, -v24
  v_fma_f32 v137, v137, s55, -v24
  v_exp_f32 v130, v130
  v_fma_f32 v138, v138, s55, -v24
  v_fma_f32 v139, v139, s55, -v24
  v_exp_f32 v131, v131
  v_fma_f32 v140, v140, s55, -v24
  v_fma_f32 v141, v141, s55, -v24
  v_exp_f32 v132, v132
  v_fma_f32 v142, v142, s55, -v24
  v_fma_f32 v143, v143, s55, -v24
  v_exp_f32 v133, v133
  s_add_u32 m0, s53, 13184
  s_waitcnt vmcnt(5)
  buffer_load_dwordx4 v1, s[20:23], s51 offen offset:128 nt lds
  v_exp_f32 v134, v134
  v_exp_f32 v135, v135
  v_exp_f32 v136, v136
  v_exp_f32 v137, v137
  v_exp_f32 v138, v138
  v_exp_f32 v139, v139
  v_cvt_pk_bf16_f32 v176, v128, v129
  v_exp_f32 v140, v140
  v_cvt_pk_bf16_f32 v177, v130, v131
  v_exp_f32 v141, v141
  v_cvt_pk_bf16_f32 v178, v132, v133
  v_exp_f32 v142, v142
  v_cvt_pk_bf16_f32 v179, v134, v135
  v_exp_f32 v143, v143
  v_cvt_pk_bf16_f32 v180, v136, v137
  s_waitcnt vmcnt(5)
  buffer_load_dwordx4 v2, s[20:23], s51 offen offset:2176 nt lds
  s_xor_b32 s51, s51, 0x54000
  v_fma_f32 v26, v25, v22, v128
  v_add_f32 v27, v130, v131
  v_add_f32 v28, v132, v133
  v_add_f32 v29, v134, v135
  v_add_f32 v26, v26, v129
  v_cvt_pk_bf16_f32 v181, v138, v139
  v_cvt_pk_bf16_f32 v182, v140, v141
  v_cvt_pk_bf16_f32 v183, v142, v143
  v_add_f32 v26, v26, v136
  v_accvgpr_write_b32 a48, v176
  v_add_f32 v27, v27, v137
  v_accvgpr_write_b32 a49, v177
  v_add_f32 v28, v28, v138
  v_accvgpr_write_b32 a50, v178
  v_add_f32 v29, v29, v139
  v_accvgpr_write_b32 a51, v179
  v_add_f32 v26, v26, v140
  v_accvgpr_write_b32 a52, v180
  v_add_f32 v27, v27, v141
  v_accvgpr_write_b32 a53, v181
  v_add_f32 v28, v28, v142
  v_accvgpr_write_b32 a54, v182
  v_add_f32 v29, v29, v143
  v_accvgpr_write_b32 a55, v183
  v_add_f32 v26, v26, v27
  v_add_f32 v28, v28, v29
  v_add_f32 v25, v26, v28
  ds_read_b128 v[144:147], v6 offset:24576
  ds_read_b128 v[148:151], v7 offset:24576
  ds_read_b128 v[152:155], v8 offset:24576
  ds_read_b128 v[156:159], v9 offset:24576
  ds_read_b128 v[160:163], v6 offset:25600
  ds_read_b128 v[164:167], v7 offset:25600
  ds_read_b128 v[168:171], v8 offset:25600
  ds_read_b128 v[172:175], v9 offset:25600
  s_add_u32 m0, s53, 16384
  s_waitcnt vmcnt(4)
  buffer_load_dwordx4 v1, s[20:23], s51 offen nt lds
  s_waitcnt lgkmcnt(4)
  v_mfma_f32_32x32x16_bf16 v[128:143], v[144:147], v[32:35], 0
  v_mfma_f32_32x32x16_bf16 v[128:143], v[148:151], v[36:39], v[128:143]
  v_mfma_f32_32x32x16_bf16 v[128:143], v[152:155], v[40:43], v[128:143]
  v_mfma_f32_32x32x16_bf16 v[128:143], v[156:159], v[44:47], v[128:143]
  s_waitcnt lgkmcnt(0)
  v_mfma_f32_32x32x16_bf16 v[128:143], v[160:163], v[48:51], v[128:143]
  v_mfma_f32_32x32x16_bf16 v[128:143], v[164:167], v[52:55], v[128:143]
  v_mfma_f32_32x32x16_bf16 v[128:143], v[168:171], v[56:59], v[128:143]
  v_mfma_f32_32x32x16_bf16 v[128:143], v[172:175], v[60:63], v[128:143]
  s_waitcnt vmcnt(4)
  buffer_load_dwordx4 v2, s[20:23], s51 offen offset:2048 nt lds
  v_mov_b32 v31, v24
  s_nop 8
  v_max3_f32 v26, v128, v129, v130
  v_max3_f32 v27, v131, v132, v133
  v_max3_f32 v28, v134, v135, v136
  v_max3_f32 v29, v137, v138, v139
  v_max3_f32 v30, v140, v141, v142
  v_max3_f32 v26, v26, v27, v28
  v_max3_f32 v29, v29, v30, v143
  v_max_f32 v27, v26, v29
  v_max_f32 v26, v26, v29
  s_nop 1
  v_permlane32_swap_b32 v26, v27
  v_max3_f32 v23, v26, v27, v23
  v_mul_f32 v24, s55, v23
  v_sub_f32 v31, v31, v24
  v_exp_f32 v22, v31
  v_fma_f32 v128, v128, s55, -v24
  v_fma_f32 v129, v129, s55, -v24
  v_fma_f32 v130, v130, s55, -v24
  v_fma_f32 v131, v131, s55, -v24
  ds_write_b32 v231, v22 offset:896
  v_fma_f32 v132, v132, s55, -v24
  v_fma_f32 v133, v133, s55, -v24
  v_exp_f32 v128, v128
  v_fma_f32 v134, v134, s55, -v24
  v_fma_f32 v135, v135, s55, -v24
  v_exp_f32 v129, v129
  v_fma_f32 v136, v136, s55, -v24
  v_fma_f32 v137, v137, s55, -v24
  v_exp_f32 v130, v130
  v_fma_f32 v138, v138, s55, -v24
  v_fma_f32 v139, v139, s55, -v24
  v_exp_f32 v131, v131
  v_fma_f32 v140, v140, s55, -v24
  v_fma_f32 v141, v141, s55, -v24
  v_exp_f32 v132, v132
  v_fma_f32 v142, v142, s55, -v24
  v_fma_f32 v143, v143, s55, -v24
  v_exp_f32 v133, v133
  s_add_u32 m0, s53, 17280
  s_waitcnt vmcnt(4)
  buffer_load_dwordx4 v1, s[20:23], s51 offen offset:128 nt lds
  v_exp_f32 v134, v134
  v_exp_f32 v135, v135
  v_exp_f32 v136, v136
  v_exp_f32 v137, v137
  v_exp_f32 v138, v138
  v_exp_f32 v139, v139
  v_cvt_pk_bf16_f32 v176, v128, v129
  v_exp_f32 v140, v140
  v_cvt_pk_bf16_f32 v177, v130, v131
  v_exp_f32 v141, v141
  v_cvt_pk_bf16_f32 v178, v132, v133
  v_exp_f32 v142, v142
  v_cvt_pk_bf16_f32 v179, v134, v135
  v_exp_f32 v143, v143
  v_cvt_pk_bf16_f32 v180, v136, v137
  v_fma_f32 v26, v25, v22, v128
  v_add_f32 v27, v130, v131
  v_add_f32 v28, v132, v133
  v_add_f32 v29, v134, v135
  v_add_f32 v26, v26, v129
  v_cvt_pk_bf16_f32 v181, v138, v139
  v_cvt_pk_bf16_f32 v182, v140, v141
  v_cvt_pk_bf16_f32 v183, v142, v143
  v_add_f32 v26, v26, v136
  v_accvgpr_write_b32 a56, v176
  v_add_f32 v27, v27, v137
  v_accvgpr_write_b32 a57, v177
  v_add_f32 v28, v28, v138
  v_accvgpr_write_b32 a58, v178
  v_add_f32 v29, v29, v139
  v_accvgpr_write_b32 a59, v179
  v_add_f32 v26, v26, v140
  v_accvgpr_write_b32 a60, v180
  v_add_f32 v27, v27, v141
  v_accvgpr_write_b32 a61, v181
  v_add_f32 v28, v28, v142
  v_accvgpr_write_b32 a62, v182
  v_add_f32 v29, v29, v143
  v_accvgpr_write_b32 a63, v183
  v_add_f32 v26, v26, v27
  v_add_f32 v28, v28, v29
  v_add_f32 v25, v26, v28
  s_waitcnt vmcnt(4)
  buffer_load_dwordx4 v2, s[20:23], s51 offen offset:2176 nt lds
  s_xor_b32 s51, s51, 16384
  ds_read_b128 v[144:147], v6
  ds_read_b128 v[148:151], v7
  ds_read_b128 v[152:155], v8
  ds_read_b128 v[156:159], v9
  ds_read_b128 v[160:163], v6 offset:1024
  ds_read_b128 v[164:167], v7 offset:1024
  ds_read_b128 v[168:171], v8 offset:1024
  ds_read_b128 v[172:175], v9 offset:1024
  s_add_u32 m0, s53, 20480
  s_waitcnt vmcnt(4)
  buffer_load_dwordx4 v1, s[20:23], s51 offen nt lds
  s_waitcnt lgkmcnt(4)
  v_mfma_f32_32x32x16_bf16 v[128:143], v[144:147], v[32:35], 0
  v_mfma_f32_32x32x16_bf16 v[128:143], v[148:151], v[36:39], v[128:143]
  v_mfma_f32_32x32x16_bf16 v[128:143], v[152:155], v[40:43], v[128:143]
  v_mfma_f32_32x32x16_bf16 v[128:143], v[156:159], v[44:47], v[128:143]
  s_waitcnt lgkmcnt(0)
  v_mfma_f32_32x32x16_bf16 v[128:143], v[160:163], v[48:51], v[128:143]
  v_mfma_f32_32x32x16_bf16 v[128:143], v[164:167], v[52:55], v[128:143]
  v_mfma_f32_32x32x16_bf16 v[128:143], v[168:171], v[56:59], v[128:143]
  v_mfma_f32_32x32x16_bf16 v[128:143], v[172:175], v[60:63], v[128:143]
  s_waitcnt vmcnt(4)
  buffer_load_dwordx4 v2, s[20:23], s51 offen offset:2048 nt lds
  v_mov_b32 v31, v24
  s_nop 8
  v_max3_f32 v26, v128, v129, v130
  v_max3_f32 v27, v131, v132, v133
  v_max3_f32 v28, v134, v135, v136
  v_max3_f32 v29, v137, v138, v139
  v_max3_f32 v30, v140, v141, v142
  v_max3_f32 v26, v26, v27, v28
  v_max3_f32 v29, v29, v30, v143
  v_max_f32 v27, v26, v29
  v_max_f32 v26, v26, v29
  s_nop 1
  v_permlane32_swap_b32 v26, v27
  v_max3_f32 v23, v26, v27, v23
  v_mul_f32 v24, s55, v23
  v_sub_f32 v31, v31, v24
  v_exp_f32 v22, v31
  v_fma_f32 v128, v128, s55, -v24
  v_fma_f32 v129, v129, s55, -v24
  v_fma_f32 v130, v130, s55, -v24
  v_fma_f32 v131, v131, s55, -v24
  ds_write_b32 v231, v22 offset:1024
  v_fma_f32 v132, v132, s55, -v24
  v_fma_f32 v133, v133, s55, -v24
  v_exp_f32 v128, v128
  v_fma_f32 v134, v134, s55, -v24
  v_fma_f32 v135, v135, s55, -v24
  v_exp_f32 v129, v129
  v_fma_f32 v136, v136, s55, -v24
  v_fma_f32 v137, v137, s55, -v24
  v_exp_f32 v130, v130
  v_fma_f32 v138, v138, s55, -v24
  v_fma_f32 v139, v139, s55, -v24
  v_exp_f32 v131, v131
  v_fma_f32 v140, v140, s55, -v24
  v_fma_f32 v141, v141, s55, -v24
  v_exp_f32 v132, v132
  v_fma_f32 v142, v142, s55, -v24
  v_fma_f32 v143, v143, s55, -v24
  v_exp_f32 v133, v133
  s_add_u32 m0, s53, 21376
  s_waitcnt vmcnt(4)
  buffer_load_dwordx4 v1, s[20:23], s51 offen offset:128 nt lds
  v_exp_f32 v134, v134
  v_exp_f32 v135, v135
  v_exp_f32 v136, v136
  v_exp_f32 v137, v137
  v_exp_f32 v138, v138
  v_exp_f32 v139, v139
  v_cvt_pk_bf16_f32 v176, v128, v129
  v_exp_f32 v140, v140
  v_cvt_pk_bf16_f32 v177, v130, v131
  v_exp_f32 v141, v141
  v_cvt_pk_bf16_f32 v178, v132, v133
  v_exp_f32 v142, v142
  v_cvt_pk_bf16_f32 v179, v134, v135
  v_exp_f32 v143, v143
  v_cvt_pk_bf16_f32 v180, v136, v137
  v_fma_f32 v26, v25, v22, v128
  v_add_f32 v27, v130, v131
  v_add_f32 v28, v132, v133
  v_add_f32 v29, v134, v135
  v_add_f32 v26, v26, v129
  v_cvt_pk_bf16_f32 v181, v138, v139
  v_cvt_pk_bf16_f32 v182, v140, v141
  v_cvt_pk_bf16_f32 v183, v142, v143
  v_add_f32 v26, v26, v136
  v_accvgpr_write_b32 a64, v176
  v_add_f32 v27, v27, v137
  v_accvgpr_write_b32 a65, v177
  v_add_f32 v28, v28, v138
  v_accvgpr_write_b32 a66, v178
  v_add_f32 v29, v29, v139
  v_accvgpr_write_b32 a67, v179
  v_add_f32 v26, v26, v140
  v_accvgpr_write_b32 a68, v180
  v_add_f32 v27, v27, v141
  v_accvgpr_write_b32 a69, v181
  v_add_f32 v28, v28, v142
  v_accvgpr_write_b32 a70, v182
  v_add_f32 v29, v29, v143
  v_accvgpr_write_b32 a71, v183
  v_add_f32 v26, v26, v27
  v_add_f32 v28, v28, v29
  v_add_f32 v25, v26, v28
  s_waitcnt vmcnt(4)
  buffer_load_dwordx4 v2, s[20:23], s51 offen offset:2176 nt lds
  s_xor_b32 s51, s51, 0x14000
  ds_read_b128 v[144:147], v6 offset:8192
  ds_read_b128 v[148:151], v7 offset:8192
  ds_read_b128 v[152:155], v8 offset:8192
  ds_read_b128 v[156:159], v9 offset:8192
  ds_read_b128 v[160:163], v6 offset:9216
  ds_read_b128 v[164:167], v7 offset:9216
  ds_read_b128 v[168:171], v8 offset:9216
  ds_read_b128 v[172:175], v9 offset:9216
  s_waitcnt lgkmcnt(4)
  v_mfma_f32_32x32x16_bf16 v[128:143], v[144:147], v[32:35], 0
  v_mfma_f32_32x32x16_bf16 v[128:143], v[148:151], v[36:39], v[128:143]
  v_mfma_f32_32x32x16_bf16 v[128:143], v[152:155], v[40:43], v[128:143]
  v_mfma_f32_32x32x16_bf16 v[128:143], v[156:159], v[44:47], v[128:143]
  s_add_u32 m0, s53, 24576
  s_waitcnt vmcnt(4)
  buffer_load_dwordx4 v1, s[20:23], s51 offen nt lds
  s_cmp_eq_u32 s63, 9
  s_cbranch_scc0 1f
  global_load_dword v255, v254, s[16:17] sc1
1:
  s_waitcnt lgkmcnt(0)
  v_mfma_f32_32x32x16_bf16 v[128:143], v[160:163], v[48:51], v[128:143]
  v_mfma_f32_32x32x16_bf16 v[128:143], v[164:167], v[52:55], v[128:143]
  v_mfma_f32_32x32x16_bf16 v[128:143], v[168:171], v[56:59], v[128:143]
  v_mfma_f32_32x32x16_bf16 v[128:143], v[172:175], v[60:63], v[128:143]
  s_waitcnt vmcnt(4)
  buffer_load_dwordx4 v2, s[20:23], s51 offen offset:2048 nt lds
  v_mov_b32 v31, v24
  s_nop 8
  v_max3_f32 v26, v128, v129, v130
  v_max3_f32 v27, v131, v132, v133
  v_max3_f32 v28, v134, v135, v136
  v_max3_f32 v29, v137, v138, v139
  v_max3_f32 v30, v140, v141, v142
  v_max3_f32 v26, v26, v27, v28
  v_max3_f32 v29, v29, v30, v143
  v_max_f32 v27, v26, v29
  v_max_f32 v26, v26, v29
  s_nop 1
  v_permlane32_swap_b32 v26, v27
  v_max3_f32 v23, v26, v27, v23
  v_mul_f32 v24, s55, v23
  v_sub_f32 v31, v31, v24
  v_exp_f32 v22, v31
  v_fma_f32 v128, v128, s55, -v24
  v_fma_f32 v129, v129, s55, -v24
  v_fma_f32 v130, v130, s55, -v24
  v_fma_f32 v131, v131, s55, -v24
  ds_write_b32 v231, v22 offset:1152
  v_fma_f32 v132, v132, s55, -v24
  v_fma_f32 v133, v133, s55, -v24
  v_exp_f32 v128, v128
  v_fma_f32 v134, v134, s55, -v24
  v_fma_f32 v135, v135, s55, -v24
  v_exp_f32 v129, v129
  v_fma_f32 v136, v136, s55, -v24
  v_fma_f32 v137, v137, s55, -v24
  v_exp_f32 v130, v130
  v_fma_f32 v138, v138, s55, -v24
  v_fma_f32 v139, v139, s55, -v24
  v_exp_f32 v131, v131
  v_fma_f32 v140, v140, s55, -v24
  v_fma_f32 v141, v141, s55, -v24
  v_exp_f32 v132, v132
  v_fma_f32 v142, v142, s55, -v24
  v_fma_f32 v143, v143, s55, -v24
  v_exp_f32 v133, v133
  s_add_u32 m0, s53, 25472
  s_waitcnt vmcnt(4)
  buffer_load_dwordx4 v1, s[20:23], s51 offen offset:128 nt lds
  v_exp_f32 v134, v134
  v_exp_f32 v135, v135
  v_exp_f32 v136, v136
  v_exp_f32 v137, v137
  v_exp_f32 v138, v138
  v_exp_f32 v139, v139
  v_cvt_pk_bf16_f32 v176, v128, v129
  v_exp_f32 v140, v140
  v_cvt_pk_bf16_f32 v177, v130, v131
  v_exp_f32 v141, v141
  v_cvt_pk_bf16_f32 v178, v132, v133
  v_exp_f32 v142, v142
  v_cvt_pk_bf16_f32 v179, v134, v135
  v_exp_f32 v143, v143
  v_cvt_pk_bf16_f32 v180, v136, v137
  v_fma_f32 v26, v25, v22, v128
  v_add_f32 v27, v130, v131
  v_add_f32 v28, v132, v133
  v_add_f32 v29, v134, v135
  v_add_f32 v26, v26, v129
  v_cvt_pk_bf16_f32 v181, v138, v139
  v_cvt_pk_bf16_f32 v182, v140, v141
  v_cvt_pk_bf16_f32 v183, v142, v143
  v_add_f32 v26, v26, v136
  v_accvgpr_write_b32 a72, v176
  v_add_f32 v27, v27, v137
  v_accvgpr_write_b32 a73, v177
  v_add_f32 v28, v28, v138
  v_accvgpr_write_b32 a74, v178
  v_add_f32 v29, v29, v139
  v_accvgpr_write_b32 a75, v179
  v_add_f32 v26, v26, v140
  v_accvgpr_write_b32 a76, v180
  v_add_f32 v27, v27, v141
  v_accvgpr_write_b32 a77, v181
  v_add_f32 v28, v28, v142
  v_accvgpr_write_b32 a78, v182
  v_add_f32 v29, v29, v143
  v_accvgpr_write_b32 a79, v183
  v_add_f32 v26, v26, v27
  v_add_f32 v28, v28, v29
  v_add_f32 v25, v26, v28
  s_waitcnt vmcnt(4)
  buffer_load_dwordx4 v2, s[20:23], s51 offen offset:2176 nt lds
  s_xor_b32 s51, s51, 16384
  s_add_u32 m0, s53, 28672
  s_waitcnt vmcnt(4)
  buffer_load_dwordx4 v1, s[20:23], s51 offen nt lds
  ds_read_b128 v[144:147], v6 offset:16384
  ds_read_b128 v[148:151], v7 offset:16384
  ds_read_b128 v[152:155], v8 offset:16384
  ds_read_b128 v[156:159], v9 offset:16384
  ds_read_b128 v[160:163], v6 offset:17408
  ds_read_b128 v[164:167], v7 offset:17408
  ds_read_b128 v[168:171], v8 offset:17408
  ds_read_b128 v[172:175], v9 offset:17408
  s_waitcnt lgkmcnt(4)
  v_mfma_f32_32x32x16_bf16 v[128:143], v[144:147], v[32:35], 0
  v_mfma_f32_32x32x16_bf16 v[128:143], v[148:151], v[36:39], v[128:143]
  v_mfma_f32_32x32x16_bf16 v[128:143], v[152:155], v[40:43], v[128:143]
  v_mfma_f32_32x32x16_bf16 v[128:143], v[156:159], v[44:47], v[128:143]
  s_waitcnt vmcnt(4)
  buffer_load_dwordx4 v2, s[20:23], s51 offen offset:2048 nt lds
  s_cmp_eq_u32 s63, 10
  s_cbranch_scc0 1f
  global_load_dword v255, v254, s[16:17] sc1
1:
  s_waitcnt lgkmcnt(0)
  v_mfma_f32_32x32x16_bf16 v[128:143], v[160:163], v[48:51], v[128:143]
  v_mfma_f32_32x32x16_bf16 v[128:143], v[164:167], v[52:55], v[128:143]
  v_mfma_f32_32x32x16_bf16 v[128:143], v[168:171], v[56:59], v[128:143]
  v_mfma_f32_32x32x16_bf16 v[128:143], v[172:175], v[60:63], v[128:143]
  s_add_u32 m0, s53, 29568
  s_waitcnt vmcnt(4)
  buffer_load_dwordx4 v1, s[20:23], s51 offen offset:128 nt lds
  v_mov_b32 v31, v24
  s_nop 7
  v_max3_f32 v26, v128, v129, v130
  v_max3_f32 v27, v131, v132, v133
  v_max3_f32 v28, v134, v135, v136
  v_max3_f32 v29, v137, v138, v139
  v_max3_f32 v30, v140, v141, v142
  v_max3_f32 v26, v26, v27, v28
  v_max3_f32 v29, v29, v30, v143
  v_max_f32 v27, v26, v29
  v_max_f32 v26, v26, v29
  s_nop 1
  v_permlane32_swap_b32 v26, v27
  v_max3_f32 v23, v26, v27, v23
  v_mul_f32 v24, s55, v23
  v_sub_f32 v31, v31, v24
  v_exp_f32 v22, v31
  v_fma_f32 v128, v128, s55, -v24
  v_fma_f32 v129, v129, s55, -v24
  v_fma_f32 v130, v130, s55, -v24
  v_fma_f32 v131, v131, s55, -v24
  ds_write_b32 v231, v22 offset:1280
  v_fma_f32 v132, v132, s55, -v24
  v_fma_f32 v133, v133, s55, -v24
  v_exp_f32 v128, v128
  v_fma_f32 v134, v134, s55, -v24
  v_fma_f32 v135, v135, s55, -v24
  v_exp_f32 v129, v129
  v_fma_f32 v136, v136, s55, -v24
  v_fma_f32 v137, v137, s55, -v24
  v_exp_f32 v130, v130
  v_fma_f32 v138, v138, s55, -v24
  v_fma_f32 v139, v139, s55, -v24
  v_exp_f32 v131, v131
  v_fma_f32 v140, v140, s55, -v24
  v_fma_f32 v141, v141, s55, -v24
  v_exp_f32 v132, v132
  v_fma_f32 v142, v142, s55, -v24
  v_fma_f32 v143, v143, s55, -v24
  v_exp_f32 v133, v133
  s_waitcnt vmcnt(4)
  buffer_load_dwordx4 v2, s[20:23], s51 offen offset:2176 nt lds
  s_xor_b32 s51, s51, 0xd4000
  v_exp_f32 v134, v134
  v_exp_f32 v135, v135
  v_exp_f32 v136, v136
  v_exp_f32 v137, v137
  v_exp_f32 v138, v138
  v_exp_f32 v139, v139
  v_cvt_pk_bf16_f32 v176, v128, v129
  v_exp_f32 v140, v140
  v_cvt_pk_bf16_f32 v177, v130, v131
  v_exp_f32 v141, v141
  v_cvt_pk_bf16_f32 v178, v132, v133
  v_exp_f32 v142, v142
  v_cvt_pk_bf16_f32 v179, v134, v135
  v_exp_f32 v143, v143
  v_cvt_pk_bf16_f32 v180, v136, v137
  v_fma_f32 v26, v25, v22, v128
  v_add_f32 v27, v130, v131
  v_add_f32 v28, v132, v133
  v_add_f32 v29, v134, v135
  v_add_f32 v26, v26, v129
  v_cvt_pk_bf16_f32 v181, v138, v139
  v_cvt_pk_bf16_f32 v182, v140, v141
  v_cvt_pk_bf16_f32 v183, v142, v143
  v_add_f32 v26, v26, v136
  v_accvgpr_write_b32 a80, v176
  v_add_f32 v27, v27, v137
  v_accvgpr_write_b32 a81, v177
  v_add_f32 v28, v28, v138
  v_accvgpr_write_b32 a82, v178
  v_add_f32 v29, v29, v139
  v_accvgpr_write_b32 a83, v179
  v_add_f32 v26, v26, v140
  v_accvgpr_write_b32 a84, v180
  v_add_f32 v27, v27, v141
  v_accvgpr_write_b32 a85, v181
  v_add_f32 v28, v28, v142
  v_accvgpr_write_b32 a86, v182
  v_add_f32 v29, v29, v143
  v_accvgpr_write_b32 a87, v183
  v_add_f32 v26, v26, v27
  v_add_f32 v28, v28, v29
  v_add_f32 v25, v26, v28
  s_mov_b32 m0, s53
  s_waitcnt vmcnt(4)
  buffer_load_dwordx4 v1, s[20:23], s51 offen nt lds
  s_waitcnt vmcnt(4)
  buffer_load_dwordx4 v2, s[20:23], s51 offen offset:2048 nt lds
  s_add_u32 m0, s53, 896
  s_waitcnt vmcnt(4)
  buffer_load_dwordx4 v1, s[20:23], s51 offen offset:128 nt lds
  s_waitcnt vmcnt(4)
  buffer_load_dwordx4 v2, s[20:23], s51 offen offset:2176 nt lds
  s_xor_b32 s51, s51, 16384
  s_add_u32 m0, s53, 4096
  s_waitcnt vmcnt(4)
  buffer_load_dwordx4 v1, s[20:23], s51 offen nt lds
  ds_read_b128 v[144:147], v6 offset:24576
  ds_read_b128 v[148:151], v7 offset:24576
  ds_read_b128 v[152:155], v8 offset:24576
  ds_read_b128 v[156:159], v9 offset:24576
  ds_read_b128 v[160:163], v6 offset:25600
  ds_read_b128 v[164:167], v7 offset:25600
  ds_read_b128 v[168:171], v8 offset:25600
  ds_read_b128 v[172:175], v9 offset:25600
  s_waitcnt lgkmcnt(4)
  v_mfma_f32_32x32x16_bf16 v[128:143], v[144:147], v[32:35], 0
  v_mfma_f32_32x32x16_bf16 v[128:143], v[148:151], v[36:39], v[128:143]
  v_mfma_f32_32x32x16_bf16 v[128:143], v[152:155], v[40:43], v[128:143]
  v_mfma_f32_32x32x16_bf16 v[128:143], v[156:159], v[44:47], v[128:143]
  s_waitcnt vmcnt(4)
  buffer_load_dwordx4 v2, s[20:23], s51 offen offset:2048 nt lds
  s_waitcnt lgkmcnt(0)
  v_mfma_f32_32x32x16_bf16 v[128:143], v[160:163], v[48:51], v[128:143]
  v_mfma_f32_32x32x16_bf16 v[128:143], v[164:167], v[52:55], v[128:143]
  v_mfma_f32_32x32x16_bf16 v[128:143], v[168:171], v[56:59], v[128:143]
  v_mfma_f32_32x32x16_bf16 v[128:143], v[172:175], v[60:63], v[128:143]
  v_mov_b32 v31, v24
  s_nop 10
  v_max3_f32 v26, v128, v129, v130
  v_max3_f32 v27, v131, v132, v133
  v_max3_f32 v28, v134, v135, v136
  v_max3_f32 v29, v137, v138, v139
  v_max3_f32 v30, v140, v141, v142
  v_max3_f32 v26, v26, v27, v28
  v_max3_f32 v29, v29, v30, v143
  v_max_f32 v27, v26, v29
  v_max_f32 v26, v26, v29
  s_nop 1
  v_permlane32_swap_b32 v26, v27
  v_max3_f32 v23, v26, v27, v23
  v_mul_f32 v24, s55, v23
  v_sub_f32 v31, v31, v24
  v_exp_f32 v22, v31
  v_fma_f32 v128, v128, s55, -v24
  v_fma_f32 v129, v129, s55, -v24
  v_fma_f32 v130, v130, s55, -v24
  v_fma_f32 v131, v131, s55, -v24
  ds_write_b32 v231, v22 offset:1408
  s_add_u32 m0, s53, 4992
  s_waitcnt vmcnt(4)
  buffer_load_dwordx4 v1, s[20:23], s51 offen offset:128 nt lds
  v_fma_f32 v132, v132, s55, -v24
  v_fma_f32 v133, v133, s55, -v24
  v_exp_f32 v128, v128
  v_fma_f32 v134, v134, s55, -v24
  v_fma_f32 v135, v135, s55, -v24
  v_exp_f32 v129, v129
  v_fma_f32 v136, v136, s55, -v24
  v_fma_f32 v137, v137, s55, -v24
  v_exp_f32 v130, v130
  v_fma_f32 v138, v138, s55, -v24
  v_fma_f32 v139, v139, s55, -v24
  v_exp_f32 v131, v131
  v_fma_f32 v140, v140, s55, -v24
  v_fma_f32 v141, v141, s55, -v24
  v_exp_f32 v132, v132
  v_fma_f32 v142, v142, s55, -v24
  v_fma_f32 v143, v143, s55, -v24
  v_exp_f32 v133, v133
  v_exp_f32 v134, v134
  v_exp_f32 v135, v135
  v_exp_f32 v136, v136
  v_exp_f32 v137, v137
  v_exp_f32 v138, v138
  v_exp_f32 v139, v139
  v_cvt_pk_bf16_f32 v176, v128, v129
  v_exp_f32 v140, v140
  v_cvt_pk_bf16_f32 v177, v130, v131
  v_exp_f32 v141, v141
  v_cvt_pk_bf16_f32 v178, v132, v133
  v_exp_f32 v142, v142
  v_cvt_pk_bf16_f32 v179, v134, v135
  v_exp_f32 v143, v143
  v_cvt_pk_bf16_f32 v180, v136, v137
  s_waitcnt vmcnt(4)
  buffer_load_dwordx4 v2, s[20:23], s51 offen offset:2176 nt lds
  s_xor_b32 s51, s51, 0x14000
  v_fma_f32 v26, v25, v22, v128
  v_add_f32 v27, v130, v131
  v_add_f32 v28, v132, v133
  v_add_f32 v29, v134, v135
  v_add_f32 v26, v26, v129
  v_cvt_pk_bf16_f32 v181, v138, v139
  v_cvt_pk_bf16_f32 v182, v140, v141
  v_cvt_pk_bf16_f32 v183, v142, v143
  v_add_f32 v26, v26, v136
  v_accvgpr_write_b32 a88, v176
  v_add_f32 v27, v27, v137
  v_accvgpr_write_b32 a89, v177
  v_add_f32 v28, v28, v138
  v_accvgpr_write_b32 a90, v178
  v_add_f32 v29, v29, v139
  v_accvgpr_write_b32 a91, v179
  v_add_f32 v26, v26, v140
  v_accvgpr_write_b32 a92, v180
  v_add_f32 v27, v27, v141
  v_accvgpr_write_b32 a93, v181
  v_add_f32 v28, v28, v142
  v_accvgpr_write_b32 a94, v182
  v_add_f32 v29, v29, v143
  v_accvgpr_write_b32 a95, v183
  v_add_f32 v26, v26, v27
  v_add_f32 v28, v28, v29
  v_add_f32 v25, v26, v28
  s_add_u32 m0, s53, 8192
  s_waitcnt vmcnt(4)
  buffer_load_dwordx4 v1, s[20:23], s51 offen nt lds
  s_waitcnt vmcnt(4)
  buffer_load_dwordx4 v2, s[20:23], s51 offen offset:2048 nt lds
  s_add_u32 m0, s53, 9088
  s_waitcnt vmcnt(4)
  buffer_load_dwordx4 v1, s[20:23], s51 offen offset:128 nt lds
  s_waitcnt vmcnt(4)
  buffer_load_dwordx4 v2, s[20:23], s51 offen offset:2176 nt lds
  s_xor_b32 s51, s51, 16384
  s_add_u32 m0, s53, 12288
  s_waitcnt vmcnt(4)
  buffer_load_dwordx4 v1, s[20:23], s51 offen nt lds
  ds_read_b128 v[144:147], v6
  ds_read_b128 v[148:151], v7
  ds_read_b128 v[152:155], v8
  ds_read_b128 v[156:159], v9
  ds_read_b128 v[160:163], v6 offset:1024
  ds_read_b128 v[164:167], v7 offset:1024
  ds_read_b128 v[168:171], v8 offset:1024
  ds_read_b128 v[172:175], v9 offset:1024
  s_waitcnt vmcnt(4)
  buffer_load_dwordx4 v2, s[20:23], s51 offen offset:2048 nt lds
  s_waitcnt lgkmcnt(4)
  v_mfma_f32_32x32x16_bf16 v[128:143], v[144:147], v[32:35], 0
  v_mfma_f32_32x32x16_bf16 v[128:143], v[148:151], v[36:39], v[128:143]
  v_mfma_f32_32x32x16_bf16 v[128:143], v[152:155], v[40:43], v[128:143]
  v_mfma_f32_32x32x16_bf16 v[128:143], v[156:159], v[44:47], v[128:143]
  s_cmp_lt_u32 s63, 9
  s_cbranch_scc1 2f
  s_mov_b32 s69, 0x200000
1:
  v_cmp_ne_u32 vcc, 1, v255
  s_sub_u32 s69, s69, 1
  s_cbranch_vccz 2f
  s_cmp_eq_u32 s69, 0
  s_cbranch_scc1 2f
  global_load_dword v255, v254, s[16:17] sc1
  s_waitcnt vmcnt(0)
  s_branch 1b
2:
  v_cmp_gt_u32 s[92:93], 32, v0
  v_lshlrev_b32 v254, 2, v0
  v_mov_b32 v26, 512
  v_cndmask_b32 v254, v26, v254, s[92:93]
  v_cndmask_b32 v247, 0, 1, s[92:93]
  v_subrev_u32 v26, 32, v0
  v_mul_u32_u24 v26, 342, v26
  v_lshrrev_b32 v26, 10, v26
  v_add_u32 v26, 1, v26
  v_cndmask_b32 v248, v26, 0, s[92:93]
  s_and_b32 s60, s2, 7
  v_lshlrev_b32 v249, 14, v0
  v_add_u32 v249, 5243008, v249
  v_cmp_ne_u32 s[92:93], s60, v0
  v_mov_b32 v26, 0x40000000
  s_movk_i32 s97, 512
  v_cndmask_b32 v249, v26, v249, s[92:93]
  s_lshr_b32 s96, s2, 3
  s_cmp_eq_u32 s3, 3
  s_cselect_b32 s96, s96, 0x100
  s_mov_b64 vcc, 0
  s_barrier
  s_waitcnt lgkmcnt(0)
  v_mfma_f32_32x32x16_bf16 v[128:143], v[160:163], v[48:51], v[128:143]
  v_mfma_f32_32x32x16_bf16 v[128:143], v[164:167], v[52:55], v[128:143]
  v_mfma_f32_32x32x16_bf16 v[128:143], v[168:171], v[56:59], v[128:143]
  v_mfma_f32_32x32x16_bf16 v[128:143], v[172:175], v[60:63], v[128:143]
  s_add_u32 m0, s53, 13184
  s_waitcnt vmcnt(4)
  buffer_load_dwordx4 v1, s[20:23], s51 offen offset:128 nt lds
  v_mov_b32 v31, v24
  s_nop 7
  v_max3_f32 v26, v128, v129, v130
  v_max3_f32 v27, v131, v132, v133
  v_max3_f32 v28, v134, v135, v136
  v_max3_f32 v29, v137, v138, v139
  v_max3_f32 v30, v140, v141, v142
  v_max3_f32 v26, v26, v27, v28
  v_max3_f32 v29, v29, v30, v143
  v_max_f32 v27, v26, v29
  v_max_f32 v26, v26, v29
  s_nop 1
  v_permlane32_swap_b32 v26, v27
  v_max3_f32 v23, v26, v27, v23
  v_mul_f32 v24, s55, v23
  v_sub_f32 v31, v31, v24
  v_exp_f32 v22, v31
  v_fma_f32 v128, v128, s55, -v24
  v_fma_f32 v129, v129, s55, -v24
  v_fma_f32 v130, v130, s55, -v24
  v_fma_f32 v131, v131, s55, -v24
  ds_write_b32 v231, v22 offset:1536
  v_fma_f32 v132, v132, s55, -v24
  v_fma_f32 v133, v133, s55, -v24
  v_exp_f32 v128, v128
  v_fma_f32 v134, v134, s55, -v24
  v_fma_f32 v135, v135, s55, -v24
  v_exp_f32 v129, v129
  v_fma_f32 v136, v136, s55, -v24
  v_fma_f32 v137, v137, s55, -v24
  v_exp_f32 v130, v130
  v_fma_f32 v138, v138, s55, -v24
  v_fma_f32 v139, v139, s55, -v24
  v_exp_f32 v131, v131
  v_fma_f32 v140, v140, s55, -v24
  v_fma_f32 v141, v141, s55, -v24
  v_exp_f32 v132, v132
  v_fma_f32 v142, v142, s55, -v24
  v_fma_f32 v143, v143, s55, -v24
  v_exp_f32 v133, v133
  s_waitcnt vmcnt(4)
  buffer_load_dwordx4 v2, s[20:23], s51 offen offset:2176 nt lds
  s_xor_b32 s51, s51, 0x54000
  v_exp_f32 v134, v134
  v_exp_f32 v135, v135
  v_exp_f32 v136, v136
  v_exp_f32 v137, v137
  v_exp_f32 v138, v138
  v_exp_f32 v139, v139
  v_cvt_pk_bf16_f32 v176, v128, v129
  v_exp_f32 v140, v140
  v_cvt_pk_bf16_f32 v177, v130, v131
  v_exp_f32 v141, v141
  v_cvt_pk_bf16_f32 v178, v132, v133
  v_exp_f32 v142, v142
  v_cvt_pk_bf16_f32 v179, v134, v135
  v_exp_f32 v143, v143
  v_cvt_pk_bf16_f32 v180, v136, v137
  v_fma_f32 v26, v25, v22, v128
  v_add_f32 v27, v130, v131
  v_add_f32 v28, v132, v133
  v_add_f32 v29, v134, v135
  v_add_f32 v26, v26, v129
  v_cvt_pk_bf16_f32 v181, v138, v139
  v_cvt_pk_bf16_f32 v182, v140, v141
  v_cvt_pk_bf16_f32 v183, v142, v143
  v_add_f32 v26, v26, v136
  v_accvgpr_write_b32 a96, v176
  v_add_f32 v27, v27, v137
  v_accvgpr_write_b32 a97, v177
  v_add_f32 v28, v28, v138
  v_accvgpr_write_b32 a98, v178
  v_add_f32 v29, v29, v139
  v_accvgpr_write_b32 a99, v179
  v_add_f32 v26, v26, v140
  v_accvgpr_write_b32 a100, v180
  v_add_f32 v27, v27, v141
  v_accvgpr_write_b32 a101, v181
  v_add_f32 v28, v28, v142
  v_accvgpr_write_b32 a102, v182
  v_add_f32 v29, v29, v143
  v_accvgpr_write_b32 a103, v183
  v_add_f32 v26, v26, v27
  v_add_f32 v28, v28, v29
  v_add_f32 v25, v26, v28
  s_add_u32 m0, s53, 16384
  s_waitcnt vmcnt(4)
  buffer_load_dwordx4 v1, s[20:23], s51 offen nt lds
  s_waitcnt vmcnt(4)
  buffer_load_dwordx4 v2, s[20:23], s51 offen offset:2048 nt lds
  s_add_u32 m0, s53, 17280
  s_waitcnt vmcnt(4)
  buffer_load_dwordx4 v1, s[20:23], s51 offen offset:128 nt lds
  s_waitcnt vmcnt(4)
  buffer_load_dwordx4 v2, s[20:23], s51 offen offset:2176 nt lds
  s_xor_b32 s51, s51, 16384
  s_waitcnt lgkmcnt(0)
  s_branch L_join
L_B:
  s_add_u32 m0, s53, 24576
  s_nop 0
  buffer_load_dwordx4 v1, s[20:23], s51 offen nt lds
  s_waitcnt vmcnt(17)
  v_perm_b32 v192, v132, v128, s56
  v_perm_b32 v193, v140, v136, s56
  v_perm_b32 v194, v148, v144, s56
  v_perm_b32 v195, v156, v152, s56
  v_perm_b32 v196, v132, v128, s57
  v_perm_b32 v197, v140, v136, s57
  v_mfma_f32_16x16x32_bf16 v[32:35], v[192:195], a[216:219], v[32:35]
  v_perm_b32 v198, v148, v144, s57
  v_perm_b32 v199, v156, v152, s57
  buffer_load_dwordx4 v2, s[20:23], s51 offen offset:2048 nt lds
  v_perm_b32 v200, v133, v129, s56
  v_perm_b32 v201, v141, v137, s56
  v_mfma_f32_16x16x32_bf16 v[36:39], v[196:199], a[216:219], v[36:39]
  v_perm_b32 v202, v149, v145, s56
  v_perm_b32 v203, v157, v153, s56
  v_perm_b32 v204, v133, v129, s57
  v_perm_b32 v205, v141, v137, s57
  v_mfma_f32_16x16x32_bf16 v[40:43], v[200:203], a[216:219], v[40:43]
  v_perm_b32 v206, v149, v145, s57
  v_perm_b32 v207, v157, v153, s57
  s_add_u32 m0, s53, 25472
  s_nop 0
  buffer_load_dwordx4 v1, s[20:23], s51 offen offset:128 nt lds
  v_perm_b32 v192, v134, v130, s56
  v_perm_b32 v193, v142, v138, s56
  v_mfma_f32_16x16x32_bf16 v[44:47], v[204:207], a[216:219], v[44:47]
  v_perm_b32 v194, v150, v146, s56
  v_perm_b32 v195, v158, v154, s56
  v_perm_b32 v196, v134, v130, s57
  v_perm_b32 v197, v142, v138, s57
  v_mfma_f32_16x16x32_bf16 v[48:51], v[192:195], a[216:219], v[48:51]
  v_perm_b32 v198, v150, v146, s57
  v_perm_b32 v199, v158, v154, s57
  buffer_load_dwordx4 v2, s[20:23], s51 offen offset:2176 nt lds
  s_xor_b32 s51, s51, 16384
  v_perm_b32 v200, v135, v131, s56
  v_perm_b32 v201, v143, v139, s56
  v_mfma_f32_16x16x32_bf16 v[52:55], v[196:199], a[216:219], v[52:55]
  v_perm_b32 v202, v151, v147, s56
  v_perm_b32 v203, v159, v155, s56
  v_perm_b32 v204, v135, v131, s57
  v_perm_b32 v205, v143, v139, s57
  v_mfma_f32_16x16x32_bf16 v[56:59], v[200:203], a[216:219], v[56:59]
  v_perm_b32 v206, v151, v147, s57
  v_perm_b32 v207, v159, v155, s57
  s_nop 1
  v_mfma_f32_16x16x32_bf16 v[60:63], v[204:207], a[216:219], v[60:63]
  s_add_u32 m0, s53, 28672
  s_nop 0
  buffer_load_dwordx4 v1, s[20:23], s51 offen nt lds
  s_waitcnt vmcnt(13)
  v_perm_b32 v192, v164, v160, s56
  v_perm_b32 v193, v172, v168, s56
  v_perm_b32 v194, v180, v176, s56
  v_perm_b32 v195, v188, v184, s56
  v_perm_b32 v196, v164, v160, s57
  v_perm_b32 v197, v172, v168, s57
  v_mfma_f32_16x16x32_bf16 v[32:35], v[192:195], a[220:223], v[32:35]
  v_perm_b32 v198, v180, v176, s57
  v_perm_b32 v199, v188, v184, s57
  buffer_load_dwordx4 v2, s[20:23], s51 offen offset:2048 nt lds
  v_perm_b32 v200, v165, v161, s56
  v_perm_b32 v201, v173, v169, s56
  v_mfma_f32_16x16x32_bf16 v[36:39], v[196:199], a[220:223], v[36:39]
  v_perm_b32 v202, v181, v177, s56
  v_perm_b32 v203, v189, v185, s56
  v_perm_b32 v204, v165, v161, s57
  v_perm_b32 v205, v173, v169, s57
  v_mfma_f32_16x16x32_bf16 v[40:43], v[200:203], a[220:223], v[40:43]
  v_perm_b32 v206, v181, v177, s57
  v_perm_b32 v207, v189, v185, s57
  s_add_u32 m0, s53, 29568
  s_nop 0
  buffer_load_dwordx4 v1, s[20:23], s51 offen offset:128 nt lds
  v_perm_b32 v192, v166, v162, s56
  v_perm_b32 v193, v174, v170, s56
  v_mfma_f32_16x16x32_bf16 v[44:47], v[204:207], a[220:223], v[44:47]
  v_perm_b32 v194, v182, v178, s56
  v_perm_b32 v195, v190, v186, s56
  v_perm_b32 v196, v166, v162, s57
  v_perm_b32 v197, v174, v170, s57
  v_mfma_f32_16x16x32_bf16 v[48:51], v[192:195], a[220:223], v[48:51]
  v_perm_b32 v198, v182, v178, s57
  v_perm_b32 v199, v190, v186, s57
  buffer_load_dwordx4 v2, s[20:23], s51 offen offset:2176 nt lds
  s_xor_b32 s51, s51, 0xd4000
  v_perm_b32 v200, v167, v163, s56
  v_perm_b32 v201, v175, v171, s56
  v_mfma_f32_16x16x32_bf16 v[52:55], v[196:199], a[220:223], v[52:55]
  v_perm_b32 v202, v183, v179, s56
  v_perm_b32 v203, v191, v187, s56
  v_perm_b32 v204, v167, v163, s57
  v_perm_b32 v205, v175, v171, s57
  v_mfma_f32_16x16x32_bf16 v[56:59], v[200:203], a[220:223], v[56:59]
  v_perm_b32 v206, v183, v179, s57
  v_perm_b32 v207, v191, v187, s57
  s_nop 1
  v_mfma_f32_16x16x32_bf16 v[60:63], v[204:207], a[220:223], v[60:63]
  s_mov_b32 m0, s53
  s_nop 0
  buffer_load_dwordx4 v1, s[20:23], s51 offen nt lds
  s_waitcnt vmcnt(9)
  v_perm_b32 v192, v68, v64, s56
  v_perm_b32 v193, v76, v72, s56
  v_perm_b32 v194, v84, v80, s56
  v_perm_b32 v195, v92, v88, s56
  v_perm_b32 v196, v68, v64, s57
  v_perm_b32 v197, v76, v72, s57
  v_mfma_f32_16x16x32_bf16 v[32:35], v[192:195], a[224:227], v[32:35]
  v_perm_b32 v198, v84, v80, s57
  v_perm_b32 v199, v92, v88, s57
  buffer_load_dwordx4 v2, s[20:23], s51 offen offset:2048 nt lds
  v_perm_b32 v200, v69, v65, s56
  v_perm_b32 v201, v77, v73, s56
  v_mfma_f32_16x16x32_bf16 v[36:39], v[196:199], a[224:227], v[36:39]
  v_perm_b32 v202, v85, v81, s56
  v_perm_b32 v203, v93, v89, s56
  v_perm_b32 v204, v69, v65, s57
  v_perm_b32 v205, v77, v73, s57
  v_mfma_f32_16x16x32_bf16 v[40:43], v[200:203], a[224:227], v[40:43]
  v_perm_b32 v206, v85, v81, s57
  v_perm_b32 v207, v93, v89, s57
  s_add_u32 m0, s53, 896
  s_nop 0
  buffer_load_dwordx4 v1, s[20:23], s51 offen offset:128 nt lds
  v_perm_b32 v192, v70, v66, s56
  v_perm_b32 v193, v78, v74, s56
  v_mfma_f32_16x16x32_bf16 v[44:47], v[204:207], a[224:227], v[44:47]
  v_perm_b32 v194, v86, v82, s56
  v_perm_b32 v195, v94, v90, s56
  v_perm_b32 v196, v70, v66, s57
  v_perm_b32 v197, v78, v74, s57
  v_mfma_f32_16x16x32_bf16 v[48:51], v[192:195], a[224:227], v[48:51]
  v_perm_b32 v198, v86, v82, s57
  v_perm_b32 v199, v94, v90, s57
  buffer_load_dwordx4 v2, s[20:23], s51 offen offset:2176 nt lds
  s_xor_b32 s51, s51, 16384
  v_perm_b32 v200, v71, v67, s56
  v_perm_b32 v201, v79, v75, s56
  v_mfma_f32_16x16x32_bf16 v[52:55], v[196:199], a[224:227], v[52:55]
  v_perm_b32 v202, v87, v83, s56
  v_perm_b32 v203, v95, v91, s56
  v_perm_b32 v204, v71, v67, s57
  v_perm_b32 v205, v79, v75, s57
  v_mfma_f32_16x16x32_bf16 v[56:59], v[200:203], a[224:227], v[56:59]
  v_perm_b32 v206, v87, v83, s57
  v_perm_b32 v207, v95, v91, s57
  s_nop 1
  v_mfma_f32_16x16x32_bf16 v[60:63], v[204:207], a[224:227], v[60:63]
  s_add_u32 m0, s53, 4096
  s_waitcnt vmcnt(11)
  buffer_load_dwordx4 v1, s[20:23], s51 offen nt lds
  v_xor_b32 v26, 16384, v21
  s_nop 6
  ds_write_b64 v21, v[34:35]
  ds_write_b64 v21, v[38:39] offset:512
  ds_write_b64 v21, v[42:43] offset:1024
  ds_write_b64 v21, v[46:47] offset:1536
  ds_write_b64 v21, v[50:51] offset:2048
  ds_write_b64 v21, v[54:55] offset:2560
  ds_write_b64 v21, v[58:59] offset:3072
  ds_write_b64 v21, v[62:63] offset:3584
  v_and_b32 v27, 15, v0
  v_lshrrev_b32 v28, 4, v0
  v_lshlrev_b32 v28, 2, v28
  v_xor_b32 v28, s59, v28
  v_xor_b32 v28, v28, v27
  v_lshlrev_b32 v28, 4, v28
  v_lshl_add_u32 v28, v27, 8, v28
  s_and_b32 s60, s3, 1
  s_lshl_b32 s60, s60, 13
  s_add_u32 s60, s60, 135168
  v_add_u32 v28, s60, v28
  v_xor_b32 v29, 16, v28
  s_waitcnt lgkmcnt(0)
  s_barrier
  ds_read_b64 v[64:65], v26
  ds_read_b64 v[66:67], v26 offset:512
  ds_read_b64 v[68:69], v26 offset:1024
  ds_read_b64 v[70:71], v26 offset:1536
  ds_read_b64 v[72:73], v26 offset:2048
  ds_read_b64 v[74:75], v26 offset:2560
  ds_read_b64 v[76:77], v26 offset:3072
  ds_read_b64 v[78:79], v26 offset:3584
  s_waitcnt vmcnt(11)
  buffer_load_dwordx4 v2, s[20:23], s51 offen offset:2048 nt lds
  s_waitcnt lgkmcnt(7)
  v_add_f32 v64, v64, v32
  v_add_f32 v65, v65, v33
  s_waitcnt lgkmcnt(6)
  v_add_f32 v66, v66, v36
  v_add_f32 v67, v67, v37
  s_waitcnt lgkmcnt(5)
  v_add_f32 v68, v68, v40
  v_add_f32 v69, v69, v41
  s_waitcnt lgkmcnt(4)
  v_add_f32 v70, v70, v44
  v_add_f32 v71, v71, v45
  s_waitcnt lgkmcnt(3)
  v_add_f32 v72, v72, v48
  v_add_f32 v73, v73, v49
  s_waitcnt lgkmcnt(2)
  v_add_f32 v74, v74, v52
  v_add_f32 v75, v75, v53
  s_waitcnt lgkmcnt(1)
  v_add_f32 v76, v76, v56
  v_add_f32 v77, v77, v57
  s_waitcnt lgkmcnt(0)
  v_add_f32 v78, v78, v60
  v_add_f32 v79, v79, v61
  v_cvt_pk_bf16_f32 v80, v64, v66
  v_cvt_pk_bf16_f32 v81, v68, v70
  v_cvt_pk_bf16_f32 v82, v72, v74
  v_cvt_pk_bf16_f32 v83, v76, v78
  ds_write_b128 v28, v[80:83]
  v_cvt_pk_bf16_f32 v84, v65, v67
  v_cvt_pk_bf16_f32 v85, v69, v71
  v_cvt_pk_bf16_f32 v86, v73, v75
  v_cvt_pk_bf16_f32 v87, v77, v79
  ds_write_b128 v29, v[84:87]
  v_lshrrev_b32 v26, 5, v0
  v_xor_b32 v26, v26, v27
  v_lshlrev_b32 v26, 4, v26
  v_lshl_add_u32 v26, v27, 8, v26
  v_and_b32 v27, 16, v0
  v_lshl_add_u32 v26, v27, 9, v26
  v_add_u32 v96, 135168, v26
  v_xor_b32 v97, 32, v96
  v_xor_b32 v98, 64, v96
  v_xor_b32 v99, 96, v96
  v_xor_b32 v100, 128, v96
  v_xor_b32 v101, 160, v96
  v_xor_b32 v102, 192, v96
  v_xor_b32 v103, 224, v96
  s_waitcnt lgkmcnt(0)
  s_barrier
  ds_read_b128 v[32:35], v96
  ds_read_b128 v[36:39], v97
  ds_read_b128 v[40:43], v98
  ds_read_b128 v[44:47], v99
  ds_read_b128 v[48:51], v100
  ds_read_b128 v[52:55], v101
  ds_read_b128 v[56:59], v102
  ds_read_b128 v[60:63], v103
  s_waitcnt lgkmcnt(0)
  ds_read_b128 v[144:147], v6 offset:16384
  ds_read_b128 v[148:151], v7 offset:16384
  ds_read_b128 v[152:155], v8 offset:16384
  ds_read_b128 v[156:159], v9 offset:16384
  ds_read_b128 v[160:163], v6 offset:17408
  ds_read_b128 v[164:167], v7 offset:17408
  ds_read_b128 v[168:171], v8 offset:17408
  ds_read_b128 v[172:175], v9 offset:17408
  s_add_u32 m0, s53, 4992
  s_waitcnt vmcnt(11)
  buffer_load_dwordx4 v1, s[20:23], s51 offen offset:128 nt lds
  v_mfma_f32_32x32x16_bf16 v[128:143], a[64:67], v[32:35], 0
  v_mfma_f32_32x32x16_bf16 v[128:143], a[68:71], v[36:39], v[128:143]
  v_mfma_f32_32x32x16_bf16 v[128:143], a[72:75], v[40:43], v[128:143]
  v_mfma_f32_32x32x16_bf16 v[128:143], a[76:79], v[44:47], v[128:143]
  s_waitcnt vmcnt(11)
  buffer_load_dwordx4 v2, s[20:23], s51 offen offset:2176 nt lds
  s_xor_b32 s51, s51, 0x14000
  s_cmp_eq_u32 s63, 3
  s_cbranch_scc0 1f
  s_waitcnt vmcnt(0)
  s_mov_b64 exec, 1
  global_store_dword v254, v253, s[16:17] sc1
  s_mov_b64 exec, -1
1:
  v_mfma_f32_32x32x16_bf16 v[128:143], a[80:83], v[48:51], v[128:143]
  v_mfma_f32_32x32x16_bf16 v[128:143], a[84:87], v[52:55], v[128:143]
  v_mfma_f32_32x32x16_bf16 v[128:143], a[88:91], v[56:59], v[128:143]
  v_mfma_f32_32x32x16_bf16 v[128:143], a[92:95], v[60:63], v[128:143]
  s_nop 11
  v_max3_f32 v26, v128, v129, v130
  v_max3_f32 v27, v131, v132, v133
  v_max3_f32 v28, v134, v135, v136
  v_max3_f32 v29, v137, v138, v139
  v_max3_f32 v30, v140, v141, v142
  v_max3_f32 v26, v26, v27, v28
  v_max3_f32 v29, v29, v30, v143
  v_max_f32 v27, v26, v29
  v_max_f32 v26, v26, v29
  s_nop 1
  v_permlane32_swap_b32 v26, v27
  v_max_f32 v23, v26, v27
  v_mul_f32 v24, s55, v23
  v_fma_f32 v128, v128, s55, -v24
  v_fma_f32 v129, v129, s55, -v24
  v_fma_f32 v130, v130, s55, -v24
  v_fma_f32 v131, v131, s55, -v24
  s_add_u32 m0, s53, 8192
  s_waitcnt vmcnt(11)
  buffer_load_dwordx4 v1, s[20:23], s51 offen nt lds
  v_fma_f32 v132, v132, s55, -v24
  v_fma_f32 v133, v133, s55, -v24
  v_exp_f32 v128, v128
  v_fma_f32 v134, v134, s55, -v24
  v_fma_f32 v135, v135, s55, -v24
  v_exp_f32 v129, v129
  v_fma_f32 v136, v136, s55, -v24
  v_fma_f32 v137, v137, s55, -v24
  v_exp_f32 v130, v130
  v_fma_f32 v138, v138, s55, -v24
  v_fma_f32 v139, v139, s55, -v24
  v_exp_f32 v131, v131
  v_fma_f32 v140, v140, s55, -v24
  v_fma_f32 v141, v141, s55, -v24
  v_exp_f32 v132, v132
  v_fma_f32 v142, v142, s55, -v24
  v_fma_f32 v143, v143, s55, -v24
  v_exp_f32 v133, v133
  s_waitcnt vmcnt(11)
  buffer_load_dwordx4 v2, s[20:23], s51 offen offset:2048 nt lds
  v_exp_f32 v134, v134
  v_exp_f32 v135, v135
  v_exp_f32 v136, v136
  v_exp_f32 v137, v137
  v_exp_f32 v138, v138
  v_exp_f32 v139, v139
  v_cvt_pk_bf16_f32 v176, v128, v129
  v_exp_f32 v140, v140
  v_cvt_pk_bf16_f32 v177, v130, v131
  v_exp_f32 v141, v141
  v_cvt_pk_bf16_f32 v178, v132, v133
  v_exp_f32 v142, v142
  v_cvt_pk_bf16_f32 v179, v134, v135
  v_exp_f32 v143, v143
  v_cvt_pk_bf16_f32 v180, v136, v137
  v_add_f32 v26, v128, v129
  v_add_f32 v27, v130, v131
  v_add_f32 v28, v132, v133
  v_add_f32 v29, v134, v135
  v_cvt_pk_bf16_f32 v181, v138, v139
  v_cvt_pk_bf16_f32 v182, v140, v141
  v_cvt_pk_bf16_f32 v183, v142, v143
  v_add_f32 v26, v26, v136
  v_accvgpr_write_b32 a0, v176
  v_add_f32 v27, v27, v137
  v_accvgpr_write_b32 a1, v177
  v_add_f32 v28, v28, v138
  v_accvgpr_write_b32 a2, v178
  v_add_f32 v29, v29, v139
  v_accvgpr_write_b32 a3, v179
  v_add_f32 v26, v26, v140
  v_accvgpr_write_b32 a4, v180
  v_add_f32 v27, v27, v141
  v_accvgpr_write_b32 a5, v181
  v_add_f32 v28, v28, v142
  v_accvgpr_write_b32 a6, v182
  v_add_f32 v29, v29, v143
  v_accvgpr_write_b32 a7, v183
  v_add_f32 v26, v26, v27
  v_add_f32 v28, v28, v29
  v_add_f32 v25, v26, v28
  s_add_u32 m0, s53, 9088
  s_waitcnt vmcnt(11)
  buffer_load_dwordx4 v1, s[20:23], s51 offen offset:128 nt lds
  v_mfma_f32_32x32x16_bf16 v[128:143], a[96:99], v[32:35], 0
  v_mfma_f32_32x32x16_bf16 v[128:143], a[100:103], v[36:39], v[128:143]
  v_mfma_f32_32x32x16_bf16 v[128:143], a[104:107], v[40:43], v[128:143]
  v_mfma_f32_32x32x16_bf16 v[128:143], a[108:111], v[44:47], v[128:143]
  s_waitcnt vmcnt(11)
  buffer_load_dwordx4 v2, s[20:23], s51 offen offset:2176 nt lds
  s_xor_b32 s51, s51, 16384
  s_cmp_eq_u32 s63, 4
  s_cbranch_scc0 1f
  s_waitcnt vmcnt(0)
  s_mov_b64 exec, 1
  global_store_dword v254, v253, s[16:17] sc1
  s_mov_b64 exec, -1
1:
  v_mfma_f32_32x32x16_bf16 v[128:143], a[112:115], v[48:51], v[128:143]
  v_mfma_f32_32x32x16_bf16 v[128:143], a[116:119], v[52:55], v[128:143]
  v_mfma_f32_32x32x16_bf16 v[128:143], a[120:123], v[56:59], v[128:143]
  v_mfma_f32_32x32x16_bf16 v[128:143], a[124:127], v[60:63], v[128:143]
  v_mov_b32 v31, v24
  s_nop 10
  v_max3_f32 v26, v128, v129, v130
  v_max3_f32 v27, v131, v132, v133
  v_max3_f32 v28, v134, v135, v136
  v_max3_f32 v29, v137, v138, v139
  v_max3_f32 v30, v140, v141, v142
  v_max3_f32 v26, v26, v27, v28
  v_max3_f32 v29, v29, v30, v143
  v_max_f32 v27, v26, v29
  v_max_f32 v26, v26, v29
  s_nop 1
  v_permlane32_swap_b32 v26, v27
  v_max3_f32 v23, v26, v27, v23
  v_mul_f32 v24, s55, v23
  v_sub_f32 v31, v31, v24
  v_exp_f32 v22, v31
  v_fma_f32 v128, v128, s55, -v24
  v_fma_f32 v129, v129, s55, -v24
  v_fma_f32 v130, v130, s55, -v24
  v_fma_f32 v131, v131, s55, -v24
  ds_write_b32 v231, v22 offset:128
  s_add_u32 m0, s53, 12288
  s_waitcnt vmcnt(11)
  buffer_load_dwordx4 v1, s[20:23], s51 offen nt lds
  v_fma_f32 v132, v132, s55, -v24
  v_fma_f32 v133, v133, s55, -v24
  v_exp_f32 v128, v128
  v_fma_f32 v134, v134, s55, -v24
  v_fma_f32 v135, v135, s55, -v24
  v_exp_f32 v129, v129
  v_fma_f32 v136, v136, s55, -v24
  v_fma_f32 v137, v137, s55, -v24
  v_exp_f32 v130, v130
  v_fma_f32 v138, v138, s55, -v24
  v_fma_f32 v139, v139, s55, -v24
  v_exp_f32 v131, v131
  v_fma_f32 v140, v140, s55, -v24
  v_fma_f32 v141, v141, s55, -v24
  v_exp_f32 v132, v132
  v_fma_f32 v142, v142, s55, -v24
  v_fma_f32 v143, v143, s55, -v24
  v_exp_f32 v133, v133
  s_waitcnt vmcnt(11)
  buffer_load_dwordx4 v2, s[20:23], s51 offen offset:2048 nt lds
  v_exp_f32 v134, v134
  v_exp_f32 v135, v135
  v_exp_f32 v136, v136
  v_exp_f32 v137, v137
  v_exp_f32 v138, v138
  v_exp_f32 v139, v139
  v_cvt_pk_bf16_f32 v176, v128, v129
  v_exp_f32 v140, v140
  v_cvt_pk_bf16_f32 v177, v130, v131
  v_exp_f32 v141, v141
  v_cvt_pk_bf16_f32 v178, v132, v133
  v_exp_f32 v142, v142
  v_cvt_pk_bf16_f32 v179, v134, v135
  v_exp_f32 v143, v143
  v_cvt_pk_bf16_f32 v180, v136, v137
  v_fma_f32 v26, v25, v22, v128
  v_add_f32 v27, v130, v131
  v_add_f32 v28, v132, v133
  v_add_f32 v29, v134, v135
  v_add_f32 v26, v26, v129
  v_cvt_pk_bf16_f32 v181, v138, v139
  v_cvt_pk_bf16_f32 v182, v140, v141
  v_cvt_pk_bf16_f32 v183, v142, v143
  v_add_f32 v26, v26, v136
  v_accvgpr_write_b32 a8, v176
  v_add_f32 v27, v27, v137
  v_accvgpr_write_b32 a9, v177
  v_add_f32 v28, v28, v138
  v_accvgpr_write_b32 a10, v178
  v_add_f32 v29, v29, v139
  v_accvgpr_write_b32 a11, v179
  v_add_f32 v26, v26, v140
  v_accvgpr_write_b32 a12, v180
  v_add_f32 v27, v27, v141
  v_accvgpr_write_b32 a13, v181
  v_add_f32 v28, v28, v142
  v_accvgpr_write_b32 a14, v182
  v_add_f32 v29, v29, v143
  v_accvgpr_write_b32 a15, v183
  v_add_f32 v26, v26, v27
  v_add_f32 v28, v28, v29
  v_add_f32 v25, v26, v28
  s_add_u32 m0, s53, 13184
  s_waitcnt vmcnt(11)
  buffer_load_dwordx4 v1, s[20:23], s51 offen offset:128 nt lds
  s_waitcnt lgkmcnt(5)
  v_mfma_f32_32x32x16_bf16 v[128:143], v[144:147], v[32:35], 0
  v_mfma_f32_32x32x16_bf16 v[128:143], v[148:151], v[36:39], v[128:143]
  v_mfma_f32_32x32x16_bf16 v[128:143], v[152:155], v[40:43], v[128:143]
  v_mfma_f32_32x32x16_bf16 v[128:143], v[156:159], v[44:47], v[128:143]
  s_waitcnt vmcnt(11)
  buffer_load_dwordx4 v2, s[20:23], s51 offen offset:2176 nt lds
  s_xor_b32 s51, s51, 0x54000
  s_waitcnt lgkmcnt(1)
  v_mfma_f32_32x32x16_bf16 v[128:143], v[160:163], v[48:51], v[128:143]
  v_mfma_f32_32x32x16_bf16 v[128:143], v[164:167], v[52:55], v[128:143]
  v_mfma_f32_32x32x16_bf16 v[128:143], v[168:171], v[56:59], v[128:143]
  v_mfma_f32_32x32x16_bf16 v[128:143], v[172:175], v[60:63], v[128:143]
  v_mov_b32 v31, v24
  s_nop 10
  v_max3_f32 v26, v128, v129, v130
  v_max3_f32 v27, v131, v132, v133
  v_max3_f32 v28, v134, v135, v136
  v_max3_f32 v29, v137, v138, v139
  v_max3_f32 v30, v140, v141, v142
  v_max3_f32 v26, v26, v27, v28
  v_max3_f32 v29, v29, v30, v143
  v_max_f32 v27, v26, v29
  v_max_f32 v26, v26, v29
  s_nop 1
  v_permlane32_swap_b32 v26, v27
  v_max3_f32 v23, v26, v27, v23
  v_mul_f32 v24, s55, v23
  v_sub_f32 v31, v31, v24
  v_exp_f32 v22, v31
  v_fma_f32 v128, v128, s55, -v24
  v_fma_f32 v129, v129, s55, -v24
  v_fma_f32 v130, v130, s55, -v24
  v_fma_f32 v131, v131, s55, -v24
  ds_write_b32 v231, v22 offset:256
  s_add_u32 m0, s53, 16384
  s_waitcnt vmcnt(11)
  buffer_load_dwordx4 v1, s[20:23], s51 offen nt lds
  v_fma_f32 v132, v132, s55, -v24
  v_fma_f32 v133, v133, s55, -v24
  v_exp_f32 v128, v128
  v_fma_f32 v134, v134, s55, -v24
  v_fma_f32 v135, v135, s55, -v24
  v_exp_f32 v129, v129
  v_fma_f32 v136, v136, s55, -v24
  v_fma_f32 v137, v137, s55, -v24
  v_exp_f32 v130, v130
  v_fma_f32 v138, v138, s55, -v24
  v_fma_f32 v139, v139, s55, -v24
  v_exp_f32 v131, v131
  v_fma_f32 v140, v140, s55, -v24
  v_fma_f32 v141, v141, s55, -v24
  v_exp_f32 v132, v132
  v_fma_f32 v142, v142, s55, -v24
  v_fma_f32 v143, v143, s55, -v24
  v_exp_f32 v133, v133
  s_waitcnt vmcnt(11)
  buffer_load_dwordx4 v2, s[20:23], s51 offen offset:2048 nt lds
  v_exp_f32 v134, v134
  v_exp_f32 v135, v135
  v_exp_f32 v136, v136
  v_exp_f32 v137, v137
  v_exp_f32 v138, v138
  v_exp_f32 v139, v139
  v_cvt_pk_bf16_f32 v176, v128, v129
  v_exp_f32 v140, v140
  v_cvt_pk_bf16_f32 v177, v130, v131
  v_exp_f32 v141, v141
  v_cvt_pk_bf16_f32 v178, v132, v133
  v_exp_f32 v142, v142
  v_cvt_pk_bf16_f32 v179, v134, v135
  v_exp_f32 v143, v143
  v_cvt_pk_bf16_f32 v180, v136, v137
  v_fma_f32 v26, v25, v22, v128
  v_add_f32 v27, v130, v131
  v_add_f32 v28, v132, v133
  v_add_f32 v29, v134, v135
  v_add_f32 v26, v26, v129
  v_cvt_pk_bf16_f32 v181, v138, v139
  v_cvt_pk_bf16_f32 v182, v140, v141
  v_cvt_pk_bf16_f32 v183, v142, v143
  v_add_f32 v26, v26, v136
  v_accvgpr_write_b32 a16, v176
  v_add_f32 v27, v27, v137
  v_accvgpr_write_b32 a17, v177
  v_add_f32 v28, v28, v138
  v_accvgpr_write_b32 a18, v178
  v_add_f32 v29, v29, v139
  v_accvgpr_write_b32 a19, v179
  v_add_f32 v26, v26, v140
  v_accvgpr_write_b32 a20, v180
  v_add_f32 v27, v27, v141
  v_accvgpr_write_b32 a21, v181
  v_add_f32 v28, v28, v142
  v_accvgpr_write_b32 a22, v182
  v_add_f32 v29, v29, v143
  v_accvgpr_write_b32 a23, v183
  v_add_f32 v26, v26, v27
  v_add_f32 v28, v28, v29
  v_add_f32 v25, v26, v28
  s_add_u32 m0, s53, 17280
  s_waitcnt vmcnt(11)
  buffer_load_dwordx4 v1, s[20:23], s51 offen offset:128 nt lds
  ds_read_b128 v[144:147], v6 offset:24576
  ds_read_b128 v[148:151], v7 offset:24576
  ds_read_b128 v[152:155], v8 offset:24576
  ds_read_b128 v[156:159], v9 offset:24576
  ds_read_b128 v[160:163], v6 offset:25600
  ds_read_b128 v[164:167], v7 offset:25600
  ds_read_b128 v[168:171], v8 offset:25600
  ds_read_b128 v[172:175], v9 offset:25600
  s_waitcnt vmcnt(11)
  buffer_load_dwordx4 v2, s[20:23], s51 offen offset:2176 nt lds
  s_xor_b32 s51, s51, 16384
  s_waitcnt lgkmcnt(4)
  v_mfma_f32_32x32x16_bf16 v[128:143], v[144:147], v[32:35], 0
  v_mfma_f32_32x32x16_bf16 v[128:143], v[148:151], v[36:39], v[128:143]
  v_mfma_f32_32x32x16_bf16 v[128:143], v[152:155], v[40:43], v[128:143]
  v_mfma_f32_32x32x16_bf16 v[128:143], v[156:159], v[44:47], v[128:143]
  s_waitcnt lgkmcnt(0)
  v_mfma_f32_32x32x16_bf16 v[128:143], v[160:163], v[48:51], v[128:143]
  v_mfma_f32_32x32x16_bf16 v[128:143], v[164:167], v[52:55], v[128:143]
  v_mfma_f32_32x32x16_bf16 v[128:143], v[168:171], v[56:59], v[128:143]
  v_mfma_f32_32x32x16_bf16 v[128:143], v[172:175], v[60:63], v[128:143]
  s_add_u32 m0, s53, 20480
  s_waitcnt vmcnt(11)
  buffer_load_dwordx4 v1, s[20:23], s51 offen nt lds
  v_mov_b32 v31, v24
  s_nop 7
  v_max3_f32 v26, v128, v129, v130
  v_max3_f32 v27, v131, v132, v133
  v_max3_f32 v28, v134, v135, v136
  v_max3_f32 v29, v137, v138, v139
  v_max3_f32 v30, v140, v141, v142
  v_max3_f32 v26, v26, v27, v28
  v_max3_f32 v29, v29, v30, v143
  v_max_f32 v27, v26, v29
  v_max_f32 v26, v26, v29
  s_nop 1
  v_permlane32_swap_b32 v26, v27
  v_max3_f32 v23, v26, v27, v23
  v_mul_f32 v24, s55, v23
  v_sub_f32 v31, v31, v24
  v_exp_f32 v22, v31
  v_fma_f32 v128, v128, s55, -v24
  v_fma_f32 v129, v129, s55, -v24
  v_fma_f32 v130, v130, s55, -v24
  v_fma_f32 v131, v131, s55, -v24
  ds_write_b32 v231, v22 offset:384
  s_waitcnt vmcnt(11)
  buffer_load_dwordx4 v2, s[20:23], s51 offen offset:2048 nt lds
  v_fma_f32 v132, v132, s55, -v24
  v_fma_f32 v133, v133, s55, -v24
  v_exp_f32 v128, v128
  v_fma_f32 v134, v134, s55, -v24
  v_fma_f32 v135, v135, s55, -v24
  v_exp_f32 v129, v129
  v_fma_f32 v136, v136, s55, -v24
  v_fma_f32 v137, v137, s55, -v24
  v_exp_f32 v130, v130
  v_fma_f32 v138, v138, s55, -v24
  v_fma_f32 v139, v139, s55, -v24
  v_exp_f32 v131, v131
  v_fma_f32 v140, v140, s55, -v24
  v_fma_f32 v141, v141, s55, -v24
  v_exp_f32 v132, v132
  v_fma_f32 v142, v142, s55, -v24
  v_fma_f32 v143, v143, s55, -v24
  v_exp_f32 v133, v133
  v_exp_f32 v134, v134
  v_exp_f32 v135, v135
  v_exp_f32 v136, v136
  v_exp_f32 v137, v137
  v_exp_f32 v138, v138
  v_exp_f32 v139, v139
  v_cvt_pk_bf16_f32 v176, v128, v129
  v_exp_f32 v140, v140
  v_cvt_pk_bf16_f32 v177, v130, v131
  v_exp_f32 v141, v141
  v_cvt_pk_bf16_f32 v178, v132, v133
  v_exp_f32 v142, v142
  v_cvt_pk_bf16_f32 v179, v134, v135
  v_exp_f32 v143, v143
  v_cvt_pk_bf16_f32 v180, v136, v137
  s_add_u32 m0, s53, 21376
  s_waitcnt vmcnt(11)
  buffer_load_dwordx4 v1, s[20:23], s51 offen offset:128 nt lds
  v_fma_f32 v26, v25, v22, v128
  v_add_f32 v27, v130, v131
  v_add_f32 v28, v132, v133
  v_add_f32 v29, v134, v135
  v_add_f32 v26, v26, v129
  v_cvt_pk_bf16_f32 v181, v138, v139
  v_cvt_pk_bf16_f32 v182, v140, v141
  v_cvt_pk_bf16_f32 v183, v142, v143
  v_add_f32 v26, v26, v136
  v_accvgpr_write_b32 a24, v176
  v_add_f32 v27, v27, v137
  v_accvgpr_write_b32 a25, v177
  v_add_f32 v28, v28, v138
  v_accvgpr_write_b32 a26, v178
  v_add_f32 v29, v29, v139
  v_accvgpr_write_b32 a27, v179
  v_add_f32 v26, v26, v140
  v_accvgpr_write_b32 a28, v180
  v_add_f32 v27, v27, v141
  v_accvgpr_write_b32 a29, v181
  v_add_f32 v28, v28, v142
  v_accvgpr_write_b32 a30, v182
  v_add_f32 v29, v29, v143
  v_accvgpr_write_b32 a31, v183
  v_add_f32 v26, v26, v27
  v_add_f32 v28, v28, v29
  v_add_f32 v25, v26, v28
  s_waitcnt vmcnt(11)
  buffer_load_dwordx4 v2, s[20:23], s51 offen offset:2176 nt lds
  s_xor_b32 s51, s51, 0x14000
  ds_read_b128 v[144:147], v6
  ds_read_b128 v[148:151], v7
  ds_read_b128 v[152:155], v8
  ds_read_b128 v[156:159], v9
  ds_read_b128 v[160:163], v6 offset:1024
  ds_read_b128 v[164:167], v7 offset:1024
  ds_read_b128 v[168:171], v8 offset:1024
  ds_read_b128 v[172:175], v9 offset:1024
  s_waitcnt lgkmcnt(4)
  v_mfma_f32_32x32x16_bf16 v[128:143], v[144:147], v[32:35], 0
  v_mfma_f32_32x32x16_bf16 v[128:143], v[148:151], v[36:39], v[128:143]
  v_mfma_f32_32x32x16_bf16 v[128:143], v[152:155], v[40:43], v[128:143]
  v_mfma_f32_32x32x16_bf16 v[128:143], v[156:159], v[44:47], v[128:143]
  s_add_u32 m0, s53, 24576
  s_waitcnt vmcnt(11)
  buffer_load_dwordx4 v1, s[20:23], s51 offen nt lds
  s_waitcnt lgkmcnt(0)
  v_mfma_f32_32x32x16_bf16 v[128:143], v[160:163], v[48:51], v[128:143]
  v_mfma_f32_32x32x16_bf16 v[128:143], v[164:167], v[52:55], v[128:143]
  v_mfma_f32_32x32x16_bf16 v[128:143], v[168:171], v[56:59], v[128:143]
  v_mfma_f32_32x32x16_bf16 v[128:143], v[172:175], v[60:63], v[128:143]
  s_waitcnt vmcnt(11)
  buffer_load_dwordx4 v2, s[20:23], s51 offen offset:2048 nt lds
  v_mov_b32 v31, v24
  s_nop 8
  v_max3_f32 v26, v128, v129, v130
  v_max3_f32 v27, v131, v132, v133
  v_max3_f32 v28, v134, v135, v136
  v_max3_f32 v29, v137, v138, v139
  v_max3_f32 v30, v140, v141, v142
  v_max3_f32 v26, v26, v27, v28
  v_max3_f32 v29, v29, v30, v143
  v_max_f32 v27, v26, v29
  v_max_f32 v26, v26, v29
  s_nop 1
  v_permlane32_swap_b32 v26, v27
  v_max3_f32 v23, v26, v27, v23
  v_mul_f32 v24, s55, v23
  v_sub_f32 v31, v31, v24
  v_exp_f32 v22, v31
  v_fma_f32 v128, v128, s55, -v24
  v_fma_f32 v129, v129, s55, -v24
  v_fma_f32 v130, v130, s55, -v24
  v_fma_f32 v131, v131, s55, -v24
  ds_write_b32 v231, v22 offset:512
  v_fma_f32 v132, v132, s55, -v24
  v_fma_f32 v133, v133, s55, -v24
  v_exp_f32 v128, v128
  v_fma_f32 v134, v134, s55, -v24
  v_fma_f32 v135, v135, s55, -v24
  v_exp_f32 v129, v129
  v_fma_f32 v136, v136, s55, -v24
  v_fma_f32 v137, v137, s55, -v24
  v_exp_f32 v130, v130
  v_fma_f32 v138, v138, s55, -v24
  v_fma_f32 v139, v139, s55, -v24
  v_exp_f32 v131, v131
  v_fma_f32 v140, v140, s55, -v24
  v_fma_f32 v141, v141, s55, -v24
  v_exp_f32 v132, v132
  v_fma_f32 v142, v142, s55, -v24
  v_fma_f32 v143, v143, s55, -v24
  v_exp_f32 v133, v133
  s_add_u32 m0, s53, 25472
  s_waitcnt vmcnt(11)
  buffer_load_dwordx4 v1, s[20:23], s51 offen offset:128 nt lds
  v_exp_f32 v134, v134
  v_exp_f32 v135, v135
  v_exp_f32 v136, v136
  v_exp_f32 v137, v137
  v_exp_f32 v138, v138
  v_exp_f32 v139, v139
  v_cvt_pk_bf16_f32 v176, v128, v129
  v_exp_f32 v140, v140
  v_cvt_pk_bf16_f32 v177, v130, v131
  v_exp_f32 v141, v141
  v_cvt_pk_bf16_f32 v178, v132, v133
  v_exp_f32 v142, v142
  v_cvt_pk_bf16_f32 v179, v134, v135
  v_exp_f32 v143, v143
  v_cvt_pk_bf16_f32 v180, v136, v137
  s_waitcnt vmcnt(11)
  buffer_load_dwordx4 v2, s[20:23], s51 offen offset:2176 nt lds
  s_xor_b32 s51, s51, 16384
  v_fma_f32 v26, v25, v22, v128
  v_add_f32 v27, v130, v131
  v_add_f32 v28, v132, v133
  v_add_f32 v29, v134, v135
  v_add_f32 v26, v26, v129
  v_cvt_pk_bf16_f32 v181, v138, v139
  v_cvt_pk_bf16_f32 v182, v140, v141
  v_cvt_pk_bf16_f32 v183, v142, v143
  v_add_f32 v26, v26, v136
  v_accvgpr_write_b32 a32, v176
  v_add_f32 v27, v27, v137
  v_accvgpr_write_b32 a33, v177
  v_add_f32 v28, v28, v138
  v_accvgpr_write_b32 a34, v178
  v_add_f32 v29, v29, v139
  v_accvgpr_write_b32 a35, v179
  v_add_f32 v26, v26, v140
  v_accvgpr_write_b32 a36, v180
  v_add_f32 v27, v27, v141
  v_accvgpr_write_b32 a37, v181
  v_add_f32 v28, v28, v142
  v_accvgpr_write_b32 a38, v182
  v_add_f32 v29, v29, v143
  v_accvgpr_write_b32 a39, v183
  v_add_f32 v26, v26, v27
  v_add_f32 v28, v28, v29
  v_add_f32 v25, v26, v28
  ds_read_b128 v[144:147], v6 offset:8192
  ds_read_b128 v[148:151], v7 offset:8192
  ds_read_b128 v[152:155], v8 offset:8192
  ds_read_b128 v[156:159], v9 offset:8192
  ds_read_b128 v[160:163], v6 offset:9216
  ds_read_b128 v[164:167], v7 offset:9216
  ds_read_b128 v[168:171], v8 offset:9216
  ds_read_b128 v[172:175], v9 offset:9216
  s_add_u32 m0, s53, 28672
  s_waitcnt vmcnt(11)
  buffer_load_dwordx4 v1, s[20:23], s51 offen nt lds
  s_waitcnt lgkmcnt(4)
  v_mfma_f32_32x32x16_bf16 v[128:143], v[144:147], v[32:35], 0
  v_mfma_f32_32x32x16_bf16 v[128:143], v[148:151], v[36:39], v[128:143]
  v_mfma_f32_32x32x16_bf16 v[128:143], v[152:155], v[40:43], v[128:143]
  v_mfma_f32_32x32x16_bf16 v[128:143], v[156:159], v[44:47], v[128:143]
  s_waitcnt vmcnt(11)
  buffer_load_dwordx4 v2, s[20:23], s51 offen offset:2048 nt lds
  s_waitcnt lgkmcnt(0)
  v_mfma_f32_32x32x16_bf16 v[128:143], v[160:163], v[48:51], v[128:143]
  v_mfma_f32_32x32x16_bf16 v[128:143], v[164:167], v[52:55], v[128:143]
  v_mfma_f32_32x32x16_bf16 v[128:143], v[168:171], v[56:59], v[128:143]
  v_mfma_f32_32x32x16_bf16 v[128:143], v[172:175], v[60:63], v[128:143]
  v_mov_b32 v31, v24
  s_nop 10
  v_max3_f32 v26, v128, v129, v130
  v_max3_f32 v27, v131, v132, v133
  v_max3_f32 v28, v134, v135, v136
  v_max3_f32 v29, v137, v138, v139
  v_max3_f32 v30, v140, v141, v142
  v_max3_f32 v26, v26, v27, v28
  v_max3_f32 v29, v29, v30, v143
  v_max_f32 v27, v26, v29
  v_max_f32 v26, v26, v29
  s_nop 1
  v_permlane32_swap_b32 v26, v27
  v_max3_f32 v23, v26, v27, v23
  v_mul_f32 v24, s55, v23
  v_sub_f32 v31, v31, v24
  v_exp_f32 v22, v31
  v_fma_f32 v128, v128, s55, -v24
  v_fma_f32 v129, v129, s55, -v24
  v_fma_f32 v130, v130, s55, -v24
  v_fma_f32 v131, v131, s55, -v24
  ds_write_b32 v231, v22 offset:640
  s_add_u32 m0, s53, 29568
  s_waitcnt vmcnt(11)
  buffer_load_dwordx4 v1, s[20:23], s51 offen offset:128 nt lds
  v_fma_f32 v132, v132, s55, -v24
  v_fma_f32 v133, v133, s55, -v24
  v_exp_f32 v128, v128
  v_fma_f32 v134, v134, s55, -v24
  v_fma_f32 v135, v135, s55, -v24
  v_exp_f32 v129, v129
  v_fma_f32 v136, v136, s55, -v24
  v_fma_f32 v137, v137, s55, -v24
  v_exp_f32 v130, v130
  v_fma_f32 v138, v138, s55, -v24
  v_fma_f32 v139, v139, s55, -v24
  v_exp_f32 v131, v131
  v_fma_f32 v140, v140, s55, -v24
  v_fma_f32 v141, v141, s55, -v24
  v_exp_f32 v132, v132
  v_fma_f32 v142, v142, s55, -v24
  v_fma_f32 v143, v143, s55, -v24
  v_exp_f32 v133, v133
  s_waitcnt vmcnt(11)
  buffer_load_dwordx4 v2, s[20:23], s51 offen offset:2176 nt lds
  s_xor_b32 s51, s51, 0x1d4000
  v_exp_f32 v134, v134
  v_exp_f32 v135, v135
  v_exp_f32 v136, v136
  v_exp_f32 v137, v137
  v_exp_f32 v138, v138
  v_exp_f32 v139, v139
  v_cvt_pk_bf16_f32 v176, v128, v129
  v_exp_f32 v140, v140
  v_cvt_pk_bf16_f32 v177, v130, v131
  v_exp_f32 v141, v141
  v_cvt_pk_bf16_f32 v178, v132, v133
  v_exp_f32 v142, v142
  v_cvt_pk_bf16_f32 v179, v134, v135
  v_exp_f32 v143, v143
  v_cvt_pk_bf16_f32 v180, v136, v137
  v_fma_f32 v26, v25, v22, v128
  v_add_f32 v27, v130, v131
  v_add_f32 v28, v132, v133
  v_add_f32 v29, v134, v135
  v_add_f32 v26, v26, v129
  v_cvt_pk_bf16_f32 v181, v138, v139
  v_cvt_pk_bf16_f32 v182, v140, v141
  v_cvt_pk_bf16_f32 v183, v142, v143
  v_add_f32 v26, v26, v136
  v_accvgpr_write_b32 a40, v176
  v_add_f32 v27, v27, v137
  v_accvgpr_write_b32 a41, v177
  v_add_f32 v28, v28, v138
  v_accvgpr_write_b32 a42, v178
  v_add_f32 v29, v29, v139
  v_accvgpr_write_b32 a43, v179
  v_add_f32 v26, v26, v140
  v_accvgpr_write_b32 a44, v180
  v_add_f32 v27, v27, v141
  v_accvgpr_write_b32 a45, v181
  v_add_f32 v28, v28, v142
  v_accvgpr_write_b32 a46, v182
  v_add_f32 v29, v29, v143
  v_accvgpr_write_b32 a47, v183
  v_add_f32 v26, v26, v27
  v_add_f32 v28, v28, v29
  v_add_f32 v25, v26, v28
  s_mov_b32 m0, s53
  s_waitcnt vmcnt(4)
  buffer_load_dwordx4 v1, s[20:23], s51 offen nt lds
  ds_read_b128 v[144:147], v6 offset:16384
  ds_read_b128 v[148:151], v7 offset:16384
  ds_read_b128 v[152:155], v8 offset:16384
  ds_read_b128 v[156:159], v9 offset:16384
  ds_read_b128 v[160:163], v6 offset:17408
  ds_read_b128 v[164:167], v7 offset:17408
  ds_read_b128 v[168:171], v8 offset:17408
  ds_read_b128 v[172:175], v9 offset:17408
  s_waitcnt vmcnt(4)
  buffer_load_dwordx4 v2, s[20:23], s51 offen offset:2048 nt lds
  s_waitcnt lgkmcnt(4)
  v_mfma_f32_32x32x16_bf16 v[128:143], v[144:147], v[32:35], 0
  v_mfma_f32_32x32x16_bf16 v[128:143], v[148:151], v[36:39], v[128:143]
  v_mfma_f32_32x32x16_bf16 v[128:143], v[152:155], v[40:43], v[128:143]
  v_mfma_f32_32x32x16_bf16 v[128:143], v[156:159], v[44:47], v[128:143]
  s_waitcnt lgkmcnt(0)
  v_mfma_f32_32x32x16_bf16 v[128:143], v[160:163], v[48:51], v[128:143]
  v_mfma_f32_32x32x16_bf16 v[128:143], v[164:167], v[52:55], v[128:143]
  v_mfma_f32_32x32x16_bf16 v[128:143], v[168:171], v[56:59], v[128:143]
  v_mfma_f32_32x32x16_bf16 v[128:143], v[172:175], v[60:63], v[128:143]
  s_add_u32 m0, s53, 896
  s_waitcnt vmcnt(4)
  buffer_load_dwordx4 v1, s[20:23], s51 offen offset:128 nt lds
  v_mov_b32 v31, v24
  s_nop 7
  v_max3_f32 v26, v128, v129, v130
  v_max3_f32 v27, v131, v132, v133
  v_max3_f32 v28, v134, v135, v136
  v_max3_f32 v29, v137, v138, v139
  v_max3_f32 v30, v140, v141, v142
  v_max3_f32 v26, v26, v27, v28
  v_max3_f32 v29, v29, v30, v143
  v_max_f32 v27, v26, v29
  v_max_f32 v26, v26, v29
  s_nop 1
  v_permlane32_swap_b32 v26, v27
  v_max3_f32 v23, v26, v27, v23
  v_mul_f32 v24, s55, v23
  v_sub_f32 v31, v31, v24
  v_exp_f32 v22, v31
  v_fma_f32 v128, v128, s55, -v24
  v_fma_f32 v129, v129, s55, -v24
  v_fma_f32 v130, v130, s55, -v24
  v_fma_f32 v131, v131, s55, -v24
  ds_write_b32 v231, v22 offset:768
  s_waitcnt vmcnt(4)
  buffer_load_dwordx4 v2, s[20:23], s51 offen offset:2176 nt lds
  s_xor_b32 s51, s51, 16384
  v_fma_f32 v132, v132, s55, -v24
  v_fma_f32 v133, v133, s55, -v24
  v_exp_f32 v128, v128
  v_fma_f32 v134, v134, s55, -v24
  v_fma_f32 v135, v135, s55, -v24
  v_exp_f32 v129, v129
  v_fma_f32 v136, v136, s55, -v24
  v_fma_f32 v137, v137, s55, -v24
  v_exp_f32 v130, v130
  v_fma_f32 v138, v138, s55, -v24
  v_fma_f32 v139, v139, s55, -v24
  v_exp_f32 v131, v131
  v_fma_f32 v140, v140, s55, -v24
  v_fma_f32 v141, v141, s55, -v24
  v_exp_f32 v132, v132
  v_fma_f32 v142, v142, s55, -v24
  v_fma_f32 v143, v143, s55, -v24
  v_exp_f32 v133, v133
  v_exp_f32 v134, v134
  v_exp_f32 v135, v135
  v_exp_f32 v136, v136
  v_exp_f32 v137, v137
  v_exp_f32 v138, v138
  v_exp_f32 v139, v139
  v_cvt_pk_bf16_f32 v176, v128, v129
  v_exp_f32 v140, v140
  v_cvt_pk_bf16_f32 v177, v130, v131
  v_exp_f32 v141, v141
  v_cvt_pk_bf16_f32 v178, v132, v133
  v_exp_f32 v142, v142
  v_cvt_pk_bf16_f32 v179, v134, v135
  v_exp_f32 v143, v143
  v_cvt_pk_bf16_f32 v180, v136, v137
  s_add_u32 m0, s53, 4096
  s_waitcnt vmcnt(4)
  buffer_load_dwordx4 v1, s[20:23], s51 offen nt lds
  v_fma_f32 v26, v25, v22, v128
  v_add_f32 v27, v130, v131
  v_add_f32 v28, v132, v133
  v_add_f32 v29, v134, v135
  v_add_f32 v26, v26, v129
  v_cvt_pk_bf16_f32 v181, v138, v139
  v_cvt_pk_bf16_f32 v182, v140, v141
  v_cvt_pk_bf16_f32 v183, v142, v143
  v_add_f32 v26, v26, v136
  v_accvgpr_write_b32 a48, v176
  v_add_f32 v27, v27, v137
  v_accvgpr_write_b32 a49, v177
  v_add_f32 v28, v28, v138
  v_accvgpr_write_b32 a50, v178
  v_add_f32 v29, v29, v139
  v_accvgpr_write_b32 a51, v179
  v_add_f32 v26, v26, v140
  v_accvgpr_write_b32 a52, v180
  v_add_f32 v27, v27, v141
  v_accvgpr_write_b32 a53, v181
  v_add_f32 v28, v28, v142
  v_accvgpr_write_b32 a54, v182
  v_add_f32 v29, v29, v143
  v_accvgpr_write_b32 a55, v183
  v_add_f32 v26, v26, v27
  v_add_f32 v28, v28, v29
  v_add_f32 v25, v26, v28
  s_waitcnt vmcnt(4)
  buffer_load_dwordx4 v2, s[20:23], s51 offen offset:2048 nt lds
  ds_read_b128 v[144:147], v6 offset:24576
  ds_read_b128 v[148:151], v7 offset:24576
  ds_read_b128 v[152:155], v8 offset:24576
  ds_read_b128 v[156:159], v9 offset:24576
  ds_read_b128 v[160:163], v6 offset:25600
  ds_read_b128 v[164:167], v7 offset:25600
  ds_read_b128 v[168:171], v8 offset:25600
  ds_read_b128 v[172:175], v9 offset:25600
  s_waitcnt lgkmcnt(4)
  v_mfma_f32_32x32x16_bf16 v[128:143], v[144:147], v[32:35], 0
  v_mfma_f32_32x32x16_bf16 v[128:143], v[148:151], v[36:39], v[128:143]
  v_mfma_f32_32x32x16_bf16 v[128:143], v[152:155], v[40:43], v[128:143]
  v_mfma_f32_32x32x16_bf16 v[128:143], v[156:159], v[44:47], v[128:143]
  s_add_u32 m0, s53, 4992
  s_waitcnt vmcnt(4)
  buffer_load_dwordx4 v1, s[20:23], s51 offen offset:128 nt lds
  s_waitcnt lgkmcnt(0)
  v_mfma_f32_32x32x16_bf16 v[128:143], v[160:163], v[48:51], v[128:143]
  v_mfma_f32_32x32x16_bf16 v[128:143], v[164:167], v[52:55], v[128:143]
  v_mfma_f32_32x32x16_bf16 v[128:143], v[168:171], v[56:59], v[128:143]
  v_mfma_f32_32x32x16_bf16 v[128:143], v[172:175], v[60:63], v[128:143]
  s_waitcnt vmcnt(4)
  buffer_load_dwordx4 v2, s[20:23], s51 offen offset:2176 nt lds
  s_xor_b32 s51, s51, 0x14000
  v_mov_b32 v31, v24
  s_nop 7
  v_max3_f32 v26, v128, v129, v130
  v_max3_f32 v27, v131, v132, v133
  v_max3_f32 v28, v134, v135, v136
  v_max3_f32 v29, v137, v138, v139
  v_max3_f32 v30, v140, v141, v142
  v_max3_f32 v26, v26, v27, v28
  v_max3_f32 v29, v29, v30, v143
  v_max_f32 v27, v26, v29
  v_max_f32 v26, v26, v29
  s_nop 1
  v_permlane32_swap_b32 v26, v27
  v_max3_f32 v23, v26, v27, v23
  v_mul_f32 v24, s55, v23
  v_sub_f32 v31, v31, v24
  v_exp_f32 v22, v31
  v_fma_f32 v128, v128, s55, -v24
  v_fma_f32 v129, v129, s55, -v24
  v_fma_f32 v130, v130, s55, -v24
  v_fma_f32 v131, v131, s55, -v24
  ds_write_b32 v231, v22 offset:896
  v_fma_f32 v132, v132, s55, -v24
  v_fma_f32 v133, v133, s55, -v24
  v_exp_f32 v128, v128
  v_fma_f32 v134, v134, s55, -v24
  v_fma_f32 v135, v135, s55, -v24
  v_exp_f32 v129, v129
  v_fma_f32 v136, v136, s55, -v24
  v_fma_f32 v137, v137, s55, -v24
  v_exp_f32 v130, v130
  v_fma_f32 v138, v138, s55, -v24
  v_fma_f32 v139, v139, s55, -v24
  v_exp_f32 v131, v131
  v_fma_f32 v140, v140, s55, -v24
  v_fma_f32 v141, v141, s55, -v24
  v_exp_f32 v132, v132
  v_fma_f32 v142, v142, s55, -v24
  v_fma_f32 v143, v143, s55, -v24
  v_exp_f32 v133, v133
  s_add_u32 m0, s53, 8192
  s_waitcnt vmcnt(4)
  buffer_load_dwordx4 v1, s[20:23], s51 offen nt lds
  v_exp_f32 v134, v134
  v_exp_f32 v135, v135
  v_exp_f32 v136, v136
  v_exp_f32 v137, v137
  v_exp_f32 v138, v138
  v_exp_f32 v139, v139
  v_cvt_pk_bf16_f32 v176, v128, v129
  v_exp_f32 v140, v140
  v_cvt_pk_bf16_f32 v177, v130, v131
  v_exp_f32 v141, v141
  v_cvt_pk_bf16_f32 v178, v132, v133
  v_exp_f32 v142, v142
  v_cvt_pk_bf16_f32 v179, v134, v135
  v_exp_f32 v143, v143
  v_cvt_pk_bf16_f32 v180, v136, v137
  s_waitcnt vmcnt(4)
  buffer_load_dwordx4 v2, s[20:23], s51 offen offset:2048 nt lds
  v_fma_f32 v26, v25, v22, v128
  v_add_f32 v27, v130, v131
  v_add_f32 v28, v132, v133
  v_add_f32 v29, v134, v135
  v_add_f32 v26, v26, v129
  v_cvt_pk_bf16_f32 v181, v138, v139
  v_cvt_pk_bf16_f32 v182, v140, v141
  v_cvt_pk_bf16_f32 v183, v142, v143
  v_add_f32 v26, v26, v136
  v_accvgpr_write_b32 a56, v176
  v_add_f32 v27, v27, v137
  v_accvgpr_write_b32 a57, v177
  v_add_f32 v28, v28, v138
  v_accvgpr_write_b32 a58, v178
  v_add_f32 v29, v29, v139
  v_accvgpr_write_b32 a59, v179
  v_add_f32 v26, v26, v140
  v_accvgpr_write_b32 a60, v180
  v_add_f32 v27, v27, v141
  v_accvgpr_write_b32 a61, v181
  v_add_f32 v28, v28, v142
  v_accvgpr_write_b32 a62, v182
  v_add_f32 v29, v29, v143
  v_accvgpr_write_b32 a63, v183
  v_add_f32 v26, v26, v27
  v_add_f32 v28, v28, v29
  v_add_f32 v25, v26, v28
  s_add_u32 m0, s53, 9088
  s_waitcnt vmcnt(4)
  buffer_load_dwordx4 v1, s[20:23], s51 offen offset:128 nt lds
  s_waitcnt vmcnt(4)
  buffer_load_dwordx4 v2, s[20:23], s51 offen offset:2176 nt lds
  s_xor_b32 s51, s51, 16384
  s_add_u32 m0, s53, 12288
  s_waitcnt vmcnt(4)
  buffer_load_dwordx4 v1, s[20:23], s51 offen nt lds
  ds_read_b128 v[144:147], v6
  ds_read_b128 v[148:151], v7
  ds_read_b128 v[152:155], v8
  ds_read_b128 v[156:159], v9
  ds_read_b128 v[160:163], v6 offset:1024
  ds_read_b128 v[164:167], v7 offset:1024
  ds_read_b128 v[168:171], v8 offset:1024
  ds_read_b128 v[172:175], v9 offset:1024
  s_waitcnt vmcnt(4)
  buffer_load_dwordx4 v2, s[20:23], s51 offen offset:2048 nt lds
  s_waitcnt lgkmcnt(4)
  v_mfma_f32_32x32x16_bf16 v[128:143], v[144:147], v[32:35], 0
  v_mfma_f32_32x32x16_bf16 v[128:143], v[148:151], v[36:39], v[128:143]
  v_mfma_f32_32x32x16_bf16 v[128:143], v[152:155], v[40:43], v[128:143]
  v_mfma_f32_32x32x16_bf16 v[128:143], v[156:159], v[44:47], v[128:143]
  s_waitcnt lgkmcnt(0)
  v_mfma_f32_32x32x16_bf16 v[128:143], v[160:163], v[48:51], v[128:143]
  v_mfma_f32_32x32x16_bf16 v[128:143], v[164:167], v[52:55], v[128:143]
  v_mfma_f32_32x32x16_bf16 v[128:143], v[168:171], v[56:59], v[128:143]
  v_mfma_f32_32x32x16_bf16 v[128:143], v[172:175], v[60:63], v[128:143]
  s_add_u32 m0, s53, 13184
  s_waitcnt vmcnt(4)
  buffer_load_dwordx4 v1, s[20:23], s51 offen offset:128 nt lds
  v_mov_b32 v31, v24
  s_nop 7
  v_max3_f32 v26, v128, v129, v130
  v_max3_f32 v27, v131, v132, v133
  v_max3_f32 v28, v134, v135, v136
  v_max3_f32 v29, v137, v138, v139
  v_max3_f32 v30, v140, v141, v142
  v_max3_f32 v26, v26, v27, v28
  v_max3_f32 v29, v29, v30, v143
  v_max_f32 v27, v26, v29
  v_max_f32 v26, v26, v29
  s_nop 1
  v_permlane32_swap_b32 v26, v27
  v_max3_f32 v23, v26, v27, v23
  v_mul_f32 v24, s55, v23
  v_sub_f32 v31, v31, v24
  v_exp_f32 v22, v31
  v_fma_f32 v128, v128, s55, -v24
  v_fma_f32 v129, v129, s55, -v24
  v_fma_f32 v130, v130, s55, -v24
  v_fma_f32 v131, v131, s55, -v24
  ds_write_b32 v231, v22 offset:1024
  s_waitcnt vmcnt(4)
  buffer_load_dwordx4 v2, s[20:23], s51 offen offset:2176 nt lds
  s_xor_b32 s51, s51, 0x54000
  v_fma_f32 v132, v132, s55, -v24
  v_fma_f32 v133, v133, s55, -v24
  v_exp_f32 v128, v128
  v_fma_f32 v134, v134, s55, -v24
  v_fma_f32 v135, v135, s55, -v24
  v_exp_f32 v129, v129
  v_fma_f32 v136, v136, s55, -v24
  v_fma_f32 v137, v137, s55, -v24
  v_exp_f32 v130, v130
  v_fma_f32 v138, v138, s55, -v24
  v_fma_f32 v139, v139, s55, -v24
  v_exp_f32 v131, v131
  v_fma_f32 v140, v140, s55, -v24
  v_fma_f32 v141, v141, s55, -v24
  v_exp_f32 v132, v132
  v_fma_f32 v142, v142, s55, -v24
  v_fma_f32 v143, v143, s55, -v24
  v_exp_f32 v133, v133
  v_exp_f32 v134, v134
  v_exp_f32 v135, v135
  v_exp_f32 v136, v136
  v_exp_f32 v137, v137
  v_exp_f32 v138, v138
  v_exp_f32 v139, v139
  v_cvt_pk_bf16_f32 v176, v128, v129
  v_exp_f32 v140, v140
  v_cvt_pk_bf16_f32 v177, v130, v131
  v_exp_f32 v141, v141
  v_cvt_pk_bf16_f32 v178, v132, v133
  v_exp_f32 v142, v142
  v_cvt_pk_bf16_f32 v179, v134, v135
  v_exp_f32 v143, v143
  v_cvt_pk_bf16_f32 v180, v136, v137
  s_add_u32 m0, s53, 16384
  s_waitcnt vmcnt(4)
  buffer_load_dwordx4 v1, s[20:23], s51 offen nt lds
  v_fma_f32 v26, v25, v22, v128
  v_add_f32 v27, v130, v131
  v_add_f32 v28, v132, v133
  v_add_f32 v29, v134, v135
  v_add_f32 v26, v26, v129
  v_cvt_pk_bf16_f32 v181, v138, v139
  v_cvt_pk_bf16_f32 v182, v140, v141
  v_cvt_pk_bf16_f32 v183, v142, v143
  v_add_f32 v26, v26, v136
  v_accvgpr_write_b32 a64, v176
  v_add_f32 v27, v27, v137
  v_accvgpr_write_b32 a65, v177
  v_add_f32 v28, v28, v138
  v_accvgpr_write_b32 a66, v178
  v_add_f32 v29, v29, v139
  v_accvgpr_write_b32 a67, v179
  v_add_f32 v26, v26, v140
  v_accvgpr_write_b32 a68, v180
  v_add_f32 v27, v27, v141
  v_accvgpr_write_b32 a69, v181
  v_add_f32 v28, v28, v142
  v_accvgpr_write_b32 a70, v182
  v_add_f32 v29, v29, v143
  v_accvgpr_write_b32 a71, v183
  v_add_f32 v26, v26, v27
  v_add_f32 v28, v28, v29
  v_add_f32 v25, v26, v28
  s_waitcnt vmcnt(4)
  buffer_load_dwordx4 v2, s[20:23], s51 offen offset:2048 nt lds
  s_add_u32 m0, s53, 17280
  s_waitcnt vmcnt(4)
  buffer_load_dwordx4 v1, s[20:23], s51 offen offset:128 nt lds
  s_waitcnt vmcnt(4)
  buffer_load_dwordx4 v2, s[20:23], s51 offen offset:2176 nt lds
  s_xor_b32 s51, s51, 16384
  s_add_u32 m0, s53, 20480
  s_waitcnt vmcnt(4)
  buffer_load_dwordx4 v1, s[20:23], s51 offen nt lds
  ds_read_b128 v[144:147], v6 offset:8192
  ds_read_b128 v[148:151], v7 offset:8192
  ds_read_b128 v[152:155], v8 offset:8192
  ds_read_b128 v[156:159], v9 offset:8192
  ds_read_b128 v[160:163], v6 offset:9216
  ds_read_b128 v[164:167], v7 offset:9216
  ds_read_b128 v[168:171], v8 offset:9216
  ds_read_b128 v[172:175], v9 offset:9216
  s_waitcnt vmcnt(4)
  buffer_load_dwordx4 v2, s[20:23], s51 offen offset:2048 nt lds
  s_waitcnt lgkmcnt(4)
  v_mfma_f32_32x32x16_bf16 v[128:143], v[144:147], v[32:35], 0
  v_mfma_f32_32x32x16_bf16 v[128:143], v[148:151], v[36:39], v[128:143]
  v_mfma_f32_32x32x16_bf16 v[128:143], v[152:155], v[40:43], v[128:143]
  v_mfma_f32_32x32x16_bf16 v[128:143], v[156:159], v[44:47], v[128:143]
  s_cmp_eq_u32 s63, 9
  s_cbranch_scc0 1f
  global_load_dword v255, v254, s[16:17] sc1
1:
  s_waitcnt lgkmcnt(0)
  v_mfma_f32_32x32x16_bf16 v[128:143], v[160:163], v[48:51], v[128:143]
  v_mfma_f32_32x32x16_bf16 v[128:143], v[164:167], v[52:55], v[128:143]
  v_mfma_f32_32x32x16_bf16 v[128:143], v[168:171], v[56:59], v[128:143]
  v_mfma_f32_32x32x16_bf16 v[128:143], v[172:175], v[60:63], v[128:143]
  s_add_u32 m0, s53, 21376
  s_waitcnt vmcnt(4)
  buffer_load_dwordx4 v1, s[20:23], s51 offen offset:128 nt lds
  v_mov_b32 v31, v24
  s_nop 7
  v_max3_f32 v26, v128, v129, v130
  v_max3_f32 v27, v131, v132, v133
  v_max3_f32 v28, v134, v135, v136
  v_max3_f32 v29, v137, v138, v139
  v_max3_f32 v30, v140, v141, v142
  v_max3_f32 v26, v26, v27, v28
  v_max3_f32 v29, v29, v30, v143
  v_max_f32 v27, v26, v29
  v_max_f32 v26, v26, v29
  s_nop 1
  v_permlane32_swap_b32 v26, v27
  v_max3_f32 v23, v26, v27, v23
  v_mul_f32 v24, s55, v23
  v_sub_f32 v31, v31, v24
  v_exp_f32 v22, v31
  v_fma_f32 v128, v128, s55, -v24
  v_fma_f32 v129, v129, s55, -v24
  v_fma_f32 v130, v130, s55, -v24
  v_fma_f32 v131, v131, s55, -v24
  ds_write_b32 v231, v22 offset:1152
  s_waitcnt vmcnt(4)
  buffer_load_dwordx4 v2, s[20:23], s51 offen offset:2176 nt lds
  s_xor_b32 s51, s51, 0x14000
  v_fma_f32 v132, v132, s55, -v24
  v_fma_f32 v133, v133, s55, -v24
  v_exp_f32 v128, v128
  v_fma_f32 v134, v134, s55, -v24
  v_fma_f32 v135, v135, s55, -v24
  v_exp_f32 v129, v129
  v_fma_f32 v136, v136, s55, -v24
  v_fma_f32 v137, v137, s55, -v24
  v_exp_f32 v130, v130
  v_fma_f32 v138, v138, s55, -v24
  v_fma_f32 v139, v139, s55, -v24
  v_exp_f32 v131, v131
  v_fma_f32 v140, v140, s55, -v24
  v_fma_f32 v141, v141, s55, -v24
  v_exp_f32 v132, v132
  v_fma_f32 v142, v142, s55, -v24
  v_fma_f32 v143, v143, s55, -v24
  v_exp_f32 v133, v133
  v_exp_f32 v134, v134
  v_exp_f32 v135, v135
  v_exp_f32 v136, v136
  v_exp_f32 v137, v137
  v_exp_f32 v138, v138
  v_exp_f32 v139, v139
  v_cvt_pk_bf16_f32 v176, v128, v129
  v_exp_f32 v140, v140
  v_cvt_pk_bf16_f32 v177, v130, v131
  v_exp_f32 v141, v141
  v_cvt_pk_bf16_f32 v178, v132, v133
  v_exp_f32 v142, v142
  v_cvt_pk_bf16_f32 v179, v134, v135
  v_exp_f32 v143, v143
  v_cvt_pk_bf16_f32 v180, v136, v137
  s_add_u32 m0, s53, 24576
  s_waitcnt vmcnt(4)
  buffer_load_dwordx4 v1, s[20:23], s51 offen nt lds
  v_fma_f32 v26, v25, v22, v128
  v_add_f32 v27, v130, v131
  v_add_f32 v28, v132, v133
  v_add_f32 v29, v134, v135
  v_add_f32 v26, v26, v129
  v_cvt_pk_bf16_f32 v181, v138, v139
  v_cvt_pk_bf16_f32 v182, v140, v141
  v_cvt_pk_bf16_f32 v183, v142, v143
  v_add_f32 v26, v26, v136
  v_accvgpr_write_b32 a72, v176
  v_add_f32 v27, v27, v137
  v_accvgpr_write_b32 a73, v177
  v_add_f32 v28, v28, v138
  v_accvgpr_write_b32 a74, v178
  v_add_f32 v29, v29, v139
  v_accvgpr_write_b32 a75, v179
  v_add_f32 v26, v26, v140
  v_accvgpr_write_b32 a76, v180
  v_add_f32 v27, v27, v141
  v_accvgpr_write_b32 a77, v181
  v_add_f32 v28, v28, v142
  v_accvgpr_write_b32 a78, v182
  v_add_f32 v29, v29, v143
  v_accvgpr_write_b32 a79, v183
  v_add_f32 v26, v26, v27
  v_add_f32 v28, v28, v29
  v_add_f32 v25, v26, v28
  s_waitcnt vmcnt(4)
  buffer_load_dwordx4 v2, s[20:23], s51 offen offset:2048 nt lds
  s_add_u32 m0, s53, 25472
  s_waitcnt vmcnt(4)
  buffer_load_dwordx4 v1, s[20:23], s51 offen offset:128 nt lds
  s_waitcnt vmcnt(4)
  buffer_load_dwordx4 v2, s[20:23], s51 offen offset:2176 nt lds
  s_xor_b32 s51, s51, 16384
  s_add_u32 m0, s53, 28672
  s_waitcnt vmcnt(4)
  buffer_load_dwordx4 v1, s[20:23], s51 offen nt lds
  ds_read_b128 v[144:147], v6 offset:16384
  ds_read_b128 v[148:151], v7 offset:16384
  ds_read_b128 v[152:155], v8 offset:16384
  ds_read_b128 v[156:159], v9 offset:16384
  ds_read_b128 v[160:163], v6 offset:17408
  ds_read_b128 v[164:167], v7 offset:17408
  ds_read_b128 v[168:171], v8 offset:17408
  ds_read_b128 v[172:175], v9 offset:17408
  s_waitcnt vmcnt(4)
  buffer_load_dwordx4 v2, s[20:23], s51 offen offset:2048 nt lds
  s_waitcnt lgkmcnt(4)
  v_mfma_f32_32x32x16_bf16 v[128:143], v[144:147], v[32:35], 0
  v_mfma_f32_32x32x16_bf16 v[128:143], v[148:151], v[36:39], v[128:143]
  v_mfma_f32_32x32x16_bf16 v[128:143], v[152:155], v[40:43], v[128:143]
  v_mfma_f32_32x32x16_bf16 v[128:143], v[156:159], v[44:47], v[128:143]
  s_cmp_eq_u32 s63, 10
  s_cbranch_scc0 1f
  global_load_dword v255, v254, s[16:17] sc1
1:
  s_waitcnt lgkmcnt(0)
  v_mfma_f32_32x32x16_bf16 v[128:143], v[160:163], v[48:51], v[128:143]
  v_mfma_f32_32x32x16_bf16 v[128:143], v[164:167], v[52:55], v[128:143]
  v_mfma_f32_32x32x16_bf16 v[128:143], v[168:171], v[56:59], v[128:143]
  v_mfma_f32_32x32x16_bf16 v[128:143], v[172:175], v[60:63], v[128:143]
  s_add_u32 m0, s53, 29568
  s_waitcnt vmcnt(4)
  buffer_load_dwordx4 v1, s[20:23], s51 offen offset:128 nt lds
  v_mov_b32 v31, v24
  s_nop 7
  v_max3_f32 v26, v128, v129, v130
  v_max3_f32 v27, v131, v132, v133
  v_max3_f32 v28, v134, v135, v136
  v_max3_f32 v29, v137, v138, v139
  v_max3_f32 v30, v140, v141, v142
  v_max3_f32 v26, v26, v27, v28
  v_max3_f32 v29, v29, v30, v143
  v_max_f32 v27, v26, v29
  v_max_f32 v26, v26, v29
  s_nop 1
  v_permlane32_swap_b32 v26, v27
  v_max3_f32 v23, v26, v27, v23
  v_mul_f32 v24, s55, v23
  v_sub_f32 v31, v31, v24
  v_exp_f32 v22, v31
  v_fma_f32 v128, v128, s55, -v24
  v_fma_f32 v129, v129, s55, -v24
  v_fma_f32 v130, v130, s55, -v24
  v_fma_f32 v131, v131, s55, -v24
  ds_write_b32 v231, v22 offset:1280
  s_waitcnt vmcnt(4)
  buffer_load_dwordx4 v2, s[20:23], s51 offen offset:2176 nt lds
  s_xor_b32 s51, s51, 0xd4000
  v_fma_f32 v132, v132, s55, -v24
  v_fma_f32 v133, v133, s55, -v24
  v_exp_f32 v128, v128
  v_fma_f32 v134, v134, s55, -v24
  v_fma_f32 v135, v135, s55, -v24
  v_exp_f32 v129, v129
  v_fma_f32 v136, v136, s55, -v24
  v_fma_f32 v137, v137, s55, -v24
  v_exp_f32 v130, v130
  v_fma_f32 v138, v138, s55, -v24
  v_fma_f32 v139, v139, s55, -v24
  v_exp_f32 v131, v131
  v_fma_f32 v140, v140, s55, -v24
  v_fma_f32 v141, v141, s55, -v24
  v_exp_f32 v132, v132
  v_fma_f32 v142, v142, s55, -v24
  v_fma_f32 v143, v143, s55, -v24
  v_exp_f32 v133, v133
  v_exp_f32 v134, v134
  v_exp_f32 v135, v135
  v_exp_f32 v136, v136
  v_exp_f32 v137, v137
  v_exp_f32 v138, v138
  v_exp_f32 v139, v139
  v_cvt_pk_bf16_f32 v176, v128, v129
  v_exp_f32 v140, v140
  v_cvt_pk_bf16_f32 v177, v130, v131
  v_exp_f32 v141, v141
  v_cvt_pk_bf16_f32 v178, v132, v133
  v_exp_f32 v142, v142
  v_cvt_pk_bf16_f32 v179, v134, v135
  v_exp_f32 v143, v143
  v_cvt_pk_bf16_f32 v180, v136, v137
  s_mov_b32 m0, s53
  s_waitcnt vmcnt(4)
  buffer_load_dwordx4 v1, s[20:23], s51 offen nt lds
  v_fma_f32 v26, v25, v22, v128
  v_add_f32 v27, v130, v131
  v_add_f32 v28, v132, v133
  v_add_f32 v29, v134, v135
  v_add_f32 v26, v26, v129
  v_cvt_pk_bf16_f32 v181, v138, v139
  v_cvt_pk_bf16_f32 v182, v140, v141
  v_cvt_pk_bf16_f32 v183, v142, v143
  v_add_f32 v26, v26, v136
  v_accvgpr_write_b32 a80, v176
  v_add_f32 v27, v27, v137
  v_accvgpr_write_b32 a81, v177
  v_add_f32 v28, v28, v138
  v_accvgpr_write_b32 a82, v178
  v_add_f32 v29, v29, v139
  v_accvgpr_write_b32 a83, v179
  v_add_f32 v26, v26, v140
  v_accvgpr_write_b32 a84, v180
  v_add_f32 v27, v27, v141
  v_accvgpr_write_b32 a85, v181
  v_add_f32 v28, v28, v142
  v_accvgpr_write_b32 a86, v182
  v_add_f32 v29, v29, v143
  v_accvgpr_write_b32 a87, v183
  v_add_f32 v26, v26, v27
  v_add_f32 v28, v28, v29
  v_add_f32 v25, v26, v28
  s_waitcnt vmcnt(4)
  buffer_load_dwordx4 v2, s[20:23], s51 offen offset:2048 nt lds
  s_add_u32 m0, s53, 896
  s_waitcnt vmcnt(4)
  buffer_load_dwordx4 v1, s[20:23], s51 offen offset:128 nt lds
  s_waitcnt vmcnt(4)
  buffer_load_dwordx4 v2, s[20:23], s51 offen offset:2176 nt lds
  s_xor_b32 s51, s51, 16384
  s_add_u32 m0, s53, 4096
  s_waitcnt vmcnt(4)
  buffer_load_dwordx4 v1, s[20:23], s51 offen nt lds
  ds_read_b128 v[144:147], v6 offset:24576
  ds_read_b128 v[148:151], v7 offset:24576
  ds_read_b128 v[152:155], v8 offset:24576
  ds_read_b128 v[156:159], v9 offset:24576
  ds_read_b128 v[160:163], v6 offset:25600
  ds_read_b128 v[164:167], v7 offset:25600
  ds_read_b128 v[168:171], v8 offset:25600
  ds_read_b128 v[172:175], v9 offset:25600
  s_waitcnt vmcnt(4)
  buffer_load_dwordx4 v2, s[20:23], s51 offen offset:2048 nt lds
  s_waitcnt lgkmcnt(4)
  v_mfma_f32_32x32x16_bf16 v[128:143], v[144:147], v[32:35], 0
  v_mfma_f32_32x32x16_bf16 v[128:143], v[148:151], v[36:39], v[128:143]
  v_mfma_f32_32x32x16_bf16 v[128:143], v[152:155], v[40:43], v[128:143]
  v_mfma_f32_32x32x16_bf16 v[128:143], v[156:159], v[44:47], v[128:143]
  s_waitcnt lgkmcnt(0)
  v_mfma_f32_32x32x16_bf16 v[128:143], v[160:163], v[48:51], v[128:143]
  v_mfma_f32_32x32x16_bf16 v[128:143], v[164:167], v[52:55], v[128:143]
  v_mfma_f32_32x32x16_bf16 v[128:143], v[168:171], v[56:59], v[128:143]
  v_mfma_f32_32x32x16_bf16 v[128:143], v[172:175], v[60:63], v[128:143]
  s_add_u32 m0, s53, 4992
  s_waitcnt vmcnt(4)
  buffer_load_dwordx4 v1, s[20:23], s51 offen offset:128 nt lds
  v_mov_b32 v31, v24
  s_nop 7
  v_max3_f32 v26, v128, v129, v130
  v_max3_f32 v27, v131, v132, v133
  v_max3_f32 v28, v134, v135, v136
  v_max3_f32 v29, v137, v138, v139
  v_max3_f32 v30, v140, v141, v142
  v_max3_f32 v26, v26, v27, v28
  v_max3_f32 v29, v29, v30, v143
  v_max_f32 v27, v26, v29
  v_max_f32 v26, v26, v29
  s_nop 1
  v_permlane32_swap_b32 v26, v27
  v_max3_f32 v23, v26, v27, v23
  v_mul_f32 v24, s55, v23
  v_sub_f32 v31, v31, v24
  v_exp_f32 v22, v31
  v_fma_f32 v128, v128, s55, -v24
  v_fma_f32 v129, v129, s55, -v24
  v_fma_f32 v130, v130, s55, -v24
  v_fma_f32 v131, v131, s55, -v24
  ds_write_b32 v231, v22 offset:1408
  s_waitcnt vmcnt(4)
  buffer_load_dwordx4 v2, s[20:23], s51 offen offset:2176 nt lds
  s_xor_b32 s51, s51, 0x14000
  v_fma_f32 v132, v132, s55, -v24
  v_fma_f32 v133, v133, s55, -v24
  v_exp_f32 v128, v128
  v_fma_f32 v134, v134, s55, -v24
  v_fma_f32 v135, v135, s55, -v24
  v_exp_f32 v129, v129
  v_fma_f32 v136, v136, s55, -v24
  v_fma_f32 v137, v137, s55, -v24
  v_exp_f32 v130, v130
  v_fma_f32 v138, v138, s55, -v24
  v_fma_f32 v139, v139, s55, -v24
  v_exp_f32 v131, v131
  v_fma_f32 v140, v140, s55, -v24
  v_fma_f32 v141, v141, s55, -v24
  v_exp_f32 v132, v132
  v_fma_f32 v142, v142, s55, -v24
  v_fma_f32 v143, v143, s55, -v24
  v_exp_f32 v133, v133
  v_exp_f32 v134, v134
  v_exp_f32 v135, v135
  v_exp_f32 v136, v136
  v_exp_f32 v137, v137
  v_exp_f32 v138, v138
  v_exp_f32 v139, v139
  v_cvt_pk_bf16_f32 v176, v128, v129
  v_exp_f32 v140, v140
  v_cvt_pk_bf16_f32 v177, v130, v131
  v_exp_f32 v141, v141
  v_cvt_pk_bf16_f32 v178, v132, v133
  v_exp_f32 v142, v142
  v_cvt_pk_bf16_f32 v179, v134, v135
  v_exp_f32 v143, v143
  v_cvt_pk_bf16_f32 v180, v136, v137
  s_add_u32 m0, s53, 8192
  s_waitcnt vmcnt(4)
  buffer_load_dwordx4 v1, s[20:23], s51 offen nt lds
  v_fma_f32 v26, v25, v22, v128
  v_add_f32 v27, v130, v131
  v_add_f32 v28, v132, v133
  v_add_f32 v29, v134, v135
  v_add_f32 v26, v26, v129
  v_cvt_pk_bf16_f32 v181, v138, v139
  v_cvt_pk_bf16_f32 v182, v140, v141
  v_cvt_pk_bf16_f32 v183, v142, v143
  v_add_f32 v26, v26, v136
  v_accvgpr_write_b32 a88, v176
  v_add_f32 v27, v27, v137
  v_accvgpr_write_b32 a89, v177
  v_add_f32 v28, v28, v138
  v_accvgpr_write_b32 a90, v178
  v_add_f32 v29, v29, v139
  v_accvgpr_write_b32 a91, v179
  v_add_f32 v26, v26, v140
  v_accvgpr_write_b32 a92, v180
  v_add_f32 v27, v27, v141
  v_accvgpr_write_b32 a93, v181
  v_add_f32 v28, v28, v142
  v_accvgpr_write_b32 a94, v182
  v_add_f32 v29, v29, v143
  v_accvgpr_write_b32 a95, v183
  v_add_f32 v26, v26, v27
  v_add_f32 v28, v28, v29
  v_add_f32 v25, v26, v28
  s_waitcnt vmcnt(4)
  buffer_load_dwordx4 v2, s[20:23], s51 offen offset:2048 nt lds
  s_add_u32 m0, s53, 9088
  s_waitcnt vmcnt(4)
  buffer_load_dwordx4 v1, s[20:23], s51 offen offset:128 nt lds
  s_waitcnt vmcnt(4)
  buffer_load_dwordx4 v2, s[20:23], s51 offen offset:2176 nt lds
  s_xor_b32 s51, s51, 16384
  s_add_u32 m0, s53, 12288
  s_waitcnt vmcnt(4)
  buffer_load_dwordx4 v1, s[20:23], s51 offen nt lds
  ds_read_b128 v[144:147], v6
  ds_read_b128 v[148:151], v7
  ds_read_b128 v[152:155], v8
  ds_read_b128 v[156:159], v9
  ds_read_b128 v[160:163], v6 offset:1024
  ds_read_b128 v[164:167], v7 offset:1024
  ds_read_b128 v[168:171], v8 offset:1024
  ds_read_b128 v[172:175], v9 offset:1024
  s_waitcnt vmcnt(4)
  buffer_load_dwordx4 v2, s[20:23], s51 offen offset:2048 nt lds
  s_waitcnt lgkmcnt(4)
  v_mfma_f32_32x32x16_bf16 v[128:143], v[144:147], v[32:35], 0
  v_mfma_f32_32x32x16_bf16 v[128:143], v[148:151], v[36:39], v[128:143]
  v_mfma_f32_32x32x16_bf16 v[128:143], v[152:155], v[40:43], v[128:143]
  v_mfma_f32_32x32x16_bf16 v[128:143], v[156:159], v[44:47], v[128:143]
  s_cmp_lt_u32 s63, 9
  s_cbranch_scc1 2f
  s_mov_b32 s69, 0x200000
1:
  v_cmp_ne_u32 vcc, 1, v255
  s_sub_u32 s69, s69, 1
  s_cbranch_vccz 2f
  s_cmp_eq_u32 s69, 0
  s_cbranch_scc1 2f
  global_load_dword v255, v254, s[16:17] sc1
  s_waitcnt vmcnt(0)
  s_branch 1b
2:
  v_cmp_gt_u32 s[92:93], 32, v0
  v_lshlrev_b32 v254, 2, v0
  v_mov_b32 v26, 512
  v_cndmask_b32 v254, v26, v254, s[92:93]
  v_cndmask_b32 v247, 0, 1, s[92:93]
  v_subrev_u32 v26, 32, v0
  v_mul_u32_u24 v26, 342, v26
  v_lshrrev_b32 v26, 10, v26
  v_add_u32 v26, 1, v26
  v_cndmask_b32 v248, v26, 0, s[92:93]
  s_and_b32 s60, s2, 7
  v_lshlrev_b32 v249, 14, v0
  v_add_u32 v249, 5243008, v249
  v_cmp_ne_u32 s[92:93], s60, v0
  v_mov_b32 v26, 0x40000000
  s_movk_i32 s97, 512
  v_cndmask_b32 v249, v26, v249, s[92:93]
  s_lshr_b32 s96, s2, 3
  s_cmp_eq_u32 s3, 3
  s_cselect_b32 s96, s96, 0x100
  s_mov_b64 vcc, 0
  s_barrier
  s_waitcnt lgkmcnt(0)
  v_mfma_f32_32x32x16_bf16 v[128:143], v[160:163], v[48:51], v[128:143]
  v_mfma_f32_32x32x16_bf16 v[128:143], v[164:167], v[52:55], v[128:143]
  v_mfma_f32_32x32x16_bf16 v[128:143], v[168:171], v[56:59], v[128:143]
  v_mfma_f32_32x32x16_bf16 v[128:143], v[172:175], v[60:63], v[128:143]
  s_add_u32 m0, s53, 13184
  s_waitcnt vmcnt(4)
  buffer_load_dwordx4 v1, s[20:23], s51 offen offset:128 nt lds
  v_mov_b32 v31, v24
  s_nop 7
  v_max3_f32 v26, v128, v129, v130
  v_max3_f32 v27, v131, v132, v133
  v_max3_f32 v28, v134, v135, v136
  v_max3_f32 v29, v137, v138, v139
  v_max3_f32 v30, v140, v141, v142
  v_max3_f32 v26, v26, v27, v28
  v_max3_f32 v29, v29, v30, v143
  v_max_f32 v27, v26, v29
  v_max_f32 v26, v26, v29
  s_nop 1
  v_permlane32_swap_b32 v26, v27
  v_max3_f32 v23, v26, v27, v23
  v_mul_f32 v24, s55, v23
  v_sub_f32 v31, v31, v24
  v_exp_f32 v22, v31
  v_fma_f32 v128, v128, s55, -v24
  v_fma_f32 v129, v129, s55, -v24
  v_fma_f32 v130, v130, s55, -v24
  v_fma_f32 v131, v131, s55, -v24
  ds_write_b32 v231, v22 offset:1536
  s_waitcnt vmcnt(4)
  buffer_load_dwordx4 v2, s[20:23], s51 offen offset:2176 nt lds
  s_xor_b32 s51, s51, 0x54000
  v_fma_f32 v132, v132, s55, -v24
  v_fma_f32 v133, v133, s55, -v24
  v_exp_f32 v128, v128
  v_fma_f32 v134, v134, s55, -v24
  v_fma_f32 v135, v135, s55, -v24
  v_exp_f32 v129, v129
  v_fma_f32 v136, v136, s55, -v24
  v_fma_f32 v137, v137, s55, -v24
  v_exp_f32 v130, v130
  v_fma_f32 v138, v138, s55, -v24
  v_fma_f32 v139, v139, s55, -v24
  v_exp_f32 v131, v131
  v_fma_f32 v140, v140, s55, -v24
  v_fma_f32 v141, v141, s55, -v24
  v_exp_f32 v132, v132
  v_fma_f32 v142, v142, s55, -v24
  v_fma_f32 v143, v143, s55, -v24
  v_exp_f32 v133, v133
  v_exp_f32 v134, v134
  v_exp_f32 v135, v135
  v_exp_f32 v136, v136
  v_exp_f32 v137, v137
  v_exp_f32 v138, v138
  v_exp_f32 v139, v139
  v_cvt_pk_bf16_f32 v176, v128, v129
  v_exp_f32 v140, v140
  v_cvt_pk_bf16_f32 v177, v130, v131
  v_exp_f32 v141, v141
  v_cvt_pk_bf16_f32 v178, v132, v133
  v_exp_f32 v142, v142
  v_cvt_pk_bf16_f32 v179, v134, v135
  v_exp_f32 v143, v143
  v_cvt_pk_bf16_f32 v180, v136, v137
  s_add_u32 m0, s53, 16384
  s_waitcnt vmcnt(4)
  buffer_load_dwordx4 v1, s[20:23], s51 offen nt lds
  v_fma_f32 v26, v25, v22, v128
  v_add_f32 v27, v130, v131
  v_add_f32 v28, v132, v133
  v_add_f32 v29, v134, v135
  v_add_f32 v26, v26, v129
  v_cvt_pk_bf16_f32 v181, v138, v139
  v_cvt_pk_bf16_f32 v182, v140, v141
  v_cvt_pk_bf16_f32 v183, v142, v143
  v_add_f32 v26, v26, v136
  v_accvgpr_write_b32 a96, v176
  v_add_f32 v27, v27, v137
  v_accvgpr_write_b32 a97, v177
  v_add_f32 v28, v28, v138
  v_accvgpr_write_b32 a98, v178
  v_add_f32 v29, v29, v139
  v_accvgpr_write_b32 a99, v179
  v_add_f32 v26, v26, v140
  v_accvgpr_write_b32 a100, v180
  v_add_f32 v27, v27, v141
  v_accvgpr_write_b32 a101, v181
  v_add_f32 v28, v28, v142
  v_accvgpr_write_b32 a102, v182
  v_add_f32 v29, v29, v143
  v_accvgpr_write_b32 a103, v183
  v_add_f32 v26, v26, v27
  v_add_f32 v28, v28, v29
  v_add_f32 v25, v26, v28
  s_waitcnt vmcnt(4)
  buffer_load_dwordx4 v2, s[20:23], s51 offen offset:2048 nt lds
  s_add_u32 m0, s53, 17280
  s_waitcnt vmcnt(4)
  buffer_load_dwordx4 v1, s[20:23], s51 offen offset:128 nt lds
  s_waitcnt vmcnt(4)
  buffer_load_dwordx4 v2, s[20:23], s51 offen offset:2176 nt lds
  s_xor_b32 s51, s51, 16384
  s_waitcnt lgkmcnt(0)
L_join:
  s_add_u32 m0, s53, 20480
  s_waitcnt vmcnt(4)
  buffer_load_dwordx4 v1, s[20:23], s51 offen nt lds
  s_barrier
  ds_read_b128 v[144:147], v6 offset:8192
  ds_read_b128 v[148:151], v7 offset:8192
  ds_read_b128 v[152:155], v8 offset:8192
  ds_read_b128 v[156:159], v9 offset:8192
  ds_read_b128 v[160:163], v6 offset:9216
  ds_read_b128 v[164:167], v7 offset:9216
  ds_read_b128 v[168:171], v8 offset:9216
  ds_read_b128 v[172:175], v9 offset:9216
  buffer_load_dwordx4 v2, s[20:23], s51 offen offset:2048 nt lds
  s_waitcnt lgkmcnt(4)
  v_mfma_f32_32x32x16_bf16 v[128:143], v[144:147], v[32:35], 0
  v_mfma_f32_32x32x16_bf16 v[128:143], v[148:151], v[36:39], v[128:143]
  v_mfma_f32_32x32x16_bf16 v[128:143], v[152:155], v[40:43], v[128:143]
  v_mfma_f32_32x32x16_bf16 v[128:143], v[156:159], v[44:47], v[128:143]
  s_add_u32 m0, s53, 21376
  s_waitcnt vmcnt(5)
  buffer_load_dwordx4 v1, s[20:23], s51 offen offset:128 nt lds
  s_lshl1_add_u32 s62, s3, 0
  s_mul_i32 s62, s62, 36864
  s_add_u32 s62, s62, s66
  s_add_u32 m0, s53, 24576
  s_nop 0
  buffer_load_dwordx4 v19, s[36:39], s62 offen lds
  s_addk_i32 s62, 9216
  s_waitcnt lgkmcnt(0)
  v_mfma_f32_32x32x16_bf16 v[128:143], v[160:163], v[48:51], v[128:143]
  v_mfma_f32_32x32x16_bf16 v[128:143], v[164:167], v[52:55], v[128:143]
  v_mfma_f32_32x32x16_bf16 v[128:143], v[168:171], v[56:59], v[128:143]
  v_mfma_f32_32x32x16_bf16 v[128:143], v[172:175], v[60:63], v[128:143]
  s_add_u32 m0, s53, 21376
  s_waitcnt vmcnt(6)
  buffer_load_dwordx4 v2, s[20:23], s51 offen offset:2176 nt lds
  s_xor_b32 s51, s51, 0x14000
  v_mov_b32 v31, v24
  s_nop 6
  v_max3_f32 v26, v128, v129, v130
  v_max3_f32 v27, v131, v132, v133
  v_max3_f32 v28, v134, v135, v136
  v_max3_f32 v29, v137, v138, v139
  v_max3_f32 v30, v140, v141, v142
  v_max3_f32 v26, v26, v27, v28
  v_max3_f32 v29, v29, v30, v143
  v_max_f32 v27, v26, v29
  v_max_f32 v26, v26, v29
  s_nop 1
  v_permlane32_swap_b32 v26, v27
  v_max3_f32 v23, v26, v27, v23
  v_mul_f32 v24, s55, v23
  v_sub_f32 v31, v31, v24
  v_exp_f32 v22, v31
  v_fma_f32 v128, v128, s55, -v24
  v_fma_f32 v129, v129, s55, -v24
  v_fma_f32 v130, v130, s55, -v24
  v_fma_f32 v131, v131, s55, -v24
  ds_write_b32 v231, v22 offset:1664
  s_mov_b32 m0, s53
  s_waitcnt vmcnt(6)
  buffer_load_dwordx4 v1, s[20:23], s51 offen nt lds
  s_barrier
  v_fma_f32 v132, v132, s55, -v24
  v_fma_f32 v133, v133, s55, -v24
  v_exp_f32 v128, v128
  v_fma_f32 v134, v134, s55, -v24
  v_fma_f32 v135, v135, s55, -v24
  v_exp_f32 v129, v129
  v_fma_f32 v136, v136, s55, -v24
  v_fma_f32 v137, v137, s55, -v24
  v_exp_f32 v130, v130
  v_fma_f32 v138, v138, s55, -v24
  v_fma_f32 v139, v139, s55, -v24
  v_exp_f32 v131, v131
  v_fma_f32 v140, v140, s55, -v24
  v_fma_f32 v141, v141, s55, -v24
  v_exp_f32 v132, v132
  v_fma_f32 v142, v142, s55, -v24
  v_fma_f32 v143, v143, s55, -v24
  v_exp_f32 v133, v133
  s_waitcnt vmcnt(6)
  buffer_load_dwordx4 v2, s[20:23], s51 offen offset:2048 nt lds
  v_exp_f32 v134, v134
  v_exp_f32 v135, v135
  v_exp_f32 v136, v136
  v_exp_f32 v137, v137
  v_exp_f32 v138, v138
  v_exp_f32 v139, v139
  v_cvt_pk_bf16_f32 v176, v128, v129
  v_exp_f32 v140, v140
  v_cvt_pk_bf16_f32 v177, v130, v131
  v_exp_f32 v141, v141
  v_cvt_pk_bf16_f32 v178, v132, v133
  v_exp_f32 v142, v142
  v_cvt_pk_bf16_f32 v179, v134, v135
  v_exp_f32 v143, v143
  v_cvt_pk_bf16_f32 v180, v136, v137
  s_add_u32 m0, s53, 896
  s_waitcnt vmcnt(6)
  buffer_load_dwordx4 v1, s[20:23], s51 offen offset:128 nt lds
  s_add_u32 m0, s53, 25600
  s_nop 0
  buffer_load_dwordx4 v19, s[36:39], s62 offen lds
  s_addk_i32 s62, 9216
  v_fma_f32 v26, v25, v22, v128
  v_add_f32 v27, v130, v131
  v_add_f32 v28, v132, v133
  v_add_f32 v29, v134, v135
  v_add_f32 v26, v26, v129
  v_cvt_pk_bf16_f32 v181, v138, v139
  v_cvt_pk_bf16_f32 v182, v140, v141
  v_cvt_pk_bf16_f32 v183, v142, v143
  v_add_f32 v26, v26, v136
  v_accvgpr_write_b32 a104, v176
  v_add_f32 v27, v27, v137
  v_accvgpr_write_b32 a105, v177
  v_add_f32 v28, v28, v138
  v_accvgpr_write_b32 a106, v178
  v_add_f32 v29, v29, v139
  v_accvgpr_write_b32 a107, v179
  v_add_f32 v26, v26, v140
  v_accvgpr_write_b32 a108, v180
  v_add_f32 v27, v27, v141
  v_accvgpr_write_b32 a109, v181
  v_add_f32 v28, v28, v142
  v_accvgpr_write_b32 a110, v182
  v_add_f32 v29, v29, v143
  v_accvgpr_write_b32 a111, v183
  v_add_f32 v26, v26, v27
  v_add_f32 v28, v28, v29
  v_add_f32 v25, v26, v28
  s_add_u32 m0, s53, 896
  s_waitcnt vmcnt(7)
  buffer_load_dwordx4 v2, s[20:23], s51 offen offset:2176 nt lds
  s_xor_b32 s51, s51, 16384
  s_add_u32 m0, s53, 4096
  s_waitcnt vmcnt(7)
  buffer_load_dwordx4 v1, s[20:23], s51 offen nt lds
  s_barrier
  s_waitcnt vmcnt(5)
  buffer_load_dwordx4 v2, s[20:23], s51 offen offset:2048 nt lds
  ds_read_b128 v[144:147], v6 offset:16384
  ds_read_b128 v[148:151], v7 offset:16384
  ds_read_b128 v[152:155], v8 offset:16384
  ds_read_b128 v[156:159], v9 offset:16384
  ds_read_b128 v[160:163], v6 offset:17408
  ds_read_b128 v[164:167], v7 offset:17408
  ds_read_b128 v[168:171], v8 offset:17408
  ds_read_b128 v[172:175], v9 offset:17408
  s_add_u32 m0, s53, 4992
  s_waitcnt vmcnt(5)
  buffer_load_dwordx4 v1, s[20:23], s51 offen offset:128 nt lds
  s_add_u32 m0, s53, 26624
  s_nop 0
  buffer_load_dwordx4 v19, s[36:39], s62 offen lds
  s_addk_i32 s62, 9216
  s_waitcnt lgkmcnt(4)
  v_mfma_f32_32x32x16_bf16 v[128:143], v[144:147], v[32:35], 0
  v_mfma_f32_32x32x16_bf16 v[128:143], v[148:151], v[36:39], v[128:143]
  v_mfma_f32_32x32x16_bf16 v[128:143], v[152:155], v[40:43], v[128:143]
  v_mfma_f32_32x32x16_bf16 v[128:143], v[156:159], v[44:47], v[128:143]
  s_add_u32 m0, s53, 4992
  s_waitcnt vmcnt(6)
  buffer_load_dwordx4 v2, s[20:23], s51 offen offset:2176 nt lds
  s_xor_b32 s51, s51, 0x1f4000
  s_waitcnt lgkmcnt(0)
  v_mfma_f32_32x32x16_bf16 v[128:143], v[160:163], v[48:51], v[128:143]
  v_mfma_f32_32x32x16_bf16 v[128:143], v[164:167], v[52:55], v[128:143]
  v_mfma_f32_32x32x16_bf16 v[128:143], v[168:171], v[56:59], v[128:143]
  v_mfma_f32_32x32x16_bf16 v[128:143], v[172:175], v[60:63], v[128:143]
  s_add_u32 m0, s53, 8192
  s_cbranch_vccnz 9f
  s_waitcnt vmcnt(5)
9:
  buffer_load_dwordx4 v1, s[20:23], s51 offen nt lds
  s_add_u32 s91, s91, 1
  s_and_b32 s60, s91, 3
  s_cmp_eq_u32 s60, s3
  s_cbranch_scc0 1f
  v_mov_b32 v252, s91
  s_mov_b64 exec, 1
  buffer_store_dword v252, off, s[40:43], s94
  s_mov_b64 exec, -1
1:
  s_barrier
  buffer_load_dword v255, v254, s[40:43], s95 offen sc1
  s_addk_i32 s97, 512
  s_add_u32 s96, s96, 30
  s_and_b32 s96, s96, 0x11f
  s_cmp_eq_u32 s96, 0
  s_cbranch_scc0 1f
  s_add_u32 s60, s97, s95
  s_mov_b32 exec_hi, 0
  buffer_store_dword v253, v254, s[40:43], s60 offen sc1
  s_mov_b32 exec_hi, -1
1:
  v_mov_b32 v31, v24
  v_max3_f32 v26, v128, v129, v130
  v_max3_f32 v27, v131, v132, v133
  v_max3_f32 v28, v134, v135, v136
  v_max3_f32 v29, v137, v138, v139
  v_max3_f32 v30, v140, v141, v142
  v_max3_f32 v26, v26, v27, v28
  v_max3_f32 v29, v29, v30, v143
  v_max_f32 v27, v26, v29
  v_max_f32 v26, v26, v29
  s_nop 1
  v_permlane32_swap_b32 v26, v27
  v_max3_f32 v23, v26, v27, v23
  v_mul_f32 v24, s55, v23
  v_sub_f32 v31, v31, v24
  v_exp_f32 v22, v31
  v_fma_f32 v128, v128, s55, -v24
  v_fma_f32 v129, v129, s55, -v24
  v_fma_f32 v130, v130, s55, -v24
  v_fma_f32 v131, v131, s55, -v24
  ds_write_b32 v231, v22 offset:1792
  s_cbranch_vccnz 9f
  s_waitcnt vmcnt(6)
9:
  buffer_load_dwordx4 v2, s[20:23], s51 offen offset:2048 nt lds
  v_fma_f32 v132, v132, s55, -v24
  v_fma_f32 v133, v133, s55, -v24
  v_exp_f32 v128, v128
  v_fma_f32 v134, v134, s55, -v24
  v_fma_f32 v135, v135, s55, -v24
  v_exp_f32 v129, v129
  v_fma_f32 v136, v136, s55, -v24
  v_fma_f32 v137, v137, s55, -v24
  v_exp_f32 v130, v130
  v_fma_f32 v138, v138, s55, -v24
  v_fma_f32 v139, v139, s55, -v24
  v_exp_f32 v131, v131
  v_fma_f32 v140, v140, s55, -v24
  v_fma_f32 v141, v141, s55, -v24
  v_exp_f32 v132, v132
  v_fma_f32 v142, v142, s55, -v24
  v_fma_f32 v143, v143, s55, -v24
  v_exp_f32 v133, v133
  s_add_u32 m0, s53, 9088
  s_cbranch_vccnz 9f
  s_waitcnt vmcnt(6)
9:
  buffer_load_dwordx4 v1, s[20:23], s51 offen offset:128 nt lds
  s_cmp_eq_u32 s96, 1
  s_cbranch_scc0 1f
  buffer_load_dword v250, v249, s[40:43], s97 offen sc1
1:
  s_add_u32 m0, s53, 27648
  s_nop 0
  buffer_load_dwordx4 v19, s[36:39], s62 offen lds
  v_exp_f32 v134, v134
  v_exp_f32 v135, v135
  v_exp_f32 v136, v136
  v_exp_f32 v137, v137
  v_exp_f32 v138, v138
  v_exp_f32 v139, v139
  v_cvt_pk_bf16_f32 v176, v128, v129
  v_exp_f32 v140, v140
  v_cvt_pk_bf16_f32 v177, v130, v131
  v_exp_f32 v141, v141
  v_cvt_pk_bf16_f32 v178, v132, v133
  v_exp_f32 v142, v142
  v_cvt_pk_bf16_f32 v179, v134, v135
  v_exp_f32 v143, v143
  v_cvt_pk_bf16_f32 v180, v136, v137
  s_add_u32 m0, s53, 9088
  s_cbranch_vccnz 9f
  s_waitcnt vmcnt(7)
9:
  s_waitcnt vmcnt(10)
  buffer_load_dwordx4 v2, s[20:23], s51 offen offset:2176 nt lds
  s_xor_b32 s51, s51, 16384
  v_fma_f32 v26, v25, v22, v128
  v_add_f32 v27, v130, v131
  v_add_f32 v28, v132, v133
  v_add_f32 v29, v134, v135
  v_add_f32 v26, v26, v129
  v_cvt_pk_bf16_f32 v181, v138, v139
  v_cvt_pk_bf16_f32 v182, v140, v141
  v_cvt_pk_bf16_f32 v183, v142, v143
  v_add_f32 v26, v26, v136
  v_accvgpr_write_b32 a112, v176
  v_add_f32 v27, v27, v137
  v_accvgpr_write_b32 a113, v177
  v_add_f32 v28, v28, v138
  v_accvgpr_write_b32 a114, v178
  v_add_f32 v29, v29, v139
  v_accvgpr_write_b32 a115, v179
  v_add_f32 v26, v26, v140
  v_accvgpr_write_b32 a116, v180
  v_add_f32 v27, v27, v141
  v_accvgpr_write_b32 a117, v181
  v_add_f32 v28, v28, v142
  v_accvgpr_write_b32 a118, v182
  v_add_f32 v29, v29, v143
  v_accvgpr_write_b32 a119, v183
  v_add_f32 v26, v26, v27
  v_add_f32 v28, v28, v29
  v_add_f32 v25, v26, v28
  s_add_u32 m0, s53, 12288
  s_cbranch_vccnz 9f
  s_waitcnt vmcnt(6)
9:
  s_waitcnt vmcnt(10)
  buffer_load_dwordx4 v1, s[20:23], s51 offen nt lds
  s_barrier
  s_cbranch_vccnz 9f
  s_waitcnt vmcnt(6)
9:
  s_waitcnt vmcnt(10)
  buffer_load_dwordx4 v2, s[20:23], s51 offen offset:2048 nt lds
  s_add_u32 m0, s53, 13184
  s_cbranch_vccnz 9f
  s_waitcnt vmcnt(5)
9:
  s_waitcnt vmcnt(10)
  buffer_load_dwordx4 v1, s[20:23], s51 offen offset:128 nt lds
  s_lshl1_add_u32 s98, s3, 1
  s_mul_i32 s98, s98, 36864
  s_add_u32 s98, s98, s66
  s_add_u32 m0, s53, 28672
  s_nop 0
  buffer_load_dwordx4 v19, s[36:39], s98 offen lds
  s_addk_i32 s98, 9216
  s_add_u32 m0, s53, 13184
  s_cbranch_vccnz 9f
  s_waitcnt vmcnt(6)
9:
  s_waitcnt vmcnt(10)
  buffer_load_dwordx4 v2, s[20:23], s51 offen offset:2176 nt lds
  s_xor_b32 s51, s51, 0x14000
  ds_read_b128 v[144:147], v6
  ds_read_b128 v[148:151], v7
  ds_read_b128 v[152:155], v8
  ds_read_b128 v[156:159], v9
  ds_read_b128 v[160:163], v6 offset:1024
  ds_read_b128 v[164:167], v7 offset:1024
  ds_read_b128 v[168:171], v8 offset:1024
  ds_read_b128 v[172:175], v9 offset:1024
  s_add_u32 m0, s53, 16384
  s_cbranch_vccnz 9f
  s_waitcnt vmcnt(5)
9:
  s_waitcnt vmcnt(10)
  buffer_load_dwordx4 v1, s[20:23], s51 offen nt lds
  s_barrier
  s_waitcnt lgkmcnt(4)
  v_mfma_f32_32x32x16_bf16 v[128:143], v[144:147], v[32:35], 0
  v_mfma_f32_32x32x16_bf16 v[128:143], v[148:151], v[36:39], v[128:143]
  v_mfma_f32_32x32x16_bf16 v[128:143], v[152:155], v[40:43], v[128:143]
  v_mfma_f32_32x32x16_bf16 v[128:143], v[156:159], v[44:47], v[128:143]
  s_cbranch_vccnz 9f
  s_waitcnt vmcnt(5)
9:
  s_waitcnt vmcnt(9)
  buffer_load_dwordx4 v2, s[20:23], s51 offen offset:2048 nt lds
  v_add_u32 v248, v248, v247
  v_cmp_le_i32 s[92:93], v248, v255
  s_nop 0
  s_bcnt1_i32_b64 s60, s[92:93]
  s_cmp_ge_u32 s60, 33
  s_cselect_b64 vcc, -1, 0
  s_waitcnt lgkmcnt(0)
  v_mfma_f32_32x32x16_bf16 v[128:143], v[160:163], v[48:51], v[128:143]
  v_mfma_f32_32x32x16_bf16 v[128:143], v[164:167], v[52:55], v[128:143]
  v_mfma_f32_32x32x16_bf16 v[128:143], v[168:171], v[56:59], v[128:143]
  v_mfma_f32_32x32x16_bf16 v[128:143], v[172:175], v[60:63], v[128:143]
  s_add_u32 m0, s53, 17280
  s_cbranch_vccnz 9f
  s_waitcnt vmcnt(5)
9:
  s_waitcnt vmcnt(9)
  buffer_load_dwordx4 v1, s[20:23], s51 offen offset:128 nt lds
  s_add_u32 m0, s53, 29696
  s_nop 0
  buffer_load_dwordx4 v19, s[36:39], s98 offen lds
  s_addk_i32 s98, 9216
  v_mov_b32 v31, v24
  s_nop 2
  v_max3_f32 v26, v128, v129, v130
  v_max3_f32 v27, v131, v132, v133
  v_max3_f32 v28, v134, v135, v136
  v_max3_f32 v29, v137, v138, v139
  v_max3_f32 v30, v140, v141, v142
  v_max3_f32 v26, v26, v27, v28
  v_max3_f32 v29, v29, v30, v143
  v_max_f32 v27, v26, v29
  v_max_f32 v26, v26, v29
  s_nop 1
  v_permlane32_swap_b32 v26, v27
  v_max3_f32 v23, v26, v27, v23
  v_mul_f32 v24, s55, v23
  v_sub_f32 v31, v31, v24
  v_exp_f32 v22, v31
  v_fma_f32 v128, v128, s55, -v24
  v_fma_f32 v129, v129, s55, -v24
  v_fma_f32 v130, v130, s55, -v24
  v_fma_f32 v131, v131, s55, -v24
  ds_write_b32 v231, v22 offset:1920
  s_add_u32 m0, s53, 17280
  s_cbranch_vccnz 9f
  s_waitcnt vmcnt(6)
9:
  s_waitcnt vmcnt(9)
  buffer_load_dwordx4 v2, s[20:23], s51 offen offset:2176 nt lds
  s_xor_b32 s51, s51, 16384
  s_cmp_eq_u32 s96, 1
  s_cbranch_scc0 1f
  v_cmp_lt_i32 s[92:93], 0, v250
  s_nop 0
  s_bcnt1_i32_b32 s60, s92
  v_mov_b32 v250, s60
  s_mov_b64 exec, 1
  buffer_store_dword v250, off, s[40:43], s95 offset:512
  buffer_store_dword v250, off, s[40:43], s95 offset:768
  buffer_store_dword v250, off, s[40:43], s95 offset:1792
  s_mov_b64 exec, -1
1:
  v_fma_f32 v132, v132, s55, -v24
  v_fma_f32 v133, v133, s55, -v24
  v_exp_f32 v128, v128
  v_fma_f32 v134, v134, s55, -v24
  v_fma_f32 v135, v135, s55, -v24
  v_exp_f32 v129, v129
  v_fma_f32 v136, v136, s55, -v24
  v_fma_f32 v137, v137, s55, -v24
  v_exp_f32 v130, v130
  v_fma_f32 v138, v138, s55, -v24
  v_fma_f32 v139, v139, s55, -v24
  v_exp_f32 v131, v131
  v_fma_f32 v140, v140, s55, -v24
  v_fma_f32 v141, v141, s55, -v24
  v_exp_f32 v132, v132
  v_fma_f32 v142, v142, s55, -v24
  v_fma_f32 v143, v143, s55, -v24
  v_exp_f32 v133, v133
  s_add_u32 m0, s53, 20480
  s_cbranch_vccnz 9f
  s_waitcnt vmcnt(5)
9:
  s_waitcnt vmcnt(9)
  buffer_load_dwordx4 v1, s[20:23], s51 offen nt lds
  s_barrier
  v_exp_f32 v134, v134
  v_exp_f32 v135, v135
  v_exp_f32 v136, v136
  v_exp_f32 v137, v137
  v_exp_f32 v138, v138
  v_exp_f32 v139, v139
  v_cvt_pk_bf16_f32 v176, v128, v129
  v_exp_f32 v140, v140
  v_cvt_pk_bf16_f32 v177, v130, v131
  v_exp_f32 v141, v141
  v_cvt_pk_bf16_f32 v178, v132, v133
  v_exp_f32 v142, v142
  v_cvt_pk_bf16_f32 v179, v134, v135
  v_exp_f32 v143, v143
  v_cvt_pk_bf16_f32 v180, v136, v137
  s_cbranch_vccnz 9f
  s_waitcnt vmcnt(5)
9:
  s_waitcnt vmcnt(9)
  buffer_load_dwordx4 v2, s[20:23], s51 offen offset:2048 nt lds
  v_fma_f32 v26, v25, v22, v128
  v_add_f32 v27, v130, v131
  v_add_f32 v28, v132, v133
  v_add_f32 v29, v134, v135
  v_add_f32 v26, v26, v129
  v_cvt_pk_bf16_f32 v181, v138, v139
  v_cvt_pk_bf16_f32 v182, v140, v141
  v_cvt_pk_bf16_f32 v183, v142, v143
  v_add_f32 v26, v26, v136
  v_accvgpr_write_b32 a120, v176
  v_add_f32 v27, v27, v137
  v_accvgpr_write_b32 a121, v177
  v_add_f32 v28, v28, v138
  v_accvgpr_write_b32 a122, v178
  v_add_f32 v29, v29, v139
  v_accvgpr_write_b32 a123, v179
  v_add_f32 v26, v26, v140
  v_accvgpr_write_b32 a124, v180
  v_add_f32 v27, v27, v141
  v_accvgpr_write_b32 a125, v181
  v_add_f32 v28, v28, v142
  v_accvgpr_write_b32 a126, v182
  v_add_f32 v29, v29, v143
  v_accvgpr_write_b32 a127, v183
  v_add_f32 v26, v26, v27
  v_add_f32 v28, v28, v29
  v_add_f32 v25, v26, v28
  s_add_u32 m0, s53, 21376
  s_cbranch_vccnz 9f
  s_waitcnt vmcnt(5)
9:
  s_waitcnt vmcnt(9)
  buffer_load_dwordx4 v1, s[20:23], s51 offen offset:128 nt lds
  s_add_u32 m0, s53, 30720
  s_nop 0
  buffer_load_dwordx4 v19, s[36:39], s98 offen lds
  s_addk_i32 s98, 9216
  s_add_u32 m0, s53, 21376
  s_cbranch_vccnz 9f
  s_waitcnt vmcnt(6)
9:
  s_waitcnt vmcnt(9)
  buffer_load_dwordx4 v2, s[20:23], s51 offen offset:2176 nt lds
  s_xor_b32 s51, s51, 0x54000
  ds_read_b128 v[144:147], v6 offset:8192
  ds_read_b128 v[148:151], v7 offset:8192
  ds_read_b128 v[152:155], v8 offset:8192
  ds_read_b128 v[156:159], v9 offset:8192
  ds_read_b128 v[160:163], v6 offset:9216
  ds_read_b128 v[164:167], v7 offset:9216
  ds_read_b128 v[168:171], v8 offset:9216
  ds_read_b128 v[172:175], v9 offset:9216
  s_mov_b32 m0, s53
  s_cbranch_vccnz 9f
  s_waitcnt vmcnt(5)
9:
  s_waitcnt vmcnt(9)
  buffer_load_dwordx4 v1, s[20:23], s51 offen nt lds
  s_add_u32 s91, s91, 1
  s_and_b32 s60, s91, 3
  s_cmp_eq_u32 s60, s3
  s_cbranch_scc0 1f
  v_mov_b32 v252, s91
  s_mov_b64 exec, 1
  buffer_store_dword v252, off, s[40:43], s94 offset:256
  s_mov_b64 exec, -1
1:
  s_barrier
  buffer_load_dword v251, v254, s[40:43], s95 offen offset:256 sc1
  s_addk_i32 s97, 512
  s_add_u32 s96, s96, 30
  s_and_b32 s96, s96, 0x11f
  s_cmp_eq_u32 s96, 0
  s_cbranch_scc0 1f
  s_add_u32 s60, s97, s95
  s_mov_b32 exec_hi, 0
  buffer_store_dword v253, v254, s[40:43], s60 offen sc1
  s_mov_b32 exec_hi, -1
1:
  s_waitcnt lgkmcnt(4)
  v_mfma_f32_32x32x16_bf16 v[128:143], v[144:147], v[32:35], 0
  v_mfma_f32_32x32x16_bf16 v[128:143], v[148:151], v[36:39], v[128:143]
  v_mfma_f32_32x32x16_bf16 v[128:143], v[152:155], v[40:43], v[128:143]
  v_mfma_f32_32x32x16_bf16 v[128:143], v[156:159], v[44:47], v[128:143]
  s_cbranch_vccnz 9f
  s_waitcnt vmcnt(6)
9:
  s_waitcnt vmcnt(10)
  buffer_load_dwordx4 v2, s[20:23], s51 offen offset:2048 nt lds
  s_waitcnt lgkmcnt(0)
  v_mfma_f32_32x32x16_bf16 v[128:143], v[160:163], v[48:51], v[128:143]
  v_mfma_f32_32x32x16_bf16 v[128:143], v[164:167], v[52:55], v[128:143]
  v_mfma_f32_32x32x16_bf16 v[128:143], v[168:171], v[56:59], v[128:143]
  v_mfma_f32_32x32x16_bf16 v[128:143], v[172:175], v[60:63], v[128:143]
  s_add_u32 m0, s53, 896
  s_cbranch_vccnz 9f
  s_waitcnt vmcnt(6)
9:
  s_waitcnt vmcnt(10)
  buffer_load_dwordx4 v1, s[20:23], s51 offen offset:128 nt lds
  s_cmp_eq_u32 s96, 1
  s_cbranch_scc0 1f
  buffer_load_dword v250, v249, s[40:43], s97 offen sc1
1:
  s_add_u32 m0, s53, 31744
  s_nop 0
  buffer_load_dwordx4 v19, s[36:39], s98 offen lds
  v_mov_b32 v31, v24
  s_nop 1
  v_max3_f32 v26, v128, v129, v130
  v_max3_f32 v27, v131, v132, v133
  v_max3_f32 v28, v134, v135, v136
  v_max3_f32 v29, v137, v138, v139
  v_max3_f32 v30, v140, v141, v142
  v_max3_f32 v26, v26, v27, v28
  v_max3_f32 v29, v29, v30, v143
  v_max_f32 v27, v26, v29
  v_max_f32 v26, v26, v29
  s_nop 1
  v_permlane32_swap_b32 v26, v27
  v_max3_f32 v23, v26, v27, v23
  v_mul_f32 v24, s55, v23
  v_sub_f32 v31, v31, v24
  v_exp_f32 v22, v31
  v_fma_f32 v128, v128, s55, -v24
  v_fma_f32 v129, v129, s55, -v24
  v_fma_f32 v130, v130, s55, -v24
  v_fma_f32 v131, v131, s55, -v24
  ds_write_b32 v231, v22 offset:2048
  s_add_u32 m0, s53, 896
  s_cbranch_vccnz 9f
  s_waitcnt vmcnt(7)
9:
  s_waitcnt vmcnt(10)
  buffer_load_dwordx4 v2, s[20:23], s51 offen offset:2176 nt lds
  s_xor_b32 s51, s51, 16384
  v_fma_f32 v132, v132, s55, -v24
  v_fma_f32 v133, v133, s55, -v24
  v_exp_f32 v128, v128
  v_fma_f32 v134, v134, s55, -v24
  v_fma_f32 v135, v135, s55, -v24
  v_exp_f32 v129, v129
  v_fma_f32 v136, v136, s55, -v24
  v_fma_f32 v137, v137, s55, -v24
  v_exp_f32 v130, v130
  v_fma_f32 v138, v138, s55, -v24
  v_fma_f32 v139, v139, s55, -v24
  v_exp_f32 v131, v131
  v_fma_f32 v140, v140, s55, -v24
  v_fma_f32 v141, v141, s55, -v24
  v_exp_f32 v132, v132
  v_fma_f32 v142, v142, s55, -v24
  v_fma_f32 v143, v143, s55, -v24
  v_exp_f32 v133, v133
  s_add_u32 m0, s53, 4096
  s_cbranch_vccnz 9f
  s_waitcnt vmcnt(6)
9:
  s_waitcnt vmcnt(10)
  buffer_load_dwordx4 v1, s[20:23], s51 offen nt lds
  s_barrier
  v_exp_f32 v134, v134
  v_exp_f32 v135, v135
  v_exp_f32 v136, v136
  v_exp_f32 v137, v137
  v_exp_f32 v138, v138
  v_exp_f32 v139, v139
  v_cvt_pk_bf16_f32 v176, v128, v129
  v_exp_f32 v140, v140
  v_cvt_pk_bf16_f32 v177, v130, v131
  v_exp_f32 v141, v141
  v_cvt_pk_bf16_f32 v178, v132, v133
  v_exp_f32 v142, v142
  v_cvt_pk_bf16_f32 v179, v134, v135
  v_exp_f32 v143, v143
  v_cvt_pk_bf16_f32 v180, v136, v137
  s_cbranch_vccnz 9f
  s_waitcnt vmcnt(6)
9:
  s_waitcnt vmcnt(10)
  buffer_load_dwordx4 v2, s[20:23], s51 offen offset:2048 nt lds
  v_fma_f32 v26, v25, v22, v128
  v_add_f32 v27, v130, v131
  v_add_f32 v28, v132, v133
  v_add_f32 v29, v134, v135
  v_add_f32 v26, v26, v129
  v_cvt_pk_bf16_f32 v181, v138, v139
  v_cvt_pk_bf16_f32 v182, v140, v141
  v_cvt_pk_bf16_f32 v183, v142, v143
  v_add_f32 v26, v26, v136
  v_accvgpr_write_b32 a128, v176
  v_add_f32 v27, v27, v137
  v_accvgpr_write_b32 a129, v177
  v_add_f32 v28, v28, v138
  v_accvgpr_write_b32 a130, v178
  v_add_f32 v29, v29, v139
  v_accvgpr_write_b32 a131, v179
  v_add_f32 v26, v26, v140
  v_accvgpr_write_b32 a132, v180
  v_add_f32 v27, v27, v141
  v_accvgpr_write_b32 a133, v181
  v_add_f32 v28, v28, v142
  v_accvgpr_write_b32 a134, v182
  v_add_f32 v29, v29, v143
  v_accvgpr_write_b32 a135, v183
  v_add_f32 v26, v26, v27
  v_add_f32 v28, v28, v29
  v_add_f32 v25, v26, v28
  s_add_u32 m0, s53, 4992
  s_cbranch_vccnz 9f
  s_waitcnt vmcnt(5)
9:
  s_waitcnt vmcnt(10)
  buffer_load_dwordx4 v1, s[20:23], s51 offen offset:128 nt lds
  s_cbranch_vccnz 9f
  s_waitcnt vmcnt(5)
9:
  s_waitcnt vmcnt(9)
  buffer_load_dwordx4 v2, s[20:23], s51 offen offset:2176 nt lds
  s_xor_b32 s51, s51, 0x14000
  ds_read_b128 v[144:147], v6 offset:16384
  ds_read_b128 v[148:151], v7 offset:16384
  ds_read_b128 v[152:155], v8 offset:16384
  ds_read_b128 v[156:159], v9 offset:16384
  ds_read_b128 v[160:163], v6 offset:17408
  ds_read_b128 v[164:167], v7 offset:17408
  ds_read_b128 v[168:171], v8 offset:17408
  ds_read_b128 v[172:175], v9 offset:17408
  s_add_u32 m0, s53, 8192
  s_cbranch_vccnz 9f
  s_waitcnt vmcnt(4)
9:
  s_waitcnt vmcnt(9)
  buffer_load_dwordx4 v1, s[20:23], s51 offen nt lds
  s_barrier
  s_waitcnt lgkmcnt(4)
  v_mfma_f32_32x32x16_bf16 v[128:143], v[144:147], v[32:35], 0
  v_mfma_f32_32x32x16_bf16 v[128:143], v[148:151], v[36:39], v[128:143]
  v_mfma_f32_32x32x16_bf16 v[128:143], v[152:155], v[40:43], v[128:143]
  v_mfma_f32_32x32x16_bf16 v[128:143], v[156:159], v[44:47], v[128:143]
  s_cbranch_vccnz 9f
  s_waitcnt vmcnt(4)
9:
  s_waitcnt vmcnt(8)
  buffer_load_dwordx4 v2, s[20:23], s51 offen offset:2048 nt lds
  v_add_u32 v248, v248, v247
  v_cmp_le_i32 s[92:93], v248, v251
  s_nop 0
  s_bcnt1_i32_b64 s60, s[92:93]
  s_cmp_ge_u32 s60, 33
  s_cselect_b64 vcc, -1, 0
  s_waitcnt lgkmcnt(0)
  v_mfma_f32_32x32x16_bf16 v[128:143], v[160:163], v[48:51], v[128:143]
  v_mfma_f32_32x32x16_bf16 v[128:143], v[164:167], v[52:55], v[128:143]
  v_mfma_f32_32x32x16_bf16 v[128:143], v[168:171], v[56:59], v[128:143]
  v_mfma_f32_32x32x16_bf16 v[128:143], v[172:175], v[60:63], v[128:143]
  s_add_u32 m0, s53, 9088
  s_cbranch_vccnz 9f
  s_waitcnt vmcnt(4)
9:
  s_waitcnt vmcnt(8)
  buffer_load_dwordx4 v1, s[20:23], s51 offen offset:128 nt lds
  v_mov_b32 v31, v24
  s_nop 6
  v_max3_f32 v26, v128, v129, v130
  v_max3_f32 v27, v131, v132, v133
  v_max3_f32 v28, v134, v135, v136
  v_max3_f32 v29, v137, v138, v139
  v_max3_f32 v30, v140, v141, v142
  v_max3_f32 v26, v26, v27, v28
  v_max3_f32 v29, v29, v30, v143
  v_max_f32 v27, v26, v29
  v_max_f32 v26, v26, v29
  s_nop 1
  v_permlane32_swap_b32 v26, v27
  v_max3_f32 v23, v26, v27, v23
  v_mul_f32 v24, s55, v23
  v_sub_f32 v31, v31, v24
  v_exp_f32 v22, v31
  v_fma_f32 v128, v128, s55, -v24
  v_fma_f32 v129, v129, s55, -v24
  v_fma_f32 v130, v130, s55, -v24
  v_fma_f32 v131, v131, s55, -v24
  ds_write_b32 v231, v22 offset:2176
  s_cbranch_vccnz 9f
  s_waitcnt vmcnt(4)
9:
  s_waitcnt vmcnt(7)
  buffer_load_dwordx4 v2, s[20:23], s51 offen offset:2176 nt lds
  s_xor_b32 s51, s51, 16384
  s_cmp_eq_u32 s96, 1
  s_cbranch_scc0 1f
  v_cmp_lt_i32 s[92:93], 0, v250
  s_nop 0
  s_bcnt1_i32_b32 s60, s92
  v_mov_b32 v250, s60
  s_mov_b64 exec, 1
  buffer_store_dword v250, off, s[40:43], s95 offset:512
  buffer_store_dword v250, off, s[40:43], s95 offset:768
  buffer_store_dword v250, off, s[40:43], s95 offset:1792
  s_mov_b64 exec, -1
1:
  v_fma_f32 v132, v132, s55, -v24
  v_fma_f32 v133, v133, s55, -v24
  v_exp_f32 v128, v128
  v_fma_f32 v134, v134, s55, -v24
  v_fma_f32 v135, v135, s55, -v24
  v_exp_f32 v129, v129
  v_fma_f32 v136, v136, s55, -v24
  v_fma_f32 v137, v137, s55, -v24
  v_exp_f32 v130, v130
  v_fma_f32 v138, v138, s55, -v24
  v_fma_f32 v139, v139, s55, -v24
  v_exp_f32 v131, v131
  v_fma_f32 v140, v140, s55, -v24
  v_fma_f32 v141, v141, s55, -v24
  v_exp_f32 v132, v132
  v_fma_f32 v142, v142, s55, -v24
  v_fma_f32 v143, v143, s55, -v24
  v_exp_f32 v133, v133
  s_add_u32 m0, s53, 12288
  s_cbranch_vccnz 9f
  s_waitcnt vmcnt(4)
9:
  s_waitcnt vmcnt(7)
  buffer_load_dwordx4 v1, s[20:23], s51 offen nt lds
  s_barrier
  v_exp_f32 v134, v134
  v_exp_f32 v135, v135
  v_exp_f32 v136, v136
  v_exp_f32 v137, v137
  v_exp_f32 v138, v138
  v_exp_f32 v139, v139
  v_cvt_pk_bf16_f32 v176, v128, v129
  v_exp_f32 v140, v140
  v_cvt_pk_bf16_f32 v177, v130, v131
  v_exp_f32 v141, v141
  v_cvt_pk_bf16_f32 v178, v132, v133
  v_exp_f32 v142, v142
  v_cvt_pk_bf16_f32 v179, v134, v135
  v_exp_f32 v143, v143
  v_cvt_pk_bf16_f32 v180, v136, v137
  s_cbranch_vccnz 9f
  s_waitcnt vmcnt(4)
9:
  s_waitcnt vmcnt(7)
  buffer_load_dwordx4 v2, s[20:23], s51 offen offset:2048 nt lds
  v_fma_f32 v26, v25, v22, v128
  v_add_f32 v27, v130, v131
  v_add_f32 v28, v132, v133
  v_add_f32 v29, v134, v135
  v_add_f32 v26, v26, v129
  v_cvt_pk_bf16_f32 v181, v138, v139
  v_cvt_pk_bf16_f32 v182, v140, v141
  v_cvt_pk_bf16_f32 v183, v142, v143
  v_add_f32 v26, v26, v136
  v_accvgpr_write_b32 a136, v176
  v_add_f32 v27, v27, v137
  v_accvgpr_write_b32 a137, v177
  v_add_f32 v28, v28, v138
  v_accvgpr_write_b32 a138, v178
  v_add_f32 v29, v29, v139
  v_accvgpr_write_b32 a139, v179
  v_add_f32 v26, v26, v140
  v_accvgpr_write_b32 a140, v180
  v_add_f32 v27, v27, v141
  v_accvgpr_write_b32 a141, v181
  v_add_f32 v28, v28, v142
  v_accvgpr_write_b32 a142, v182
  v_add_f32 v29, v29, v143
  v_accvgpr_write_b32 a143, v183
  v_add_f32 v26, v26, v27
  v_add_f32 v28, v28, v29
  v_add_f32 v25, v26, v28
  s_add_u32 m0, s53, 13184
  s_cbranch_vccnz 9f
  s_waitcnt vmcnt(4)
9:
  s_waitcnt vmcnt(7)
  buffer_load_dwordx4 v1, s[20:23], s51 offen offset:128 nt lds
  s_barrier
  v_lshrrev_b32 v252, 2, v0
  v_and_b32 v21, 3, v0
  v_lshlrev_b32 v21, 3, v21
  v_lshl_add_u32 v21, v252, 7, v21
  s_lshl_b32 s60, s3, 5
  s_addk_i32 s60, 24576
  s_and_b32 s61, s3, 1
  s_lshl2_add_u32 s61, s59, s61
  s_lshl_b32 s61, s61, 12
  s_add_u32 s60, s60, s61
  v_add_u32 v21, s60, v21
  ds_read_b64_tr_b16 v[192:193], v21
  ds_read_b64_tr_b16 v[194:195], v21 offset:2048
  v_xor_b32 v11, 4096, v21
  ds_read_b64_tr_b16 v[196:197], v11
  ds_read_b64_tr_b16 v[198:199], v11 offset:2048
  v_xor_b32 v12, 32768, v21
  ds_read_b64_tr_b16 v[200:201], v12
  ds_read_b64_tr_b16 v[202:203], v12 offset:2048
  v_xor_b32 v13, 36864, v21
  ds_read_b64_tr_b16 v[204:205], v13
  ds_read_b64_tr_b16 v[206:207], v13 offset:2048
  s_cbranch_vccnz 9f
  s_waitcnt vmcnt(4)
9:
  s_waitcnt vmcnt(7)
  buffer_load_dwordx4 v2, s[20:23], s51 offen offset:2176 nt lds
  s_xor_b32 s51, s51, 0xd4000
  ds_read_b128 v[144:147], v6
  ds_read_b128 v[148:151], v7
  ds_read_b128 v[152:155], v8
  ds_read_b128 v[156:159], v9
  ds_read_b128 v[160:163], v6 offset:1024
  ds_read_b128 v[164:167], v7 offset:1024
  s_waitcnt lgkmcnt(14)
  ds_read_b128 v[168:171], v8 offset:1024
  s_waitcnt lgkmcnt(14)
  ds_read_b128 v[172:175], v9 offset:1024
  s_add_u32 m0, s53, 16384
  s_cbranch_vccnz 9f
  s_waitcnt vmcnt(4)
9:
  s_waitcnt vmcnt(7)
  buffer_load_dwordx4 v1, s[20:23], s51 offen nt lds
  s_add_u32 s91, s91, 1
  s_and_b32 s60, s91, 3
  s_cmp_eq_u32 s60, s3
  s_cbranch_scc0 1f
  v_mov_b32 v252, s91
  s_mov_b64 exec, 1
  buffer_store_dword v252, off, s[40:43], s94 offset:1280
  s_mov_b64 exec, -1
1:
  s_barrier
  buffer_load_dword v246, v254, s[40:43], s95 offen offset:1280 sc1
  s_addk_i32 s97, 512
  s_add_u32 s96, s96, 30
  s_and_b32 s96, s96, 0x11f
  s_cmp_eq_u32 s96, 0
  s_cbranch_scc0 1f
  s_add_u32 s60, s97, s95
  s_mov_b32 exec_hi, 0
  buffer_store_dword v253, v254, s[40:43], s60 offen sc1
  s_mov_b32 exec_hi, -1
1:
  s_waitcnt lgkmcnt(4)
  v_mfma_f32_32x32x16_bf16 v[128:143], v[144:147], v[32:35], 0
  v_mfma_f32_32x32x16_bf16 v[128:143], v[148:151], v[36:39], v[128:143]
  v_mfma_f32_32x32x16_bf16 v[128:143], v[152:155], v[40:43], v[128:143]
  v_mfma_f32_32x32x16_bf16 v[128:143], v[156:159], v[44:47], v[128:143]
  s_cbranch_vccnz 9f
  s_waitcnt vmcnt(5)
9:
  s_waitcnt vmcnt(8)
  buffer_load_dwordx4 v2, s[20:23], s51 offen offset:2048 nt lds
  s_waitcnt lgkmcnt(0)
  v_mfma_f32_32x32x16_bf16 v[128:143], v[160:163], v[48:51], v[128:143]
  v_mfma_f32_32x32x16_bf16 v[128:143], v[164:167], v[52:55], v[128:143]
  v_mfma_f32_32x32x16_bf16 v[128:143], v[168:171], v[56:59], v[128:143]
  v_mfma_f32_32x32x16_bf16 v[128:143], v[172:175], v[60:63], v[128:143]
  s_add_u32 m0, s53, 17280
  s_cbranch_vccnz 9f
  s_waitcnt vmcnt(5)
9:
  s_waitcnt vmcnt(8)
  buffer_load_dwordx4 v1, s[20:23], s51 offen offset:128 nt lds
  s_cmp_eq_u32 s96, 1
  s_cbranch_scc0 1f
  buffer_load_dword v250, v249, s[40:43], s97 offen sc1
1:
  v_mov_b32 v31, v24
  s_nop 4
  v_max3_f32 v26, v128, v129, v130
  v_max3_f32 v27, v131, v132, v133
  v_max3_f32 v28, v134, v135, v136
  v_max3_f32 v29, v137, v138, v139
  v_max3_f32 v30, v140, v141, v142
  v_max3_f32 v26, v26, v27, v28
  v_max3_f32 v29, v29, v30, v143
  v_max_f32 v27, v26, v29
  v_max_f32 v26, v26, v29
  s_nop 1
  v_permlane32_swap_b32 v26, v27
  v_max3_f32 v23, v26, v27, v23
  v_mul_f32 v24, s55, v23
  v_sub_f32 v31, v31, v24
  v_exp_f32 v22, v31
  v_fma_f32 v128, v128, s55, -v24
  v_fma_f32 v129, v129, s55, -v24
  v_fma_f32 v130, v130, s55, -v24
  v_fma_f32 v131, v131, s55, -v24
  ds_write_b32 v231, v22 offset:2304
  s_cbranch_vccnz 9f
  s_waitcnt vmcnt(5)
9:
  s_waitcnt vmcnt(8)
  buffer_load_dwordx4 v2, s[20:23], s51 offen offset:2176 nt lds
  s_xor_b32 s51, s51, 16384
  v_fma_f32 v132, v132, s55, -v24
  v_fma_f32 v133, v133, s55, -v24
  v_exp_f32 v128, v128
  v_fma_f32 v134, v134, s55, -v24
  v_fma_f32 v135, v135, s55, -v24
  v_exp_f32 v129, v129
  v_fma_f32 v136, v136, s55, -v24
  v_fma_f32 v137, v137, s55, -v24
  v_exp_f32 v130, v130
  v_fma_f32 v138, v138, s55, -v24
  v_fma_f32 v139, v139, s55, -v24
  v_exp_f32 v131, v131
  v_fma_f32 v140, v140, s55, -v24
  v_fma_f32 v141, v141, s55, -v24
  v_exp_f32 v132, v132
  v_fma_f32 v142, v142, s55, -v24
  v_fma_f32 v143, v143, s55, -v24
  v_exp_f32 v133, v133
  s_add_u32 m0, s53, 20480
  s_cbranch_vccnz 9f
  s_waitcnt vmcnt(5)
9:
  s_waitcnt vmcnt(8)
  buffer_load_dwordx4 v1, s[20:23], s51 offen nt lds
  s_barrier
  v_exp_f32 v134, v134
  v_exp_f32 v135, v135
  v_exp_f32 v136, v136
  v_exp_f32 v137, v137
  v_exp_f32 v138, v138
  v_exp_f32 v139, v139
  v_cvt_pk_bf16_f32 v176, v128, v129
  v_exp_f32 v140, v140
  v_cvt_pk_bf16_f32 v177, v130, v131
  v_exp_f32 v141, v141
  v_cvt_pk_bf16_f32 v178, v132, v133
  v_exp_f32 v142, v142
  v_cvt_pk_bf16_f32 v179, v134, v135
  v_exp_f32 v143, v143
  v_cvt_pk_bf16_f32 v180, v136, v137
  s_cbranch_vccnz 9f
  s_waitcnt vmcnt(5)
9:
  s_waitcnt vmcnt(8)
  buffer_load_dwordx4 v2, s[20:23], s51 offen offset:2048 nt lds
  v_fma_f32 v26, v25, v22, v128
  v_add_f32 v27, v130, v131
  v_add_f32 v28, v132, v133
  v_add_f32 v29, v134, v135
  v_add_f32 v26, v26, v129
  v_cvt_pk_bf16_f32 v181, v138, v139
  v_cvt_pk_bf16_f32 v182, v140, v141
  v_cvt_pk_bf16_f32 v183, v142, v143
  v_add_f32 v26, v26, v136
  v_accvgpr_write_b32 a144, v176
  v_add_f32 v27, v27, v137
  v_accvgpr_write_b32 a145, v177
  v_add_f32 v28, v28, v138
  v_accvgpr_write_b32 a146, v178
  v_add_f32 v29, v29, v139
  v_accvgpr_write_b32 a147, v179
  v_add_f32 v26, v26, v140
  v_accvgpr_write_b32 a148, v180
  v_add_f32 v27, v27, v141
  v_accvgpr_write_b32 a149, v181
  v_add_f32 v28, v28, v142
  v_accvgpr_write_b32 a150, v182
  v_add_f32 v29, v29, v143
  v_accvgpr_write_b32 a151, v183
  v_add_f32 v26, v26, v27
  v_add_f32 v28, v28, v29
  v_add_f32 v25, v26, v28
  s_add_u32 m0, s53, 21376
  s_cbranch_vccnz 9f
  s_waitcnt vmcnt(4)
9:
  s_waitcnt vmcnt(8)
  buffer_load_dwordx4 v1, s[20:23], s51 offen offset:128 nt lds
  v_add_u32 v21, 0x10000, v21
  ds_read_b64_tr_b16 v[208:209], v21
  ds_read_b64_tr_b16 v[210:211], v21 offset:2048
  v_xor_b32 v11, 4096, v21
  ds_read_b64_tr_b16 v[212:213], v11
  ds_read_b64_tr_b16 v[214:215], v11 offset:2048
  v_xor_b32 v12, 32768, v21
  ds_read_b64_tr_b16 v[216:217], v12
  ds_read_b64_tr_b16 v[218:219], v12 offset:2048
  v_xor_b32 v13, 36864, v21
  ds_read_b64_tr_b16 v[220:221], v13
  ds_read_b64_tr_b16 v[222:223], v13 offset:2048
  s_cbranch_vccnz 9f
  s_waitcnt vmcnt(4)
9:
  s_waitcnt vmcnt(8)
  buffer_load_dwordx4 v2, s[20:23], s51 offen offset:2176 nt lds
  s_xor_b32 s51, s51, 0x14000
  ds_read_b128 v[144:147], v6 offset:8192
  ds_read_b128 v[148:151], v7 offset:8192
  ds_read_b128 v[152:155], v8 offset:8192
  ds_read_b128 v[156:159], v9 offset:8192
  ds_read_b128 v[160:163], v6 offset:9216
  ds_read_b128 v[164:167], v7 offset:9216
  s_waitcnt lgkmcnt(14)
  ds_read_b128 v[168:171], v8 offset:9216
  s_waitcnt lgkmcnt(14)
  ds_read_b128 v[172:175], v9 offset:9216
  s_mov_b32 m0, s53
  s_cbranch_vccnz 9f
  s_waitcnt vmcnt(4)
9:
  s_waitcnt vmcnt(8)
  buffer_load_dwordx4 v1, s[20:23], s51 offen nt lds
  s_barrier
  s_waitcnt lgkmcnt(4)
  v_mfma_f32_32x32x16_bf16 v[128:143], v[144:147], v[32:35], 0
  v_mfma_f32_32x32x16_bf16 v[128:143], v[148:151], v[36:39], v[128:143]
  v_mfma_f32_32x32x16_bf16 v[128:143], v[152:155], v[40:43], v[128:143]
  v_mfma_f32_32x32x16_bf16 v[128:143], v[156:159], v[44:47], v[128:143]
  s_cbranch_vccnz 9f
  s_waitcnt vmcnt(4)
9:
  s_waitcnt vmcnt(7)
  buffer_load_dwordx4 v2, s[20:23], s51 offen offset:2048 nt lds
  v_add_u32 v248, v248, v247
  v_cmp_le_i32 s[92:93], v248, v246
  s_nop 0
  s_bcnt1_i32_b64 s60, s[92:93]
  s_cmp_ge_u32 s60, 33
  s_cselect_b64 vcc, -1, 0
  s_waitcnt lgkmcnt(0)
  v_mfma_f32_32x32x16_bf16 v[128:143], v[160:163], v[48:51], v[128:143]
  v_mfma_f32_32x32x16_bf16 v[128:143], v[164:167], v[52:55], v[128:143]
  v_mfma_f32_32x32x16_bf16 v[128:143], v[168:171], v[56:59], v[128:143]
  v_mfma_f32_32x32x16_bf16 v[128:143], v[172:175], v[60:63], v[128:143]
  s_add_u32 m0, s53, 896
  s_cbranch_vccnz 9f
  s_waitcnt vmcnt(4)
9:
  s_waitcnt vmcnt(7)
  buffer_load_dwordx4 v1, s[20:23], s51 offen offset:128 nt lds
  v_mov_b32 v31, v24
  s_nop 6
  v_max3_f32 v26, v128, v129, v130
  v_max3_f32 v27, v131, v132, v133
  v_max3_f32 v28, v134, v135, v136
  v_max3_f32 v29, v137, v138, v139
  v_max3_f32 v30, v140, v141, v142
  v_max3_f32 v26, v26, v27, v28
  v_max3_f32 v29, v29, v30, v143
  v_max_f32 v27, v26, v29
  v_max_f32 v26, v26, v29
  s_nop 1
  v_permlane32_swap_b32 v26, v27
  v_max3_f32 v23, v26, v27, v23
  v_mul_f32 v24, s55, v23
  v_sub_f32 v31, v31, v24
  v_exp_f32 v22, v31
  v_fma_f32 v128, v128, s55, -v24
  v_fma_f32 v129, v129, s55, -v24
  v_fma_f32 v130, v130, s55, -v24
  v_fma_f32 v131, v131, s55, -v24
  ds_write_b32 v231, v22 offset:2432
  s_cbranch_vccnz 9f
  s_waitcnt vmcnt(4)
9:
  s_waitcnt vmcnt(7)
  buffer_load_dwordx4 v2, s[20:23], s51 offen offset:2176 nt lds
  s_xor_b32 s51, s51, 16384
  s_cmp_eq_u32 s96, 1
  s_cbranch_scc0 1f
  v_cmp_lt_i32 s[92:93], 0, v250
  s_nop 0
  s_bcnt1_i32_b32 s60, s92
  v_mov_b32 v250, s60
  s_mov_b64 exec, 1
  buffer_store_dword v250, off, s[40:43], s95 offset:512
  buffer_store_dword v250, off, s[40:43], s95 offset:768
  buffer_store_dword v250, off, s[40:43], s95 offset:1792
  s_mov_b64 exec, -1
1:
  v_fma_f32 v132, v132, s55, -v24
  v_fma_f32 v133, v133, s55, -v24
  v_exp_f32 v128, v128
  v_fma_f32 v134, v134, s55, -v24
  v_fma_f32 v135, v135, s55, -v24
  v_exp_f32 v129, v129
  v_fma_f32 v136, v136, s55, -v24
  v_fma_f32 v137, v137, s55, -v24
  v_exp_f32 v130, v130
  v_fma_f32 v138, v138, s55, -v24
  v_fma_f32 v139, v139, s55, -v24
  v_exp_f32 v131, v131
  v_fma_f32 v140, v140, s55, -v24
  v_fma_f32 v141, v141, s55, -v24
  v_exp_f32 v132, v132
  v_fma_f32 v142, v142, s55, -v24
  v_fma_f32 v143, v143, s55, -v24
  v_exp_f32 v133, v133
  s_add_u32 m0, s53, 4096
  s_cbranch_vccnz 9f
  s_waitcnt vmcnt(4)
9:
  s_waitcnt vmcnt(7)
  buffer_load_dwordx4 v1, s[20:23], s51 offen nt lds
  s_barrier
  v_exp_f32 v134, v134
  v_exp_f32 v135, v135
  v_exp_f32 v136, v136
  v_exp_f32 v137, v137
  v_exp_f32 v138, v138
  v_exp_f32 v139, v139
  v_cvt_pk_bf16_f32 v176, v128, v129
  v_exp_f32 v140, v140
  v_cvt_pk_bf16_f32 v177, v130, v131
  v_exp_f32 v141, v141
  v_cvt_pk_bf16_f32 v178, v132, v133
  v_exp_f32 v142, v142
  v_cvt_pk_bf16_f32 v179, v134, v135
  v_exp_f32 v143, v143
  v_cvt_pk_bf16_f32 v180, v136, v137
  s_cbranch_vccnz 9f
  s_waitcnt vmcnt(4)
9:
  s_waitcnt vmcnt(7)
  buffer_load_dwordx4 v2, s[20:23], s51 offen offset:2048 nt lds
  v_fma_f32 v26, v25, v22, v128
  v_add_f32 v27, v130, v131
  v_add_f32 v28, v132, v133
  v_add_f32 v29, v134, v135
  v_add_f32 v26, v26, v129
  v_cvt_pk_bf16_f32 v181, v138, v139
  v_cvt_pk_bf16_f32 v182, v140, v141
  v_cvt_pk_bf16_f32 v183, v142, v143
  v_add_f32 v26, v26, v136
  v_accvgpr_write_b32 a152, v176
  v_add_f32 v27, v27, v137
  v_accvgpr_write_b32 a153, v177
  v_add_f32 v28, v28, v138
  v_accvgpr_write_b32 a154, v178
  v_add_f32 v29, v29, v139
  v_accvgpr_write_b32 a155, v179
  v_add_f32 v26, v26, v140
  v_accvgpr_write_b32 a156, v180
  v_add_f32 v27, v27, v141
  v_accvgpr_write_b32 a157, v181
  v_add_f32 v28, v28, v142
  v_accvgpr_write_b32 a158, v182
  v_add_f32 v29, v29, v143
  v_accvgpr_write_b32 a159, v183
  v_add_f32 v26, v26, v27
  v_add_f32 v28, v28, v29
  v_add_f32 v25, v26, v28
  s_add_u32 m0, s53, 4992
  s_cbranch_vccnz 9f
  s_waitcnt vmcnt(4)
9:
  s_waitcnt vmcnt(7)
  buffer_load_dwordx4 v1, s[20:23], s51 offen offset:128 nt lds
  s_waitcnt lgkmcnt(0)
  s_barrier
  s_cbranch_vccnz 9f
  s_waitcnt vmcnt(4)
9:
  s_waitcnt vmcnt(7)
  buffer_load_dwordx4 v2, s[20:23], s51 offen offset:2176 nt lds
  s_xor_b32 s51, s51, 0x54000
  ds_read_b128 v[144:147], v6 offset:16384
  ds_read_b128 v[148:151], v7 offset:16384
  ds_read_b128 v[152:155], v8 offset:16384
  ds_read_b128 v[156:159], v9 offset:16384
  ds_read_b128 v[160:163], v6 offset:17408
  ds_read_b128 v[164:167], v7 offset:17408
  ds_read_b128 v[168:171], v8 offset:17408
  ds_read_b128 v[172:175], v9 offset:17408
  s_add_u32 m0, s53, 8192
  s_cbranch_vccnz 9f
  s_waitcnt vmcnt(4)
9:
  s_waitcnt vmcnt(7)
  buffer_load_dwordx4 v1, s[20:23], s51 offen nt lds
  s_add_u32 s91, s91, 1
  s_and_b32 s60, s91, 3
  s_cmp_eq_u32 s60, s3
  s_cbranch_scc0 1f
  v_mov_b32 v252, s91
  s_mov_b64 exec, 1
  buffer_store_dword v252, off, s[40:43], s94
  s_mov_b64 exec, -1
1:
  s_barrier
  buffer_load_dword v255, v254, s[40:43], s95 offen sc1
  s_addk_i32 s97, 512
  s_add_u32 s96, s96, 30
  s_and_b32 s96, s96, 0x11f
  s_cmp_eq_u32 s96, 0
  s_cbranch_scc0 1f
  s_add_u32 s60, s97, s95
  s_mov_b32 exec_hi, 0
  buffer_store_dword v253, v254, s[40:43], s60 offen sc1
  s_mov_b32 exec_hi, -1
1:
  s_waitcnt lgkmcnt(4)
  v_mfma_f32_32x32x16_bf16 v[128:143], v[144:147], v[32:35], 0
  v_mfma_f32_32x32x16_bf16 v[128:143], v[148:151], v[36:39], v[128:143]
  v_mfma_f32_32x32x16_bf16 v[128:143], v[152:155], v[40:43], v[128:143]
  v_mfma_f32_32x32x16_bf16 v[128:143], v[156:159], v[44:47], v[128:143]
  s_cbranch_vccnz 9f
  s_waitcnt vmcnt(5)
9:
  s_waitcnt vmcnt(8)
  buffer_load_dwordx4 v2, s[20:23], s51 offen offset:2048 nt lds
  s_waitcnt lgkmcnt(0)
  v_mfma_f32_32x32x16_bf16 v[128:143], v[160:163], v[48:51], v[128:143]
  v_mfma_f32_32x32x16_bf16 v[128:143], v[164:167], v[52:55], v[128:143]
  v_mfma_f32_32x32x16_bf16 v[128:143], v[168:171], v[56:59], v[128:143]
  v_mfma_f32_32x32x16_bf16 v[128:143], v[172:175], v[60:63], v[128:143]
  s_add_u32 m0, s53, 9088
  s_cbranch_vccnz 9f
  s_waitcnt vmcnt(5)
9:
  s_waitcnt vmcnt(8)
  buffer_load_dwordx4 v1, s[20:23], s51 offen offset:128 nt lds
  s_cmp_eq_u32 s96, 1
  s_cbranch_scc0 1f
  buffer_load_dword v250, v249, s[40:43], s97 offen sc1
1:
  s_load_dword s100, s[8:9], s52
  v_mov_b32 v31, v24
  s_nop 3
  v_max3_f32 v26, v128, v129, v130
  v_max3_f32 v27, v131, v132, v133
  v_max3_f32 v28, v134, v135, v136
  v_max3_f32 v29, v137, v138, v139
  v_max3_f32 v30, v140, v141, v142
  v_max3_f32 v26, v26, v27, v28
  v_max3_f32 v29, v29, v30, v143
  v_max_f32 v27, v26, v29
  v_max_f32 v26, v26, v29
  s_nop 1
  v_permlane32_swap_b32 v26, v27
  v_max3_f32 v23, v26, v27, v23
  v_mul_f32 v24, s55, v23
  v_sub_f32 v31, v31, v24
  v_exp_f32 v22, v31
  v_fma_f32 v128, v128, s55, -v24
  v_fma_f32 v129, v129, s55, -v24
  v_fma_f32 v130, v130, s55, -v24
  v_fma_f32 v131, v131, s55, -v24
  ds_write_b32 v231, v22 offset:2560
  s_cbranch_vccnz 9f
  s_waitcnt vmcnt(5)
9:
  s_waitcnt vmcnt(8)
  buffer_load_dwordx4 v2, s[20:23], s51 offen offset:2176 nt lds
  s_xor_b32 s51, s51, 16384
  v_fma_f32 v132, v132, s55, -v24
  v_fma_f32 v133, v133, s55, -v24
  v_exp_f32 v128, v128
  v_fma_f32 v134, v134, s55, -v24
  v_fma_f32 v135, v135, s55, -v24
  v_exp_f32 v129, v129
  v_fma_f32 v136, v136, s55, -v24
  v_fma_f32 v137, v137, s55, -v24
  v_exp_f32 v130, v130
  v_fma_f32 v138, v138, s55, -v24
  v_fma_f32 v139, v139, s55, -v24
  v_exp_f32 v131, v131
  v_fma_f32 v140, v140, s55, -v24
  v_fma_f32 v141, v141, s55, -v24
  v_exp_f32 v132, v132
  v_fma_f32 v142, v142, s55, -v24
  v_fma_f32 v143, v143, s55, -v24
  v_exp_f32 v133, v133
  s_add_u32 m0, s53, 12288
  s_cbranch_vccnz 9f
  s_waitcnt vmcnt(5)
9:
  s_waitcnt vmcnt(8)
  buffer_load_dwordx4 v1, s[20:23], s51 offen nt lds
  s_barrier
  v_exp_f32 v134, v134
  v_exp_f32 v135, v135
  v_exp_f32 v136, v136
  v_exp_f32 v137, v137
  v_exp_f32 v138, v138
  v_exp_f32 v139, v139
  v_cvt_pk_bf16_f32 v176, v128, v129
  v_exp_f32 v140, v140
  v_cvt_pk_bf16_f32 v177, v130, v131
  v_exp_f32 v141, v141
  v_cvt_pk_bf16_f32 v178, v132, v133
  v_exp_f32 v142, v142
  v_cvt_pk_bf16_f32 v179, v134, v135
  v_exp_f32 v143, v143
  v_cvt_pk_bf16_f32 v180, v136, v137
  s_cbranch_vccnz 9f
  s_waitcnt vmcnt(5)
9:
  s_waitcnt vmcnt(8)
  buffer_load_dwordx4 v2, s[20:23], s51 offen offset:2048 nt lds
  v_fma_f32 v26, v25, v22, v128
  v_add_f32 v27, v130, v131
  v_add_f32 v28, v132, v133
  v_add_f32 v29, v134, v135
  v_add_f32 v26, v26, v129
  v_cvt_pk_bf16_f32 v181, v138, v139
  v_cvt_pk_bf16_f32 v182, v140, v141
  v_cvt_pk_bf16_f32 v183, v142, v143
  v_add_f32 v26, v26, v136
  v_accvgpr_write_b32 a160, v176
  v_add_f32 v27, v27, v137
  v_accvgpr_write_b32 a161, v177
  v_add_f32 v28, v28, v138
  v_accvgpr_write_b32 a162, v178
  v_add_f32 v29, v29, v139
  v_accvgpr_write_b32 a163, v179
  v_add_f32 v26, v26, v140
  v_accvgpr_write_b32 a164, v180
  v_add_f32 v27, v27, v141
  v_accvgpr_write_b32 a165, v181
  v_add_f32 v28, v28, v142
  v_accvgpr_write_b32 a166, v182
  v_add_f32 v29, v29, v143
  v_accvgpr_write_b32 a167, v183
  v_add_f32 v26, v26, v27
  v_add_f32 v28, v28, v29
  v_add_f32 v25, v26, v28
  s_add_u32 m0, s53, 13184
  s_cbranch_vccnz 9f
  s_waitcnt vmcnt(4)
9:
  s_waitcnt vmcnt(8)
  buffer_load_dwordx4 v1, s[20:23], s51 offen offset:128 nt lds
  s_cbranch_vccnz 9f
  s_waitcnt vmcnt(4)
9:
  s_waitcnt vmcnt(8)
  buffer_load_dwordx4 v2, s[20:23], s51 offen offset:2176 nt lds
  s_xor_b32 s51, s51, 0x14000
  ds_read_b128 v[144:147], v6
  ds_read_b128 v[148:151], v7
  ds_read_b128 v[152:155], v8
  ds_read_b128 v[156:159], v9
  ds_read_b128 v[160:163], v6 offset:1024
  ds_read_b128 v[164:167], v7 offset:1024
  ds_read_b128 v[168:171], v8 offset:1024
  ds_read_b128 v[172:175], v9 offset:1024
  s_add_u32 m0, s53, 16384
  s_cbranch_vccnz 9f
  s_waitcnt vmcnt(4)
9:
  s_waitcnt vmcnt(8)
  buffer_load_dwordx4 v1, s[20:23], s51 offen nt lds
  s_barrier
  s_waitcnt lgkmcnt(4)
  v_mfma_f32_32x32x16_bf16 v[128:143], v[144:147], v[32:35], 0
  v_mfma_f32_32x32x16_bf16 v[128:143], v[148:151], v[36:39], v[128:143]
  v_mfma_f32_32x32x16_bf16 v[128:143], v[152:155], v[40:43], v[128:143]
  v_mfma_f32_32x32x16_bf16 v[128:143], v[156:159], v[44:47], v[128:143]
  s_cbranch_vccnz 9f
  s_waitcnt vmcnt(4)
9:
  s_waitcnt vmcnt(7)
  buffer_load_dwordx4 v2, s[20:23], s51 offen offset:2048 nt lds
  v_add_u32 v248, v248, v247
  v_cmp_le_i32 s[92:93], v248, v255
  s_nop 0
  s_bcnt1_i32_b64 s60, s[92:93]
  s_cmp_ge_u32 s60, 33
  s_cselect_b64 vcc, -1, 0
  s_waitcnt lgkmcnt(0)
  v_mfma_f32_32x32x16_bf16 v[128:143], v[160:163], v[48:51], v[128:143]
  v_mfma_f32_32x32x16_bf16 v[128:143], v[164:167], v[52:55], v[128:143]
  v_mfma_f32_32x32x16_bf16 v[128:143], v[168:171], v[56:59], v[128:143]
  v_mfma_f32_32x32x16_bf16 v[128:143], v[172:175], v[60:63], v[128:143]
  s_add_u32 m0, s53, 17280
  s_cbranch_vccnz 9f
  s_waitcnt vmcnt(4)
9:
  s_waitcnt vmcnt(7)
  buffer_load_dwordx4 v1, s[20:23], s51 offen offset:128 nt lds
  v_mov_b32 v31, v24
  s_nop 6
  v_max3_f32 v26, v128, v129, v130
  v_max3_f32 v27, v131, v132, v133
  v_max3_f32 v28, v134, v135, v136
  v_max3_f32 v29, v137, v138, v139
  v_max3_f32 v30, v140, v141, v142
  v_max3_f32 v26, v26, v27, v28
  v_max3_f32 v29, v29, v30, v143
  v_max_f32 v27, v26, v29
  v_max_f32 v26, v26, v29
  s_nop 1
  v_permlane32_swap_b32 v26, v27
  v_max3_f32 v23, v26, v27, v23
  v_mul_f32 v24, s55, v23
  v_sub_f32 v31, v31, v24
  v_exp_f32 v22, v31
  v_fma_f32 v128, v128, s55, -v24
  v_fma_f32 v129, v129, s55, -v24
  v_fma_f32 v130, v130, s55, -v24
  v_fma_f32 v131, v131, s55, -v24
  ds_write_b32 v231, v22 offset:2688
  s_cbranch_vccnz 9f
  s_waitcnt vmcnt(4)
9:
  s_waitcnt vmcnt(7)
  buffer_load_dwordx4 v2, s[20:23], s51 offen offset:2176 nt lds
  s_xor_b32 s51, s51, 16384
  s_cmp_eq_u32 s96, 1
  s_cbranch_scc0 1f
  v_cmp_lt_i32 s[92:93], 0, v250
  s_nop 0
  s_bcnt1_i32_b32 s60, s92
  v_mov_b32 v250, s60
  s_mov_b64 exec, 1
  buffer_store_dword v250, off, s[40:43], s95 offset:512
  buffer_store_dword v250, off, s[40:43], s95 offset:768
  buffer_store_dword v250, off, s[40:43], s95 offset:1792
  s_mov_b64 exec, -1
1:
  v_fma_f32 v132, v132, s55, -v24
  v_fma_f32 v133, v133, s55, -v24
  v_exp_f32 v128, v128
  v_fma_f32 v134, v134, s55, -v24
  v_fma_f32 v135, v135, s55, -v24
  v_exp_f32 v129, v129
  v_fma_f32 v136, v136, s55, -v24
  v_fma_f32 v137, v137, s55, -v24
  v_exp_f32 v130, v130
  v_fma_f32 v138, v138, s55, -v24
  v_fma_f32 v139, v139, s55, -v24
  v_exp_f32 v131, v131
  v_fma_f32 v140, v140, s55, -v24
  v_fma_f32 v141, v141, s55, -v24
  v_exp_f32 v132, v132
  v_fma_f32 v142, v142, s55, -v24
  v_fma_f32 v143, v143, s55, -v24
  v_exp_f32 v133, v133
  s_add_u32 m0, s53, 20480
  s_cbranch_vccnz 9f
  s_waitcnt vmcnt(4)
9:
  s_waitcnt vmcnt(7)
  buffer_load_dwordx4 v1, s[20:23], s51 offen nt lds
  s_barrier
  v_exp_f32 v134, v134
  v_exp_f32 v135, v135
  v_exp_f32 v136, v136
  v_exp_f32 v137, v137
  v_exp_f32 v138, v138
  v_exp_f32 v139, v139
  v_cvt_pk_bf16_f32 v176, v128, v129
  v_exp_f32 v140, v140
  v_cvt_pk_bf16_f32 v177, v130, v131
  v_exp_f32 v141, v141
  v_cvt_pk_bf16_f32 v178, v132, v133
  v_exp_f32 v142, v142
  v_cvt_pk_bf16_f32 v179, v134, v135
  v_exp_f32 v143, v143
  v_cvt_pk_bf16_f32 v180, v136, v137
  s_cbranch_vccnz 9f
  s_waitcnt vmcnt(4)
9:
  s_waitcnt vmcnt(7)
  buffer_load_dwordx4 v2, s[20:23], s51 offen offset:2048 nt lds
  v_fma_f32 v26, v25, v22, v128
  v_add_f32 v27, v130, v131
  v_add_f32 v28, v132, v133
  v_add_f32 v29, v134, v135
  v_add_f32 v26, v26, v129
  v_cvt_pk_bf16_f32 v181, v138, v139
  v_cvt_pk_bf16_f32 v182, v140, v141
  v_cvt_pk_bf16_f32 v183, v142, v143
  v_add_f32 v26, v26, v136
  v_accvgpr_write_b32 a168, v176
  v_add_f32 v27, v27, v137
  v_accvgpr_write_b32 a169, v177
  v_add_f32 v28, v28, v138
  v_accvgpr_write_b32 a170, v178
  v_add_f32 v29, v29, v139
  v_accvgpr_write_b32 a171, v179
  v_add_f32 v26, v26, v140
  v_accvgpr_write_b32 a172, v180
  v_add_f32 v27, v27, v141
  v_accvgpr_write_b32 a173, v181
  v_add_f32 v28, v28, v142
  v_accvgpr_write_b32 a174, v182
  v_add_f32 v29, v29, v143
  v_accvgpr_write_b32 a175, v183
  v_add_f32 v26, v26, v27
  v_add_f32 v28, v28, v29
  v_add_f32 v25, v26, v28
  s_add_u32 m0, s53, 21376
  s_cbranch_vccnz 9f
  s_waitcnt vmcnt(4)
9:
  s_waitcnt vmcnt(7)
  buffer_load_dwordx4 v1, s[20:23], s51 offen offset:128 nt lds
  s_cbranch_vccnz 9f
  s_waitcnt vmcnt(4)
9:
  s_waitcnt vmcnt(7)
  buffer_load_dwordx4 v2, s[20:23], s51 offen offset:2176 nt lds
  s_xor_b32 s51, s51, 0x1d4000
  ds_read_b128 v[144:147], v6 offset:8192
  ds_read_b128 v[148:151], v7 offset:8192
  ds_read_b128 v[152:155], v8 offset:8192
  ds_read_b128 v[156:159], v9 offset:8192
  ds_read_b128 v[160:163], v6 offset:9216
  ds_read_b128 v[164:167], v7 offset:9216
  ds_read_b128 v[168:171], v8 offset:9216
  ds_read_b128 v[172:175], v9 offset:9216
  s_mov_b32 m0, s53
  s_cbranch_vccnz 9f
  s_waitcnt vmcnt(4)
9:
  s_waitcnt vmcnt(7)
  buffer_load_dwordx4 v1, s[20:23], s51 offen nt lds
  s_add_u32 s91, s91, 1
  s_and_b32 s60, s91, 3
  s_cmp_eq_u32 s60, s3
  s_cbranch_scc0 1f
  v_mov_b32 v252, s91
  s_mov_b64 exec, 1
  buffer_store_dword v252, off, s[40:43], s94 offset:256
  s_mov_b64 exec, -1
1:
  s_barrier
  buffer_load_dword v251, v254, s[40:43], s95 offen offset:256 sc1
  s_addk_i32 s97, 512
  s_add_u32 s96, s96, 30
  s_and_b32 s96, s96, 0x11f
  s_cmp_eq_u32 s96, 0
  s_cbranch_scc0 1f
  s_add_u32 s60, s97, s95
  s_mov_b32 exec_hi, 0
  buffer_store_dword v253, v254, s[40:43], s60 offen sc1
  s_mov_b32 exec_hi, -1
1:
  s_waitcnt lgkmcnt(4)
  v_mfma_f32_32x32x16_bf16 v[128:143], v[144:147], v[32:35], 0
  v_mfma_f32_32x32x16_bf16 v[128:143], v[148:151], v[36:39], v[128:143]
  v_mfma_f32_32x32x16_bf16 v[128:143], v[152:155], v[40:43], v[128:143]
  v_mfma_f32_32x32x16_bf16 v[128:143], v[156:159], v[44:47], v[128:143]
  s_cbranch_vccnz 9f
  s_waitcnt vmcnt(5)
9:
  s_waitcnt vmcnt(8)
  buffer_load_dwordx4 v2, s[20:23], s51 offen offset:2048 nt lds
  s_waitcnt lgkmcnt(0)
  v_mfma_f32_32x32x16_bf16 v[128:143], v[160:163], v[48:51], v[128:143]
  v_mfma_f32_32x32x16_bf16 v[128:143], v[164:167], v[52:55], v[128:143]
  v_mfma_f32_32x32x16_bf16 v[128:143], v[168:171], v[56:59], v[128:143]
  v_mfma_f32_32x32x16_bf16 v[128:143], v[172:175], v[60:63], v[128:143]
  s_add_u32 m0, s53, 896
  s_cbranch_vccnz 9f
  s_waitcnt vmcnt(5)
9:
  s_waitcnt vmcnt(8)
  buffer_load_dwordx4 v1, s[20:23], s51 offen offset:128 nt lds
  s_cmp_eq_u32 s96, 1
  s_cbranch_scc0 1f
  buffer_load_dword v250, v249, s[40:43], s97 offen sc1
1:
  v_mov_b32 v31, v24
  s_nop 4
  v_max3_f32 v26, v128, v129, v130
  v_max3_f32 v27, v131, v132, v133
  v_max3_f32 v28, v134, v135, v136
  v_max3_f32 v29, v137, v138, v139
  v_max3_f32 v30, v140, v141, v142
  v_max3_f32 v26, v26, v27, v28
  v_max3_f32 v29, v29, v30, v143
  v_max_f32 v27, v26, v29
  v_max_f32 v26, v26, v29
  s_nop 1
  v_permlane32_swap_b32 v26, v27
  v_max3_f32 v23, v26, v27, v23
  v_mul_f32 v24, s55, v23
  v_sub_f32 v31, v31, v24
  v_exp_f32 v22, v31
  v_fma_f32 v128, v128, s55, -v24
  v_fma_f32 v129, v129, s55, -v24
  v_fma_f32 v130, v130, s55, -v24
  v_fma_f32 v131, v131, s55, -v24
  ds_write_b32 v231, v22 offset:2816
  s_cbranch_vccnz 9f
  s_waitcnt vmcnt(5)
9:
  s_waitcnt vmcnt(8)
  buffer_load_dwordx4 v2, s[20:23], s51 offen offset:2176 nt lds
  s_xor_b32 s51, s51, 16384
  v_fma_f32 v132, v132, s55, -v24
  v_fma_f32 v133, v133, s55, -v24
  v_exp_f32 v128, v128
  v_fma_f32 v134, v134, s55, -v24
  v_fma_f32 v135, v135, s55, -v24
  v_exp_f32 v129, v129
  v_fma_f32 v136, v136, s55, -v24
  v_fma_f32 v137, v137, s55, -v24
  v_exp_f32 v130, v130
  v_fma_f32 v138, v138, s55, -v24
  v_fma_f32 v139, v139, s55, -v24
  v_exp_f32 v131, v131
  v_fma_f32 v140, v140, s55, -v24
  v_fma_f32 v141, v141, s55, -v24
  v_exp_f32 v132, v132
  v_fma_f32 v142, v142, s55, -v24
  v_fma_f32 v143, v143, s55, -v24
  v_exp_f32 v133, v133
  s_add_u32 m0, s53, 4096
  s_cbranch_vccnz 9f
  s_waitcnt vmcnt(5)
9:
  s_waitcnt vmcnt(8)
  buffer_load_dwordx4 v1, s[20:23], s51 offen nt lds
  s_barrier
  v_exp_f32 v134, v134
  v_exp_f32 v135, v135
  v_exp_f32 v136, v136
  v_exp_f32 v137, v137
  v_exp_f32 v138, v138
  v_exp_f32 v139, v139
  v_cvt_pk_bf16_f32 v176, v128, v129
  v_exp_f32 v140, v140
  v_cvt_pk_bf16_f32 v177, v130, v131
  v_exp_f32 v141, v141
  v_cvt_pk_bf16_f32 v178, v132, v133
  v_exp_f32 v142, v142
  v_cvt_pk_bf16_f32 v179, v134, v135
  v_exp_f32 v143, v143
  v_cvt_pk_bf16_f32 v180, v136, v137
  s_cbranch_vccnz 9f
  s_waitcnt vmcnt(5)
9:
  s_waitcnt vmcnt(8)
  buffer_load_dwordx4 v2, s[20:23], s51 offen offset:2048 nt lds
  v_fma_f32 v26, v25, v22, v128
  v_add_f32 v27, v130, v131
  v_add_f32 v28, v132, v133
  v_add_f32 v29, v134, v135
  v_add_f32 v26, v26, v129
  v_cvt_pk_bf16_f32 v181, v138, v139
  v_cvt_pk_bf16_f32 v182, v140, v141
  v_cvt_pk_bf16_f32 v183, v142, v143
  v_add_f32 v26, v26, v136
  v_accvgpr_write_b32 a176, v176
  v_add_f32 v27, v27, v137
  v_accvgpr_write_b32 a177, v177
  v_add_f32 v28, v28, v138
  v_accvgpr_write_b32 a178, v178
  v_add_f32 v29, v29, v139
  v_accvgpr_write_b32 a179, v179
  v_add_f32 v26, v26, v140
  v_accvgpr_write_b32 a180, v180
  v_add_f32 v27, v27, v141
  v_accvgpr_write_b32 a181, v181
  v_add_f32 v28, v28, v142
  v_accvgpr_write_b32 a182, v182
  v_add_f32 v29, v29, v143
  v_accvgpr_write_b32 a183, v183
  v_add_f32 v26, v26, v27
  v_add_f32 v28, v28, v29
  v_add_f32 v25, v26, v28
  s_add_u32 m0, s53, 4992
  s_cbranch_vccnz 9f
  s_waitcnt vmcnt(4)
9:
  s_waitcnt vmcnt(8)
  buffer_load_dwordx4 v1, s[20:23], s51 offen offset:128 nt lds
  s_cbranch_vccnz 9f
  s_waitcnt vmcnt(4)
9:
  s_waitcnt vmcnt(8)
  buffer_load_dwordx4 v2, s[20:23], s51 offen offset:2176 nt lds
  s_xor_b32 s51, s51, 0x14000
  ds_read_b128 v[144:147], v6 offset:16384
  ds_read_b128 v[148:151], v7 offset:16384
  ds_read_b128 v[152:155], v8 offset:16384
  ds_read_b128 v[156:159], v9 offset:16384
  ds_read_b128 v[160:163], v6 offset:17408
  ds_read_b128 v[164:167], v7 offset:17408
  ds_read_b128 v[168:171], v8 offset:17408
  ds_read_b128 v[172:175], v9 offset:17408
  s_add_u32 m0, s53, 8192
  s_cbranch_vccnz 9f
  s_waitcnt vmcnt(4)
9:
  s_waitcnt vmcnt(8)
  buffer_load_dwordx4 v1, s[20:23], s51 offen nt lds
  s_barrier
  s_waitcnt lgkmcnt(4)
  v_mfma_f32_32x32x16_bf16 v[128:143], v[144:147], v[32:35], 0
  v_mfma_f32_32x32x16_bf16 v[128:143], v[148:151], v[36:39], v[128:143]
  v_mfma_f32_32x32x16_bf16 v[128:143], v[152:155], v[40:43], v[128:143]
  v_mfma_f32_32x32x16_bf16 v[128:143], v[156:159], v[44:47], v[128:143]
  s_cbranch_vccnz 9f
  s_waitcnt vmcnt(4)
9:
  s_waitcnt vmcnt(7)
  buffer_load_dwordx4 v2, s[20:23], s51 offen offset:2048 nt lds
  v_add_u32 v248, v248, v247
  v_cmp_le_i32 s[92:93], v248, v251
  s_nop 0
  s_bcnt1_i32_b64 s60, s[92:93]
  s_cmp_ge_u32 s60, 33
  s_cselect_b64 vcc, -1, 0
  s_waitcnt lgkmcnt(0)
  v_mfma_f32_32x32x16_bf16 v[128:143], v[160:163], v[48:51], v[128:143]
  v_mfma_f32_32x32x16_bf16 v[128:143], v[164:167], v[52:55], v[128:143]
  v_mfma_f32_32x32x16_bf16 v[128:143], v[168:171], v[56:59], v[128:143]
  v_mfma_f32_32x32x16_bf16 v[128:143], v[172:175], v[60:63], v[128:143]
  s_add_u32 m0, s53, 9088
  s_cbranch_vccnz 9f
  s_waitcnt vmcnt(4)
9:
  s_waitcnt vmcnt(7)
  buffer_load_dwordx4 v1, s[20:23], s51 offen offset:128 nt lds
  v_mov_b32 v31, v24
  s_nop 6
  v_max3_f32 v26, v128, v129, v130
  v_max3_f32 v27, v131, v132, v133
  v_max3_f32 v28, v134, v135, v136
  v_max3_f32 v29, v137, v138, v139
  v_max3_f32 v30, v140, v141, v142
  v_max3_f32 v26, v26, v27, v28
  v_max3_f32 v29, v29, v30, v143
  v_max_f32 v27, v26, v29
  v_max_f32 v26, v26, v29
  s_nop 1
  v_permlane32_swap_b32 v26, v27
  v_max3_f32 v23, v26, v27, v23
  v_mul_f32 v24, s55, v23
  v_sub_f32 v31, v31, v24
  v_exp_f32 v22, v31
  v_fma_f32 v128, v128, s55, -v24
  v_fma_f32 v129, v129, s55, -v24
  v_fma_f32 v130, v130, s55, -v24
  v_fma_f32 v131, v131, s55, -v24
  ds_write_b32 v231, v22 offset:2944
  s_cbranch_vccnz 9f
  s_waitcnt vmcnt(4)
9:
  s_waitcnt vmcnt(7)
  buffer_load_dwordx4 v2, s[20:23], s51 offen offset:2176 nt lds
  s_xor_b32 s51, s51, 16384
  s_cmp_eq_u32 s96, 1
  s_cbranch_scc0 1f
  v_cmp_lt_i32 s[92:93], 0, v250
  s_nop 0
  s_bcnt1_i32_b32 s60, s92
  v_mov_b32 v250, s60
  s_mov_b64 exec, 1
  buffer_store_dword v250, off, s[40:43], s95 offset:512
  buffer_store_dword v250, off, s[40:43], s95 offset:768
  buffer_store_dword v250, off, s[40:43], s95 offset:1792
  s_mov_b64 exec, -1
1:
  v_fma_f32 v132, v132, s55, -v24
  v_fma_f32 v133, v133, s55, -v24
  v_exp_f32 v128, v128
  v_fma_f32 v134, v134, s55, -v24
  v_fma_f32 v135, v135, s55, -v24
  v_exp_f32 v129, v129
  v_fma_f32 v136, v136, s55, -v24
  v_fma_f32 v137, v137, s55, -v24
  v_exp_f32 v130, v130
  v_fma_f32 v138, v138, s55, -v24
  v_fma_f32 v139, v139, s55, -v24
  v_exp_f32 v131, v131
  v_fma_f32 v140, v140, s55, -v24
  v_fma_f32 v141, v141, s55, -v24
  v_exp_f32 v132, v132
  v_fma_f32 v142, v142, s55, -v24
  v_fma_f32 v143, v143, s55, -v24
  v_exp_f32 v133, v133
  s_add_u32 m0, s53, 12288
  s_cbranch_vccnz 9f
  s_waitcnt vmcnt(4)
9:
  s_waitcnt vmcnt(7)
  buffer_load_dwordx4 v1, s[20:23], s51 offen nt lds
  s_barrier
  v_exp_f32 v134, v134
  v_exp_f32 v135, v135
  v_exp_f32 v136, v136
  v_exp_f32 v137, v137
  v_exp_f32 v138, v138
  v_exp_f32 v139, v139
  v_cvt_pk_bf16_f32 v176, v128, v129
  v_exp_f32 v140, v140
  v_cvt_pk_bf16_f32 v177, v130, v131
  v_exp_f32 v141, v141
  v_cvt_pk_bf16_f32 v178, v132, v133
  v_exp_f32 v142, v142
  v_cvt_pk_bf16_f32 v179, v134, v135
  v_exp_f32 v143, v143
  v_cvt_pk_bf16_f32 v180, v136, v137
  s_cbranch_vccnz 9f
  s_waitcnt vmcnt(4)
9:
  s_waitcnt vmcnt(7)
  buffer_load_dwordx4 v2, s[20:23], s51 offen offset:2048 nt lds
  v_fma_f32 v26, v25, v22, v128
  v_add_f32 v27, v130, v131
  v_add_f32 v28, v132, v133
  v_add_f32 v29, v134, v135
  v_add_f32 v26, v26, v129
  v_cvt_pk_bf16_f32 v181, v138, v139
  v_cvt_pk_bf16_f32 v182, v140, v141
  v_cvt_pk_bf16_f32 v183, v142, v143
  v_add_f32 v26, v26, v136
  v_accvgpr_write_b32 a184, v176
  v_add_f32 v27, v27, v137
  v_accvgpr_write_b32 a185, v177
  v_add_f32 v28, v28, v138
  v_accvgpr_write_b32 a186, v178
  v_add_f32 v29, v29, v139
  v_accvgpr_write_b32 a187, v179
  v_add_f32 v26, v26, v140
  v_accvgpr_write_b32 a188, v180
  v_add_f32 v27, v27, v141
  v_accvgpr_write_b32 a189, v181
  v_add_f32 v28, v28, v142
  v_accvgpr_write_b32 a190, v182
  v_add_f32 v29, v29, v143
  v_accvgpr_write_b32 a191, v183
  v_add_f32 v26, v26, v27
  v_add_f32 v28, v28, v29
  v_add_f32 v25, v26, v28
  s_add_u32 m0, s53, 13184
  s_cbranch_vccnz 9f
  s_waitcnt vmcnt(4)
9:
  s_waitcnt vmcnt(7)
  buffer_load_dwordx4 v1, s[20:23], s51 offen offset:128 nt lds
  s_cbranch_vccnz 9f
  s_waitcnt vmcnt(4)
9:
  s_waitcnt vmcnt(7)
  buffer_load_dwordx4 v2, s[20:23], s51 offen offset:2176 nt lds
  s_xor_b32 s51, s51, 0x54000
  ds_read_b128 v[144:147], v6
  ds_read_b128 v[148:151], v7
  ds_read_b128 v[152:155], v8
  ds_read_b128 v[156:159], v9
  ds_read_b128 v[160:163], v6 offset:1024
  ds_read_b128 v[164:167], v7 offset:1024
  ds_read_b128 v[168:171], v8 offset:1024
  ds_read_b128 v[172:175], v9 offset:1024
  s_add_u32 m0, s53, 16384
  s_cbranch_vccnz 9f
  s_waitcnt vmcnt(4)
9:
  s_waitcnt vmcnt(7)
  buffer_load_dwordx4 v1, s[20:23], s51 offen nt lds
  s_add_u32 s91, s91, 1
  s_and_b32 s60, s91, 3
  s_cmp_eq_u32 s60, s3
  s_cbranch_scc0 1f
  v_mov_b32 v252, s91
  s_mov_b64 exec, 1
  buffer_store_dword v252, off, s[40:43], s94 offset:1280
  s_mov_b64 exec, -1
1:
  s_barrier
  buffer_load_dword v246, v254, s[40:43], s95 offen offset:1280 sc1
  s_addk_i32 s97, 512
  s_add_u32 s96, s96, 30
  s_and_b32 s96, s96, 0x11f
  s_cmp_eq_u32 s96, 0
  s_cbranch_scc0 1f
  s_add_u32 s60, s97, s95
  s_mov_b32 exec_hi, 0
  buffer_store_dword v253, v254, s[40:43], s60 offen sc1
  s_mov_b32 exec_hi, -1
1:
  s_waitcnt lgkmcnt(4)
  v_mfma_f32_32x32x16_bf16 v[128:143], v[144:147], v[32:35], 0
  v_mfma_f32_32x32x16_bf16 v[128:143], v[148:151], v[36:39], v[128:143]
  v_mfma_f32_32x32x16_bf16 v[128:143], v[152:155], v[40:43], v[128:143]
  v_mfma_f32_32x32x16_bf16 v[128:143], v[156:159], v[44:47], v[128:143]
  s_cbranch_vccnz 9f
  s_waitcnt vmcnt(5)
9:
  s_waitcnt vmcnt(8)
  buffer_load_dwordx4 v2, s[20:23], s51 offen offset:2048 nt lds
  s_waitcnt lgkmcnt(0)
  v_mfma_f32_32x32x16_bf16 v[128:143], v[160:163], v[48:51], v[128:143]
  v_mfma_f32_32x32x16_bf16 v[128:143], v[164:167], v[52:55], v[128:143]
  v_mfma_f32_32x32x16_bf16 v[128:143], v[168:171], v[56:59], v[128:143]
  v_mfma_f32_32x32x16_bf16 v[128:143], v[172:175], v[60:63], v[128:143]
  s_add_u32 m0, s53, 17280
  s_cbranch_vccnz 9f
  s_waitcnt vmcnt(5)
9:
  s_waitcnt vmcnt(8)
  buffer_load_dwordx4 v1, s[20:23], s51 offen offset:128 nt lds
  s_cmp_eq_u32 s96, 1
  s_cbranch_scc0 1f
  buffer_load_dword v250, v249, s[40:43], s97 offen sc1
1:
  v_mov_b32 v31, v24
  s_nop 4
  v_max3_f32 v26, v128, v129, v130
  v_max3_f32 v27, v131, v132, v133
  v_max3_f32 v28, v134, v135, v136
  v_max3_f32 v29, v137, v138, v139
  v_max3_f32 v30, v140, v141, v142
  v_max3_f32 v26, v26, v27, v28
  v_max3_f32 v29, v29, v30, v143
  v_max_f32 v27, v26, v29
  v_max_f32 v26, v26, v29
  s_nop 1
  v_permlane32_swap_b32 v26, v27
  v_max3_f32 v23, v26, v27, v23
  v_mul_f32 v24, s55, v23
  v_sub_f32 v31, v31, v24
  v_exp_f32 v22, v31
  v_fma_f32 v128, v128, s55, -v24
  v_fma_f32 v129, v129, s55, -v24
  v_fma_f32 v130, v130, s55, -v24
  v_fma_f32 v131, v131, s55, -v24
  ds_write_b32 v231, v22 offset:3072
  s_cbranch_vccnz 9f
  s_waitcnt vmcnt(5)
9:
  s_waitcnt vmcnt(8)
  buffer_load_dwordx4 v2, s[20:23], s51 offen offset:2176 nt lds
  s_xor_b32 s51, s51, 16384
  v_fma_f32 v132, v132, s55, -v24
  v_fma_f32 v133, v133, s55, -v24
  v_exp_f32 v128, v128
  v_fma_f32 v134, v134, s55, -v24
  v_fma_f32 v135, v135, s55, -v24
  v_exp_f32 v129, v129
  v_fma_f32 v136, v136, s55, -v24
  v_fma_f32 v137, v137, s55, -v24
  v_exp_f32 v130, v130
  v_fma_f32 v138, v138, s55, -v24
  v_fma_f32 v139, v139, s55, -v24
  v_exp_f32 v131, v131
  v_fma_f32 v140, v140, s55, -v24
  v_fma_f32 v141, v141, s55, -v24
  v_exp_f32 v132, v132
  v_fma_f32 v142, v142, s55, -v24
  v_fma_f32 v143, v143, s55, -v24
  v_exp_f32 v133, v133
  s_add_u32 m0, s53, 20480
  s_cbranch_vccnz 9f
  s_waitcnt vmcnt(5)
9:
  s_waitcnt vmcnt(8)
  buffer_load_dwordx4 v1, s[20:23], s51 offen nt lds
  s_barrier
  v_exp_f32 v134, v134
  v_exp_f32 v135, v135
  v_exp_f32 v136, v136
  v_exp_f32 v137, v137
  v_exp_f32 v138, v138
  v_exp_f32 v139, v139
  v_cvt_pk_bf16_f32 v176, v128, v129
  v_exp_f32 v140, v140
  v_cvt_pk_bf16_f32 v177, v130, v131
  v_exp_f32 v141, v141
  v_cvt_pk_bf16_f32 v178, v132, v133
  v_exp_f32 v142, v142
  v_cvt_pk_bf16_f32 v179, v134, v135
  v_exp_f32 v143, v143
  v_cvt_pk_bf16_f32 v180, v136, v137
  s_cbranch_vccnz 9f
  s_waitcnt vmcnt(5)
9:
  s_waitcnt vmcnt(8)
  buffer_load_dwordx4 v2, s[20:23], s51 offen offset:2048 nt lds
  v_fma_f32 v26, v25, v22, v128
  v_add_f32 v27, v130, v131
  v_add_f32 v28, v132, v133
  v_add_f32 v29, v134, v135
  v_add_f32 v26, v26, v129
  v_cvt_pk_bf16_f32 v181, v138, v139
  v_cvt_pk_bf16_f32 v182, v140, v141
  v_cvt_pk_bf16_f32 v183, v142, v143
  v_add_f32 v26, v26, v136
  v_accvgpr_write_b32 a192, v176
  v_add_f32 v27, v27, v137
  v_accvgpr_write_b32 a193, v177
  v_add_f32 v28, v28, v138
  v_accvgpr_write_b32 a194, v178
  v_add_f32 v29, v29, v139
  v_accvgpr_write_b32 a195, v179
  v_add_f32 v26, v26, v140
  v_accvgpr_write_b32 a196, v180
  v_add_f32 v27, v27, v141
  v_accvgpr_write_b32 a197, v181
  v_add_f32 v28, v28, v142
  v_accvgpr_write_b32 a198, v182
  v_add_f32 v29, v29, v143
  v_accvgpr_write_b32 a199, v183
  v_add_f32 v26, v26, v27
  v_add_f32 v28, v28, v29
  v_add_f32 v25, v26, v28
  s_add_u32 m0, s53, 21376
  s_cbranch_vccnz 9f
  s_waitcnt vmcnt(4)
9:
  s_waitcnt vmcnt(8)
  buffer_load_dwordx4 v1, s[20:23], s51 offen offset:128 nt lds
  s_cbranch_vccnz 9f
  s_waitcnt vmcnt(4)
9:
  s_waitcnt vmcnt(8)
  buffer_load_dwordx4 v2, s[20:23], s51 offen offset:2176 nt lds
  s_xor_b32 s51, s51, 0x14000
  ds_read_b128 v[144:147], v6 offset:8192
  ds_read_b128 v[148:151], v7 offset:8192
  ds_read_b128 v[152:155], v8 offset:8192
  ds_read_b128 v[156:159], v9 offset:8192
  ds_read_b128 v[160:163], v6 offset:9216
  ds_read_b128 v[164:167], v7 offset:9216
  ds_read_b128 v[168:171], v8 offset:9216
  ds_read_b128 v[172:175], v9 offset:9216
  s_mov_b32 m0, s53
  s_cbranch_vccnz 9f
  s_waitcnt vmcnt(4)
9:
  s_waitcnt vmcnt(8)
  buffer_load_dwordx4 v1, s[20:23], s51 offen nt lds
  s_barrier
  s_waitcnt lgkmcnt(4)
  v_mfma_f32_32x32x16_bf16 v[128:143], v[144:147], v[32:35], 0
  v_mfma_f32_32x32x16_bf16 v[128:143], v[148:151], v[36:39], v[128:143]
  v_mfma_f32_32x32x16_bf16 v[128:143], v[152:155], v[40:43], v[128:143]
  v_mfma_f32_32x32x16_bf16 v[128:143], v[156:159], v[44:47], v[128:143]
  s_cbranch_vccnz 9f
  s_waitcnt vmcnt(4)
9:
  s_waitcnt vmcnt(7)
  buffer_load_dwordx4 v2, s[20:23], s51 offen offset:2048 nt lds
  v_add_u32 v248, v248, v247
  v_cmp_le_i32 s[92:93], v248, v246
  s_nop 0
  s_bcnt1_i32_b64 s60, s[92:93]
  s_cmp_ge_u32 s60, 33
  s_cselect_b64 vcc, -1, 0
  s_lshl_b32 s62, s3, 1
  s_xor_b32 s62, s62, 0
  s_mul_i32 s62, s62, 18432
  s_add_u32 s62, s62, s66
  s_add_u32 m0, s53, 24576
  s_nop 0
  buffer_load_dwordx4 v18, s[36:39], s62 offen lds
  s_addk_i32 s62, 4608
  s_waitcnt lgkmcnt(0)
  v_mfma_f32_32x32x16_bf16 v[128:143], v[160:163], v[48:51], v[128:143]
  v_mfma_f32_32x32x16_bf16 v[128:143], v[164:167], v[52:55], v[128:143]
  v_mfma_f32_32x32x16_bf16 v[128:143], v[168:171], v[56:59], v[128:143]
  v_mfma_f32_32x32x16_bf16 v[128:143], v[172:175], v[60:63], v[128:143]
  s_add_u32 m0, s53, 896
  s_cbranch_vccnz 9f
  s_waitcnt vmcnt(5)
9:
  s_waitcnt vmcnt(8)
  buffer_load_dwordx4 v1, s[20:23], s51 offen offset:128 nt lds
  v_mov_b32 v31, v24
  s_nop 6
  v_max3_f32 v26, v128, v129, v130
  v_max3_f32 v27, v131, v132, v133
  v_max3_f32 v28, v134, v135, v136
  v_max3_f32 v29, v137, v138, v139
  v_max3_f32 v30, v140, v141, v142
  v_max3_f32 v26, v26, v27, v28
  v_max3_f32 v29, v29, v30, v143
  v_max_f32 v27, v26, v29
  v_max_f32 v26, v26, v29
  s_nop 1
  v_permlane32_swap_b32 v26, v27
  v_max3_f32 v23, v26, v27, v23
  v_mul_f32 v24, s55, v23
  v_sub_f32 v31, v31, v24
  v_exp_f32 v22, v31
  v_fma_f32 v128, v128, s55, -v24
  v_fma_f32 v129, v129, s55, -v24
  v_fma_f32 v130, v130, s55, -v24
  v_fma_f32 v131, v131, s55, -v24
  ds_write_b32 v231, v22 offset:3200
  s_cbranch_vccnz 9f
  s_waitcnt vmcnt(5)
9:
  s_waitcnt vmcnt(8)
  buffer_load_dwordx4 v2, s[20:23], s51 offen offset:2176 nt lds
  s_xor_b32 s51, s51, 16384
  s_cmp_eq_u32 s96, 1
  s_cbranch_scc0 1f
  v_cmp_lt_i32 s[92:93], 0, v250
  s_nop 0
  s_bcnt1_i32_b32 s60, s92
  v_mov_b32 v250, s60
  s_mov_b64 exec, 1
  buffer_store_dword v250, off, s[40:43], s95 offset:512
  buffer_store_dword v250, off, s[40:43], s95 offset:768
  buffer_store_dword v250, off, s[40:43], s95 offset:1792
  s_mov_b64 exec, -1
1:
  v_fma_f32 v132, v132, s55, -v24
  v_fma_f32 v133, v133, s55, -v24
  v_exp_f32 v128, v128
  v_fma_f32 v134, v134, s55, -v24
  v_fma_f32 v135, v135, s55, -v24
  v_exp_f32 v129, v129
  v_fma_f32 v136, v136, s55, -v24
  v_fma_f32 v137, v137, s55, -v24
  v_exp_f32 v130, v130
  v_fma_f32 v138, v138, s55, -v24
  v_fma_f32 v139, v139, s55, -v24
  v_exp_f32 v131, v131
  v_fma_f32 v140, v140, s55, -v24
  v_fma_f32 v141, v141, s55, -v24
  v_exp_f32 v132, v132
  v_fma_f32 v142, v142, s55, -v24
  v_fma_f32 v143, v143, s55, -v24
  v_exp_f32 v133, v133
  s_add_u32 m0, s53, 4096
  s_cbranch_vccnz 9f
  s_waitcnt vmcnt(5)
9:
  s_waitcnt vmcnt(8)
  buffer_load_dwordx4 v1, s[20:23], s51 offen nt lds
  s_barrier
  v_exp_f32 v134, v134
  v_exp_f32 v135, v135
  v_exp_f32 v136, v136
  v_exp_f32 v137, v137
  v_exp_f32 v138, v138
  v_exp_f32 v139, v139
  v_cvt_pk_bf16_f32 v176, v128, v129
  v_exp_f32 v140, v140
  v_cvt_pk_bf16_f32 v177, v130, v131
  v_exp_f32 v141, v141
  v_cvt_pk_bf16_f32 v178, v132, v133
  v_exp_f32 v142, v142
  v_cvt_pk_bf16_f32 v179, v134, v135
  v_exp_f32 v143, v143
  v_cvt_pk_bf16_f32 v180, v136, v137
  s_cbranch_vccnz 9f
  s_waitcnt vmcnt(5)
9:
  s_waitcnt vmcnt(8)
  buffer_load_dwordx4 v2, s[20:23], s51 offen offset:2048 nt lds
  s_add_u32 m0, s53, 25600
  s_nop 0
  buffer_load_dwordx4 v18, s[36:39], s62 offen lds
  s_addk_i32 s62, 4608
  v_fma_f32 v26, v25, v22, v128
  v_add_f32 v27, v130, v131
  v_add_f32 v28, v132, v133
  v_add_f32 v29, v134, v135
  v_add_f32 v26, v26, v129
  v_cvt_pk_bf16_f32 v181, v138, v139
  v_cvt_pk_bf16_f32 v182, v140, v141
  v_cvt_pk_bf16_f32 v183, v142, v143
  v_add_f32 v26, v26, v136
  v_accvgpr_write_b32 a200, v176
  v_add_f32 v27, v27, v137
  v_accvgpr_write_b32 a201, v177
  v_add_f32 v28, v28, v138
  v_accvgpr_write_b32 a202, v178
  v_add_f32 v29, v29, v139
  v_accvgpr_write_b32 a203, v179
  v_add_f32 v26, v26, v140
  v_accvgpr_write_b32 a204, v180
  v_add_f32 v27, v27, v141
  v_accvgpr_write_b32 a205, v181
  v_add_f32 v28, v28, v142
  v_accvgpr_write_b32 a206, v182
  v_add_f32 v29, v29, v143
  v_accvgpr_write_b32 a207, v183
  v_add_f32 v26, v26, v27
  v_add_f32 v28, v28, v29
  v_add_f32 v25, v26, v28
  s_add_u32 m0, s53, 4992
  s_cbranch_vccnz 9f
  s_waitcnt vmcnt(6)
9:
  s_waitcnt vmcnt(9)
  buffer_load_dwordx4 v1, s[20:23], s51 offen offset:128 nt lds
  s_cbranch_vccnz 9f
  s_waitcnt vmcnt(5)
9:
  s_waitcnt vmcnt(9)
  buffer_load_dwordx4 v2, s[20:23], s51 offen offset:2176 nt lds
  s_xor_b32 s51, s51, 0xd4000
  ds_read_b128 v[144:147], v6 offset:16384
  ds_read_b128 v[148:151], v7 offset:16384
  ds_read_b128 v[152:155], v8 offset:16384
  ds_read_b128 v[156:159], v9 offset:16384
  ds_read_b128 v[160:163], v6 offset:17408
  ds_read_b128 v[164:167], v7 offset:17408
  ds_read_b128 v[168:171], v8 offset:17408
  ds_read_b128 v[172:175], v9 offset:17408
  s_add_u32 m0, s53, 8192
  s_cbranch_vccnz 9f
  s_waitcnt vmcnt(5)
9:
  s_waitcnt vmcnt(9)
  buffer_load_dwordx4 v1, s[20:23], s51 offen nt lds
  s_add_u32 s91, s91, 1
  s_and_b32 s60, s91, 3
  s_cmp_eq_u32 s60, s3
  s_cbranch_scc0 1f
  v_mov_b32 v252, s91
  s_mov_b64 exec, 1
  buffer_store_dword v252, off, s[40:43], s94
  s_mov_b64 exec, -1
1:
  s_barrier
  buffer_load_dword v255, v254, s[40:43], s95 offen sc1
  s_addk_i32 s97, 512
  s_add_u32 s96, s96, 30
  s_and_b32 s96, s96, 0x11f
  s_cmp_eq_u32 s96, 0
  s_cbranch_scc0 1f
  s_add_u32 s60, s97, s95
  s_mov_b32 exec_hi, 0
  buffer_store_dword v253, v254, s[40:43], s60 offen sc1
  s_mov_b32 exec_hi, -1
1:
  s_waitcnt lgkmcnt(4)
  v_mfma_f32_32x32x16_bf16 v[128:143], v[144:147], v[32:35], 0
  v_mfma_f32_32x32x16_bf16 v[128:143], v[148:151], v[36:39], v[128:143]
  v_mfma_f32_32x32x16_bf16 v[128:143], v[152:155], v[40:43], v[128:143]
  v_mfma_f32_32x32x16_bf16 v[128:143], v[156:159], v[44:47], v[128:143]
  s_cbranch_vccnz 9f
  s_waitcnt vmcnt(6)
9:
  s_waitcnt vmcnt(10)
  buffer_load_dwordx4 v2, s[20:23], s51 offen offset:2048 nt lds
  s_add_u32 m0, s53, 26624
  s_nop 0
  buffer_load_dwordx4 v18, s[36:39], s62 offen lds
  s_addk_i32 s62, 4608
  s_waitcnt lgkmcnt(0)
  v_mfma_f32_32x32x16_bf16 v[128:143], v[160:163], v[48:51], v[128:143]
  v_mfma_f32_32x32x16_bf16 v[128:143], v[164:167], v[52:55], v[128:143]
  v_mfma_f32_32x32x16_bf16 v[128:143], v[168:171], v[56:59], v[128:143]
  v_mfma_f32_32x32x16_bf16 v[128:143], v[172:175], v[60:63], v[128:143]
  s_add_u32 m0, s53, 9088
  s_cbranch_vccnz 9f
  s_waitcnt vmcnt(7)
9:
  s_waitcnt vmcnt(10)
  buffer_load_dwordx4 v1, s[20:23], s51 offen offset:128 nt lds
  s_cmp_eq_u32 s96, 1
  s_cbranch_scc0 1f
  buffer_load_dword v250, v249, s[40:43], s97 offen sc1
1:
  v_mov_b32 v31, v24
  s_nop 4
  v_max3_f32 v26, v128, v129, v130
  v_max3_f32 v27, v131, v132, v133
  v_max3_f32 v28, v134, v135, v136
  v_max3_f32 v29, v137, v138, v139
  v_max3_f32 v30, v140, v141, v142
  v_max3_f32 v26, v26, v27, v28
  v_max3_f32 v29, v29, v30, v143
  v_max_f32 v27, v26, v29
  v_max_f32 v26, v26, v29
  s_nop 1
  v_permlane32_swap_b32 v26, v27
  v_max3_f32 v23, v26, v27, v23
  v_mul_f32 v24, s55, v23
  v_sub_f32 v31, v31, v24
  v_exp_f32 v22, v31
  v_fma_f32 v128, v128, s55, -v24
  v_fma_f32 v129, v129, s55, -v24
  v_fma_f32 v130, v130, s55, -v24
  v_fma_f32 v131, v131, s55, -v24
  ds_write_b32 v231, v22 offset:3328
  s_cbranch_vccnz 9f
  s_waitcnt vmcnt(6)
9:
  s_waitcnt vmcnt(10)
  buffer_load_dwordx4 v2, s[20:23], s51 offen offset:2176 nt lds
  s_xor_b32 s51, s51, 16384
  v_fma_f32 v132, v132, s55, -v24
  v_fma_f32 v133, v133, s55, -v24
  v_exp_f32 v128, v128
  v_fma_f32 v134, v134, s55, -v24
  v_fma_f32 v135, v135, s55, -v24
  v_exp_f32 v129, v129
  v_fma_f32 v136, v136, s55, -v24
  v_fma_f32 v137, v137, s55, -v24
  v_exp_f32 v130, v130
  v_fma_f32 v138, v138, s55, -v24
  v_fma_f32 v139, v139, s55, -v24
  v_exp_f32 v131, v131
  v_fma_f32 v140, v140, s55, -v24
  v_fma_f32 v141, v141, s55, -v24
  v_exp_f32 v132, v132
  v_fma_f32 v142, v142, s55, -v24
  v_fma_f32 v143, v143, s55, -v24
  v_exp_f32 v133, v133
  s_add_u32 m0, s53, 12288
  s_cbranch_vccnz 9f
  s_waitcnt vmcnt(6)
9:
  s_waitcnt vmcnt(10)
  buffer_load_dwordx4 v1, s[20:23], s51 offen nt lds
  s_barrier
  v_exp_f32 v134, v134
  v_exp_f32 v135, v135
  v_exp_f32 v136, v136
  v_exp_f32 v137, v137
  v_exp_f32 v138, v138
  v_exp_f32 v139, v139
  v_cvt_pk_bf16_f32 v176, v128, v129
  v_exp_f32 v140, v140
  v_cvt_pk_bf16_f32 v177, v130, v131
  v_exp_f32 v141, v141
  v_cvt_pk_bf16_f32 v178, v132, v133
  v_exp_f32 v142, v142
  v_cvt_pk_bf16_f32 v179, v134, v135
  v_exp_f32 v143, v143
  v_cvt_pk_bf16_f32 v180, v136, v137
  s_cbranch_vccnz 9f
  s_waitcnt vmcnt(6)
9:
  s_waitcnt vmcnt(10)
  buffer_load_dwordx4 v2, s[20:23], s51 offen offset:2048 nt lds
  s_add_u32 m0, s53, 27648
  s_nop 0
  buffer_load_dwordx4 v18, s[36:39], s62 offen lds
  v_fma_f32 v26, v25, v22, v128
  v_add_f32 v27, v130, v131
  v_add_f32 v28, v132, v133
  v_add_f32 v29, v134, v135
  v_add_f32 v26, v26, v129
  v_cvt_pk_bf16_f32 v181, v138, v139
  v_cvt_pk_bf16_f32 v182, v140, v141
  v_cvt_pk_bf16_f32 v183, v142, v143
  v_add_f32 v26, v26, v136
  v_accvgpr_write_b32 a208, v176
  v_add_f32 v27, v27, v137
  v_accvgpr_write_b32 a209, v177
  v_add_f32 v28, v28, v138
  v_accvgpr_write_b32 a210, v178
  v_add_f32 v29, v29, v139
  v_accvgpr_write_b32 a211, v179
  v_add_f32 v26, v26, v140
  v_accvgpr_write_b32 a212, v180
  v_add_f32 v27, v27, v141
  v_accvgpr_write_b32 a213, v181
  v_add_f32 v28, v28, v142
  v_accvgpr_write_b32 a214, v182
  v_add_f32 v29, v29, v143
  v_accvgpr_write_b32 a215, v183
  v_add_f32 v26, v26, v27
  v_add_f32 v28, v28, v29
  v_add_f32 v25, v26, v28
  s_add_u32 m0, s53, 13184
  s_cbranch_vccnz 9f
  s_waitcnt vmcnt(6)
9:
  s_waitcnt vmcnt(10)
  buffer_load_dwordx4 v1, s[20:23], s51 offen offset:128 nt lds
  s_cbranch_vccnz 9f
  s_waitcnt vmcnt(5)
9:
  s_waitcnt vmcnt(10)
  buffer_load_dwordx4 v2, s[20:23], s51 offen offset:2176 nt lds
  s_xor_b32 s51, s51, 0x14000
  ds_read_b128 v[144:147], v6
  ds_read_b128 v[148:151], v7
  ds_read_b128 v[152:155], v8
  ds_read_b128 v[156:159], v9
  ds_read_b128 v[160:163], v6 offset:1024
  ds_read_b128 v[164:167], v7 offset:1024
  ds_read_b128 v[168:171], v8 offset:1024
  ds_read_b128 v[172:175], v9 offset:1024
  s_add_u32 m0, s53, 16384
  s_cbranch_vccnz 9f
  s_waitcnt vmcnt(5)
9:
  s_waitcnt vmcnt(10)
  buffer_load_dwordx4 v1, s[20:23], s51 offen nt lds
  s_barrier
  s_waitcnt lgkmcnt(4)
  v_mfma_f32_32x32x16_bf16 v[128:143], v[144:147], v[32:35], 0
  v_mfma_f32_32x32x16_bf16 v[128:143], v[148:151], v[36:39], v[128:143]
  v_mfma_f32_32x32x16_bf16 v[128:143], v[152:155], v[40:43], v[128:143]
  v_mfma_f32_32x32x16_bf16 v[128:143], v[156:159], v[44:47], v[128:143]
  s_cbranch_vccnz 9f
  s_waitcnt vmcnt(5)
9:
  s_waitcnt vmcnt(9)
  buffer_load_dwordx4 v2, s[20:23], s51 offen offset:2048 nt lds
  v_add_u32 v248, v248, v247
  v_cmp_le_i32 s[92:93], v248, v255
  s_nop 0
  s_bcnt1_i32_b64 s60, s[92:93]
  s_cmp_ge_u32 s60, 33
  s_cselect_b64 vcc, -1, 0
  s_waitcnt lgkmcnt(0)
  v_mfma_f32_32x32x16_bf16 v[128:143], v[160:163], v[48:51], v[128:143]
  v_mfma_f32_32x32x16_bf16 v[128:143], v[164:167], v[52:55], v[128:143]
  v_mfma_f32_32x32x16_bf16 v[128:143], v[168:171], v[56:59], v[128:143]
  v_mfma_f32_32x32x16_bf16 v[128:143], v[172:175], v[60:63], v[128:143]
  s_add_u32 m0, s53, 17280
  s_cbranch_vccnz 9f
  s_waitcnt vmcnt(5)
9:
  s_waitcnt vmcnt(8)
  buffer_load_dwordx4 v1, s[20:23], s51 offen offset:128 nt lds
  v_mov_b32 v31, v24
  s_nop 6
  v_max3_f32 v26, v128, v129, v130
  v_max3_f32 v27, v131, v132, v133
  v_max3_f32 v28, v134, v135, v136
  v_max3_f32 v29, v137, v138, v139
  v_max3_f32 v30, v140, v141, v142
  v_max3_f32 v26, v26, v27, v28
  v_max3_f32 v29, v29, v30, v143
  v_max_f32 v27, v26, v29
  v_max_f32 v26, v26, v29
  s_nop 1
  v_permlane32_swap_b32 v26, v27
  v_max3_f32 v23, v26, v27, v23
  v_mul_f32 v24, s55, v23
  v_sub_f32 v31, v31, v24
  v_exp_f32 v22, v31
  v_fma_f32 v128, v128, s55, -v24
  v_fma_f32 v129, v129, s55, -v24
  v_fma_f32 v130, v130, s55, -v24
  v_fma_f32 v131, v131, s55, -v24
  ds_write_b32 v231, v22 offset:3456
  s_cbranch_vccnz 9f
  s_waitcnt vmcnt(4)
9:
  s_waitcnt vmcnt(8)
  buffer_load_dwordx4 v2, s[20:23], s51 offen offset:2176 nt lds
  s_xor_b32 s51, s51, 16384
  s_cmp_eq_u32 s96, 1
  s_cbranch_scc0 1f
  v_cmp_lt_i32 s[92:93], 0, v250
  s_nop 0
  s_bcnt1_i32_b32 s60, s92
  v_mov_b32 v250, s60
  s_mov_b64 exec, 1
  buffer_store_dword v250, off, s[40:43], s95 offset:512
  buffer_store_dword v250, off, s[40:43], s95 offset:768
  buffer_store_dword v250, off, s[40:43], s95 offset:1792
  s_mov_b64 exec, -1
1:
  s_lshl_b32 s98, s3, 1
  s_xor_b32 s98, s98, 1
  s_mul_i32 s98, s98, 18432
  s_add_u32 s98, s98, s66
  s_add_u32 m0, s53, 28672
  s_nop 0
  buffer_load_dwordx4 v18, s[36:39], s98 offen lds
  s_addk_i32 s98, 4608
  v_fma_f32 v132, v132, s55, -v24
  v_fma_f32 v133, v133, s55, -v24
  v_exp_f32 v128, v128
  v_fma_f32 v134, v134, s55, -v24
  v_fma_f32 v135, v135, s55, -v24
  v_exp_f32 v129, v129
  v_fma_f32 v136, v136, s55, -v24
  v_fma_f32 v137, v137, s55, -v24
  v_exp_f32 v130, v130
  v_fma_f32 v138, v138, s55, -v24
  v_fma_f32 v139, v139, s55, -v24
  v_exp_f32 v131, v131
  v_fma_f32 v140, v140, s55, -v24
  v_fma_f32 v141, v141, s55, -v24
  v_exp_f32 v132, v132
  v_fma_f32 v142, v142, s55, -v24
  v_fma_f32 v143, v143, s55, -v24
  v_exp_f32 v133, v133
  s_add_u32 m0, s53, 20480
  s_cbranch_vccnz 9f
  s_waitcnt vmcnt(5)
9:
  s_waitcnt vmcnt(9)
  buffer_load_dwordx4 v1, s[20:23], s51 offen nt lds
  s_barrier
  v_exp_f32 v134, v134
  v_exp_f32 v135, v135
  v_exp_f32 v136, v136
  v_exp_f32 v137, v137
  v_exp_f32 v138, v138
  v_exp_f32 v139, v139
  v_cvt_pk_bf16_f32 v176, v128, v129
  v_exp_f32 v140, v140
  v_cvt_pk_bf16_f32 v177, v130, v131
  v_exp_f32 v141, v141
  v_cvt_pk_bf16_f32 v178, v132, v133
  v_exp_f32 v142, v142
  v_cvt_pk_bf16_f32 v179, v134, v135
  v_exp_f32 v143, v143
  v_cvt_pk_bf16_f32 v180, v136, v137
  s_cbranch_vccnz 9f
  s_waitcnt vmcnt(5)
9:
  s_waitcnt vmcnt(9)
  buffer_load_dwordx4 v2, s[20:23], s51 offen offset:2048 nt lds
  v_fma_f32 v26, v25, v22, v128
  v_add_f32 v27, v130, v131
  v_add_f32 v28, v132, v133
  v_add_f32 v29, v134, v135
  v_add_f32 v26, v26, v129
  v_cvt_pk_bf16_f32 v181, v138, v139
  v_cvt_pk_bf16_f32 v182, v140, v141
  v_cvt_pk_bf16_f32 v183, v142, v143
  v_add_f32 v26, v26, v136
  v_accvgpr_write_b32 a216, v176
  v_add_f32 v27, v27, v137
  v_accvgpr_write_b32 a217, v177
  v_add_f32 v28, v28, v138
  v_accvgpr_write_b32 a218, v178
  v_add_f32 v29, v29, v139
  v_accvgpr_write_b32 a219, v179
  v_add_f32 v26, v26, v140
  v_accvgpr_write_b32 a220, v180
  v_add_f32 v27, v27, v141
  v_accvgpr_write_b32 a221, v181
  v_add_f32 v28, v28, v142
  v_accvgpr_write_b32 a222, v182
  v_add_f32 v29, v29, v143
  v_accvgpr_write_b32 a223, v183
  v_add_f32 v26, v26, v27
  v_add_f32 v28, v28, v29
  v_add_f32 v25, v26, v28
  s_add_u32 m0, s53, 21376
  s_cbranch_vccnz 9f
  s_waitcnt vmcnt(5)
9:
  s_waitcnt vmcnt(8)
  buffer_load_dwordx4 v1, s[20:23], s51 offen offset:128 nt lds
  s_cbranch_vccnz 9f
  s_waitcnt vmcnt(5)
9:
  s_waitcnt vmcnt(8)
  buffer_load_dwordx4 v2, s[20:23], s51 offen offset:2176 nt lds
  s_xor_b32 s51, s51, 0x54000
  s_add_u32 m0, s53, 29696
  s_nop 0
  buffer_load_dwordx4 v18, s[36:39], s98 offen lds
  s_addk_i32 s98, 4608
  ds_read_b128 v[144:147], v6 offset:8192
  ds_read_b128 v[148:151], v7 offset:8192
  ds_read_b128 v[152:155], v8 offset:8192
  ds_read_b128 v[156:159], v9 offset:8192
  ds_read_b128 v[160:163], v6 offset:9216
  ds_read_b128 v[164:167], v7 offset:9216
  ds_read_b128 v[168:171], v8 offset:9216
  ds_read_b128 v[172:175], v9 offset:9216
  s_mov_b32 m0, s53
  s_cbranch_vccnz 9f
  s_waitcnt vmcnt(6)
9:
  s_waitcnt vmcnt(9)
  buffer_load_dwordx4 v1, s[20:23], s51 offen nt lds
  s_add_u32 s91, s91, 1
  s_and_b32 s60, s91, 3
  s_cmp_eq_u32 s60, s3
  s_cbranch_scc0 1f
  v_mov_b32 v252, s91
  s_mov_b64 exec, 1
  buffer_store_dword v252, off, s[40:43], s94 offset:256
  s_mov_b64 exec, -1
1:
  s_barrier
  buffer_load_dword v251, v254, s[40:43], s95 offen offset:256 sc1
  s_addk_i32 s97, 512
  s_add_u32 s96, s96, 30
  s_and_b32 s96, s96, 0x11f
  s_cmp_eq_u32 s96, 0
  s_cbranch_scc0 1f
  s_add_u32 s60, s97, s95
  s_mov_b32 exec_hi, 0
  buffer_store_dword v253, v254, s[40:43], s60 offen sc1
  s_mov_b32 exec_hi, -1
1:
  s_waitcnt lgkmcnt(4)
  v_mfma_f32_32x32x16_bf16 v[128:143], v[144:147], v[32:35], 0
  v_mfma_f32_32x32x16_bf16 v[128:143], v[148:151], v[36:39], v[128:143]
  v_mfma_f32_32x32x16_bf16 v[128:143], v[152:155], v[40:43], v[128:143]
  v_mfma_f32_32x32x16_bf16 v[128:143], v[156:159], v[44:47], v[128:143]
  s_cbranch_vccnz 9f
  s_waitcnt vmcnt(6)
9:
  s_waitcnt vmcnt(10)
  buffer_load_dwordx4 v2, s[20:23], s51 offen offset:2048 nt lds
  s_waitcnt lgkmcnt(0)
  v_mfma_f32_32x32x16_bf16 v[128:143], v[160:163], v[48:51], v[128:143]
  v_mfma_f32_32x32x16_bf16 v[128:143], v[164:167], v[52:55], v[128:143]
  v_mfma_f32_32x32x16_bf16 v[128:143], v[168:171], v[56:59], v[128:143]
  v_mfma_f32_32x32x16_bf16 v[128:143], v[172:175], v[60:63], v[128:143]
  s_add_u32 m0, s53, 896
  s_cbranch_vccnz 9f
  s_waitcnt vmcnt(6)
9:
  s_waitcnt vmcnt(10)
  buffer_load_dwordx4 v1, s[20:23], s51 offen offset:128 nt lds
  s_cmp_eq_u32 s96, 1
  s_cbranch_scc0 1f
  buffer_load_dword v250, v249, s[40:43], s97 offen sc1
1:
  v_mov_b32 v31, v24
  s_nop 4
  v_max3_f32 v26, v128, v129, v130
  v_max3_f32 v27, v131, v132, v133
  v_max3_f32 v28, v134, v135, v136
  v_max3_f32 v29, v137, v138, v139
  v_max3_f32 v30, v140, v141, v142
  v_max3_f32 v26, v26, v27, v28
  v_max3_f32 v29, v29, v30, v143
  v_max_f32 v27, v26, v29
  v_max_f32 v26, v26, v29
  s_nop 1
  v_permlane32_swap_b32 v26, v27
  v_max3_f32 v23, v26, v27, v23
  v_mul_f32 v24, s55, v23
  v_sub_f32 v31, v31, v24
  v_exp_f32 v22, v31
  v_fma_f32 v128, v128, s55, -v24
  v_fma_f32 v129, v129, s55, -v24
  v_fma_f32 v130, v130, s55, -v24
  v_fma_f32 v131, v131, s55, -v24
  ds_write_b32 v231, v22 offset:3584
  s_cbranch_vccnz 9f
  s_waitcnt vmcnt(6)
9:
  s_waitcnt vmcnt(10)
  buffer_load_dwordx4 v2, s[20:23], s51 offen offset:2176 nt lds
  s_xor_b32 s51, s51, 16384
  s_add_u32 m0, s53, 30720
  s_nop 0
  buffer_load_dwordx4 v18, s[36:39], s98 offen lds
  s_addk_i32 s98, 4608
  v_fma_f32 v132, v132, s55, -v24
  v_fma_f32 v133, v133, s55, -v24
  v_exp_f32 v128, v128
  v_fma_f32 v134, v134, s55, -v24
  v_fma_f32 v135, v135, s55, -v24
  v_exp_f32 v129, v129
  v_fma_f32 v136, v136, s55, -v24
  v_fma_f32 v137, v137, s55, -v24
  v_exp_f32 v130, v130
  v_fma_f32 v138, v138, s55, -v24
  v_fma_f32 v139, v139, s55, -v24
  v_exp_f32 v131, v131
  v_fma_f32 v140, v140, s55, -v24
  v_fma_f32 v141, v141, s55, -v24
  v_exp_f32 v132, v132
  v_fma_f32 v142, v142, s55, -v24
  v_fma_f32 v143, v143, s55, -v24
  v_exp_f32 v133, v133
  s_add_u32 m0, s53, 4096
  s_cbranch_vccnz 9f
  s_waitcnt vmcnt(7)
9:
  s_waitcnt vmcnt(10)
  buffer_load_dwordx4 v1, s[20:23], s51 offen nt lds
  s_barrier
  v_exp_f32 v134, v134
  v_exp_f32 v135, v135
  v_exp_f32 v136, v136
  v_exp_f32 v137, v137
  v_exp_f32 v138, v138
  v_exp_f32 v139, v139
  v_cvt_pk_bf16_f32 v176, v128, v129
  v_exp_f32 v140, v140
  v_cvt_pk_bf16_f32 v177, v130, v131
  v_exp_f32 v141, v141
  v_cvt_pk_bf16_f32 v178, v132, v133
  v_exp_f32 v142, v142
  v_cvt_pk_bf16_f32 v179, v134, v135
  v_exp_f32 v143, v143
  v_cvt_pk_bf16_f32 v180, v136, v137
  s_cbranch_vccnz 9f
  s_waitcnt vmcnt(6)
9:
  s_waitcnt vmcnt(10)
  buffer_load_dwordx4 v2, s[20:23], s51 offen offset:2048 nt lds
  v_fma_f32 v26, v25, v22, v128
  v_add_f32 v27, v130, v131
  v_add_f32 v28, v132, v133
  v_add_f32 v29, v134, v135
  v_add_f32 v26, v26, v129
  v_cvt_pk_bf16_f32 v181, v138, v139
  v_cvt_pk_bf16_f32 v182, v140, v141
  v_cvt_pk_bf16_f32 v183, v142, v143
  v_add_f32 v26, v26, v136
  v_accvgpr_write_b32 a224, v176
  v_add_f32 v27, v27, v137
  v_accvgpr_write_b32 a225, v177
  v_add_f32 v28, v28, v138
  v_accvgpr_write_b32 a226, v178
  v_add_f32 v29, v29, v139
  v_accvgpr_write_b32 a227, v179
  v_add_f32 v26, v26, v140
  v_accvgpr_write_b32 a228, v180
  v_add_f32 v27, v27, v141
  v_accvgpr_write_b32 a229, v181
  v_add_f32 v28, v28, v142
  v_accvgpr_write_b32 a230, v182
  v_add_f32 v29, v29, v143
  v_accvgpr_write_b32 a231, v183
  v_add_f32 v26, v26, v27
  v_add_f32 v28, v28, v29
  v_add_f32 v25, v26, v28
  s_add_u32 m0, s53, 4992
  s_cbranch_vccnz 9f
  s_waitcnt vmcnt(5)
9:
  s_waitcnt vmcnt(10)
  buffer_load_dwordx4 v1, s[20:23], s51 offen offset:128 nt lds
  s_cbranch_vccnz 9f
  s_waitcnt vmcnt(5)
9:
  s_waitcnt vmcnt(10)
  buffer_load_dwordx4 v2, s[20:23], s51 offen offset:2176 nt lds
  s_xor_b32 s51, s51, 0x14000
  s_add_u32 m0, s53, 31744
  s_nop 0
  buffer_load_dwordx4 v18, s[36:39], s98 offen lds
  ds_read_b128 v[144:147], v6 offset:16384
  ds_read_b128 v[148:151], v7 offset:16384
  ds_read_b128 v[152:155], v8 offset:16384
  ds_read_b128 v[156:159], v9 offset:16384
  ds_read_b128 v[160:163], v6 offset:17408
  ds_read_b128 v[164:167], v7 offset:17408
  ds_read_b128 v[168:171], v8 offset:17408
  ds_read_b128 v[172:175], v9 offset:17408
  s_add_u32 m0, s53, 8192
  s_cbranch_vccnz 9f
  s_waitcnt vmcnt(6)
9:
  s_waitcnt vmcnt(10)
  buffer_load_dwordx4 v1, s[20:23], s51 offen nt lds
  s_barrier
  s_waitcnt lgkmcnt(4)
  v_mfma_f32_32x32x16_bf16 v[128:143], v[144:147], v[32:35], 0
  v_mfma_f32_32x32x16_bf16 v[128:143], v[148:151], v[36:39], v[128:143]
  v_mfma_f32_32x32x16_bf16 v[128:143], v[152:155], v[40:43], v[128:143]
  v_mfma_f32_32x32x16_bf16 v[128:143], v[156:159], v[44:47], v[128:143]
  s_cbranch_vccnz 9f
  s_waitcnt vmcnt(5)
9:
  s_waitcnt vmcnt(9)
  buffer_load_dwordx4 v2, s[20:23], s51 offen offset:2048 nt lds
  v_add_u32 v248, v248, v247
  v_cmp_le_i32 s[92:93], v248, v251
  s_nop 0
  s_bcnt1_i32_b64 s60, s[92:93]
  s_cmp_ge_u32 s60, 33
  s_cselect_b64 vcc, -1, 0
  s_waitcnt lgkmcnt(0)
  v_mfma_f32_32x32x16_bf16 v[128:143], v[160:163], v[48:51], v[128:143]
  v_mfma_f32_32x32x16_bf16 v[128:143], v[164:167], v[52:55], v[128:143]
  v_mfma_f32_32x32x16_bf16 v[128:143], v[168:171], v[56:59], v[128:143]
  v_mfma_f32_32x32x16_bf16 v[128:143], v[172:175], v[60:63], v[128:143]
  s_add_u32 m0, s53, 9088
  s_cbranch_vccnz 9f
  s_waitcnt vmcnt(5)
9:
  s_waitcnt vmcnt(9)
  buffer_load_dwordx4 v1, s[20:23], s51 offen offset:128 nt lds
  v_mov_b32 v31, v24
  s_nop 6
  v_max3_f32 v26, v128, v129, v130
  v_max3_f32 v27, v131, v132, v133
  v_max3_f32 v28, v134, v135, v136
  v_max3_f32 v29, v137, v138, v139
  v_max3_f32 v30, v140, v141, v142
  v_max3_f32 v26, v26, v27, v28
  v_max3_f32 v29, v29, v30, v143
  v_max_f32 v27, v26, v29
  v_max_f32 v26, v26, v29
  s_nop 1
  v_permlane32_swap_b32 v26, v27
  v_max3_f32 v23, v26, v27, v23
  v_mul_f32 v24, s55, v23
  v_sub_f32 v31, v31, v24
  v_exp_f32 v22, v31
  v_fma_f32 v128, v128, s55, -v24
  v_fma_f32 v129, v129, s55, -v24
  v_fma_f32 v130, v130, s55, -v24
  v_fma_f32 v131, v131, s55, -v24
  ds_write_b32 v231, v22 offset:3712
  s_cbranch_vccnz 9f
  s_waitcnt vmcnt(5)
9:
  s_waitcnt vmcnt(9)
  buffer_load_dwordx4 v2, s[20:23], s51 offen offset:2176 nt lds
  s_xor_b32 s51, s51, 16384
  s_cmp_eq_u32 s96, 1
  s_cbranch_scc0 1f
  v_cmp_lt_i32 s[92:93], 0, v250
  s_nop 0
  s_bcnt1_i32_b32 s60, s92
  v_mov_b32 v250, s60
  s_mov_b64 exec, 1
  buffer_store_dword v250, off, s[40:43], s95 offset:512
  buffer_store_dword v250, off, s[40:43], s95 offset:768
  buffer_store_dword v250, off, s[40:43], s95 offset:1792
  s_mov_b64 exec, -1
1:
  v_fma_f32 v132, v132, s55, -v24
  v_fma_f32 v133, v133, s55, -v24
  v_exp_f32 v128, v128
  v_fma_f32 v134, v134, s55, -v24
  v_fma_f32 v135, v135, s55, -v24
  v_exp_f32 v129, v129
  v_fma_f32 v136, v136, s55, -v24
  v_fma_f32 v137, v137, s55, -v24
  v_exp_f32 v130, v130
  v_fma_f32 v138, v138, s55, -v24
  v_fma_f32 v139, v139, s55, -v24
  v_exp_f32 v131, v131
  v_fma_f32 v140, v140, s55, -v24
  v_fma_f32 v141, v141, s55, -v24
  v_exp_f32 v132, v132
  v_fma_f32 v142, v142, s55, -v24
  v_fma_f32 v143, v143, s55, -v24
  v_exp_f32 v133, v133
  s_add_u32 m0, s53, 12288
  s_cbranch_vccnz 9f
  s_waitcnt vmcnt(5)
9:
  s_waitcnt vmcnt(8)
  buffer_load_dwordx4 v1, s[20:23], s51 offen nt lds
  s_barrier
  v_exp_f32 v134, v134
  v_exp_f32 v135, v135
  v_exp_f32 v136, v136
  v_exp_f32 v137, v137
  v_exp_f32 v138, v138
  v_exp_f32 v139, v139
  v_cvt_pk_bf16_f32 v176, v128, v129
  v_exp_f32 v140, v140
  v_cvt_pk_bf16_f32 v177, v130, v131
  v_exp_f32 v141, v141
  v_cvt_pk_bf16_f32 v178, v132, v133
  v_exp_f32 v142, v142
  v_cvt_pk_bf16_f32 v179, v134, v135
  v_exp_f32 v143, v143
  v_cvt_pk_bf16_f32 v180, v136, v137
  s_cbranch_vccnz 9f
  s_waitcnt vmcnt(4)
9:
  s_waitcnt vmcnt(8)
  buffer_load_dwordx4 v2, s[20:23], s51 offen offset:2048 nt lds
  v_fma_f32 v26, v25, v22, v128
  v_add_f32 v27, v130, v131
  v_add_f32 v28, v132, v133
  v_add_f32 v29, v134, v135
  v_add_f32 v26, v26, v129
  v_cvt_pk_bf16_f32 v181, v138, v139
  v_cvt_pk_bf16_f32 v182, v140, v141
  v_cvt_pk_bf16_f32 v183, v142, v143
  v_add_f32 v26, v26, v136
  v_accvgpr_write_b32 a232, v176
  v_add_f32 v27, v27, v137
  v_accvgpr_write_b32 a233, v177
  v_add_f32 v28, v28, v138
  v_accvgpr_write_b32 a234, v178
  v_add_f32 v29, v29, v139
  v_accvgpr_write_b32 a235, v179
  v_add_f32 v26, v26, v140
  v_accvgpr_write_b32 a236, v180
  v_add_f32 v27, v27, v141
  v_accvgpr_write_b32 a237, v181
  v_add_f32 v28, v28, v142
  v_accvgpr_write_b32 a238, v182
  v_add_f32 v29, v29, v143
  v_accvgpr_write_b32 a239, v183
  v_add_f32 v26, v26, v27
  v_add_f32 v28, v28, v29
  v_add_f32 v25, v26, v28
  s_add_u32 m0, s53, 13184
  s_cbranch_vccnz 9f
  s_waitcnt vmcnt(4)
9:
  s_waitcnt vmcnt(8)
  buffer_load_dwordx4 v1, s[20:23], s51 offen offset:128 nt lds
  s_cbranch_vccnz 9f
  s_waitcnt vmcnt(4)
9:
  s_waitcnt vmcnt(8)
  buffer_load_dwordx4 v2, s[20:23], s51 offen offset:2176 nt lds
  ds_read_b128 v[144:147], v6
  ds_read_b128 v[148:151], v7
  ds_read_b128 v[152:155], v8
  ds_read_b128 v[156:159], v9
  ds_read_b128 v[160:163], v6 offset:1024
  ds_read_b128 v[164:167], v7 offset:1024
  ds_read_b128 v[168:171], v8 offset:1024
  ds_read_b128 v[172:175], v9 offset:1024
  s_add_u32 m0, s53, 16384
  s_cbranch_vccnz 9f
  s_waitcnt vmcnt(4)
9:
  s_waitcnt vmcnt(7)
  buffer_load_dwordx4 v5, s[24:27], s52 offen nt lds
  s_add_u32 s91, s91, 1
  s_and_b32 s60, s91, 3
  s_cmp_eq_u32 s60, s3
  s_cbranch_scc0 1f
  v_mov_b32 v252, s91
  s_mov_b64 exec, 1
  buffer_store_dword v252, off, s[40:43], s94 offset:1280
  s_mov_b64 exec, -1
1:
  s_barrier
  buffer_load_dword v246, v254, s[40:43], s95 offen offset:1280 sc1
  s_addk_i32 s97, 512
  s_add_u32 s96, s96, 30
  s_and_b32 s96, s96, 0x11f
  s_cmp_eq_u32 s96, 0
  s_cbranch_scc0 1f
  s_add_u32 s60, s97, s95
  s_mov_b32 exec_hi, 0
  buffer_store_dword v253, v254, s[40:43], s60 offen sc1
  s_mov_b32 exec_hi, -1
1:
  s_waitcnt lgkmcnt(4)
  v_mfma_f32_32x32x16_bf16 v[128:143], v[144:147], v[32:35], 0
  v_mfma_f32_32x32x16_bf16 v[128:143], v[148:151], v[36:39], v[128:143]
  v_mfma_f32_32x32x16_bf16 v[128:143], v[152:155], v[40:43], v[128:143]
  v_mfma_f32_32x32x16_bf16 v[128:143], v[156:159], v[44:47], v[128:143]
  s_cbranch_vccnz 9f
  s_waitcnt vmcnt(5)
9:
  s_waitcnt vmcnt(8)
  buffer_load_dwordx4 v5, s[24:27], s52 offen offset:2048 nt lds
  s_waitcnt lgkmcnt(0)
  v_mfma_f32_32x32x16_bf16 v[128:143], v[160:163], v[48:51], v[128:143]
  v_mfma_f32_32x32x16_bf16 v[128:143], v[164:167], v[52:55], v[128:143]
  v_mfma_f32_32x32x16_bf16 v[128:143], v[168:171], v[56:59], v[128:143]
  v_mfma_f32_32x32x16_bf16 v[128:143], v[172:175], v[60:63], v[128:143]
  s_add_u32 m0, s53, 17280
  s_cbranch_vccnz 9f
  s_waitcnt vmcnt(5)
9:
  s_waitcnt vmcnt(8)
  buffer_load_dwordx4 v5, s[24:27], s52 offen offset:128 nt lds
  s_cmp_eq_u32 s96, 1
  s_cbranch_scc0 1f
  buffer_load_dword v250, v249, s[40:43], s97 offen sc1
1:
  v_mov_b32 v31, v24
  s_nop 4
  v_max3_f32 v26, v128, v129, v130
  v_max3_f32 v27, v131, v132, v133
  v_max3_f32 v28, v134, v135, v136
  v_max3_f32 v29, v137, v138, v139
  v_max3_f32 v30, v140, v141, v142
  v_max3_f32 v26, v26, v27, v28
  v_max3_f32 v29, v29, v30, v143
  v_max_f32 v27, v26, v29
  v_max_f32 v26, v26, v29
  s_nop 1
  v_permlane32_swap_b32 v26, v27
  v_max3_f32 v23, v26, v27, v23
  v_mul_f32 v24, s55, v23
  v_sub_f32 v31, v31, v24
  v_exp_f32 v22, v31
  v_fma_f32 v128, v128, s55, -v24
  v_fma_f32 v129, v129, s55, -v24
  v_fma_f32 v130, v130, s55, -v24
  v_fma_f32 v131, v131, s55, -v24
  ds_write_b32 v231, v22 offset:3840
  s_cbranch_vccnz 9f
  s_waitcnt vmcnt(5)
9:
  s_waitcnt vmcnt(8)
  buffer_load_dwordx4 v5, s[24:27], s52 offen offset:2176 nt lds
  s_xor_b32 s52, s52, 16384
  v_fma_f32 v132, v132, s55, -v24
  v_fma_f32 v133, v133, s55, -v24
  v_exp_f32 v128, v128
  v_fma_f32 v134, v134, s55, -v24
  v_fma_f32 v135, v135, s55, -v24
  v_exp_f32 v129, v129
  v_fma_f32 v136, v136, s55, -v24
  v_fma_f32 v137, v137, s55, -v24
  v_exp_f32 v130, v130
  v_fma_f32 v138, v138, s55, -v24
  v_fma_f32 v139, v139, s55, -v24
  v_exp_f32 v131, v131
  v_fma_f32 v140, v140, s55, -v24
  v_fma_f32 v141, v141, s55, -v24
  v_exp_f32 v132, v132
  v_fma_f32 v142, v142, s55, -v24
  v_fma_f32 v143, v143, s55, -v24
  v_exp_f32 v133, v133
  s_add_u32 m0, s53, 20480
  s_cbranch_vccnz 9f
  s_waitcnt vmcnt(5)
9:
  s_waitcnt vmcnt(8)
  buffer_load_dwordx4 v5, s[24:27], s52 offen nt lds
  s_barrier
  v_exp_f32 v134, v134
  v_exp_f32 v135, v135
  v_exp_f32 v136, v136
  v_exp_f32 v137, v137
  v_exp_f32 v138, v138
  v_exp_f32 v139, v139
  v_cvt_pk_bf16_f32 v176, v128, v129
  v_exp_f32 v140, v140
  v_cvt_pk_bf16_f32 v177, v130, v131
  v_exp_f32 v141, v141
  v_cvt_pk_bf16_f32 v178, v132, v133
  v_exp_f32 v142, v142
  v_cvt_pk_bf16_f32 v179, v134, v135
  v_exp_f32 v143, v143
  v_cvt_pk_bf16_f32 v180, v136, v137
  s_cbranch_vccnz 9f
  s_waitcnt vmcnt(5)
9:
  s_waitcnt vmcnt(8)
  buffer_load_dwordx4 v5, s[24:27], s52 offen offset:2048 nt lds
  v_fma_f32 v26, v25, v22, v128
  v_add_f32 v27, v130, v131
  v_add_f32 v28, v132, v133
  v_add_f32 v29, v134, v135
  v_add_f32 v26, v26, v129
  v_cvt_pk_bf16_f32 v181, v138, v139
  v_cvt_pk_bf16_f32 v182, v140, v141
  v_cvt_pk_bf16_f32 v183, v142, v143
  v_add_f32 v26, v26, v136
  v_accvgpr_write_b32 a240, v176
  v_add_f32 v27, v27, v137
  v_accvgpr_write_b32 a241, v177
  v_add_f32 v28, v28, v138
  v_accvgpr_write_b32 a242, v178
  v_add_f32 v29, v29, v139
  v_accvgpr_write_b32 a243, v179
  v_add_f32 v26, v26, v140
  v_accvgpr_write_b32 a244, v180
  v_add_f32 v27, v27, v141
  v_accvgpr_write_b32 a245, v181
  v_add_f32 v28, v28, v142
  v_accvgpr_write_b32 a246, v182
  v_add_f32 v29, v29, v143
  v_accvgpr_write_b32 a247, v183
  v_add_f32 v26, v26, v27
  v_add_f32 v28, v28, v29
  v_add_f32 v25, v26, v28
  s_add_u32 m0, s53, 21376
  s_cbranch_vccnz 9f
  s_waitcnt vmcnt(4)
9:
  s_waitcnt vmcnt(8)
  buffer_load_dwordx4 v5, s[24:27], s52 offen offset:128 nt lds
  s_cbranch_vccnz 9f
  s_waitcnt vmcnt(4)
9:
  s_waitcnt vmcnt(8)
  buffer_load_dwordx4 v5, s[24:27], s52 offen offset:2176 nt lds
  s_xor_b32 s52, s52, 0x14000
  ds_read_b128 v[144:147], v6 offset:8192
  ds_read_b128 v[148:151], v7 offset:8192
  ds_read_b128 v[152:155], v8 offset:8192
  ds_read_b128 v[156:159], v9 offset:8192
  ds_read_b128 v[160:163], v6 offset:9216
  ds_read_b128 v[164:167], v7 offset:9216
  ds_read_b128 v[168:171], v8 offset:9216
  ds_read_b128 v[172:175], v9 offset:9216
  s_mov_b32 m0, s53
  s_cbranch_vccnz 9f
  s_waitcnt vmcnt(4)
9:
  s_waitcnt vmcnt(8)
  buffer_load_dwordx4 v5, s[24:27], s52 offen nt lds
  s_barrier
  s_waitcnt lgkmcnt(4)
  v_mfma_f32_32x32x16_bf16 v[128:143], v[144:147], v[32:35], 0
  v_mfma_f32_32x32x16_bf16 v[128:143], v[148:151], v[36:39], v[128:143]
  v_mfma_f32_32x32x16_bf16 v[128:143], v[152:155], v[40:43], v[128:143]
  v_mfma_f32_32x32x16_bf16 v[128:143], v[156:159], v[44:47], v[128:143]
  s_cbranch_vccnz 9f
  s_waitcnt vmcnt(4)
9:
  s_waitcnt vmcnt(7)
  buffer_load_dwordx4 v5, s[24:27], s52 offen offset:2048 nt lds
  v_add_u32 v248, v248, v247
  v_cmp_le_i32 s[92:93], v248, v246
  s_nop 0
  s_bcnt1_i32_b64 s60, s[92:93]
  s_cmp_ge_u32 s60, 33
  s_cselect_b64 vcc, -1, 0
  s_waitcnt lgkmcnt(0)
  v_mfma_f32_32x32x16_bf16 v[128:143], v[160:163], v[48:51], v[128:143]
  v_mfma_f32_32x32x16_bf16 v[128:143], v[164:167], v[52:55], v[128:143]
  v_mfma_f32_32x32x16_bf16 v[128:143], v[168:171], v[56:59], v[128:143]
  v_mfma_f32_32x32x16_bf16 v[128:143], v[172:175], v[60:63], v[128:143]
  s_add_u32 m0, s53, 896
  s_cbranch_vccnz 9f
  s_waitcnt vmcnt(4)
9:
  s_waitcnt vmcnt(7)
  buffer_load_dwordx4 v5, s[24:27], s52 offen offset:128 nt lds
  v_mov_b32 v31, v24
  s_nop 6
  v_max3_f32 v26, v128, v129, v130
  v_max3_f32 v27, v131, v132, v133
  v_max3_f32 v28, v134, v135, v136
  v_max3_f32 v29, v137, v138, v139
  v_max3_f32 v30, v140, v141, v142
  v_max3_f32 v26, v26, v27, v28
  v_max3_f32 v29, v29, v30, v143
  v_max_f32 v27, v26, v29
  v_max_f32 v26, v26, v29
  s_nop 1
  v_permlane32_swap_b32 v26, v27
  v_max3_f32 v23, v26, v27, v23
  v_mul_f32 v24, s55, v23
  v_sub_f32 v31, v31, v24
  v_exp_f32 v224, v31
  v_fma_f32 v128, v128, s55, -v24
  v_fma_f32 v129, v129, s55, -v24
  v_fma_f32 v130, v130, s55, -v24
  v_fma_f32 v131, v131, s55, -v24
  s_cbranch_vccnz 9f
  s_waitcnt vmcnt(4)
9:
  s_waitcnt vmcnt(7)
  buffer_load_dwordx4 v5, s[24:27], s52 offen offset:2176 nt lds
  s_xor_b32 s52, s52, 16384
  s_cmp_eq_u32 s96, 1
  s_cbranch_scc0 1f
  v_cmp_lt_i32 s[92:93], 0, v250
  s_nop 0
  s_bcnt1_i32_b32 s60, s92
  v_mov_b32 v250, s60
  s_mov_b64 exec, 1
  buffer_store_dword v250, off, s[40:43], s95 offset:512
  buffer_store_dword v250, off, s[40:43], s95 offset:768
  buffer_store_dword v250, off, s[40:43], s95 offset:1792
  s_mov_b64 exec, -1
1:
  v_fma_f32 v132, v132, s55, -v24
  v_fma_f32 v133, v133, s55, -v24
  v_exp_f32 v128, v128
  v_fma_f32 v134, v134, s55, -v24
  v_fma_f32 v135, v135, s55, -v24
  v_exp_f32 v129, v129
  v_fma_f32 v136, v136, s55, -v24
  v_fma_f32 v137, v137, s55, -v24
  v_exp_f32 v130, v130
  v_fma_f32 v138, v138, s55, -v24
  v_fma_f32 v139, v139, s55, -v24
  v_exp_f32 v131, v131
  v_fma_f32 v140, v140, s55, -v24
  v_fma_f32 v141, v141, s55, -v24
  v_exp_f32 v132, v132
  v_fma_f32 v142, v142, s55, -v24
  v_fma_f32 v143, v143, s55, -v24
  v_exp_f32 v133, v133
  s_add_u32 m0, s53, 4096
  s_cbranch_vccnz 9f
  s_waitcnt vmcnt(4)
9:
  s_waitcnt vmcnt(7)
  buffer_load_dwordx4 v5, s[24:27], s52 offen nt lds
  s_barrier
  v_exp_f32 v134, v134
  v_exp_f32 v135, v135
  v_exp_f32 v136, v136
  v_exp_f32 v137, v137
  v_exp_f32 v138, v138
  v_exp_f32 v139, v139
  v_exp_f32 v140, v140
  v_exp_f32 v141, v141
  v_exp_f32 v142, v142
  v_exp_f32 v143, v143
  s_cbranch_vccnz 9f
  s_waitcnt vmcnt(4)
9:
  s_waitcnt vmcnt(7)
  buffer_load_dwordx4 v5, s[24:27], s52 offen offset:2048 nt lds
  v_fma_f32 v26, v25, v224, v128
  v_add_f32 v27, v130, v131
  v_add_f32 v28, v132, v133
  v_add_f32 v29, v134, v135
  v_add_f32 v26, v26, v129
  v_add_f32 v26, v26, v136
  v_add_f32 v27, v27, v137
  v_add_f32 v28, v28, v138
  v_add_f32 v29, v29, v139
  v_add_f32 v26, v26, v140
  v_add_f32 v27, v27, v141
  v_add_f32 v28, v28, v142
  v_add_f32 v29, v29, v143
  v_add_f32 v26, v26, v27
  v_add_f32 v28, v28, v29
  v_add_f32 v25, v26, v28
  s_add_u32 m0, s53, 4992
  s_cbranch_vccnz 9f
  s_waitcnt vmcnt(4)
9:
  s_waitcnt vmcnt(7)
  buffer_load_dwordx4 v5, s[24:27], s52 offen offset:128 nt lds
  ds_read_b64_tr_b16 v[32:33], v20
  ds_read_b64_tr_b16 v[36:37], v20 offset:32
  ds_read_b64_tr_b16 v[40:41], v243
  ds_read_b64_tr_b16 v[44:45], v243 offset:32
  ds_read_b64_tr_b16 v[48:49], v244
  ds_read_b64_tr_b16 v[52:53], v244 offset:32
  ds_read_b64_tr_b16 v[56:57], v245
  ds_read_b64_tr_b16 v[60:61], v245 offset:32
  v_mov_b32 v26, v25
  s_lshl_b32 s60, s3, 3
  s_add_u32 s60, s60, 137216
  v_permlane32_swap_b32 v25, v26
  v_lshl_add_u32 v27, v230, 3, s60
  v_add_f32 v25, v25, v26
  ds_write_b64 v27, v[24:25]
  v_xor_b32 v28, 8, v27
  v_xor_b32 v29, 16, v27
  v_xor_b32 v30, 24, v27
  s_waitcnt lgkmcnt(0)
  s_barrier
  ds_read_b64 v[146:147], v28
  ds_read_b64 v[148:149], v29
  ds_read_b64 v[150:151], v30
  v_lshl_add_u32 v26, s3, 6, v0
  v_cmp_gt_u32 s[92:93], 32, v26
  v_mov_b32 v27, 0x40000000
  s_xor_b32 s60, s65, 512
  v_cndmask_b32 v26, v27, v230, s[92:93]
  s_waitcnt lgkmcnt(0)
  v_max3_f32 v152, v146, v148, v150
  v_max_f32 v152, v152, v24
  v_sub_f32 v154, v24, v152
  v_sub_f32 v155, v146, v152
  v_sub_f32 v156, v148, v152
  v_sub_f32 v157, v150, v152
  v_exp_f32 v154, v154
  v_exp_f32 v155, v155
  v_exp_f32 v156, v156
  v_exp_f32 v157, v157
  v_mul_f32 v153, v25, v154
  v_fmac_f32 v153, v147, v155
  v_fmac_f32 v153, v149, v156
  v_fmac_f32 v153, v151, v157
  v_log_f32 v226, v153
  v_rcp_f32 v153, v153
  v_add_f32 v226, v226, v152
  v_mul_f32 v225, v154, v153
  v_min_u32 v226, 0xfffffffe, v226
  buffer_store_dword v226, v26, s[40:43], s60 offen sc1
  s_cbranch_vccnz 9f
  s_waitcnt vmcnt(5)
9:
  s_waitcnt vmcnt(8)
  buffer_load_dwordx4 v5, s[24:27], s52 offen offset:2176 nt lds
  s_xor_b32 s52, s52, 0x54000
  s_lshl_b32 s62, s3, 1
  s_xor_b32 s62, s62, 4
  s_mul_i32 s62, s62, 18432
  s_add_u32 s62, s62, s66
  s_add_u32 m0, s53, 24576
  s_nop 0
  buffer_load_dwordx4 v18, s[36:39], s62 offen lds
  s_addk_i32 s62, 4608
  ds_read_b32 v22, v231 offset:128
  ds_read_b64_tr_b16 v[148:149], v15 offset:16384
  ds_read_b64_tr_b16 v[150:151], v15 offset:18432
  ds_read_b64_tr_b16 v[152:153], v16 offset:16384
  ds_read_b64_tr_b16 v[154:155], v16 offset:18432
  ds_read_b64_tr_b16 v[156:157], v17 offset:16384
  ds_read_b64_tr_b16 v[158:159], v17 offset:18432
  ds_read_b64_tr_b16 v[144:145], v14 offset:16384
  ds_read_b64_tr_b16 v[146:147], v14 offset:18432
  s_add_u32 m0, s53, 8192
  s_cbranch_vccnz 9f
  s_waitcnt vmcnt(6)
9:
  s_waitcnt vmcnt(9)
  buffer_load_dwordx4 v5, s[24:27], s52 offen nt lds
  s_add_u32 s91, s91, 1
  s_and_b32 s60, s91, 3
  s_cmp_eq_u32 s60, s3
  s_cbranch_scc0 1f
  v_mov_b32 v252, s91
  s_mov_b64 exec, 1
  buffer_store_dword v252, off, s[40:43], s94
  s_mov_b64 exec, -1
1:
  s_barrier
  buffer_load_dword v255, v254, s[40:43], s95 offen sc1
  s_addk_i32 s97, 512
  s_add_u32 s96, s96, 30
  s_and_b32 s96, s96, 0x11f
  s_cmp_eq_u32 s96, 0
  s_cbranch_scc0 1f
  s_add_u32 s60, s97, s95
  s_mov_b32 exec_hi, 0
  buffer_store_dword v253, v254, s[40:43], s60 offen sc1
  s_mov_b32 exec_hi, -1
1:
  s_waitcnt lgkmcnt(0)
  v_mfma_f32_32x32x16_bf16 v[80:95], v[148:151], a[0:3], 0
  v_mfma_f32_32x32x16_bf16 v[96:111], v[152:155], a[0:3], 0
  v_mfma_f32_32x32x16_bf16 v[112:127], v[156:159], a[0:3], 0
  v_mfma_f32_32x32x16_bf16 v[64:79], v[144:147], a[0:3], 0
  s_cbranch_vccnz 9f
  s_waitcnt vmcnt(7)
9:
  s_waitcnt vmcnt(10)
  buffer_load_dwordx4 v5, s[24:27], s52 offen offset:2048 nt lds
  ds_read_b64_tr_b16 v[164:165], v15 offset:20480
  ds_read_b64_tr_b16 v[166:167], v15 offset:22528
  ds_read_b64_tr_b16 v[168:169], v16 offset:20480
  ds_read_b64_tr_b16 v[170:171], v16 offset:22528
  ds_read_b64_tr_b16 v[172:173], v17 offset:20480
  ds_read_b64_tr_b16 v[174:175], v17 offset:22528
  ds_read_b64_tr_b16 v[160:161], v14 offset:20480
  ds_read_b64_tr_b16 v[162:163], v14 offset:22528
  s_add_u32 m0, s53, 9088
  s_cbranch_vccnz 9f
  s_waitcnt vmcnt(7)
9:
  s_waitcnt vmcnt(10)
  buffer_load_dwordx4 v5, s[24:27], s52 offen offset:128 nt lds
  s_cmp_eq_u32 s96, 1
  s_cbranch_scc0 1f
  buffer_load_dword v250, v249, s[40:43], s97 offen sc1
1:
  s_waitcnt lgkmcnt(0)
  v_mfma_f32_32x32x16_bf16 v[80:95], v[164:167], a[4:7], v[80:95]
  v_mfma_f32_32x32x16_bf16 v[96:111], v[168:171], a[4:7], v[96:111]
  v_mfma_f32_32x32x16_bf16 v[112:127], v[172:175], a[4:7], v[112:127]
  v_mfma_f32_32x32x16_bf16 v[64:79], v[160:163], a[4:7], v[64:79]
  s_cbranch_vccnz 9f
  s_waitcnt vmcnt(7)
9:
  s_waitcnt vmcnt(10)
  buffer_load_dwordx4 v5, s[24:27], s52 offen offset:2176 nt lds
  s_xor_b32 s52, s52, 16384
  s_add_u32 m0, s53, 25600
  s_nop 0
  buffer_load_dwordx4 v18, s[36:39], s62 offen lds
  s_addk_i32 s62, 4608
  s_nop 0
  v_pk_mul_f32 v[80:81], v[80:81], v[22:23] op_sel_hi:[1,0]
  v_pk_mul_f32 v[82:83], v[82:83], v[22:23] op_sel_hi:[1,0]
  v_pk_mul_f32 v[84:85], v[84:85], v[22:23] op_sel_hi:[1,0]
  v_pk_mul_f32 v[86:87], v[86:87], v[22:23] op_sel_hi:[1,0]
  v_pk_mul_f32 v[88:89], v[88:89], v[22:23] op_sel_hi:[1,0]
  v_pk_mul_f32 v[90:91], v[90:91], v[22:23] op_sel_hi:[1,0]
  v_pk_mul_f32 v[92:93], v[92:93], v[22:23] op_sel_hi:[1,0]
  v_pk_mul_f32 v[94:95], v[94:95], v[22:23] op_sel_hi:[1,0]
  v_pk_mul_f32 v[96:97], v[96:97], v[22:23] op_sel_hi:[1,0]
  v_pk_mul_f32 v[98:99], v[98:99], v[22:23] op_sel_hi:[1,0]
  v_pk_mul_f32 v[100:101], v[100:101], v[22:23] op_sel_hi:[1,0]
  v_pk_mul_f32 v[102:103], v[102:103], v[22:23] op_sel_hi:[1,0]
  v_pk_mul_f32 v[104:105], v[104:105], v[22:23] op_sel_hi:[1,0]
  v_pk_mul_f32 v[106:107], v[106:107], v[22:23] op_sel_hi:[1,0]
  v_pk_mul_f32 v[108:109], v[108:109], v[22:23] op_sel_hi:[1,0]
  v_pk_mul_f32 v[110:111], v[110:111], v[22:23] op_sel_hi:[1,0]
  s_add_u32 m0, s53, 12288
  s_cbranch_vccnz 9f
  s_waitcnt vmcnt(7)
9:
  s_waitcnt vmcnt(11)
  buffer_load_dwordx4 v5, s[24:27], s52 offen nt lds
  s_barrier
  v_pk_mul_f32 v[112:113], v[112:113], v[22:23] op_sel_hi:[1,0]
  v_pk_mul_f32 v[114:115], v[114:115], v[22:23] op_sel_hi:[1,0]
  v_pk_mul_f32 v[116:117], v[116:117], v[22:23] op_sel_hi:[1,0]
  v_pk_mul_f32 v[118:119], v[118:119], v[22:23] op_sel_hi:[1,0]
  v_pk_mul_f32 v[120:121], v[120:121], v[22:23] op_sel_hi:[1,0]
  v_pk_mul_f32 v[122:123], v[122:123], v[22:23] op_sel_hi:[1,0]
  v_pk_mul_f32 v[124:125], v[124:125], v[22:23] op_sel_hi:[1,0]
  v_pk_mul_f32 v[126:127], v[126:127], v[22:23] op_sel_hi:[1,0]
  v_pk_mul_f32 v[64:65], v[64:65], v[22:23] op_sel_hi:[1,0]
  v_pk_mul_f32 v[66:67], v[66:67], v[22:23] op_sel_hi:[1,0]
  v_pk_mul_f32 v[68:69], v[68:69], v[22:23] op_sel_hi:[1,0]
  v_pk_mul_f32 v[70:71], v[70:71], v[22:23] op_sel_hi:[1,0]
  v_pk_mul_f32 v[72:73], v[72:73], v[22:23] op_sel_hi:[1,0]
  v_pk_mul_f32 v[74:75], v[74:75], v[22:23] op_sel_hi:[1,0]
  v_pk_mul_f32 v[76:77], v[76:77], v[22:23] op_sel_hi:[1,0]
  v_pk_mul_f32 v[78:79], v[78:79], v[22:23] op_sel_hi:[1,0]
  s_cbranch_vccnz 9f
  s_waitcnt vmcnt(6)
9:
  s_waitcnt vmcnt(11)
  buffer_load_dwordx4 v5, s[24:27], s52 offen offset:2048 nt lds
  ds_read_b32 v22, v231 offset:256
  ds_read_b64_tr_b16 v[148:149], v15
  ds_read_b64_tr_b16 v[150:151], v15 offset:2048
  ds_read_b64_tr_b16 v[152:153], v16
  ds_read_b64_tr_b16 v[154:155], v16 offset:2048
  ds_read_b64_tr_b16 v[156:157], v17
  ds_read_b64_tr_b16 v[158:159], v17 offset:2048
  ds_read_b64_tr_b16 v[144:145], v14
  ds_read_b64_tr_b16 v[146:147], v14 offset:2048
  s_add_u32 m0, s53, 13184
  s_cbranch_vccnz 9f
  s_waitcnt vmcnt(5)
9:
  s_waitcnt vmcnt(11)
  buffer_load_dwordx4 v5, s[24:27], s52 offen offset:128 nt lds
  s_waitcnt lgkmcnt(0)
  v_mfma_f32_32x32x16_bf16 v[80:95], v[148:151], a[8:11], v[80:95]
  v_mfma_f32_32x32x16_bf16 v[96:111], v[152:155], a[8:11], v[96:111]
  v_mfma_f32_32x32x16_bf16 v[112:127], v[156:159], a[8:11], v[112:127]
  v_mfma_f32_32x32x16_bf16 v[64:79], v[144:147], a[8:11], v[64:79]
  s_cbranch_vccnz 9f
  s_waitcnt vmcnt(5)
9:
  s_waitcnt vmcnt(10)
  buffer_load_dwordx4 v5, s[24:27], s52 offen offset:2176 nt lds
  s_xor_b32 s52, s52, 0x14000
  s_add_u32 m0, s53, 26624
  s_nop 0
  buffer_load_dwordx4 v18, s[36:39], s62 offen lds
  s_addk_i32 s62, 4608
  ds_read_b64_tr_b16 v[164:165], v15 offset:4096
  ds_read_b64_tr_b16 v[166:167], v15 offset:6144
  ds_read_b64_tr_b16 v[168:169], v16 offset:4096
  ds_read_b64_tr_b16 v[170:171], v16 offset:6144
  ds_read_b64_tr_b16 v[172:173], v17 offset:4096
  ds_read_b64_tr_b16 v[174:175], v17 offset:6144
  ds_read_b64_tr_b16 v[160:161], v14 offset:4096
  ds_read_b64_tr_b16 v[162:163], v14 offset:6144
  s_add_u32 m0, s53, 16384
  s_cbranch_vccnz 9f
  s_waitcnt vmcnt(6)
9:
  s_waitcnt vmcnt(10)
  buffer_load_dwordx4 v5, s[24:27], s52 offen nt lds
  s_barrier
  s_waitcnt lgkmcnt(0)
  v_mfma_f32_32x32x16_bf16 v[80:95], v[164:167], a[12:15], v[80:95]
  v_mfma_f32_32x32x16_bf16 v[96:111], v[168:171], a[12:15], v[96:111]
  v_mfma_f32_32x32x16_bf16 v[112:127], v[172:175], a[12:15], v[112:127]
  v_mfma_f32_32x32x16_bf16 v[64:79], v[160:163], a[12:15], v[64:79]
  s_cbranch_vccnz 9f
  s_waitcnt vmcnt(5)
9:
  s_waitcnt vmcnt(9)
  buffer_load_dwordx4 v5, s[24:27], s52 offen offset:2048 nt lds
  v_add_u32 v248, v248, v247
  v_cmp_le_i32 s[92:93], v248, v255
  s_nop 0
  s_bcnt1_i32_b64 s60, s[92:93]
  s_cmp_ge_u32 s60, 33
  s_cselect_b64 vcc, -1, 0
  v_pk_mul_f32 v[80:81], v[80:81], v[22:23] op_sel_hi:[1,0]
  v_pk_mul_f32 v[82:83], v[82:83], v[22:23] op_sel_hi:[1,0]
  v_pk_mul_f32 v[84:85], v[84:85], v[22:23] op_sel_hi:[1,0]
  v_pk_mul_f32 v[86:87], v[86:87], v[22:23] op_sel_hi:[1,0]
  v_pk_mul_f32 v[88:89], v[88:89], v[22:23] op_sel_hi:[1,0]
  v_pk_mul_f32 v[90:91], v[90:91], v[22:23] op_sel_hi:[1,0]
  v_pk_mul_f32 v[92:93], v[92:93], v[22:23] op_sel_hi:[1,0]
  v_pk_mul_f32 v[94:95], v[94:95], v[22:23] op_sel_hi:[1,0]
  v_pk_mul_f32 v[96:97], v[96:97], v[22:23] op_sel_hi:[1,0]
  v_pk_mul_f32 v[98:99], v[98:99], v[22:23] op_sel_hi:[1,0]
  v_pk_mul_f32 v[100:101], v[100:101], v[22:23] op_sel_hi:[1,0]
  v_pk_mul_f32 v[102:103], v[102:103], v[22:23] op_sel_hi:[1,0]
  v_pk_mul_f32 v[104:105], v[104:105], v[22:23] op_sel_hi:[1,0]
  v_pk_mul_f32 v[106:107], v[106:107], v[22:23] op_sel_hi:[1,0]
  v_pk_mul_f32 v[108:109], v[108:109], v[22:23] op_sel_hi:[1,0]
  v_pk_mul_f32 v[110:111], v[110:111], v[22:23] op_sel_hi:[1,0]
  s_add_u32 m0, s53, 17280
  s_cbranch_vccnz 9f
  s_waitcnt vmcnt(5)
9:
  s_waitcnt vmcnt(9)
  buffer_load_dwordx4 v5, s[24:27], s52 offen offset:128 nt lds
  v_pk_mul_f32 v[112:113], v[112:113], v[22:23] op_sel_hi:[1,0]
  v_pk_mul_f32 v[114:115], v[114:115], v[22:23] op_sel_hi:[1,0]
  v_pk_mul_f32 v[116:117], v[116:117], v[22:23] op_sel_hi:[1,0]
  v_pk_mul_f32 v[118:119], v[118:119], v[22:23] op_sel_hi:[1,0]
  v_pk_mul_f32 v[120:121], v[120:121], v[22:23] op_sel_hi:[1,0]
  v_pk_mul_f32 v[122:123], v[122:123], v[22:23] op_sel_hi:[1,0]
  v_pk_mul_f32 v[124:125], v[124:125], v[22:23] op_sel_hi:[1,0]
  v_pk_mul_f32 v[126:127], v[126:127], v[22:23] op_sel_hi:[1,0]
  v_pk_mul_f32 v[64:65], v[64:65], v[22:23] op_sel_hi:[1,0]
  v_pk_mul_f32 v[66:67], v[66:67], v[22:23] op_sel_hi:[1,0]
  v_pk_mul_f32 v[68:69], v[68:69], v[22:23] op_sel_hi:[1,0]
  v_pk_mul_f32 v[70:71], v[70:71], v[22:23] op_sel_hi:[1,0]
  v_pk_mul_f32 v[72:73], v[72:73], v[22:23] op_sel_hi:[1,0]
  v_pk_mul_f32 v[74:75], v[74:75], v[22:23] op_sel_hi:[1,0]
  v_pk_mul_f32 v[76:77], v[76:77], v[22:23] op_sel_hi:[1,0]
  v_pk_mul_f32 v[78:79], v[78:79], v[22:23] op_sel_hi:[1,0]
  s_cbranch_vccnz 9f
  s_waitcnt vmcnt(5)
9:
  s_waitcnt vmcnt(9)
  buffer_load_dwordx4 v5, s[24:27], s52 offen offset:2176 nt lds
  s_xor_b32 s52, s52, 16384
  s_cmp_eq_u32 s96, 1
  s_cbranch_scc0 1f
  v_cmp_lt_i32 s[92:93], 0, v250
  s_nop 0
  s_bcnt1_i32_b32 s60, s92
  v_mov_b32 v250, s60
  s_mov_b64 exec, 1
  buffer_store_dword v250, off, s[40:43], s95 offset:512
  buffer_store_dword v250, off, s[40:43], s95 offset:768
  buffer_store_dword v250, off, s[40:43], s95 offset:1792
  s_mov_b64 exec, -1
1:
  ds_read_b64_tr_b16 v[34:35], v20 offset:4096
  ds_read_b64_tr_b16 v[38:39], v20 offset:4128
  ds_read_b64_tr_b16 v[42:43], v243 offset:4096
  ds_read_b64_tr_b16 v[46:47], v243 offset:4128
  ds_read_b64_tr_b16 v[50:51], v244 offset:4096
  ds_read_b64_tr_b16 v[54:55], v244 offset:4128
  ds_read_b64_tr_b16 v[58:59], v245 offset:4096
  ds_read_b64_tr_b16 v[62:63], v245 offset:4128
  s_add_u32 m0, s53, 27648
  s_nop 0
  buffer_load_dwordx4 v18, s[36:39], s62 offen lds
  ds_read_b32 v22, v231 offset:384
  ds_read_b64_tr_b16 v[148:149], v15 offset:8192
  ds_read_b64_tr_b16 v[150:151], v15 offset:10240
  ds_read_b64_tr_b16 v[152:153], v16 offset:8192
  ds_read_b64_tr_b16 v[154:155], v16 offset:10240
  ds_read_b64_tr_b16 v[156:157], v17 offset:8192
  ds_read_b64_tr_b16 v[158:159], v17 offset:10240
  s_waitcnt lgkmcnt(14)
  ds_read_b64_tr_b16 v[144:145], v14 offset:8192
  s_waitcnt lgkmcnt(14)
  ds_read_b64_tr_b16 v[146:147], v14 offset:10240
  s_add_u32 m0, s53, 20480
  s_cbranch_vccnz 9f
  s_waitcnt vmcnt(6)
9:
  s_waitcnt vmcnt(9)
  buffer_load_dwordx4 v5, s[24:27], s52 offen nt lds
  s_barrier
  s_waitcnt lgkmcnt(9)
  s_lshl_b32 s98, s3, 1
  s_xor_b32 s98, s98, 5
  s_mul_i32 s98, s98, 18432
  s_add_u32 s98, s98, s66
  s_add_u32 m0, s53, 28672
  s_nop 0
  buffer_load_dwordx4 v18, s[36:39], s98 offen lds
  s_addk_i32 s98, 4608
  s_waitcnt lgkmcnt(0)
  v_mfma_f32_32x32x16_bf16 v[80:95], v[148:151], a[16:19], v[80:95]
  v_mfma_f32_32x32x16_bf16 v[96:111], v[152:155], a[16:19], v[96:111]
  v_mfma_f32_32x32x16_bf16 v[112:127], v[156:159], a[16:19], v[112:127]
  v_mfma_f32_32x32x16_bf16 v[64:79], v[144:147], a[16:19], v[64:79]
  s_add_u32 m0, s53, 20480
  s_cbranch_vccnz 9f
  s_waitcnt vmcnt(6)
9:
  s_waitcnt vmcnt(10)
  buffer_load_dwordx4 v5, s[24:27], s52 offen offset:2048 nt lds
  s_add_u32 m0, s53, 21376
  s_cbranch_vccnz 9f
  s_waitcnt vmcnt(6)
9:
  s_waitcnt vmcnt(10)
  buffer_load_dwordx4 v5, s[24:27], s52 offen offset:128 nt lds
  s_cbranch_vccnz 9f
  s_waitcnt vmcnt(6)
9:
  s_waitcnt vmcnt(10)
  buffer_load_dwordx4 v5, s[24:27], s52 offen offset:2176 nt lds
  s_xor_b32 s52, s52, 0xd4000
  ds_read_b64_tr_b16 v[164:165], v15 offset:12288
  ds_read_b64_tr_b16 v[166:167], v15 offset:14336
  ds_read_b64_tr_b16 v[168:169], v16 offset:12288
  ds_read_b64_tr_b16 v[170:171], v16 offset:14336
  ds_read_b64_tr_b16 v[172:173], v17 offset:12288
  ds_read_b64_tr_b16 v[174:175], v17 offset:14336
  ds_read_b64_tr_b16 v[160:161], v14 offset:12288
  ds_read_b64_tr_b16 v[162:163], v14 offset:14336
  s_mov_b32 m0, s53
  s_cbranch_vccnz 9f
  s_waitcnt vmcnt(6)
9:
  s_waitcnt vmcnt(9)
  buffer_load_dwordx4 v5, s[24:27], s52 offen nt lds
  s_add_u32 s91, s91, 1
  s_and_b32 s60, s91, 3
  s_cmp_eq_u32 s60, s3
  s_cbranch_scc0 1f
  v_mov_b32 v252, s91
  s_mov_b64 exec, 1
  buffer_store_dword v252, off, s[40:43], s94 offset:256
  s_mov_b64 exec, -1
1:
  s_barrier
  buffer_load_dword v251, v254, s[40:43], s95 offen offset:256 sc1
  s_addk_i32 s97, 512
  s_add_u32 s96, s96, 30
  s_and_b32 s96, s96, 0x11f
  s_cmp_eq_u32 s96, 0
  s_cbranch_scc0 1f
  s_add_u32 s60, s97, s95
  s_mov_b32 exec_hi, 0
  buffer_store_dword v253, v254, s[40:43], s60 offen sc1
  s_mov_b32 exec_hi, -1
1:
  s_add_u32 m0, s53, 29696
  s_nop 0
  buffer_load_dwordx4 v18, s[36:39], s98 offen lds
  s_addk_i32 s98, 4608
  s_waitcnt lgkmcnt(0)
  v_mfma_f32_32x32x16_bf16 v[80:95], v[164:167], a[20:23], v[80:95]
  v_mfma_f32_32x32x16_bf16 v[96:111], v[168:171], a[20:23], v[96:111]
  v_mfma_f32_32x32x16_bf16 v[112:127], v[172:175], a[20:23], v[112:127]
  v_mfma_f32_32x32x16_bf16 v[64:79], v[160:163], a[20:23], v[64:79]
  s_mov_b32 m0, s53
  s_cbranch_vccnz 9f
  s_waitcnt vmcnt(7)
9:
  s_waitcnt vmcnt(11)
  buffer_load_dwordx4 v5, s[24:27], s52 offen offset:2048 nt lds
  s_nop 4
  v_pk_mul_f32 v[80:81], v[80:81], v[22:23] op_sel_hi:[1,0]
  v_pk_mul_f32 v[82:83], v[82:83], v[22:23] op_sel_hi:[1,0]
  v_pk_mul_f32 v[84:85], v[84:85], v[22:23] op_sel_hi:[1,0]
  v_pk_mul_f32 v[86:87], v[86:87], v[22:23] op_sel_hi:[1,0]
  v_pk_mul_f32 v[88:89], v[88:89], v[22:23] op_sel_hi:[1,0]
  v_pk_mul_f32 v[90:91], v[90:91], v[22:23] op_sel_hi:[1,0]
  v_pk_mul_f32 v[92:93], v[92:93], v[22:23] op_sel_hi:[1,0]
  v_pk_mul_f32 v[94:95], v[94:95], v[22:23] op_sel_hi:[1,0]
  v_pk_mul_f32 v[96:97], v[96:97], v[22:23] op_sel_hi:[1,0]
  v_pk_mul_f32 v[98:99], v[98:99], v[22:23] op_sel_hi:[1,0]
  v_pk_mul_f32 v[100:101], v[100:101], v[22:23] op_sel_hi:[1,0]
  v_pk_mul_f32 v[102:103], v[102:103], v[22:23] op_sel_hi:[1,0]
  v_pk_mul_f32 v[104:105], v[104:105], v[22:23] op_sel_hi:[1,0]
  v_pk_mul_f32 v[106:107], v[106:107], v[22:23] op_sel_hi:[1,0]
  v_pk_mul_f32 v[108:109], v[108:109], v[22:23] op_sel_hi:[1,0]
  v_pk_mul_f32 v[110:111], v[110:111], v[22:23] op_sel_hi:[1,0]
  s_add_u32 m0, s53, 896
  s_cbranch_vccnz 9f
  s_waitcnt vmcnt(6)
9:
  s_waitcnt vmcnt(11)
  buffer_load_dwordx4 v5, s[24:27], s52 offen offset:128 nt lds
  s_cmp_eq_u32 s96, 1
  s_cbranch_scc0 1f
  buffer_load_dword v250, v249, s[40:43], s97 offen sc1
1:
  v_pk_mul_f32 v[112:113], v[112:113], v[22:23] op_sel_hi:[1,0]
  v_pk_mul_f32 v[114:115], v[114:115], v[22:23] op_sel_hi:[1,0]
  v_pk_mul_f32 v[116:117], v[116:117], v[22:23] op_sel_hi:[1,0]
  v_pk_mul_f32 v[118:119], v[118:119], v[22:23] op_sel_hi:[1,0]
  v_pk_mul_f32 v[120:121], v[120:121], v[22:23] op_sel_hi:[1,0]
  v_pk_mul_f32 v[122:123], v[122:123], v[22:23] op_sel_hi:[1,0]
  v_pk_mul_f32 v[124:125], v[124:125], v[22:23] op_sel_hi:[1,0]
  v_pk_mul_f32 v[126:127], v[126:127], v[22:23] op_sel_hi:[1,0]
  v_pk_mul_f32 v[64:65], v[64:65], v[22:23] op_sel_hi:[1,0]
  v_pk_mul_f32 v[66:67], v[66:67], v[22:23] op_sel_hi:[1,0]
  v_pk_mul_f32 v[68:69], v[68:69], v[22:23] op_sel_hi:[1,0]
  v_pk_mul_f32 v[70:71], v[70:71], v[22:23] op_sel_hi:[1,0]
  v_pk_mul_f32 v[72:73], v[72:73], v[22:23] op_sel_hi:[1,0]
  v_pk_mul_f32 v[74:75], v[74:75], v[22:23] op_sel_hi:[1,0]
  v_pk_mul_f32 v[76:77], v[76:77], v[22:23] op_sel_hi:[1,0]
  v_pk_mul_f32 v[78:79], v[78:79], v[22:23] op_sel_hi:[1,0]
  s_cbranch_vccnz 9f
  s_waitcnt vmcnt(6)
9:
  s_waitcnt vmcnt(11)
  buffer_load_dwordx4 v5, s[24:27], s52 offen offset:2176 nt lds
  s_xor_b32 s52, s52, 16384
  ds_read_b32 v22, v231 offset:512
  ds_read_b64_tr_b16 v[148:149], v15 offset:16384
  ds_read_b64_tr_b16 v[150:151], v15 offset:18432
  ds_read_b64_tr_b16 v[152:153], v16 offset:16384
  ds_read_b64_tr_b16 v[154:155], v16 offset:18432
  ds_read_b64_tr_b16 v[156:157], v17 offset:16384
  ds_read_b64_tr_b16 v[158:159], v17 offset:18432
  ds_read_b64_tr_b16 v[144:145], v14 offset:16384
  ds_read_b64_tr_b16 v[146:147], v14 offset:18432
  s_add_u32 m0, s53, 4096
  s_cbranch_vccnz 9f
  s_waitcnt vmcnt(6)
9:
  s_waitcnt vmcnt(10)
  buffer_load_dwordx4 v5, s[24:27], s52 offen nt lds
  s_barrier
  s_add_u32 m0, s53, 30720
  s_nop 0
  buffer_load_dwordx4 v18, s[36:39], s98 offen lds
  s_addk_i32 s98, 4608
  s_waitcnt lgkmcnt(0)
  v_mfma_f32_32x32x16_bf16 v[80:95], v[148:151], a[24:27], v[80:95]
  v_mfma_f32_32x32x16_bf16 v[96:111], v[152:155], a[24:27], v[96:111]
  v_mfma_f32_32x32x16_bf16 v[112:127], v[156:159], a[24:27], v[112:127]
  v_mfma_f32_32x32x16_bf16 v[64:79], v[144:147], a[24:27], v[64:79]
  s_add_u32 m0, s53, 4096
  s_cbranch_vccnz 9f
  s_waitcnt vmcnt(7)
9:
  s_waitcnt vmcnt(10)
  buffer_load_dwordx4 v5, s[24:27], s52 offen offset:2048 nt lds
  buffer_load_dword v227, v230, s[40:43], s65 offen sc1
  s_add_u32 m0, s53, 4992
  s_cbranch_vccnz 9f
  s_waitcnt vmcnt(6)
9:
  s_waitcnt vmcnt(11)
  buffer_load_dwordx4 v5, s[24:27], s52 offen offset:128 nt lds
  s_cbranch_vccnz 9f
  s_waitcnt vmcnt(6)
9:
  s_waitcnt vmcnt(11)
  buffer_load_dwordx4 v5, s[24:27], s52 offen offset:2176 nt lds
  s_xor_b32 s52, s52, 0x14000
  ds_read_b64_tr_b16 v[164:165], v15 offset:20480
  ds_read_b64_tr_b16 v[166:167], v15 offset:22528
  ds_read_b64_tr_b16 v[168:169], v16 offset:20480
  ds_read_b64_tr_b16 v[170:171], v16 offset:22528
  ds_read_b64_tr_b16 v[172:173], v17 offset:20480
  ds_read_b64_tr_b16 v[174:175], v17 offset:22528
  ds_read_b64_tr_b16 v[160:161], v14 offset:20480
  ds_read_b64_tr_b16 v[162:163], v14 offset:22528
  s_add_u32 m0, s53, 8192
  s_cbranch_vccnz 9f
  s_waitcnt vmcnt(6)
9:
  s_waitcnt vmcnt(11)
  buffer_load_dwordx4 v5, s[24:27], s52 offen nt lds
  s_barrier
  s_add_u32 m0, s53, 31744
  s_nop 0
  buffer_load_dwordx4 v18, s[36:39], s98 offen lds
  s_waitcnt lgkmcnt(0)
  v_mfma_f32_32x32x16_bf16 v[80:95], v[164:167], a[28:31], v[80:95]
  v_mfma_f32_32x32x16_bf16 v[96:111], v[168:171], a[28:31], v[96:111]
  v_mfma_f32_32x32x16_bf16 v[112:127], v[172:175], a[28:31], v[112:127]
  v_mfma_f32_32x32x16_bf16 v[64:79], v[160:163], a[28:31], v[64:79]
  s_add_u32 m0, s53, 8192
  s_cbranch_vccnz 9f
  s_waitcnt vmcnt(7)
9:
  s_waitcnt vmcnt(10)
  buffer_load_dwordx4 v5, s[24:27], s52 offen offset:2048 nt lds
  v_add_u32 v248, v248, v247
  v_cmp_le_i32 s[92:93], v248, v251
  s_nop 0
  s_bcnt1_i32_b64 s60, s[92:93]
  s_cmp_ge_u32 s60, 33
  s_cselect_b64 vcc, -1, 0
  v_pk_mul_f32 v[80:81], v[80:81], v[22:23] op_sel_hi:[1,0]
  v_pk_mul_f32 v[82:83], v[82:83], v[22:23] op_sel_hi:[1,0]
  v_pk_mul_f32 v[84:85], v[84:85], v[22:23] op_sel_hi:[1,0]
  v_pk_mul_f32 v[86:87], v[86:87], v[22:23] op_sel_hi:[1,0]
  v_pk_mul_f32 v[88:89], v[88:89], v[22:23] op_sel_hi:[1,0]
  v_pk_mul_f32 v[90:91], v[90:91], v[22:23] op_sel_hi:[1,0]
  v_pk_mul_f32 v[92:93], v[92:93], v[22:23] op_sel_hi:[1,0]
  v_pk_mul_f32 v[94:95], v[94:95], v[22:23] op_sel_hi:[1,0]
  v_pk_mul_f32 v[96:97], v[96:97], v[22:23] op_sel_hi:[1,0]
  v_pk_mul_f32 v[98:99], v[98:99], v[22:23] op_sel_hi:[1,0]
  v_pk_mul_f32 v[100:101], v[100:101], v[22:23] op_sel_hi:[1,0]
  v_pk_mul_f32 v[102:103], v[102:103], v[22:23] op_sel_hi:[1,0]
  v_pk_mul_f32 v[104:105], v[104:105], v[22:23] op_sel_hi:[1,0]
  v_pk_mul_f32 v[106:107], v[106:107], v[22:23] op_sel_hi:[1,0]
  v_pk_mul_f32 v[108:109], v[108:109], v[22:23] op_sel_hi:[1,0]
  v_pk_mul_f32 v[110:111], v[110:111], v[22:23] op_sel_hi:[1,0]
  s_add_u32 m0, s53, 9088
  s_cbranch_vccnz 9f
  s_waitcnt vmcnt(6)
9:
  s_waitcnt vmcnt(10)
  buffer_load_dwordx4 v5, s[24:27], s52 offen offset:128 nt lds
  v_pk_mul_f32 v[112:113], v[112:113], v[22:23] op_sel_hi:[1,0]
  v_pk_mul_f32 v[114:115], v[114:115], v[22:23] op_sel_hi:[1,0]
  v_pk_mul_f32 v[116:117], v[116:117], v[22:23] op_sel_hi:[1,0]
  v_pk_mul_f32 v[118:119], v[118:119], v[22:23] op_sel_hi:[1,0]
  v_pk_mul_f32 v[120:121], v[120:121], v[22:23] op_sel_hi:[1,0]
  v_pk_mul_f32 v[122:123], v[122:123], v[22:23] op_sel_hi:[1,0]
  v_pk_mul_f32 v[124:125], v[124:125], v[22:23] op_sel_hi:[1,0]
  v_pk_mul_f32 v[126:127], v[126:127], v[22:23] op_sel_hi:[1,0]
  v_pk_mul_f32 v[64:65], v[64:65], v[22:23] op_sel_hi:[1,0]
  v_pk_mul_f32 v[66:67], v[66:67], v[22:23] op_sel_hi:[1,0]
  v_pk_mul_f32 v[68:69], v[68:69], v[22:23] op_sel_hi:[1,0]
  v_pk_mul_f32 v[70:71], v[70:71], v[22:23] op_sel_hi:[1,0]
  v_pk_mul_f32 v[72:73], v[72:73], v[22:23] op_sel_hi:[1,0]
  v_pk_mul_f32 v[74:75], v[74:75], v[22:23] op_sel_hi:[1,0]
  v_pk_mul_f32 v[76:77], v[76:77], v[22:23] op_sel_hi:[1,0]
  v_pk_mul_f32 v[78:79], v[78:79], v[22:23] op_sel_hi:[1,0]
  s_cbranch_vccnz 9f
  s_waitcnt vmcnt(5)
9:
  s_waitcnt vmcnt(10)
  buffer_load_dwordx4 v5, s[24:27], s52 offen offset:2176 nt lds
  s_xor_b32 s52, s52, 16384
  s_cmp_eq_u32 s96, 1
  s_cbranch_scc0 1f
  v_cmp_lt_i32 s[92:93], 0, v250
  s_nop 0
  s_bcnt1_i32_b32 s60, s92
  v_mov_b32 v250, s60
  s_mov_b64 exec, 1
  buffer_store_dword v250, off, s[40:43], s95 offset:512
  buffer_store_dword v250, off, s[40:43], s95 offset:768
  buffer_store_dword v250, off, s[40:43], s95 offset:1792
  s_mov_b64 exec, -1
1:
  ds_read_b32 v22, v231 offset:640
  ds_read_b64_tr_b16 v[148:149], v15
  ds_read_b64_tr_b16 v[150:151], v15 offset:2048
  ds_read_b64_tr_b16 v[152:153], v16
  ds_read_b64_tr_b16 v[154:155], v16 offset:2048
  ds_read_b64_tr_b16 v[156:157], v17
  ds_read_b64_tr_b16 v[158:159], v17 offset:2048
  ds_read_b64_tr_b16 v[144:145], v14
  ds_read_b64_tr_b16 v[146:147], v14 offset:2048
  s_add_u32 m0, s53, 12288
  s_cbranch_vccnz 9f
  s_waitcnt vmcnt(5)
9:
  s_waitcnt vmcnt(10)
  buffer_load_dwordx4 v5, s[24:27], s52 offen nt lds
  s_barrier
  s_waitcnt lgkmcnt(0)
  v_mfma_f32_32x32x16_bf16 v[80:95], v[148:151], a[32:35], v[80:95]
  v_mfma_f32_32x32x16_bf16 v[96:111], v[152:155], a[32:35], v[96:111]
  v_mfma_f32_32x32x16_bf16 v[112:127], v[156:159], a[32:35], v[112:127]
  v_mfma_f32_32x32x16_bf16 v[64:79], v[144:147], a[32:35], v[64:79]
  s_cbranch_vccnz 9f
  s_waitcnt vmcnt(5)
9:
  s_waitcnt vmcnt(9)
  buffer_load_dwordx4 v5, s[24:27], s52 offen offset:2048 nt lds
  s_add_u32 m0, s53, 13184
  s_cbranch_vccnz 9f
  s_waitcnt vmcnt(4)
9:
  s_waitcnt vmcnt(8)
  buffer_load_dwordx4 v5, s[24:27], s52 offen offset:128 nt lds
  ds_read_b64_tr_b16 a[0:1], v20
  ds_read_b64_tr_b16 a[4:5], v20 offset:32
  ds_read_b64_tr_b16 a[8:9], v243
  ds_read_b64_tr_b16 a[12:13], v243 offset:32
  ds_read_b64_tr_b16 a[16:17], v244
  ds_read_b64_tr_b16 a[20:21], v244 offset:32
  ds_read_b64_tr_b16 a[24:25], v245
  ds_read_b64_tr_b16 a[28:29], v245 offset:32
  s_cbranch_vccnz 9f
  s_waitcnt vmcnt(4)
9:
  s_waitcnt vmcnt(8)
  buffer_load_dwordx4 v5, s[24:27], s52 offen offset:2176 nt lds
  s_xor_b32 s52, s52, 0x54000
  s_waitcnt lgkmcnt(0)
  s_lshl_b32 s62, s3, 1
  s_xor_b32 s62, s62, 2
  s_mul_i32 s62, s62, 18432
  s_add_u32 s62, s62, s66
  s_add_u32 m0, s53, 24576
  s_nop 0
  buffer_load_dwordx4 v18, s[36:39], s62 offen lds
  s_addk_i32 s62, 4608
  ds_read_b64_tr_b16 v[164:165], v15 offset:4096
  ds_read_b64_tr_b16 v[166:167], v15 offset:6144
  ds_read_b64_tr_b16 v[168:169], v16 offset:4096
  ds_read_b64_tr_b16 v[170:171], v16 offset:6144
  ds_read_b64_tr_b16 v[172:173], v17 offset:4096
  ds_read_b64_tr_b16 v[174:175], v17 offset:6144
  ds_read_b64_tr_b16 v[160:161], v14 offset:4096
  ds_read_b64_tr_b16 v[162:163], v14 offset:6144
  s_add_u32 m0, s53, 16384
  s_cbranch_vccnz 9f
  s_waitcnt vmcnt(5)
9:
  s_waitcnt vmcnt(9)
  buffer_load_dwordx4 v5, s[24:27], s52 offen nt lds
  s_add_u32 s91, s91, 1
  s_and_b32 s60, s91, 3
  s_cmp_eq_u32 s60, s3
  s_cbranch_scc0 1f
  v_mov_b32 v252, s91
  s_mov_b64 exec, 1
  buffer_store_dword v252, off, s[40:43], s94 offset:1280
  s_mov_b64 exec, -1
1:
  s_barrier
  buffer_load_dword v246, v254, s[40:43], s95 offen offset:1280 sc1
  s_addk_i32 s97, 512
  s_add_u32 s96, s96, 30
  s_and_b32 s96, s96, 0x11f
  s_cmp_eq_u32 s96, 0
  s_cbranch_scc0 1f
  s_add_u32 s60, s97, s95
  s_mov_b32 exec_hi, 0
  buffer_store_dword v253, v254, s[40:43], s60 offen sc1
  s_mov_b32 exec_hi, -1
1:
  s_waitcnt lgkmcnt(0)
  v_mfma_f32_32x32x16_bf16 v[80:95], v[164:167], a[36:39], v[80:95]
  v_mfma_f32_32x32x16_bf16 v[96:111], v[168:171], a[36:39], v[96:111]
  v_mfma_f32_32x32x16_bf16 v[112:127], v[172:175], a[36:39], v[112:127]
  v_mfma_f32_32x32x16_bf16 v[64:79], v[160:163], a[36:39], v[64:79]
  s_cbranch_vccnz 9f
  s_waitcnt vmcnt(6)
9:
  s_waitcnt vmcnt(9)
  buffer_load_dwordx4 v5, s[24:27], s52 offen offset:2048 nt lds
  s_nop 5
  v_pk_mul_f32 v[80:81], v[80:81], v[22:23] op_sel_hi:[1,0]
  v_pk_mul_f32 v[82:83], v[82:83], v[22:23] op_sel_hi:[1,0]
  v_pk_mul_f32 v[84:85], v[84:85], v[22:23] op_sel_hi:[1,0]
  v_pk_mul_f32 v[86:87], v[86:87], v[22:23] op_sel_hi:[1,0]
  v_pk_mul_f32 v[88:89], v[88:89], v[22:23] op_sel_hi:[1,0]
  v_pk_mul_f32 v[90:91], v[90:91], v[22:23] op_sel_hi:[1,0]
  v_pk_mul_f32 v[92:93], v[92:93], v[22:23] op_sel_hi:[1,0]
  v_pk_mul_f32 v[94:95], v[94:95], v[22:23] op_sel_hi:[1,0]
  v_pk_mul_f32 v[96:97], v[96:97], v[22:23] op_sel_hi:[1,0]
  v_pk_mul_f32 v[98:99], v[98:99], v[22:23] op_sel_hi:[1,0]
  v_pk_mul_f32 v[100:101], v[100:101], v[22:23] op_sel_hi:[1,0]
  v_pk_mul_f32 v[102:103], v[102:103], v[22:23] op_sel_hi:[1,0]
  v_pk_mul_f32 v[104:105], v[104:105], v[22:23] op_sel_hi:[1,0]
  v_pk_mul_f32 v[106:107], v[106:107], v[22:23] op_sel_hi:[1,0]
  v_pk_mul_f32 v[108:109], v[108:109], v[22:23] op_sel_hi:[1,0]
  v_pk_mul_f32 v[110:111], v[110:111], v[22:23] op_sel_hi:[1,0]
  s_add_u32 m0, s53, 17280
  s_cbranch_vccnz 9f
  s_waitcnt vmcnt(6)
9:
  s_waitcnt vmcnt(9)
  buffer_load_dwordx4 v5, s[24:27], s52 offen offset:128 nt lds
  s_cmp_eq_u32 s96, 1
  s_cbranch_scc0 1f
  buffer_load_dword v250, v249, s[40:43], s97 offen sc1
1:
  v_pk_mul_f32 v[112:113], v[112:113], v[22:23] op_sel_hi:[1,0]
  v_pk_mul_f32 v[114:115], v[114:115], v[22:23] op_sel_hi:[1,0]
  v_pk_mul_f32 v[116:117], v[116:117], v[22:23] op_sel_hi:[1,0]
  v_pk_mul_f32 v[118:119], v[118:119], v[22:23] op_sel_hi:[1,0]
  v_pk_mul_f32 v[120:121], v[120:121], v[22:23] op_sel_hi:[1,0]
  v_pk_mul_f32 v[122:123], v[122:123], v[22:23] op_sel_hi:[1,0]
  v_pk_mul_f32 v[124:125], v[124:125], v[22:23] op_sel_hi:[1,0]
  v_pk_mul_f32 v[126:127], v[126:127], v[22:23] op_sel_hi:[1,0]
  v_pk_mul_f32 v[64:65], v[64:65], v[22:23] op_sel_hi:[1,0]
  v_pk_mul_f32 v[66:67], v[66:67], v[22:23] op_sel_hi:[1,0]
  v_pk_mul_f32 v[68:69], v[68:69], v[22:23] op_sel_hi:[1,0]
  v_pk_mul_f32 v[70:71], v[70:71], v[22:23] op_sel_hi:[1,0]
  v_pk_mul_f32 v[72:73], v[72:73], v[22:23] op_sel_hi:[1,0]
  v_pk_mul_f32 v[74:75], v[74:75], v[22:23] op_sel_hi:[1,0]
  v_pk_mul_f32 v[76:77], v[76:77], v[22:23] op_sel_hi:[1,0]
  v_pk_mul_f32 v[78:79], v[78:79], v[22:23] op_sel_hi:[1,0]
  s_cbranch_vccnz 9f
  s_waitcnt vmcnt(6)
9:
  s_waitcnt vmcnt(9)
  buffer_load_dwordx4 v5, s[24:27], s52 offen offset:2176 nt lds
  s_xor_b32 s52, s52, 16384
  s_add_u32 m0, s53, 25600
  s_nop 0
  buffer_load_dwordx4 v18, s[36:39], s62 offen lds
  s_addk_i32 s62, 4608
  ds_read_b32 v22, v231 offset:768
  ds_read_b64_tr_b16 v[148:149], v15 offset:8192
  ds_read_b64_tr_b16 v[150:151], v15 offset:10240
  ds_read_b64_tr_b16 v[152:153], v16 offset:8192
  ds_read_b64_tr_b16 v[154:155], v16 offset:10240
  ds_read_b64_tr_b16 v[156:157], v17 offset:8192
  ds_read_b64_tr_b16 v[158:159], v17 offset:10240
  ds_read_b64_tr_b16 v[144:145], v14 offset:8192
  ds_read_b64_tr_b16 v[146:147], v14 offset:10240
  s_add_u32 m0, s53, 20480
  s_cbranch_vccnz 9f
  s_waitcnt vmcnt(7)
9:
  s_waitcnt vmcnt(10)
  buffer_load_dwordx4 v5, s[24:27], s52 offen nt lds
  s_barrier
  s_waitcnt lgkmcnt(0)
  v_mfma_f32_32x32x16_bf16 v[80:95], v[148:151], a[40:43], v[80:95]
  v_mfma_f32_32x32x16_bf16 v[96:111], v[152:155], a[40:43], v[96:111]
  v_mfma_f32_32x32x16_bf16 v[112:127], v[156:159], a[40:43], v[112:127]
  v_mfma_f32_32x32x16_bf16 v[64:79], v[144:147], a[40:43], v[64:79]
  s_cbranch_vccnz 9f
  s_waitcnt vmcnt(6)
9:
  s_waitcnt vmcnt(10)
  buffer_load_dwordx4 v5, s[24:27], s52 offen offset:2048 nt lds
  s_mov_b32 s69, 0x200000
1:
  v_cmp_eq_u32 s[92:93], -1, v227
  s_sub_u32 s69, s69, 1
  s_cmp_eq_u64 s[92:93], 0
  s_cbranch_scc1 2f
  s_cmp_eq_u32 s69, 0
  s_cbranch_scc1 2f
  buffer_load_dword v227, v230, s[40:43], s65 offen sc1
  s_waitcnt vmcnt(0)
  s_branch 1b
2:
  v_sub_f32 v26, v227, v226
  v_exp_f32 v26, v26
  v_add_u32 v238, s54, v228
  v_add_f32 v26, 1.0, v26
  v_rcp_f32 v26, v26
  v_xor_b32 v239, 8192, v238
  v_xor_b32 v240, 16384, v238
  v_xor_b32 v241, 24576, v238
  v_mul_f32 v26, v26, v225
  v_mul_f32 v224, v224, v26
  v_pk_mul_f32 v[128:129], v[128:129], v[26:27] op_sel_hi:[1,0]
  v_pk_mul_f32 v[130:131], v[130:131], v[26:27] op_sel_hi:[1,0]
  v_pk_mul_f32 v[132:133], v[132:133], v[26:27] op_sel_hi:[1,0]
  v_pk_mul_f32 v[134:135], v[134:135], v[26:27] op_sel_hi:[1,0]
  v_pk_mul_f32 v[136:137], v[136:137], v[26:27] op_sel_hi:[1,0]
  v_pk_mul_f32 v[138:139], v[138:139], v[26:27] op_sel_hi:[1,0]
  v_pk_mul_f32 v[140:141], v[140:141], v[26:27] op_sel_hi:[1,0]
  v_pk_mul_f32 v[142:143], v[142:143], v[26:27] op_sel_hi:[1,0]
  v_cvt_pk_bf16_f32 v176, v128, v129
  v_cvt_pk_bf16_f32 v177, v130, v131
  v_cvt_pk_bf16_f32 v178, v132, v133
  v_cvt_pk_bf16_f32 v179, v134, v135
  ds_write_b128 v238, v[176:179] offset:4096
  v_cvt_pk_bf16_f32 v180, v136, v137
  v_cvt_pk_bf16_f32 v181, v138, v139
  v_cvt_pk_bf16_f32 v182, v140, v141
  v_cvt_pk_bf16_f32 v183, v142, v143
  ds_write_b128 v238, v[180:183] offset:5120
  s_waitcnt lgkmcnt(0)
  s_add_u32 m0, s53, 21376
  s_cbranch_vccnz 9f
  s_waitcnt vmcnt(5)
9:
  s_waitcnt vmcnt(10)
  buffer_load_dwordx4 v5, s[24:27], s52 offen offset:128 nt lds
  s_cbranch_vccnz 9f
  s_waitcnt vmcnt(5)
9:
  s_waitcnt vmcnt(10)
  buffer_load_dwordx4 v5, s[24:27], s52 offen offset:2176 nt lds
  s_xor_b32 s52, s52, 0x14000
  s_add_u32 m0, s53, 26624
  s_nop 0
  buffer_load_dwordx4 v18, s[36:39], s62 offen lds
  s_addk_i32 s62, 4608
  ds_read_b64_tr_b16 v[164:165], v15 offset:12288
  ds_read_b64_tr_b16 v[166:167], v15 offset:14336
  ds_read_b64_tr_b16 v[168:169], v16 offset:12288
  ds_read_b64_tr_b16 v[170:171], v16 offset:14336
  ds_read_b64_tr_b16 v[172:173], v17 offset:12288
  ds_read_b64_tr_b16 v[174:175], v17 offset:14336
  ds_read_b64_tr_b16 v[160:161], v14 offset:12288
  ds_read_b64_tr_b16 v[162:163], v14 offset:14336
  s_mov_b32 m0, s53
  s_cbranch_vccnz 9f
  s_waitcnt vmcnt(6)
9:
  s_waitcnt vmcnt(10)
  buffer_load_dwordx4 v5, s[24:27], s52 offen nt lds
  s_barrier
  s_waitcnt lgkmcnt(0)
  v_mfma_f32_32x32x16_bf16 v[80:95], v[164:167], a[44:47], v[80:95]
  v_mfma_f32_32x32x16_bf16 v[96:111], v[168:171], a[44:47], v[96:111]
  v_mfma_f32_32x32x16_bf16 v[112:127], v[172:175], a[44:47], v[112:127]
  v_mfma_f32_32x32x16_bf16 v[64:79], v[160:163], a[44:47], v[64:79]
  s_cbranch_vccnz 9f
  s_waitcnt vmcnt(5)
9:
  s_waitcnt vmcnt(9)
  buffer_load_dwordx4 v5, s[24:27], s52 offen offset:2048 nt lds
  v_add_u32 v248, v248, v247
  v_cmp_le_i32 s[92:93], v248, v246
  s_nop 0
  s_bcnt1_i32_b64 s60, s[92:93]
  s_cmp_ge_u32 s60, 33
  s_cselect_b64 vcc, -1, 0
  v_pk_mul_f32 v[80:81], v[80:81], v[22:23] op_sel_hi:[1,0]
  v_pk_mul_f32 v[82:83], v[82:83], v[22:23] op_sel_hi:[1,0]
  v_pk_mul_f32 v[84:85], v[84:85], v[22:23] op_sel_hi:[1,0]
  v_pk_mul_f32 v[86:87], v[86:87], v[22:23] op_sel_hi:[1,0]
  v_pk_mul_f32 v[88:89], v[88:89], v[22:23] op_sel_hi:[1,0]
  v_pk_mul_f32 v[90:91], v[90:91], v[22:23] op_sel_hi:[1,0]
  v_pk_mul_f32 v[92:93], v[92:93], v[22:23] op_sel_hi:[1,0]
  v_pk_mul_f32 v[94:95], v[94:95], v[22:23] op_sel_hi:[1,0]
  v_pk_mul_f32 v[96:97], v[96:97], v[22:23] op_sel_hi:[1,0]
  v_pk_mul_f32 v[98:99], v[98:99], v[22:23] op_sel_hi:[1,0]
  v_pk_mul_f32 v[100:101], v[100:101], v[22:23] op_sel_hi:[1,0]
  v_pk_mul_f32 v[102:103], v[102:103], v[22:23] op_sel_hi:[1,0]
  v_pk_mul_f32 v[104:105], v[104:105], v[22:23] op_sel_hi:[1,0]
  v_pk_mul_f32 v[106:107], v[106:107], v[22:23] op_sel_hi:[1,0]
  v_pk_mul_f32 v[108:109], v[108:109], v[22:23] op_sel_hi:[1,0]
  v_pk_mul_f32 v[110:111], v[110:111], v[22:23] op_sel_hi:[1,0]
  s_add_u32 m0, s53, 896
  s_cbranch_vccnz 9f
  s_waitcnt vmcnt(5)
9:
  s_waitcnt vmcnt(9)
  buffer_load_dwordx4 v5, s[24:27], s52 offen offset:128 nt lds
  v_pk_mul_f32 v[112:113], v[112:113], v[22:23] op_sel_hi:[1,0]
  v_pk_mul_f32 v[114:115], v[114:115], v[22:23] op_sel_hi:[1,0]
  v_pk_mul_f32 v[116:117], v[116:117], v[22:23] op_sel_hi:[1,0]
  v_pk_mul_f32 v[118:119], v[118:119], v[22:23] op_sel_hi:[1,0]
  v_pk_mul_f32 v[120:121], v[120:121], v[22:23] op_sel_hi:[1,0]
  v_pk_mul_f32 v[122:123], v[122:123], v[22:23] op_sel_hi:[1,0]
  v_pk_mul_f32 v[124:125], v[124:125], v[22:23] op_sel_hi:[1,0]
  v_pk_mul_f32 v[126:127], v[126:127], v[22:23] op_sel_hi:[1,0]
  v_pk_mul_f32 v[64:65], v[64:65], v[22:23] op_sel_hi:[1,0]
  v_pk_mul_f32 v[66:67], v[66:67], v[22:23] op_sel_hi:[1,0]
  v_pk_mul_f32 v[68:69], v[68:69], v[22:23] op_sel_hi:[1,0]
  v_pk_mul_f32 v[70:71], v[70:71], v[22:23] op_sel_hi:[1,0]
  v_pk_mul_f32 v[72:73], v[72:73], v[22:23] op_sel_hi:[1,0]
  v_pk_mul_f32 v[74:75], v[74:75], v[22:23] op_sel_hi:[1,0]
  v_pk_mul_f32 v[76:77], v[76:77], v[22:23] op_sel_hi:[1,0]
  v_pk_mul_f32 v[78:79], v[78:79], v[22:23] op_sel_hi:[1,0]
  s_cbranch_vccnz 9f
  s_waitcnt vmcnt(5)
9:
  s_waitcnt vmcnt(9)
  buffer_load_dwordx4 v5, s[24:27], s52 offen offset:2176 nt lds
  s_xor_b32 s52, s52, 16384
  s_cmp_eq_u32 s96, 1
  s_cbranch_scc0 1f
  v_cmp_lt_i32 s[92:93], 0, v250
  s_nop 0
  s_bcnt1_i32_b32 s60, s92
  v_mov_b32 v250, s60
  s_mov_b64 exec, 1
  buffer_store_dword v250, off, s[40:43], s95 offset:512
  buffer_store_dword v250, off, s[40:43], s95 offset:768
  buffer_store_dword v250, off, s[40:43], s95 offset:1792
  s_mov_b64 exec, -1
1:
  ds_read_b64_tr_b16 a[2:3], v20 offset:4096
  ds_read_b64_tr_b16 a[6:7], v20 offset:4128
  ds_read_b64_tr_b16 a[10:11], v243 offset:4096
  ds_read_b64_tr_b16 a[14:15], v243 offset:4128
  ds_read_b64_tr_b16 a[18:19], v244 offset:4096
  ds_read_b64_tr_b16 a[22:23], v244 offset:4128
  ds_read_b64_tr_b16 a[26:27], v245 offset:4096
  ds_read_b64_tr_b16 a[30:31], v245 offset:4128
  s_add_u32 m0, s53, 27648
  s_nop 0
  buffer_load_dwordx4 v18, s[36:39], s62 offen lds
  ds_read_b32 v22, v231 offset:896
  ds_read_b64_tr_b16 v[148:149], v15 offset:16384
  ds_read_b64_tr_b16 v[150:151], v15 offset:18432
  ds_read_b64_tr_b16 v[152:153], v16 offset:16384
  ds_read_b64_tr_b16 v[154:155], v16 offset:18432
  ds_read_b64_tr_b16 v[156:157], v17 offset:16384
  ds_read_b64_tr_b16 v[158:159], v17 offset:18432
  s_waitcnt lgkmcnt(14)
  ds_read_b64_tr_b16 v[144:145], v14 offset:16384
  s_waitcnt lgkmcnt(14)
  ds_read_b64_tr_b16 v[146:147], v14 offset:18432
  s_add_u32 m0, s53, 4096
  s_cbranch_vccnz 9f
  s_waitcnt vmcnt(6)
9:
  s_waitcnt vmcnt(9)
  buffer_load_dwordx4 v5, s[24:27], s52 offen nt lds
  s_barrier
  s_waitcnt lgkmcnt(9)
  s_lshl_b32 s98, s3, 1
  s_xor_b32 s98, s98, 3
  s_mul_i32 s98, s98, 18432
  s_add_u32 s98, s98, s66
  s_add_u32 m0, s53, 28672
  s_nop 0
  buffer_load_dwordx4 v18, s[36:39], s98 offen lds
  s_addk_i32 s98, 4608
  s_waitcnt lgkmcnt(0)
  v_mfma_f32_32x32x16_bf16 v[80:95], v[148:151], a[48:51], v[80:95]
  v_mfma_f32_32x32x16_bf16 v[96:111], v[152:155], a[48:51], v[96:111]
  v_mfma_f32_32x32x16_bf16 v[112:127], v[156:159], a[48:51], v[112:127]
  v_mfma_f32_32x32x16_bf16 v[64:79], v[144:147], a[48:51], v[64:79]
  s_add_u32 m0, s53, 4096
  s_cbranch_vccnz 9f
  s_waitcnt vmcnt(6)
9:
  s_waitcnt vmcnt(10)
  buffer_load_dwordx4 v5, s[24:27], s52 offen offset:2048 nt lds
  s_add_u32 m0, s53, 4992
  s_cbranch_vccnz 9f
  s_waitcnt vmcnt(6)
9:
  s_waitcnt vmcnt(10)
  buffer_load_dwordx4 v5, s[24:27], s52 offen offset:128 nt lds
  s_cbranch_vccnz 9f
  s_waitcnt vmcnt(6)
9:
  s_waitcnt vmcnt(10)
  buffer_load_dwordx4 v5, s[24:27], s52 offen offset:2176 nt lds
  s_xor_b32 s52, s52, 0x1d4000
  ds_read_b64_tr_b16 v[164:165], v15 offset:20480
  ds_read_b64_tr_b16 v[166:167], v15 offset:22528
  ds_read_b64_tr_b16 v[168:169], v16 offset:20480
  ds_read_b64_tr_b16 v[170:171], v16 offset:22528
  ds_read_b64_tr_b16 v[172:173], v17 offset:20480
  ds_read_b64_tr_b16 v[174:175], v17 offset:22528
  ds_read_b64_tr_b16 v[160:161], v14 offset:20480
  ds_read_b64_tr_b16 v[162:163], v14 offset:22528
  s_add_u32 m0, s53, 8192
  s_cbranch_vccnz 9f
  s_waitcnt vmcnt(6)
9:
  s_waitcnt vmcnt(9)
  buffer_load_dwordx4 v5, s[24:27], s52 offen nt lds
  s_add_u32 s91, s91, 1
  s_and_b32 s60, s91, 3
  s_cmp_eq_u32 s60, s3
  s_cbranch_scc0 1f
  v_mov_b32 v252, s91
  s_mov_b64 exec, 1
  buffer_store_dword v252, off, s[40:43], s94
  s_mov_b64 exec, -1
1:
  s_barrier
  buffer_load_dword v255, v254, s[40:43], s95 offen sc1
  s_addk_i32 s97, 512
  s_add_u32 s96, s96, 30
  s_and_b32 s96, s96, 0x11f
  s_cmp_eq_u32 s96, 0
  s_cbranch_scc0 1f
  s_add_u32 s60, s97, s95
  s_mov_b32 exec_hi, 0
  buffer_store_dword v253, v254, s[40:43], s60 offen sc1
  s_mov_b32 exec_hi, -1
1:
  s_add_u32 m0, s53, 29696
  s_nop 0
  buffer_load_dwordx4 v18, s[36:39], s98 offen lds
  s_addk_i32 s98, 4608
  s_waitcnt lgkmcnt(0)
  v_mfma_f32_32x32x16_bf16 v[80:95], v[164:167], a[52:55], v[80:95]
  v_mfma_f32_32x32x16_bf16 v[96:111], v[168:171], a[52:55], v[96:111]
  v_mfma_f32_32x32x16_bf16 v[112:127], v[172:175], a[52:55], v[112:127]
  v_mfma_f32_32x32x16_bf16 v[64:79], v[160:163], a[52:55], v[64:79]
  s_add_u32 m0, s53, 8192
  s_cbranch_vccnz 9f
  s_waitcnt vmcnt(7)
9:
  s_waitcnt vmcnt(11)
  buffer_load_dwordx4 v5, s[24:27], s52 offen offset:2048 nt lds
  s_nop 4
  v_pk_mul_f32 v[80:81], v[80:81], v[22:23] op_sel_hi:[1,0]
  v_pk_mul_f32 v[82:83], v[82:83], v[22:23] op_sel_hi:[1,0]
  v_pk_mul_f32 v[84:85], v[84:85], v[22:23] op_sel_hi:[1,0]
  v_pk_mul_f32 v[86:87], v[86:87], v[22:23] op_sel_hi:[1,0]
  v_pk_mul_f32 v[88:89], v[88:89], v[22:23] op_sel_hi:[1,0]
  v_pk_mul_f32 v[90:91], v[90:91], v[22:23] op_sel_hi:[1,0]
  v_pk_mul_f32 v[92:93], v[92:93], v[22:23] op_sel_hi:[1,0]
  v_pk_mul_f32 v[94:95], v[94:95], v[22:23] op_sel_hi:[1,0]
  v_pk_mul_f32 v[96:97], v[96:97], v[22:23] op_sel_hi:[1,0]
  v_pk_mul_f32 v[98:99], v[98:99], v[22:23] op_sel_hi:[1,0]
  v_pk_mul_f32 v[100:101], v[100:101], v[22:23] op_sel_hi:[1,0]
  v_pk_mul_f32 v[102:103], v[102:103], v[22:23] op_sel_hi:[1,0]
  v_pk_mul_f32 v[104:105], v[104:105], v[22:23] op_sel_hi:[1,0]
  v_pk_mul_f32 v[106:107], v[106:107], v[22:23] op_sel_hi:[1,0]
  v_pk_mul_f32 v[108:109], v[108:109], v[22:23] op_sel_hi:[1,0]
  v_pk_mul_f32 v[110:111], v[110:111], v[22:23] op_sel_hi:[1,0]
  s_add_u32 m0, s53, 9088
  s_cbranch_vccnz 9f
  s_waitcnt vmcnt(6)
9:
  s_waitcnt vmcnt(11)
  buffer_load_dwordx4 v5, s[24:27], s52 offen offset:128 nt lds
  s_cmp_eq_u32 s96, 1
  s_cbranch_scc0 1f
  buffer_load_dword v250, v249, s[40:43], s97 offen sc1
1:
  v_pk_mul_f32 v[112:113], v[112:113], v[22:23] op_sel_hi:[1,0]
  v_pk_mul_f32 v[114:115], v[114:115], v[22:23] op_sel_hi:[1,0]
  v_pk_mul_f32 v[116:117], v[116:117], v[22:23] op_sel_hi:[1,0]
  v_pk_mul_f32 v[118:119], v[118:119], v[22:23] op_sel_hi:[1,0]
  v_pk_mul_f32 v[120:121], v[120:121], v[22:23] op_sel_hi:[1,0]
  v_pk_mul_f32 v[122:123], v[122:123], v[22:23] op_sel_hi:[1,0]
  v_pk_mul_f32 v[124:125], v[124:125], v[22:23] op_sel_hi:[1,0]
  v_pk_mul_f32 v[126:127], v[126:127], v[22:23] op_sel_hi:[1,0]
  v_pk_mul_f32 v[64:65], v[64:65], v[22:23] op_sel_hi:[1,0]
  v_pk_mul_f32 v[66:67], v[66:67], v[22:23] op_sel_hi:[1,0]
  v_pk_mul_f32 v[68:69], v[68:69], v[22:23] op_sel_hi:[1,0]
  v_pk_mul_f32 v[70:71], v[70:71], v[22:23] op_sel_hi:[1,0]
  v_pk_mul_f32 v[72:73], v[72:73], v[22:23] op_sel_hi:[1,0]
  v_pk_mul_f32 v[74:75], v[74:75], v[22:23] op_sel_hi:[1,0]
  v_pk_mul_f32 v[76:77], v[76:77], v[22:23] op_sel_hi:[1,0]
  v_pk_mul_f32 v[78:79], v[78:79], v[22:23] op_sel_hi:[1,0]
  s_cbranch_vccnz 9f
  s_waitcnt vmcnt(6)
9:
  s_waitcnt vmcnt(11)
  buffer_load_dwordx4 v5, s[24:27], s52 offen offset:2176 nt lds
  s_xor_b32 s52, s52, 16384
  ds_read_b32 v22, v231 offset:1024
  ds_read_b64_tr_b16 v[148:149], v15
  ds_read_b64_tr_b16 v[150:151], v15 offset:2048
  ds_read_b64_tr_b16 v[152:153], v16
  ds_read_b64_tr_b16 v[154:155], v16 offset:2048
  ds_read_b64_tr_b16 v[156:157], v17
  ds_read_b64_tr_b16 v[158:159], v17 offset:2048
  ds_read_b64_tr_b16 v[144:145], v14
  ds_read_b64_tr_b16 v[146:147], v14 offset:2048
  s_add_u32 m0, s53, 12288
  s_cbranch_vccnz 9f
  s_waitcnt vmcnt(6)
9:
  s_waitcnt vmcnt(10)
  buffer_load_dwordx4 v5, s[24:27], s52 offen nt lds
  s_barrier
  s_add_u32 m0, s53, 30720
  s_nop 0
  buffer_load_dwordx4 v18, s[36:39], s98 offen lds
  s_addk_i32 s98, 4608
  s_waitcnt lgkmcnt(0)
  v_mfma_f32_32x32x16_bf16 v[80:95], v[148:151], a[56:59], v[80:95]
  v_mfma_f32_32x32x16_bf16 v[96:111], v[152:155], a[56:59], v[96:111]
  v_mfma_f32_32x32x16_bf16 v[112:127], v[156:159], a[56:59], v[112:127]
  v_mfma_f32_32x32x16_bf16 v[64:79], v[144:147], a[56:59], v[64:79]
  s_add_u32 m0, s53, 12288
  s_cbranch_vccnz 9f
  s_waitcnt vmcnt(7)
9:
  s_waitcnt vmcnt(10)
  buffer_load_dwordx4 v5, s[24:27], s52 offen offset:2048 nt lds
  s_add_u32 m0, s53, 13184
  s_cbranch_vccnz 9f
  s_waitcnt vmcnt(5)
9:
  s_waitcnt vmcnt(10)
  buffer_load_dwordx4 v5, s[24:27], s52 offen offset:128 nt lds
  s_cbranch_vccnz 9f
  s_waitcnt vmcnt(5)
9:
  s_waitcnt vmcnt(10)
  buffer_load_dwordx4 v5, s[24:27], s52 offen offset:2176 nt lds
  s_xor_b32 s52, s52, 0x14000
  ds_read_b64_tr_b16 v[164:165], v15 offset:4096
  ds_read_b64_tr_b16 v[166:167], v15 offset:6144
  ds_read_b64_tr_b16 v[168:169], v16 offset:4096
  ds_read_b64_tr_b16 v[170:171], v16 offset:6144
  ds_read_b64_tr_b16 v[172:173], v17 offset:4096
  ds_read_b64_tr_b16 v[174:175], v17 offset:6144
  ds_read_b64_tr_b16 v[160:161], v14 offset:4096
  ds_read_b64_tr_b16 v[162:163], v14 offset:6144
  s_add_u32 m0, s53, 16384
  s_cbranch_vccnz 9f
  s_waitcnt vmcnt(5)
9:
  s_waitcnt vmcnt(10)
  buffer_load_dwordx4 v5, s[24:27], s52 offen nt lds
  s_barrier
  ds_read_b64_tr_b16 v[128:129], v20
  ds_read_b64_tr_b16 v[132:133], v20 offset:32
  ds_read_b64_tr_b16 v[136:137], v243
  ds_read_b64_tr_b16 v[140:141], v243 offset:32
  ds_read_b64_tr_b16 v[176:177], v244
  ds_read_b64_tr_b16 v[180:181], v244 offset:32
  ds_read_b64_tr_b16 v[184:185], v245
  s_waitcnt lgkmcnt(14)
  ds_read_b64_tr_b16 v[188:189], v245 offset:32
  s_add_u32 m0, s53, 31744
  s_nop 0
  buffer_load_dwordx4 v18, s[36:39], s98 offen lds
  s_waitcnt lgkmcnt(8)
  v_mfma_f32_32x32x16_bf16 v[80:95], v[164:167], a[60:63], v[80:95]
  v_mfma_f32_32x32x16_bf16 v[96:111], v[168:171], a[60:63], v[96:111]
  v_mfma_f32_32x32x16_bf16 v[112:127], v[172:175], a[60:63], v[112:127]
  v_mfma_f32_32x32x16_bf16 v[64:79], v[160:163], a[60:63], v[64:79]
  s_add_u32 m0, s53, 16384
  s_cbranch_vccnz 9f
  s_waitcnt vmcnt(6)
9:
  s_waitcnt vmcnt(9)
  buffer_load_dwordx4 v5, s[24:27], s52 offen offset:2048 nt lds
  v_add_u32 v248, v248, v247
  v_cmp_le_i32 s[92:93], v248, v255
  s_nop 0
  s_bcnt1_i32_b64 s60, s[92:93]
  s_cmp_ge_u32 s60, 33
  s_cselect_b64 vcc, -1, 0
  s_waitcnt lgkmcnt(0)
  s_lshl_b32 s62, s3, 1
  s_xor_b32 s62, s62, 6
  s_mul_i32 s62, s62, 18432
  s_add_u32 s62, s62, s66
  s_add_u32 m0, s53, 24576
  s_nop 0
  buffer_load_dwordx4 v18, s[36:39], s62 offen lds
  s_addk_i32 s62, 4608
  v_pk_mul_f32 v[80:81], v[80:81], v[22:23] op_sel_hi:[1,0]
  v_pk_mul_f32 v[82:83], v[82:83], v[22:23] op_sel_hi:[1,0]
  v_pk_mul_f32 v[84:85], v[84:85], v[22:23] op_sel_hi:[1,0]
  v_pk_mul_f32 v[86:87], v[86:87], v[22:23] op_sel_hi:[1,0]
  v_pk_mul_f32 v[88:89], v[88:89], v[22:23] op_sel_hi:[1,0]
  v_pk_mul_f32 v[90:91], v[90:91], v[22:23] op_sel_hi:[1,0]
  v_pk_mul_f32 v[92:93], v[92:93], v[22:23] op_sel_hi:[1,0]
  v_pk_mul_f32 v[94:95], v[94:95], v[22:23] op_sel_hi:[1,0]
  v_pk_mul_f32 v[96:97], v[96:97], v[22:23] op_sel_hi:[1,0]
  v_pk_mul_f32 v[98:99], v[98:99], v[22:23] op_sel_hi:[1,0]
  v_pk_mul_f32 v[100:101], v[100:101], v[22:23] op_sel_hi:[1,0]
  v_pk_mul_f32 v[102:103], v[102:103], v[22:23] op_sel_hi:[1,0]
  v_pk_mul_f32 v[104:105], v[104:105], v[22:23] op_sel_hi:[1,0]
  v_pk_mul_f32 v[106:107], v[106:107], v[22:23] op_sel_hi:[1,0]
  v_pk_mul_f32 v[108:109], v[108:109], v[22:23] op_sel_hi:[1,0]
  v_pk_mul_f32 v[110:111], v[110:111], v[22:23] op_sel_hi:[1,0]
  s_add_u32 m0, s53, 17280
  s_cbranch_vccnz 9f
  s_waitcnt vmcnt(6)
9:
  s_waitcnt vmcnt(10)
  buffer_load_dwordx4 v5, s[24:27], s52 offen offset:128 nt lds
  v_pk_mul_f32 v[112:113], v[112:113], v[22:23] op_sel_hi:[1,0]
  v_pk_mul_f32 v[114:115], v[114:115], v[22:23] op_sel_hi:[1,0]
  v_pk_mul_f32 v[116:117], v[116:117], v[22:23] op_sel_hi:[1,0]
  v_pk_mul_f32 v[118:119], v[118:119], v[22:23] op_sel_hi:[1,0]
  v_pk_mul_f32 v[120:121], v[120:121], v[22:23] op_sel_hi:[1,0]
  v_pk_mul_f32 v[122:123], v[122:123], v[22:23] op_sel_hi:[1,0]
  v_pk_mul_f32 v[124:125], v[124:125], v[22:23] op_sel_hi:[1,0]
  v_pk_mul_f32 v[126:127], v[126:127], v[22:23] op_sel_hi:[1,0]
  v_pk_mul_f32 v[64:65], v[64:65], v[22:23] op_sel_hi:[1,0]
  v_pk_mul_f32 v[66:67], v[66:67], v[22:23] op_sel_hi:[1,0]
  v_pk_mul_f32 v[68:69], v[68:69], v[22:23] op_sel_hi:[1,0]
  v_pk_mul_f32 v[70:71], v[70:71], v[22:23] op_sel_hi:[1,0]
  v_pk_mul_f32 v[72:73], v[72:73], v[22:23] op_sel_hi:[1,0]
  v_pk_mul_f32 v[74:75], v[74:75], v[22:23] op_sel_hi:[1,0]
  v_pk_mul_f32 v[76:77], v[76:77], v[22:23] op_sel_hi:[1,0]
  v_pk_mul_f32 v[78:79], v[78:79], v[22:23] op_sel_hi:[1,0]
  s_cbranch_vccnz 9f
  s_waitcnt vmcnt(6)
9:
  s_waitcnt vmcnt(10)
  buffer_load_dwordx4 v5, s[24:27], s52 offen offset:2176 nt lds
  s_xor_b32 s52, s52, 16384
  s_cmp_eq_u32 s96, 1
  s_cbranch_scc0 1f
  v_cmp_lt_i32 s[92:93], 0, v250
  s_nop 0
  s_bcnt1_i32_b32 s60, s92
  v_mov_b32 v250, s60
  s_mov_b64 exec, 1
  buffer_store_dword v250, off, s[40:43], s95 offset:512
  buffer_store_dword v250, off, s[40:43], s95 offset:768
  buffer_store_dword v250, off, s[40:43], s95 offset:1792
  s_mov_b64 exec, -1
1:
  ds_read_b32 v22, v231 offset:1152
  ds_read_b64_tr_b16 v[148:149], v15 offset:8192
  ds_read_b64_tr_b16 v[150:151], v15 offset:10240
  ds_read_b64_tr_b16 v[152:153], v16 offset:8192
  ds_read_b64_tr_b16 v[154:155], v16 offset:10240
  ds_read_b64_tr_b16 v[156:157], v17 offset:8192
  ds_read_b64_tr_b16 v[158:159], v17 offset:10240
  ds_read_b64_tr_b16 v[144:145], v14 offset:8192
  ds_read_b64_tr_b16 v[146:147], v14 offset:10240
  s_add_u32 m0, s53, 20480
  s_cbranch_vccnz 9f
  s_waitcnt vmcnt(6)
9:
  s_waitcnt vmcnt(10)
  buffer_load_dwordx4 v5, s[24:27], s52 offen nt lds
  s_barrier
  s_waitcnt lgkmcnt(0)
  v_mfma_f32_32x32x16_bf16 v[80:95], v[148:151], a[64:67], v[80:95]
  v_mfma_f32_32x32x16_bf16 v[96:111], v[152:155], a[64:67], v[96:111]
  v_mfma_f32_32x32x16_bf16 v[112:127], v[156:159], a[64:67], v[112:127]
  v_mfma_f32_32x32x16_bf16 v[64:79], v[144:147], a[64:67], v[64:79]
  s_cbranch_vccnz 9f
  s_waitcnt vmcnt(6)
9:
  s_waitcnt vmcnt(9)
  buffer_load_dwordx4 v5, s[24:27], s52 offen offset:2048 nt lds
  s_add_u32 m0, s53, 25600
  s_nop 0
  buffer_load_dwordx4 v18, s[36:39], s62 offen lds
  s_addk_i32 s62, 4608
  s_add_u32 m0, s53, 21376
  s_cbranch_vccnz 9f
  s_waitcnt vmcnt(6)
9:
  s_waitcnt vmcnt(10)
  buffer_load_dwordx4 v5, s[24:27], s52 offen offset:128 nt lds
  s_cbranch_vccnz 9f
  s_waitcnt vmcnt(5)
9:
  s_waitcnt vmcnt(10)
  buffer_load_dwordx4 v5, s[24:27], s52 offen offset:2176 nt lds
  s_xor_b32 s52, s52, 0x54000
  ds_read_b64_tr_b16 v[164:165], v15 offset:12288
  ds_read_b64_tr_b16 v[166:167], v15 offset:14336
  ds_read_b64_tr_b16 v[168:169], v16 offset:12288
  ds_read_b64_tr_b16 v[170:171], v16 offset:14336
  ds_read_b64_tr_b16 v[172:173], v17 offset:12288
  ds_read_b64_tr_b16 v[174:175], v17 offset:14336
  ds_read_b64_tr_b16 v[160:161], v14 offset:12288
  ds_read_b64_tr_b16 v[162:163], v14 offset:14336
  s_mov_b32 m0, s53
  s_cbranch_vccnz 9f
  s_waitcnt vmcnt(5)
9:
  s_waitcnt vmcnt(10)
  buffer_load_dwordx4 v5, s[24:27], s52 offen nt lds
  s_add_u32 s91, s91, 1
  s_and_b32 s60, s91, 3
  s_cmp_eq_u32 s60, s3
  s_cbranch_scc0 1f
  v_mov_b32 v252, s91
  s_mov_b64 exec, 1
  buffer_store_dword v252, off, s[40:43], s94 offset:256
  s_mov_b64 exec, -1
1:
  s_barrier
  buffer_load_dword v251, v254, s[40:43], s95 offen offset:256 sc1
  s_addk_i32 s97, 512
  s_add_u32 s96, s96, 30
  s_and_b32 s96, s96, 0x11f
  s_cmp_eq_u32 s96, 0
  s_cbranch_scc0 1f
  s_add_u32 s60, s97, s95
  s_mov_b32 exec_hi, 0
  buffer_store_dword v253, v254, s[40:43], s60 offen sc1
  s_mov_b32 exec_hi, -1
1:
  s_waitcnt lgkmcnt(0)
  v_mfma_f32_32x32x16_bf16 v[80:95], v[164:167], a[68:71], v[80:95]
  v_mfma_f32_32x32x16_bf16 v[96:111], v[168:171], a[68:71], v[96:111]
  v_mfma_f32_32x32x16_bf16 v[112:127], v[172:175], a[68:71], v[112:127]
  v_mfma_f32_32x32x16_bf16 v[64:79], v[160:163], a[68:71], v[64:79]
  s_cbranch_vccnz 9f
  s_waitcnt vmcnt(6)
9:
  s_waitcnt vmcnt(10)
  buffer_load_dwordx4 v5, s[24:27], s52 offen offset:2048 nt lds
  s_add_u32 m0, s53, 26624
  s_nop 0
  buffer_load_dwordx4 v18, s[36:39], s62 offen lds
  s_addk_i32 s62, 4608
  s_nop 1
  v_pk_mul_f32 v[80:81], v[80:81], v[22:23] op_sel_hi:[1,0]
  v_pk_mul_f32 v[82:83], v[82:83], v[22:23] op_sel_hi:[1,0]
  v_pk_mul_f32 v[84:85], v[84:85], v[22:23] op_sel_hi:[1,0]
  v_pk_mul_f32 v[86:87], v[86:87], v[22:23] op_sel_hi:[1,0]
  v_pk_mul_f32 v[88:89], v[88:89], v[22:23] op_sel_hi:[1,0]
  v_pk_mul_f32 v[90:91], v[90:91], v[22:23] op_sel_hi:[1,0]
  v_pk_mul_f32 v[92:93], v[92:93], v[22:23] op_sel_hi:[1,0]
  v_pk_mul_f32 v[94:95], v[94:95], v[22:23] op_sel_hi:[1,0]
  v_pk_mul_f32 v[96:97], v[96:97], v[22:23] op_sel_hi:[1,0]
  v_pk_mul_f32 v[98:99], v[98:99], v[22:23] op_sel_hi:[1,0]
  v_pk_mul_f32 v[100:101], v[100:101], v[22:23] op_sel_hi:[1,0]
  v_pk_mul_f32 v[102:103], v[102:103], v[22:23] op_sel_hi:[1,0]
  v_pk_mul_f32 v[104:105], v[104:105], v[22:23] op_sel_hi:[1,0]
  v_pk_mul_f32 v[106:107], v[106:107], v[22:23] op_sel_hi:[1,0]
  v_pk_mul_f32 v[108:109], v[108:109], v[22:23] op_sel_hi:[1,0]
  v_pk_mul_f32 v[110:111], v[110:111], v[22:23] op_sel_hi:[1,0]
  s_add_u32 m0, s53, 896
  s_cbranch_vccnz 9f
  s_waitcnt vmcnt(7)
9:
  s_waitcnt vmcnt(10)
  buffer_load_dwordx4 v5, s[24:27], s52 offen offset:128 nt lds
  s_cmp_eq_u32 s96, 1
  s_cbranch_scc0 1f
  buffer_load_dword v250, v249, s[40:43], s97 offen sc1
1:
  v_pk_mul_f32 v[112:113], v[112:113], v[22:23] op_sel_hi:[1,0]
  v_pk_mul_f32 v[114:115], v[114:115], v[22:23] op_sel_hi:[1,0]
  v_pk_mul_f32 v[116:117], v[116:117], v[22:23] op_sel_hi:[1,0]
  v_pk_mul_f32 v[118:119], v[118:119], v[22:23] op_sel_hi:[1,0]
  v_pk_mul_f32 v[120:121], v[120:121], v[22:23] op_sel_hi:[1,0]
  v_pk_mul_f32 v[122:123], v[122:123], v[22:23] op_sel_hi:[1,0]
  v_pk_mul_f32 v[124:125], v[124:125], v[22:23] op_sel_hi:[1,0]
  v_pk_mul_f32 v[126:127], v[126:127], v[22:23] op_sel_hi:[1,0]
  v_pk_mul_f32 v[64:65], v[64:65], v[22:23] op_sel_hi:[1,0]
  v_pk_mul_f32 v[66:67], v[66:67], v[22:23] op_sel_hi:[1,0]
  v_pk_mul_f32 v[68:69], v[68:69], v[22:23] op_sel_hi:[1,0]
  v_pk_mul_f32 v[70:71], v[70:71], v[22:23] op_sel_hi:[1,0]
  v_pk_mul_f32 v[72:73], v[72:73], v[22:23] op_sel_hi:[1,0]
  v_pk_mul_f32 v[74:75], v[74:75], v[22:23] op_sel_hi:[1,0]
  v_pk_mul_f32 v[76:77], v[76:77], v[22:23] op_sel_hi:[1,0]
  v_pk_mul_f32 v[78:79], v[78:79], v[22:23] op_sel_hi:[1,0]
  s_cbranch_vccnz 9f
  s_waitcnt vmcnt(6)
9:
  s_waitcnt vmcnt(10)
  buffer_load_dwordx4 v5, s[24:27], s52 offen offset:2176 nt lds
  s_xor_b32 s52, s52, 16384
  ds_read_b32 v22, v231 offset:1280
  ds_read_b64_tr_b16 v[148:149], v15 offset:16384
  ds_read_b64_tr_b16 v[150:151], v15 offset:18432
  ds_read_b64_tr_b16 v[152:153], v16 offset:16384
  ds_read_b64_tr_b16 v[154:155], v16 offset:18432
  ds_read_b64_tr_b16 v[156:157], v17 offset:16384
  ds_read_b64_tr_b16 v[158:159], v17 offset:18432
  ds_read_b64_tr_b16 v[144:145], v14 offset:16384
  ds_read_b64_tr_b16 v[146:147], v14 offset:18432
  s_add_u32 m0, s53, 4096
  s_cbranch_vccnz 9f
  s_waitcnt vmcnt(6)
9:
  s_waitcnt vmcnt(10)
  buffer_load_dwordx4 v5, s[24:27], s52 offen nt lds
  s_barrier
  s_waitcnt lgkmcnt(0)
  v_mfma_f32_32x32x16_bf16 v[80:95], v[148:151], a[72:75], v[80:95]
  v_mfma_f32_32x32x16_bf16 v[96:111], v[152:155], a[72:75], v[96:111]
  v_mfma_f32_32x32x16_bf16 v[112:127], v[156:159], a[72:75], v[112:127]
  v_mfma_f32_32x32x16_bf16 v[64:79], v[144:147], a[72:75], v[64:79]
  s_cbranch_vccnz 9f
  s_waitcnt vmcnt(6)
9:
  s_waitcnt vmcnt(10)
  buffer_load_dwordx4 v5, s[24:27], s52 offen offset:2048 nt lds
  ds_read_b64_tr_b16 v[130:131], v20 offset:4096
  ds_read_b64_tr_b16 v[134:135], v20 offset:4128
  ds_read_b64_tr_b16 v[138:139], v243 offset:4096
  ds_read_b64_tr_b16 v[142:143], v243 offset:4128
  ds_read_b64_tr_b16 v[178:179], v244 offset:4096
  ds_read_b64_tr_b16 v[182:183], v244 offset:4128
  ds_read_b64_tr_b16 v[186:187], v245 offset:4096
  ds_read_b64_tr_b16 v[190:191], v245 offset:4128
  s_add_u32 m0, s53, 27648
  s_nop 0
  buffer_load_dwordx4 v18, s[36:39], s62 offen lds
  s_add_u32 m0, s53, 4992
  s_cbranch_vccnz 9f
  s_waitcnt vmcnt(6)
9:
  s_waitcnt vmcnt(10)
  buffer_load_dwordx4 v5, s[24:27], s52 offen offset:128 nt lds
  s_waitcnt lgkmcnt(0)
  s_lshl_b32 s98, s3, 1
  s_xor_b32 s98, s98, 7
  s_mul_i32 s98, s98, 18432
  s_add_u32 s98, s98, s66
  s_add_u32 m0, s53, 28672
  s_nop 0
  buffer_load_dwordx4 v18, s[36:39], s98 offen lds
  s_addk_i32 s98, 4608
  s_add_u32 m0, s53, 4992
  s_cbranch_vccnz 9f
  s_waitcnt vmcnt(6)
9:
  s_waitcnt vmcnt(11)
  buffer_load_dwordx4 v5, s[24:27], s52 offen offset:2176 nt lds
  s_xor_b32 s52, s52, 0x14000
  ds_read_b64_tr_b16 v[164:165], v15 offset:20480
  ds_read_b64_tr_b16 v[166:167], v15 offset:22528
  ds_read_b64_tr_b16 v[168:169], v16 offset:20480
  ds_read_b64_tr_b16 v[170:171], v16 offset:22528
  ds_read_b64_tr_b16 v[172:173], v17 offset:20480
  ds_read_b64_tr_b16 v[174:175], v17 offset:22528
  ds_read_b64_tr_b16 v[160:161], v14 offset:20480
  ds_read_b64_tr_b16 v[162:163], v14 offset:22528
  s_add_u32 m0, s53, 8192
  s_cbranch_vccnz 9f
  s_waitcnt vmcnt(6)
9:
  s_waitcnt vmcnt(11)
  buffer_load_dwordx4 v5, s[24:27], s52 offen nt lds
  s_barrier
  s_waitcnt lgkmcnt(0)
  v_mfma_f32_32x32x16_bf16 v[80:95], v[164:167], a[76:79], v[80:95]
  v_mfma_f32_32x32x16_bf16 v[96:111], v[168:171], a[76:79], v[96:111]
  v_mfma_f32_32x32x16_bf16 v[112:127], v[172:175], a[76:79], v[112:127]
  v_mfma_f32_32x32x16_bf16 v[64:79], v[160:163], a[76:79], v[64:79]
  s_cbranch_vccnz 9f
  s_waitcnt vmcnt(6)
9:
  s_waitcnt vmcnt(10)
  buffer_load_dwordx4 v5, s[24:27], s52 offen offset:2048 nt lds
  v_add_u32 v248, v248, v247
  v_cmp_le_i32 s[92:93], v248, v251
  s_nop 0
  s_bcnt1_i32_b64 s60, s[92:93]
  s_cmp_ge_u32 s60, 33
  s_cselect_b64 vcc, -1, 0
  v_pk_mul_f32 v[80:81], v[80:81], v[22:23] op_sel_hi:[1,0]
  v_pk_mul_f32 v[82:83], v[82:83], v[22:23] op_sel_hi:[1,0]
  v_pk_mul_f32 v[84:85], v[84:85], v[22:23] op_sel_hi:[1,0]
  v_pk_mul_f32 v[86:87], v[86:87], v[22:23] op_sel_hi:[1,0]
  v_pk_mul_f32 v[88:89], v[88:89], v[22:23] op_sel_hi:[1,0]
  v_pk_mul_f32 v[90:91], v[90:91], v[22:23] op_sel_hi:[1,0]
  v_pk_mul_f32 v[92:93], v[92:93], v[22:23] op_sel_hi:[1,0]
  v_pk_mul_f32 v[94:95], v[94:95], v[22:23] op_sel_hi:[1,0]
  v_pk_mul_f32 v[96:97], v[96:97], v[22:23] op_sel_hi:[1,0]
  v_pk_mul_f32 v[98:99], v[98:99], v[22:23] op_sel_hi:[1,0]
  v_pk_mul_f32 v[100:101], v[100:101], v[22:23] op_sel_hi:[1,0]
  v_pk_mul_f32 v[102:103], v[102:103], v[22:23] op_sel_hi:[1,0]
  v_pk_mul_f32 v[104:105], v[104:105], v[22:23] op_sel_hi:[1,0]
  v_pk_mul_f32 v[106:107], v[106:107], v[22:23] op_sel_hi:[1,0]
  v_pk_mul_f32 v[108:109], v[108:109], v[22:23] op_sel_hi:[1,0]
  v_pk_mul_f32 v[110:111], v[110:111], v[22:23] op_sel_hi:[1,0]
  s_add_u32 m0, s53, 9088
  s_cbranch_vccnz 9f
  s_waitcnt vmcnt(6)
9:
  s_waitcnt vmcnt(9)
  buffer_load_dwordx4 v5, s[24:27], s52 offen offset:128 nt lds
  s_add_u32 m0, s53, 29696
  s_nop 0
  buffer_load_dwordx4 v18, s[36:39], s98 offen lds
  s_addk_i32 s98, 4608
  v_pk_mul_f32 v[112:113], v[112:113], v[22:23] op_sel_hi:[1,0]
  v_pk_mul_f32 v[114:115], v[114:115], v[22:23] op_sel_hi:[1,0]
  v_pk_mul_f32 v[116:117], v[116:117], v[22:23] op_sel_hi:[1,0]
  v_pk_mul_f32 v[118:119], v[118:119], v[22:23] op_sel_hi:[1,0]
  v_pk_mul_f32 v[120:121], v[120:121], v[22:23] op_sel_hi:[1,0]
  v_pk_mul_f32 v[122:123], v[122:123], v[22:23] op_sel_hi:[1,0]
  v_pk_mul_f32 v[124:125], v[124:125], v[22:23] op_sel_hi:[1,0]
  v_pk_mul_f32 v[126:127], v[126:127], v[22:23] op_sel_hi:[1,0]
  v_pk_mul_f32 v[64:65], v[64:65], v[22:23] op_sel_hi:[1,0]
  v_pk_mul_f32 v[66:67], v[66:67], v[22:23] op_sel_hi:[1,0]
  v_pk_mul_f32 v[68:69], v[68:69], v[22:23] op_sel_hi:[1,0]
  v_pk_mul_f32 v[70:71], v[70:71], v[22:23] op_sel_hi:[1,0]
  v_pk_mul_f32 v[72:73], v[72:73], v[22:23] op_sel_hi:[1,0]
  v_pk_mul_f32 v[74:75], v[74:75], v[22:23] op_sel_hi:[1,0]
  v_pk_mul_f32 v[76:77], v[76:77], v[22:23] op_sel_hi:[1,0]
  v_pk_mul_f32 v[78:79], v[78:79], v[22:23] op_sel_hi:[1,0]
  s_add_u32 m0, s53, 9088
  s_cbranch_vccnz 9f
  s_waitcnt vmcnt(6)
9:
  s_waitcnt vmcnt(10)
  buffer_load_dwordx4 v5, s[24:27], s52 offen offset:2176 nt lds
  s_xor_b32 s52, s52, 16384
  s_cmp_eq_u32 s96, 1
  s_cbranch_scc0 1f
  v_cmp_lt_i32 s[92:93], 0, v250
  s_nop 0
  s_bcnt1_i32_b32 s60, s92
  v_mov_b32 v250, s60
  s_mov_b64 exec, 1
  buffer_store_dword v250, off, s[40:43], s95 offset:512
  buffer_store_dword v250, off, s[40:43], s95 offset:768
  buffer_store_dword v250, off, s[40:43], s95 offset:1792
  s_mov_b64 exec, -1
1:
  ds_read_b32 v22, v231 offset:1408
  ds_read_b64_tr_b16 v[148:149], v15
  ds_read_b64_tr_b16 v[150:151], v15 offset:2048
  ds_read_b64_tr_b16 v[152:153], v16
  ds_read_b64_tr_b16 v[154:155], v16 offset:2048
  ds_read_b64_tr_b16 v[156:157], v17
  ds_read_b64_tr_b16 v[158:159], v17 offset:2048
  ds_read_b64_tr_b16 v[144:145], v14
  ds_read_b64_tr_b16 v[146:147], v14 offset:2048
  s_add_u32 m0, s53, 12288
  s_cbranch_vccnz 9f
  s_waitcnt vmcnt(5)
9:
  s_waitcnt vmcnt(10)
  buffer_load_dwordx4 v5, s[24:27], s52 offen nt lds
  s_barrier
  s_waitcnt lgkmcnt(0)
  v_mfma_f32_32x32x16_bf16 v[80:95], v[148:151], a[80:83], v[80:95]
  v_mfma_f32_32x32x16_bf16 v[96:111], v[152:155], a[80:83], v[96:111]
  v_mfma_f32_32x32x16_bf16 v[112:127], v[156:159], a[80:83], v[112:127]
  v_mfma_f32_32x32x16_bf16 v[64:79], v[144:147], a[80:83], v[64:79]
  s_cbranch_vccnz 9f
  s_waitcnt vmcnt(5)
9:
  s_waitcnt vmcnt(10)
  buffer_load_dwordx4 v5, s[24:27], s52 offen offset:2048 nt lds
  s_add_u32 m0, s53, 13184
  s_cbranch_vccnz 9f
  s_waitcnt vmcnt(5)
9:
  s_waitcnt vmcnt(9)
  buffer_load_dwordx4 v5, s[24:27], s52 offen offset:128 nt lds
  s_add_u32 m0, s53, 30720
  s_nop 0
  buffer_load_dwordx4 v18, s[36:39], s98 offen lds
  s_addk_i32 s98, 4608
  s_add_u32 m0, s53, 13184
  s_cbranch_vccnz 9f
  s_waitcnt vmcnt(6)
9:
  s_waitcnt vmcnt(9)
  buffer_load_dwordx4 v5, s[24:27], s52 offen offset:2176 nt lds
  s_xor_b32 s52, s52, 0xd4000
  ds_read_b64_tr_b16 v[164:165], v15 offset:4096
  ds_read_b64_tr_b16 v[166:167], v15 offset:6144
  ds_read_b64_tr_b16 v[168:169], v16 offset:4096
  ds_read_b64_tr_b16 v[170:171], v16 offset:6144
  ds_read_b64_tr_b16 v[172:173], v17 offset:4096
  ds_read_b64_tr_b16 v[174:175], v17 offset:6144
  ds_read_b64_tr_b16 v[160:161], v14 offset:4096
  ds_read_b64_tr_b16 v[162:163], v14 offset:6144
  s_add_u32 m0, s53, 16384
  s_cbranch_vccnz 9f
  s_waitcnt vmcnt(5)
9:
  s_waitcnt vmcnt(9)
  buffer_load_dwordx4 v5, s[24:27], s52 offen nt lds
  s_add_u32 s91, s91, 1
  s_and_b32 s60, s91, 3
  s_cmp_eq_u32 s60, s3
  s_cbranch_scc0 1f
  v_mov_b32 v252, s91
  s_mov_b64 exec, 1
  buffer_store_dword v252, off, s[40:43], s94 offset:1280
  s_mov_b64 exec, -1
1:
  s_barrier
  buffer_load_dword v246, v254, s[40:43], s95 offen offset:1280 sc1
  s_addk_i32 s97, 512
  s_add_u32 s96, s96, 30
  s_and_b32 s96, s96, 0x11f
  s_cmp_eq_u32 s96, 0
  s_cbranch_scc0 1f
  s_add_u32 s60, s97, s95
  s_mov_b32 exec_hi, 0
  buffer_store_dword v253, v254, s[40:43], s60 offen sc1
  s_mov_b32 exec_hi, -1
1:
  s_waitcnt lgkmcnt(0)
  v_mfma_f32_32x32x16_bf16 v[80:95], v[164:167], a[84:87], v[80:95]
  v_mfma_f32_32x32x16_bf16 v[96:111], v[168:171], a[84:87], v[96:111]
  v_mfma_f32_32x32x16_bf16 v[112:127], v[172:175], a[84:87], v[112:127]
  v_mfma_f32_32x32x16_bf16 v[64:79], v[160:163], a[84:87], v[64:79]
  s_cbranch_vccnz 9f
  s_waitcnt vmcnt(6)
9:
  s_waitcnt vmcnt(10)
  buffer_load_dwordx4 v5, s[24:27], s52 offen offset:2048 nt lds
  s_nop 5
  v_pk_mul_f32 v[80:81], v[80:81], v[22:23] op_sel_hi:[1,0]
  v_pk_mul_f32 v[82:83], v[82:83], v[22:23] op_sel_hi:[1,0]
  v_pk_mul_f32 v[84:85], v[84:85], v[22:23] op_sel_hi:[1,0]
  v_pk_mul_f32 v[86:87], v[86:87], v[22:23] op_sel_hi:[1,0]
  v_pk_mul_f32 v[88:89], v[88:89], v[22:23] op_sel_hi:[1,0]
  v_pk_mul_f32 v[90:91], v[90:91], v[22:23] op_sel_hi:[1,0]
  v_pk_mul_f32 v[92:93], v[92:93], v[22:23] op_sel_hi:[1,0]
  v_pk_mul_f32 v[94:95], v[94:95], v[22:23] op_sel_hi:[1,0]
  v_pk_mul_f32 v[96:97], v[96:97], v[22:23] op_sel_hi:[1,0]
  v_pk_mul_f32 v[98:99], v[98:99], v[22:23] op_sel_hi:[1,0]
  v_pk_mul_f32 v[100:101], v[100:101], v[22:23] op_sel_hi:[1,0]
  v_pk_mul_f32 v[102:103], v[102:103], v[22:23] op_sel_hi:[1,0]
  v_pk_mul_f32 v[104:105], v[104:105], v[22:23] op_sel_hi:[1,0]
  v_pk_mul_f32 v[106:107], v[106:107], v[22:23] op_sel_hi:[1,0]
  v_pk_mul_f32 v[108:109], v[108:109], v[22:23] op_sel_hi:[1,0]
  v_pk_mul_f32 v[110:111], v[110:111], v[22:23] op_sel_hi:[1,0]
  s_add_u32 m0, s53, 17280
  s_cbranch_vccnz 9f
  s_waitcnt vmcnt(6)
9:
  s_waitcnt vmcnt(10)
  buffer_load_dwordx4 v5, s[24:27], s52 offen offset:128 nt lds
  s_cmp_eq_u32 s96, 1
  s_cbranch_scc0 1f
  buffer_load_dword v250, v249, s[40:43], s97 offen sc1
1:
  ds_read_b64_tr_b16 a[32:33], v20
  ds_read_b64_tr_b16 a[36:37], v20 offset:32
  ds_read_b64_tr_b16 a[40:41], v243
  ds_read_b64_tr_b16 a[44:45], v243 offset:32
  ds_read_b64_tr_b16 a[48:49], v244
  ds_read_b64_tr_b16 a[52:53], v244 offset:32
  ds_read_b64_tr_b16 a[56:57], v245
  ds_read_b64_tr_b16 a[60:61], v245 offset:32
  s_add_u32 m0, s53, 31744
  s_nop 0
  buffer_load_dwordx4 v18, s[36:39], s98 offen lds
  v_pk_mul_f32 v[112:113], v[112:113], v[22:23] op_sel_hi:[1,0]
  v_pk_mul_f32 v[114:115], v[114:115], v[22:23] op_sel_hi:[1,0]
  v_pk_mul_f32 v[116:117], v[116:117], v[22:23] op_sel_hi:[1,0]
  v_pk_mul_f32 v[118:119], v[118:119], v[22:23] op_sel_hi:[1,0]
  v_pk_mul_f32 v[120:121], v[120:121], v[22:23] op_sel_hi:[1,0]
  v_pk_mul_f32 v[122:123], v[122:123], v[22:23] op_sel_hi:[1,0]
  v_pk_mul_f32 v[124:125], v[124:125], v[22:23] op_sel_hi:[1,0]
  v_pk_mul_f32 v[126:127], v[126:127], v[22:23] op_sel_hi:[1,0]
  v_pk_mul_f32 v[64:65], v[64:65], v[22:23] op_sel_hi:[1,0]
  v_pk_mul_f32 v[66:67], v[66:67], v[22:23] op_sel_hi:[1,0]
  v_pk_mul_f32 v[68:69], v[68:69], v[22:23] op_sel_hi:[1,0]
  v_pk_mul_f32 v[70:71], v[70:71], v[22:23] op_sel_hi:[1,0]
  v_pk_mul_f32 v[72:73], v[72:73], v[22:23] op_sel_hi:[1,0]
  v_pk_mul_f32 v[74:75], v[74:75], v[22:23] op_sel_hi:[1,0]
  v_pk_mul_f32 v[76:77], v[76:77], v[22:23] op_sel_hi:[1,0]
  v_pk_mul_f32 v[78:79], v[78:79], v[22:23] op_sel_hi:[1,0]
  s_add_u32 m0, s53, 17280
  s_cbranch_vccnz 9f
  s_waitcnt vmcnt(7)
9:
  s_waitcnt vmcnt(10)
  buffer_load_dwordx4 v5, s[24:27], s52 offen offset:2176 nt lds
  s_xor_b32 s52, s52, 16384
  s_waitcnt lgkmcnt(0)
  s_lshl_b32 s62, s3, 1
  s_xor_b32 s62, s62, 8
  s_mul_i32 s62, s62, 18432
  s_add_u32 s62, s62, s66
  s_add_u32 m0, s53, 24576
  s_nop 0
  buffer_load_dwordx4 v18, s[36:39], s62 offen lds
  s_addk_i32 s62, 4608
  ds_read_b32 v22, v231 offset:1536
  ds_read_b64_tr_b16 v[148:149], v15 offset:8192
  ds_read_b64_tr_b16 v[150:151], v15 offset:10240
  ds_read_b64_tr_b16 v[152:153], v16 offset:8192
  ds_read_b64_tr_b16 v[154:155], v16 offset:10240
  ds_read_b64_tr_b16 v[156:157], v17 offset:8192
  ds_read_b64_tr_b16 v[158:159], v17 offset:10240
  ds_read_b64_tr_b16 v[144:145], v14 offset:8192
  ds_read_b64_tr_b16 v[146:147], v14 offset:10240
  s_add_u32 m0, s53, 20480
  s_cbranch_vccnz 9f
  s_waitcnt vmcnt(7)
9:
  s_waitcnt vmcnt(11)
  buffer_load_dwordx4 v5, s[24:27], s52 offen nt lds
  s_barrier
  s_waitcnt lgkmcnt(0)
  v_mfma_f32_32x32x16_bf16 v[80:95], v[148:151], a[88:91], v[80:95]
  v_mfma_f32_32x32x16_bf16 v[96:111], v[152:155], a[88:91], v[96:111]
  v_mfma_f32_32x32x16_bf16 v[112:127], v[156:159], a[88:91], v[112:127]
  v_mfma_f32_32x32x16_bf16 v[64:79], v[144:147], a[88:91], v[64:79]
  s_cbranch_vccnz 9f
  s_waitcnt vmcnt(7)
9:
  s_waitcnt vmcnt(11)
  buffer_load_dwordx4 v5, s[24:27], s52 offen offset:2048 nt lds
  s_add_u32 m0, s53, 21376
  s_cbranch_vccnz 9f
  s_waitcnt vmcnt(6)
9:
  s_waitcnt vmcnt(11)
  buffer_load_dwordx4 v5, s[24:27], s52 offen offset:128 nt lds
  s_cbranch_vccnz 9f
  s_waitcnt vmcnt(6)
9:
  s_waitcnt vmcnt(10)
  buffer_load_dwordx4 v5, s[24:27], s52 offen offset:2176 nt lds
  s_xor_b32 s52, s52, 0x14000
  s_add_u32 m0, s53, 25600
  s_nop 0
  buffer_load_dwordx4 v18, s[36:39], s62 offen lds
  s_addk_i32 s62, 4608
  ds_read_b64_tr_b16 v[164:165], v15 offset:12288
  ds_read_b64_tr_b16 v[166:167], v15 offset:14336
  ds_read_b64_tr_b16 v[168:169], v16 offset:12288
  ds_read_b64_tr_b16 v[170:171], v16 offset:14336
  ds_read_b64_tr_b16 v[172:173], v17 offset:12288
  ds_read_b64_tr_b16 v[174:175], v17 offset:14336
  ds_read_b64_tr_b16 v[160:161], v14 offset:12288
  ds_read_b64_tr_b16 v[162:163], v14 offset:14336
  s_mov_b32 m0, s53
  s_cbranch_vccnz 9f
  s_waitcnt vmcnt(6)
9:
  s_waitcnt vmcnt(11)
  buffer_load_dwordx4 v5, s[24:27], s52 offen nt lds
  s_barrier
  s_waitcnt lgkmcnt(0)
  v_mfma_f32_32x32x16_bf16 v[80:95], v[164:167], a[92:95], v[80:95]
  v_mfma_f32_32x32x16_bf16 v[96:111], v[168:171], a[92:95], v[96:111]
  v_mfma_f32_32x32x16_bf16 v[112:127], v[172:175], a[92:95], v[112:127]
  v_mfma_f32_32x32x16_bf16 v[64:79], v[160:163], a[92:95], v[64:79]
  s_cbranch_vccnz 9f
  s_waitcnt vmcnt(5)
9:
  s_waitcnt vmcnt(10)
  buffer_load_dwordx4 v5, s[24:27], s52 offen offset:2048 nt lds
  v_add_u32 v248, v248, v247
  v_cmp_le_i32 s[92:93], v248, v246
  s_nop 0
  s_bcnt1_i32_b64 s60, s[92:93]
  s_cmp_ge_u32 s60, 33
  s_cselect_b64 vcc, -1, 0
  v_pk_mul_f32 v[80:81], v[80:81], v[22:23] op_sel_hi:[1,0]
  v_pk_mul_f32 v[82:83], v[82:83], v[22:23] op_sel_hi:[1,0]
  v_pk_mul_f32 v[84:85], v[84:85], v[22:23] op_sel_hi:[1,0]
  v_pk_mul_f32 v[86:87], v[86:87], v[22:23] op_sel_hi:[1,0]
  v_pk_mul_f32 v[88:89], v[88:89], v[22:23] op_sel_hi:[1,0]
  v_pk_mul_f32 v[90:91], v[90:91], v[22:23] op_sel_hi:[1,0]
  v_pk_mul_f32 v[92:93], v[92:93], v[22:23] op_sel_hi:[1,0]
  v_pk_mul_f32 v[94:95], v[94:95], v[22:23] op_sel_hi:[1,0]
  v_pk_mul_f32 v[96:97], v[96:97], v[22:23] op_sel_hi:[1,0]
  v_pk_mul_f32 v[98:99], v[98:99], v[22:23] op_sel_hi:[1,0]
  v_pk_mul_f32 v[100:101], v[100:101], v[22:23] op_sel_hi:[1,0]
  v_pk_mul_f32 v[102:103], v[102:103], v[22:23] op_sel_hi:[1,0]
  v_pk_mul_f32 v[104:105], v[104:105], v[22:23] op_sel_hi:[1,0]
  v_pk_mul_f32 v[106:107], v[106:107], v[22:23] op_sel_hi:[1,0]
  v_pk_mul_f32 v[108:109], v[108:109], v[22:23] op_sel_hi:[1,0]
  v_pk_mul_f32 v[110:111], v[110:111], v[22:23] op_sel_hi:[1,0]
  s_add_u32 m0, s53, 896
  s_cbranch_vccnz 9f
  s_waitcnt vmcnt(5)
9:
  s_waitcnt vmcnt(10)
  buffer_load_dwordx4 v5, s[24:27], s52 offen offset:128 nt lds
  v_pk_mul_f32 v[112:113], v[112:113], v[22:23] op_sel_hi:[1,0]
  v_pk_mul_f32 v[114:115], v[114:115], v[22:23] op_sel_hi:[1,0]
  v_pk_mul_f32 v[116:117], v[116:117], v[22:23] op_sel_hi:[1,0]
  v_pk_mul_f32 v[118:119], v[118:119], v[22:23] op_sel_hi:[1,0]
  v_pk_mul_f32 v[120:121], v[120:121], v[22:23] op_sel_hi:[1,0]
  v_pk_mul_f32 v[122:123], v[122:123], v[22:23] op_sel_hi:[1,0]
  v_pk_mul_f32 v[124:125], v[124:125], v[22:23] op_sel_hi:[1,0]
  v_pk_mul_f32 v[126:127], v[126:127], v[22:23] op_sel_hi:[1,0]
  v_pk_mul_f32 v[64:65], v[64:65], v[22:23] op_sel_hi:[1,0]
  v_pk_mul_f32 v[66:67], v[66:67], v[22:23] op_sel_hi:[1,0]
  v_pk_mul_f32 v[68:69], v[68:69], v[22:23] op_sel_hi:[1,0]
  v_pk_mul_f32 v[70:71], v[70:71], v[22:23] op_sel_hi:[1,0]
  v_pk_mul_f32 v[72:73], v[72:73], v[22:23] op_sel_hi:[1,0]
  v_pk_mul_f32 v[74:75], v[74:75], v[22:23] op_sel_hi:[1,0]
  v_pk_mul_f32 v[76:77], v[76:77], v[22:23] op_sel_hi:[1,0]
  v_pk_mul_f32 v[78:79], v[78:79], v[22:23] op_sel_hi:[1,0]
  s_cbranch_vccnz 9f
  s_waitcnt vmcnt(5)
9:
  s_waitcnt vmcnt(9)
  buffer_load_dwordx4 v5, s[24:27], s52 offen offset:2176 nt lds
  s_xor_b32 s52, s52, 16384
  s_cmp_eq_u32 s96, 1
  s_cbranch_scc0 1f
  v_cmp_lt_i32 s[92:93], 0, v250
  s_nop 0
  s_bcnt1_i32_b32 s60, s92
  v_mov_b32 v250, s60
  s_mov_b64 exec, 1
  buffer_store_dword v250, off, s[40:43], s95 offset:512
  buffer_store_dword v250, off, s[40:43], s95 offset:768
  buffer_store_dword v250, off, s[40:43], s95 offset:1792
  s_mov_b64 exec, -1
1:
  s_add_u32 m0, s53, 26624
  s_nop 0
  buffer_load_dwordx4 v18, s[36:39], s62 offen lds
  s_addk_i32 s62, 4608
  ds_read_b32 v22, v231 offset:1664
  ds_read_b64_tr_b16 v[148:149], v15 offset:16384
  ds_read_b64_tr_b16 v[150:151], v15 offset:18432
  ds_read_b64_tr_b16 v[152:153], v16 offset:16384
  ds_read_b64_tr_b16 v[154:155], v16 offset:18432
  ds_read_b64_tr_b16 v[156:157], v17 offset:16384
  ds_read_b64_tr_b16 v[158:159], v17 offset:18432
  ds_read_b64_tr_b16 v[144:145], v14 offset:16384
  ds_read_b64_tr_b16 v[146:147], v14 offset:18432
  s_add_u32 m0, s53, 4096
  s_cbranch_vccnz 9f
  s_waitcnt vmcnt(6)
9:
  s_waitcnt vmcnt(9)
  buffer_load_dwordx4 v5, s[24:27], s52 offen nt lds
  s_barrier
  s_waitcnt lgkmcnt(0)
  v_mfma_f32_32x32x16_bf16 v[80:95], v[148:151], a[96:99], v[80:95]
  v_mfma_f32_32x32x16_bf16 v[96:111], v[152:155], a[96:99], v[96:111]
  v_mfma_f32_32x32x16_bf16 v[112:127], v[156:159], a[96:99], v[112:127]
  v_mfma_f32_32x32x16_bf16 v[64:79], v[144:147], a[96:99], v[64:79]
  s_cbranch_vccnz 9f
  s_waitcnt vmcnt(5)
9:
  s_waitcnt vmcnt(9)
  buffer_load_dwordx4 v5, s[24:27], s52 offen offset:2048 nt lds
  s_add_u32 m0, s53, 4992
  s_cbranch_vccnz 9f
  s_waitcnt vmcnt(5)
9:
  s_waitcnt vmcnt(9)
  buffer_load_dwordx4 v5, s[24:27], s52 offen offset:128 nt lds
  s_cbranch_vccnz 9f
  s_waitcnt vmcnt(5)
9:
  s_waitcnt vmcnt(9)
  buffer_load_dwordx4 v5, s[24:27], s52 offen offset:2176 nt lds
  s_xor_b32 s52, s52, 0x54000
  ds_read_b64_tr_b16 a[34:35], v20 offset:4096
  ds_read_b64_tr_b16 a[38:39], v20 offset:4128
  ds_read_b64_tr_b16 a[42:43], v243 offset:4096
  ds_read_b64_tr_b16 a[46:47], v243 offset:4128
  ds_read_b64_tr_b16 a[50:51], v244 offset:4096
  ds_read_b64_tr_b16 a[54:55], v244 offset:4128
  ds_read_b64_tr_b16 a[58:59], v245 offset:4096
  ds_read_b64_tr_b16 a[62:63], v245 offset:4128
  s_add_u32 m0, s53, 27648
  s_nop 0
  buffer_load_dwordx4 v18, s[36:39], s62 offen lds
  ds_read_b64_tr_b16 v[164:165], v15 offset:20480
  ds_read_b64_tr_b16 v[166:167], v15 offset:22528
  ds_read_b64_tr_b16 v[168:169], v16 offset:20480
  ds_read_b64_tr_b16 v[170:171], v16 offset:22528
  ds_read_b64_tr_b16 v[172:173], v17 offset:20480
  ds_read_b64_tr_b16 v[174:175], v17 offset:22528
  ds_read_b64_tr_b16 v[160:161], v14 offset:20480
  s_waitcnt lgkmcnt(14)
  ds_read_b64_tr_b16 v[162:163], v14 offset:22528
  s_add_u32 m0, s53, 8192
  s_cbranch_vccnz 9f
  s_waitcnt vmcnt(6)
9:
  s_waitcnt vmcnt(9)
  buffer_load_dwordx4 v5, s[24:27], s52 offen nt lds
  s_add_u32 s91, s91, 1
  s_and_b32 s60, s91, 3
  s_cmp_eq_u32 s60, s3
  s_cbranch_scc0 1f
  v_mov_b32 v252, s91
  s_mov_b64 exec, 1
  buffer_store_dword v252, off, s[40:43], s94
  s_mov_b64 exec, -1
1:
  s_barrier
  buffer_load_dword v255, v254, s[40:43], s95 offen sc1
  s_addk_i32 s97, 512
  s_add_u32 s96, s96, 30
  s_and_b32 s96, s96, 0x11f
  s_cmp_eq_u32 s96, 0
  s_cbranch_scc0 1f
  s_add_u32 s60, s97, s95
  s_mov_b32 exec_hi, 0
  buffer_store_dword v253, v254, s[40:43], s60 offen sc1
  s_mov_b32 exec_hi, -1
1:
  s_waitcnt lgkmcnt(8)
  s_lshl_b32 s98, s3, 1
  s_xor_b32 s98, s98, 9
  s_mul_i32 s98, s98, 18432
  s_add_u32 s98, s98, s66
  s_add_u32 m0, s53, 28672
  s_nop 0
  buffer_load_dwordx4 v18, s[36:39], s98 offen lds
  s_addk_i32 s98, 4608
  s_waitcnt lgkmcnt(0)
  v_mfma_f32_32x32x16_bf16 v[80:95], v[164:167], a[100:103], v[80:95]
  v_mfma_f32_32x32x16_bf16 v[96:111], v[168:171], a[100:103], v[96:111]
  v_mfma_f32_32x32x16_bf16 v[112:127], v[172:175], a[100:103], v[112:127]
  v_mfma_f32_32x32x16_bf16 v[64:79], v[160:163], a[100:103], v[64:79]
  s_add_u32 m0, s53, 8192
  s_cbranch_vccnz 9f
  s_waitcnt vmcnt(7)
9:
  s_waitcnt vmcnt(11)
  buffer_load_dwordx4 v5, s[24:27], s52 offen offset:2048 nt lds
  s_nop 4
  v_pk_mul_f32 v[80:81], v[80:81], v[22:23] op_sel_hi:[1,0]
  v_pk_mul_f32 v[82:83], v[82:83], v[22:23] op_sel_hi:[1,0]
  v_pk_mul_f32 v[84:85], v[84:85], v[22:23] op_sel_hi:[1,0]
  v_pk_mul_f32 v[86:87], v[86:87], v[22:23] op_sel_hi:[1,0]
  v_pk_mul_f32 v[88:89], v[88:89], v[22:23] op_sel_hi:[1,0]
  v_pk_mul_f32 v[90:91], v[90:91], v[22:23] op_sel_hi:[1,0]
  v_pk_mul_f32 v[92:93], v[92:93], v[22:23] op_sel_hi:[1,0]
  v_pk_mul_f32 v[94:95], v[94:95], v[22:23] op_sel_hi:[1,0]
  v_pk_mul_f32 v[96:97], v[96:97], v[22:23] op_sel_hi:[1,0]
  v_pk_mul_f32 v[98:99], v[98:99], v[22:23] op_sel_hi:[1,0]
  v_pk_mul_f32 v[100:101], v[100:101], v[22:23] op_sel_hi:[1,0]
  v_pk_mul_f32 v[102:103], v[102:103], v[22:23] op_sel_hi:[1,0]
  v_pk_mul_f32 v[104:105], v[104:105], v[22:23] op_sel_hi:[1,0]
  v_pk_mul_f32 v[106:107], v[106:107], v[22:23] op_sel_hi:[1,0]
  v_pk_mul_f32 v[108:109], v[108:109], v[22:23] op_sel_hi:[1,0]
  v_pk_mul_f32 v[110:111], v[110:111], v[22:23] op_sel_hi:[1,0]
  s_add_u32 m0, s53, 9088
  s_cbranch_vccnz 9f
  s_waitcnt vmcnt(7)
9:
  s_waitcnt vmcnt(11)
  buffer_load_dwordx4 v5, s[24:27], s52 offen offset:128 nt lds
  s_cmp_eq_u32 s96, 1
  s_cbranch_scc0 1f
  buffer_load_dword v250, v249, s[40:43], s97 offen sc1
1:
  v_pk_mul_f32 v[112:113], v[112:113], v[22:23] op_sel_hi:[1,0]
  v_pk_mul_f32 v[114:115], v[114:115], v[22:23] op_sel_hi:[1,0]
  v_pk_mul_f32 v[116:117], v[116:117], v[22:23] op_sel_hi:[1,0]
  v_pk_mul_f32 v[118:119], v[118:119], v[22:23] op_sel_hi:[1,0]
  v_pk_mul_f32 v[120:121], v[120:121], v[22:23] op_sel_hi:[1,0]
  v_pk_mul_f32 v[122:123], v[122:123], v[22:23] op_sel_hi:[1,0]
  v_pk_mul_f32 v[124:125], v[124:125], v[22:23] op_sel_hi:[1,0]
  v_pk_mul_f32 v[126:127], v[126:127], v[22:23] op_sel_hi:[1,0]
  v_pk_mul_f32 v[64:65], v[64:65], v[22:23] op_sel_hi:[1,0]
  v_pk_mul_f32 v[66:67], v[66:67], v[22:23] op_sel_hi:[1,0]
  v_pk_mul_f32 v[68:69], v[68:69], v[22:23] op_sel_hi:[1,0]
  v_pk_mul_f32 v[70:71], v[70:71], v[22:23] op_sel_hi:[1,0]
  v_pk_mul_f32 v[72:73], v[72:73], v[22:23] op_sel_hi:[1,0]
  v_pk_mul_f32 v[74:75], v[74:75], v[22:23] op_sel_hi:[1,0]
  v_pk_mul_f32 v[76:77], v[76:77], v[22:23] op_sel_hi:[1,0]
  v_pk_mul_f32 v[78:79], v[78:79], v[22:23] op_sel_hi:[1,0]
  s_cbranch_vccnz 9f
  s_waitcnt vmcnt(7)
9:
  s_waitcnt vmcnt(11)
  buffer_load_dwordx4 v5, s[24:27], s52 offen offset:2176 nt lds
  s_xor_b32 s52, s52, 16384
  ds_read_b32 v22, v231 offset:1792
  ds_read_b64_tr_b16 v[148:149], v15
  ds_read_b64_tr_b16 v[150:151], v15 offset:2048
  ds_read_b64_tr_b16 v[152:153], v16
  ds_read_b64_tr_b16 v[154:155], v16 offset:2048
  ds_read_b64_tr_b16 v[156:157], v17
  ds_read_b64_tr_b16 v[158:159], v17 offset:2048
  ds_read_b64_tr_b16 v[144:145], v14
  ds_read_b64_tr_b16 v[146:147], v14 offset:2048
  s_add_u32 m0, s53, 12288
  s_cbranch_vccnz 9f
  s_waitcnt vmcnt(7)
9:
  s_waitcnt vmcnt(10)
  buffer_load_dwordx4 v5, s[24:27], s52 offen nt lds
  s_barrier
  s_add_u32 m0, s53, 29696
  s_nop 0
  buffer_load_dwordx4 v18, s[36:39], s98 offen lds
  s_addk_i32 s98, 4608
  s_waitcnt lgkmcnt(0)
  v_mfma_f32_32x32x16_bf16 v[80:95], v[148:151], a[104:107], v[80:95]
  v_mfma_f32_32x32x16_bf16 v[96:111], v[152:155], a[104:107], v[96:111]
  v_mfma_f32_32x32x16_bf16 v[112:127], v[156:159], a[104:107], v[112:127]
  v_mfma_f32_32x32x16_bf16 v[64:79], v[144:147], a[104:107], v[64:79]
  s_add_u32 m0, s53, 12288
  s_cbranch_vccnz 9f
  s_waitcnt vmcnt(7)
9:
  s_waitcnt vmcnt(11)
  buffer_load_dwordx4 v5, s[24:27], s52 offen offset:2048 nt lds
  s_add_u32 m0, s53, 13184
  s_cbranch_vccnz 9f
  s_waitcnt vmcnt(5)
9:
  s_waitcnt vmcnt(11)
  buffer_load_dwordx4 v5, s[24:27], s52 offen offset:128 nt lds
  s_cbranch_vccnz 9f
  s_waitcnt vmcnt(5)
9:
  s_waitcnt vmcnt(11)
  buffer_load_dwordx4 v5, s[24:27], s52 offen offset:2176 nt lds
  s_xor_b32 s52, s52, 0x14000
  ds_read_b64_tr_b16 v[164:165], v15 offset:4096
  ds_read_b64_tr_b16 v[166:167], v15 offset:6144
  ds_read_b64_tr_b16 v[168:169], v16 offset:4096
  ds_read_b64_tr_b16 v[170:171], v16 offset:6144
  ds_read_b64_tr_b16 v[172:173], v17 offset:4096
  ds_read_b64_tr_b16 v[174:175], v17 offset:6144
  ds_read_b64_tr_b16 v[160:161], v14 offset:4096
  ds_read_b64_tr_b16 v[162:163], v14 offset:6144
  s_add_u32 m0, s53, 16384
  s_cbranch_vccnz 9f
  s_waitcnt vmcnt(5)
9:
  s_waitcnt vmcnt(10)
  buffer_load_dwordx4 v5, s[24:27], s52 offen nt lds
  s_barrier
  s_add_u32 m0, s53, 30720
  s_nop 0
  buffer_load_dwordx4 v18, s[36:39], s98 offen lds
  s_addk_i32 s98, 4608
  s_waitcnt lgkmcnt(0)
  v_mfma_f32_32x32x16_bf16 v[80:95], v[164:167], a[108:111], v[80:95]
  v_mfma_f32_32x32x16_bf16 v[96:111], v[168:171], a[108:111], v[96:111]
  v_mfma_f32_32x32x16_bf16 v[112:127], v[172:175], a[108:111], v[112:127]
  v_mfma_f32_32x32x16_bf16 v[64:79], v[160:163], a[108:111], v[64:79]
  s_add_u32 m0, s53, 16384
  s_cbranch_vccnz 9f
  s_waitcnt vmcnt(6)
9:
  s_waitcnt vmcnt(9)
  buffer_load_dwordx4 v5, s[24:27], s52 offen offset:2048 nt lds
  v_add_u32 v248, v248, v247
  v_cmp_le_i32 s[92:93], v248, v255
  s_nop 0
  s_bcnt1_i32_b64 s60, s[92:93]
  s_cmp_ge_u32 s60, 33
  s_cselect_b64 vcc, -1, 0
  v_pk_mul_f32 v[80:81], v[80:81], v[22:23] op_sel_hi:[1,0]
  v_pk_mul_f32 v[82:83], v[82:83], v[22:23] op_sel_hi:[1,0]
  v_pk_mul_f32 v[84:85], v[84:85], v[22:23] op_sel_hi:[1,0]
  v_pk_mul_f32 v[86:87], v[86:87], v[22:23] op_sel_hi:[1,0]
  v_pk_mul_f32 v[88:89], v[88:89], v[22:23] op_sel_hi:[1,0]
  v_pk_mul_f32 v[90:91], v[90:91], v[22:23] op_sel_hi:[1,0]
  v_pk_mul_f32 v[92:93], v[92:93], v[22:23] op_sel_hi:[1,0]
  v_pk_mul_f32 v[94:95], v[94:95], v[22:23] op_sel_hi:[1,0]
  v_pk_mul_f32 v[96:97], v[96:97], v[22:23] op_sel_hi:[1,0]
  v_pk_mul_f32 v[98:99], v[98:99], v[22:23] op_sel_hi:[1,0]
  v_pk_mul_f32 v[100:101], v[100:101], v[22:23] op_sel_hi:[1,0]
  v_pk_mul_f32 v[102:103], v[102:103], v[22:23] op_sel_hi:[1,0]
  v_pk_mul_f32 v[104:105], v[104:105], v[22:23] op_sel_hi:[1,0]
  v_pk_mul_f32 v[106:107], v[106:107], v[22:23] op_sel_hi:[1,0]
  v_pk_mul_f32 v[108:109], v[108:109], v[22:23] op_sel_hi:[1,0]
  v_pk_mul_f32 v[110:111], v[110:111], v[22:23] op_sel_hi:[1,0]
  s_add_u32 m0, s53, 17280
  s_cbranch_vccnz 9f
  s_waitcnt vmcnt(5)
9:
  s_waitcnt vmcnt(9)
  buffer_load_dwordx4 v5, s[24:27], s52 offen offset:128 nt lds
  v_pk_mul_f32 v[112:113], v[112:113], v[22:23] op_sel_hi:[1,0]
  v_pk_mul_f32 v[114:115], v[114:115], v[22:23] op_sel_hi:[1,0]
  v_pk_mul_f32 v[116:117], v[116:117], v[22:23] op_sel_hi:[1,0]
  v_pk_mul_f32 v[118:119], v[118:119], v[22:23] op_sel_hi:[1,0]
  v_pk_mul_f32 v[120:121], v[120:121], v[22:23] op_sel_hi:[1,0]
  v_pk_mul_f32 v[122:123], v[122:123], v[22:23] op_sel_hi:[1,0]
  v_pk_mul_f32 v[124:125], v[124:125], v[22:23] op_sel_hi:[1,0]
  v_pk_mul_f32 v[126:127], v[126:127], v[22:23] op_sel_hi:[1,0]
  v_pk_mul_f32 v[64:65], v[64:65], v[22:23] op_sel_hi:[1,0]
  v_pk_mul_f32 v[66:67], v[66:67], v[22:23] op_sel_hi:[1,0]
  v_pk_mul_f32 v[68:69], v[68:69], v[22:23] op_sel_hi:[1,0]
  v_pk_mul_f32 v[70:71], v[70:71], v[22:23] op_sel_hi:[1,0]
  v_pk_mul_f32 v[72:73], v[72:73], v[22:23] op_sel_hi:[1,0]
  v_pk_mul_f32 v[74:75], v[74:75], v[22:23] op_sel_hi:[1,0]
  v_pk_mul_f32 v[76:77], v[76:77], v[22:23] op_sel_hi:[1,0]
  v_pk_mul_f32 v[78:79], v[78:79], v[22:23] op_sel_hi:[1,0]
  s_cbranch_vccnz 9f
  s_waitcnt vmcnt(5)
9:
  s_waitcnt vmcnt(9)
  buffer_load_dwordx4 v5, s[24:27], s52 offen offset:2176 nt lds
  s_xor_b32 s52, s52, 16384
  s_cmp_eq_u32 s96, 1
  s_cbranch_scc0 1f
  v_cmp_lt_i32 s[92:93], 0, v250
  s_nop 0
  s_bcnt1_i32_b32 s60, s92
  v_mov_b32 v250, s60
  s_mov_b64 exec, 1
  buffer_store_dword v250, off, s[40:43], s95 offset:512
  buffer_store_dword v250, off, s[40:43], s95 offset:768
  buffer_store_dword v250, off, s[40:43], s95 offset:1792
  s_mov_b64 exec, -1
1:
  ds_read_b32 v22, v231 offset:1920
  ds_read_b64_tr_b16 v[148:149], v15 offset:8192
  ds_read_b64_tr_b16 v[150:151], v15 offset:10240
  ds_read_b64_tr_b16 v[152:153], v16 offset:8192
  ds_read_b64_tr_b16 v[154:155], v16 offset:10240
  ds_read_b64_tr_b16 v[156:157], v17 offset:8192
  ds_read_b64_tr_b16 v[158:159], v17 offset:10240
  ds_read_b64_tr_b16 v[144:145], v14 offset:8192
  ds_read_b64_tr_b16 v[146:147], v14 offset:10240
  s_add_u32 m0, s53, 20480
  s_cbranch_vccnz 9f
  s_waitcnt vmcnt(5)
9:
  s_waitcnt vmcnt(9)
  buffer_load_dwordx4 v5, s[24:27], s52 offen nt lds
  s_barrier
  ds_read_b64_tr_b16 a[64:65], v20
  ds_read_b64_tr_b16 a[68:69], v20 offset:32
  ds_read_b64_tr_b16 a[72:73], v243
  ds_read_b64_tr_b16 a[76:77], v243 offset:32
  ds_read_b64_tr_b16 a[80:81], v244
  ds_read_b64_tr_b16 a[84:85], v244 offset:32
  s_waitcnt lgkmcnt(14)
  ds_read_b64_tr_b16 a[88:89], v245
  s_waitcnt lgkmcnt(14)
  ds_read_b64_tr_b16 a[92:93], v245 offset:32
  s_add_u32 m0, s53, 31744
  s_nop 0
  buffer_load_dwordx4 v18, s[36:39], s98 offen lds
  s_waitcnt lgkmcnt(8)
  v_mfma_f32_32x32x16_bf16 v[80:95], v[148:151], a[112:115], v[80:95]
  v_mfma_f32_32x32x16_bf16 v[96:111], v[152:155], a[112:115], v[96:111]
  v_mfma_f32_32x32x16_bf16 v[112:127], v[156:159], a[112:115], v[112:127]
  v_mfma_f32_32x32x16_bf16 v[64:79], v[144:147], a[112:115], v[64:79]
  s_add_u32 m0, s53, 20480
  s_cbranch_vccnz 9f
  s_waitcnt vmcnt(6)
9:
  s_waitcnt vmcnt(9)
  buffer_load_dwordx4 v5, s[24:27], s52 offen offset:2048 nt lds
  s_waitcnt lgkmcnt(0)
  s_lshl_b32 s62, s3, 1
  s_xor_b32 s62, s62, 10
  s_mul_i32 s62, s62, 18432
  s_add_u32 s62, s62, s66
  s_add_u32 m0, s53, 24576
  s_nop 0
  buffer_load_dwordx4 v18, s[36:39], s62 offen lds
  s_addk_i32 s62, 4608
  s_add_u32 m0, s53, 21376
  s_cbranch_vccnz 9f
  s_waitcnt vmcnt(6)
9:
  s_waitcnt vmcnt(10)
  buffer_load_dwordx4 v5, s[24:27], s52 offen offset:128 nt lds
  s_cbranch_vccnz 9f
  s_waitcnt vmcnt(6)
9:
  s_waitcnt vmcnt(10)
  buffer_load_dwordx4 v5, s[24:27], s52 offen offset:2176 nt lds
  s_xor_b32 s52, s52, 0x1f4000
  ds_read_b64_tr_b16 v[164:165], v15 offset:12288
  ds_read_b64_tr_b16 v[166:167], v15 offset:14336
  ds_read_b64_tr_b16 v[168:169], v16 offset:12288
  ds_read_b64_tr_b16 v[170:171], v16 offset:14336
  ds_read_b64_tr_b16 v[172:173], v17 offset:12288
  ds_read_b64_tr_b16 v[174:175], v17 offset:14336
  ds_read_b64_tr_b16 v[160:161], v14 offset:12288
  ds_read_b64_tr_b16 v[162:163], v14 offset:14336
  s_mov_b32 m0, s53
  s_cbranch_vccnz 9f
  s_waitcnt vmcnt(6)
9:
  s_waitcnt vmcnt(10)
  buffer_load_dwordx4 v5, s[24:27], s52 offen nt lds
  s_add_u32 s91, s91, 1
  s_and_b32 s60, s91, 3
  s_cmp_eq_u32 s60, s3
  s_cbranch_scc0 1f
  v_mov_b32 v252, s91
  s_mov_b64 exec, 1
  buffer_store_dword v252, off, s[40:43], s94 offset:256
  s_mov_b64 exec, -1
1:
  s_barrier
  buffer_load_dword v251, v254, s[40:43], s95 offen offset:256 sc1
  s_addk_i32 s97, 512
  s_add_u32 s96, s96, 30
  s_and_b32 s96, s96, 0x11f
  s_cmp_eq_u32 s96, 0
  s_cbranch_scc0 1f
  s_add_u32 s60, s97, s95
  s_mov_b32 exec_hi, 0
  buffer_store_dword v253, v254, s[40:43], s60 offen sc1
  s_mov_b32 exec_hi, -1
1:
  s_waitcnt lgkmcnt(0)
  v_mfma_f32_32x32x16_bf16 v[80:95], v[164:167], a[116:119], v[80:95]
  v_mfma_f32_32x32x16_bf16 v[96:111], v[168:171], a[116:119], v[96:111]
  v_mfma_f32_32x32x16_bf16 v[112:127], v[172:175], a[116:119], v[112:127]
  v_mfma_f32_32x32x16_bf16 v[64:79], v[160:163], a[116:119], v[64:79]
  s_cbranch_vccnz 9f
  s_waitcnt vmcnt(7)
9:
  s_waitcnt vmcnt(10)
  buffer_load_dwordx4 v5, s[24:27], s52 offen offset:2048 nt lds
  s_add_u32 m0, s53, 25600
  s_nop 0
  buffer_load_dwordx4 v18, s[36:39], s62 offen lds
  s_addk_i32 s62, 4608
  s_nop 1
  v_pk_mul_f32 v[80:81], v[80:81], v[22:23] op_sel_hi:[1,0]
  v_pk_mul_f32 v[82:83], v[82:83], v[22:23] op_sel_hi:[1,0]
  v_pk_mul_f32 v[84:85], v[84:85], v[22:23] op_sel_hi:[1,0]
  v_pk_mul_f32 v[86:87], v[86:87], v[22:23] op_sel_hi:[1,0]
  v_pk_mul_f32 v[88:89], v[88:89], v[22:23] op_sel_hi:[1,0]
  v_pk_mul_f32 v[90:91], v[90:91], v[22:23] op_sel_hi:[1,0]
  v_pk_mul_f32 v[92:93], v[92:93], v[22:23] op_sel_hi:[1,0]
  v_pk_mul_f32 v[94:95], v[94:95], v[22:23] op_sel_hi:[1,0]
  v_pk_mul_f32 v[96:97], v[96:97], v[22:23] op_sel_hi:[1,0]
  v_pk_mul_f32 v[98:99], v[98:99], v[22:23] op_sel_hi:[1,0]
  v_pk_mul_f32 v[100:101], v[100:101], v[22:23] op_sel_hi:[1,0]
  v_pk_mul_f32 v[102:103], v[102:103], v[22:23] op_sel_hi:[1,0]
  v_pk_mul_f32 v[104:105], v[104:105], v[22:23] op_sel_hi:[1,0]
  v_pk_mul_f32 v[106:107], v[106:107], v[22:23] op_sel_hi:[1,0]
  v_pk_mul_f32 v[108:109], v[108:109], v[22:23] op_sel_hi:[1,0]
  v_pk_mul_f32 v[110:111], v[110:111], v[22:23] op_sel_hi:[1,0]
  s_add_u32 m0, s53, 896
  s_cbranch_vccnz 9f
  s_waitcnt vmcnt(7)
9:
  s_waitcnt vmcnt(11)
  buffer_load_dwordx4 v5, s[24:27], s52 offen offset:128 nt lds
  s_cmp_eq_u32 s96, 1
  s_cbranch_scc0 1f
  buffer_load_dword v250, v249, s[40:43], s97 offen sc1
1:
  v_pk_mul_f32 v[112:113], v[112:113], v[22:23] op_sel_hi:[1,0]
  v_pk_mul_f32 v[114:115], v[114:115], v[22:23] op_sel_hi:[1,0]
  v_pk_mul_f32 v[116:117], v[116:117], v[22:23] op_sel_hi:[1,0]
  v_pk_mul_f32 v[118:119], v[118:119], v[22:23] op_sel_hi:[1,0]
  v_pk_mul_f32 v[120:121], v[120:121], v[22:23] op_sel_hi:[1,0]
  v_pk_mul_f32 v[122:123], v[122:123], v[22:23] op_sel_hi:[1,0]
  v_pk_mul_f32 v[124:125], v[124:125], v[22:23] op_sel_hi:[1,0]
  v_pk_mul_f32 v[126:127], v[126:127], v[22:23] op_sel_hi:[1,0]
  v_pk_mul_f32 v[64:65], v[64:65], v[22:23] op_sel_hi:[1,0]
  v_pk_mul_f32 v[66:67], v[66:67], v[22:23] op_sel_hi:[1,0]
  v_pk_mul_f32 v[68:69], v[68:69], v[22:23] op_sel_hi:[1,0]
  v_pk_mul_f32 v[70:71], v[70:71], v[22:23] op_sel_hi:[1,0]
  v_pk_mul_f32 v[72:73], v[72:73], v[22:23] op_sel_hi:[1,0]
  v_pk_mul_f32 v[74:75], v[74:75], v[22:23] op_sel_hi:[1,0]
  v_pk_mul_f32 v[76:77], v[76:77], v[22:23] op_sel_hi:[1,0]
  v_pk_mul_f32 v[78:79], v[78:79], v[22:23] op_sel_hi:[1,0]
  s_cbranch_vccnz 9f
  s_waitcnt vmcnt(6)
9:
  s_waitcnt vmcnt(11)
  buffer_load_dwordx4 v5, s[24:27], s52 offen offset:2176 nt lds
  s_xor_b32 s52, s52, 16384
  ds_read_b32 v22, v231 offset:2048
  ds_read_b64_tr_b16 v[148:149], v15 offset:16384
  ds_read_b64_tr_b16 v[150:151], v15 offset:18432
  ds_read_b64_tr_b16 v[152:153], v16 offset:16384
  ds_read_b64_tr_b16 v[154:155], v16 offset:18432
  ds_read_b64_tr_b16 v[156:157], v17 offset:16384
  ds_read_b64_tr_b16 v[158:159], v17 offset:18432
  ds_read_b64_tr_b16 v[144:145], v14 offset:16384
  ds_read_b64_tr_b16 v[146:147], v14 offset:18432
  s_add_u32 m0, s53, 4096
  s_cbranch_vccnz 9f
  s_waitcnt vmcnt(6)
9:
  s_waitcnt vmcnt(11)
  buffer_load_dwordx4 v5, s[24:27], s52 offen nt lds
  s_barrier
  s_waitcnt lgkmcnt(0)
  v_mfma_f32_32x32x16_bf16 v[80:95], v[148:151], a[120:123], v[80:95]
  v_mfma_f32_32x32x16_bf16 v[96:111], v[152:155], a[120:123], v[96:111]
  v_mfma_f32_32x32x16_bf16 v[112:127], v[156:159], a[120:123], v[112:127]
  v_mfma_f32_32x32x16_bf16 v[64:79], v[144:147], a[120:123], v[64:79]
  s_cbranch_vccnz 9f
  s_waitcnt vmcnt(6)
9:
  s_waitcnt vmcnt(10)
  buffer_load_dwordx4 v5, s[24:27], s52 offen offset:2048 nt lds
  s_add_u32 m0, s53, 26624
  s_nop 0
  buffer_load_dwordx4 v18, s[36:39], s62 offen lds
  s_addk_i32 s62, 4608
  s_add_u32 m0, s53, 4992
  s_cbranch_vccnz 9f
  s_waitcnt vmcnt(6)
9:
  s_waitcnt vmcnt(10)
  buffer_load_dwordx4 v5, s[24:27], s52 offen offset:128 nt lds
  s_cbranch_vccnz 9f
  s_waitcnt vmcnt(5)
9:
  s_waitcnt vmcnt(10)
  buffer_load_dwordx4 v5, s[24:27], s52 offen offset:2176 nt lds
  s_xor_b32 s52, s52, 0x14000
  ds_read_b64_tr_b16 v[164:165], v15 offset:20480
  ds_read_b64_tr_b16 v[166:167], v15 offset:22528
  ds_read_b64_tr_b16 v[168:169], v16 offset:20480
  ds_read_b64_tr_b16 v[170:171], v16 offset:22528
  ds_read_b64_tr_b16 v[172:173], v17 offset:20480
  ds_read_b64_tr_b16 v[174:175], v17 offset:22528
  ds_read_b64_tr_b16 v[160:161], v14 offset:20480
  ds_read_b64_tr_b16 v[162:163], v14 offset:22528
  s_add_u32 m0, s53, 8192
  s_cbranch_vccnz 9f
  s_waitcnt vmcnt(5)
9:
  s_waitcnt vmcnt(10)
  buffer_load_dwordx4 v5, s[24:27], s52 offen nt lds
  s_barrier
  s_waitcnt lgkmcnt(0)
  v_mfma_f32_32x32x16_bf16 v[80:95], v[164:167], a[124:127], v[80:95]
  v_mfma_f32_32x32x16_bf16 v[96:111], v[168:171], a[124:127], v[96:111]
  v_mfma_f32_32x32x16_bf16 v[112:127], v[172:175], a[124:127], v[112:127]
  v_mfma_f32_32x32x16_bf16 v[64:79], v[160:163], a[124:127], v[64:79]
  s_cbranch_vccnz 9f
  s_waitcnt vmcnt(5)
9:
  s_waitcnt vmcnt(9)
  buffer_load_dwordx4 v5, s[24:27], s52 offen offset:2048 nt lds
  v_add_u32 v248, v248, v247
  v_cmp_le_i32 s[92:93], v248, v251
  s_nop 0
  s_bcnt1_i32_b64 s60, s[92:93]
  s_cmp_ge_u32 s60, 33
  s_cselect_b64 vcc, -1, 0
  ds_read_b64_tr_b16 a[66:67], v20 offset:4096
  ds_read_b64_tr_b16 a[70:71], v20 offset:4128
  ds_read_b64_tr_b16 a[74:75], v243 offset:4096
  ds_read_b64_tr_b16 a[78:79], v243 offset:4128
  ds_read_b64_tr_b16 a[82:83], v244 offset:4096
  ds_read_b64_tr_b16 a[86:87], v244 offset:4128
  ds_read_b64_tr_b16 a[90:91], v245 offset:4096
  ds_read_b64_tr_b16 a[94:95], v245 offset:4128
  s_add_u32 m0, s53, 27648
  s_nop 0
  buffer_load_dwordx4 v18, s[36:39], s62 offen lds
  v_pk_mul_f32 v[80:81], v[80:81], v[22:23] op_sel_hi:[1,0]
  v_pk_mul_f32 v[82:83], v[82:83], v[22:23] op_sel_hi:[1,0]
  v_pk_mul_f32 v[84:85], v[84:85], v[22:23] op_sel_hi:[1,0]
  v_pk_mul_f32 v[86:87], v[86:87], v[22:23] op_sel_hi:[1,0]
  v_pk_mul_f32 v[88:89], v[88:89], v[22:23] op_sel_hi:[1,0]
  v_pk_mul_f32 v[90:91], v[90:91], v[22:23] op_sel_hi:[1,0]
  v_pk_mul_f32 v[92:93], v[92:93], v[22:23] op_sel_hi:[1,0]
  v_pk_mul_f32 v[94:95], v[94:95], v[22:23] op_sel_hi:[1,0]
  v_pk_mul_f32 v[96:97], v[96:97], v[22:23] op_sel_hi:[1,0]
  v_pk_mul_f32 v[98:99], v[98:99], v[22:23] op_sel_hi:[1,0]
  v_pk_mul_f32 v[100:101], v[100:101], v[22:23] op_sel_hi:[1,0]
  v_pk_mul_f32 v[102:103], v[102:103], v[22:23] op_sel_hi:[1,0]
  v_pk_mul_f32 v[104:105], v[104:105], v[22:23] op_sel_hi:[1,0]
  v_pk_mul_f32 v[106:107], v[106:107], v[22:23] op_sel_hi:[1,0]
  v_pk_mul_f32 v[108:109], v[108:109], v[22:23] op_sel_hi:[1,0]
  v_pk_mul_f32 v[110:111], v[110:111], v[22:23] op_sel_hi:[1,0]
  s_add_u32 m0, s53, 9088
  s_cbranch_vccnz 9f
  s_waitcnt vmcnt(6)
9:
  s_waitcnt vmcnt(9)
  buffer_load_dwordx4 v5, s[24:27], s52 offen offset:128 nt lds
  s_waitcnt lgkmcnt(0)
  s_lshl_b32 s98, s3, 1
  s_xor_b32 s98, s98, 11
  s_mul_i32 s98, s98, 18432
  s_add_u32 s98, s98, s66
  s_add_u32 m0, s53, 28672
  s_nop 0
  buffer_load_dwordx4 v18, s[36:39], s98 offen lds
  s_addk_i32 s98, 4608
  v_pk_mul_f32 v[112:113], v[112:113], v[22:23] op_sel_hi:[1,0]
  v_pk_mul_f32 v[114:115], v[114:115], v[22:23] op_sel_hi:[1,0]
  v_pk_mul_f32 v[116:117], v[116:117], v[22:23] op_sel_hi:[1,0]
  v_pk_mul_f32 v[118:119], v[118:119], v[22:23] op_sel_hi:[1,0]
  v_pk_mul_f32 v[120:121], v[120:121], v[22:23] op_sel_hi:[1,0]
  v_pk_mul_f32 v[122:123], v[122:123], v[22:23] op_sel_hi:[1,0]
  v_pk_mul_f32 v[124:125], v[124:125], v[22:23] op_sel_hi:[1,0]
  v_pk_mul_f32 v[126:127], v[126:127], v[22:23] op_sel_hi:[1,0]
  v_pk_mul_f32 v[64:65], v[64:65], v[22:23] op_sel_hi:[1,0]
  v_pk_mul_f32 v[66:67], v[66:67], v[22:23] op_sel_hi:[1,0]
  v_pk_mul_f32 v[68:69], v[68:69], v[22:23] op_sel_hi:[1,0]
  v_pk_mul_f32 v[70:71], v[70:71], v[22:23] op_sel_hi:[1,0]
  v_pk_mul_f32 v[72:73], v[72:73], v[22:23] op_sel_hi:[1,0]
  v_pk_mul_f32 v[74:75], v[74:75], v[22:23] op_sel_hi:[1,0]
  v_pk_mul_f32 v[76:77], v[76:77], v[22:23] op_sel_hi:[1,0]
  v_pk_mul_f32 v[78:79], v[78:79], v[22:23] op_sel_hi:[1,0]
  s_add_u32 m0, s53, 9088
  s_cbranch_vccnz 9f
  s_waitcnt vmcnt(6)
9:
  s_waitcnt vmcnt(10)
  buffer_load_dwordx4 v5, s[24:27], s52 offen offset:2176 nt lds
  s_xor_b32 s52, s52, 16384
  s_cmp_eq_u32 s96, 1
  s_cbranch_scc0 1f
  v_cmp_lt_i32 s[92:93], 0, v250
  s_nop 0
  s_bcnt1_i32_b32 s60, s92
  v_mov_b32 v250, s60
  s_mov_b64 exec, 1
  buffer_store_dword v250, off, s[40:43], s95 offset:512
  buffer_store_dword v250, off, s[40:43], s95 offset:768
  buffer_store_dword v250, off, s[40:43], s95 offset:1792
  s_mov_b64 exec, -1
1:
  ds_read_b32 v22, v231 offset:2176
  ds_read_b64_tr_b16 v[148:149], v15
  ds_read_b64_tr_b16 v[150:151], v15 offset:2048
  ds_read_b64_tr_b16 v[152:153], v16
  ds_read_b64_tr_b16 v[154:155], v16 offset:2048
  ds_read_b64_tr_b16 v[156:157], v17
  ds_read_b64_tr_b16 v[158:159], v17 offset:2048
  ds_read_b64_tr_b16 v[144:145], v14
  ds_read_b64_tr_b16 v[146:147], v14 offset:2048
  s_add_u32 m0, s53, 12288
  s_cbranch_vccnz 9f
  s_waitcnt vmcnt(6)
9:
  s_waitcnt vmcnt(10)
  buffer_load_dwordx4 v5, s[24:27], s52 offen nt lds
  s_barrier
  s_waitcnt lgkmcnt(0)
  v_mfma_f32_32x32x16_bf16 v[80:95], v[148:151], a[128:131], v[80:95]
  v_mfma_f32_32x32x16_bf16 v[96:111], v[152:155], a[128:131], v[96:111]
  v_mfma_f32_32x32x16_bf16 v[112:127], v[156:159], a[128:131], v[112:127]
  v_mfma_f32_32x32x16_bf16 v[64:79], v[144:147], a[128:131], v[64:79]
  s_cbranch_vccnz 9f
  s_waitcnt vmcnt(6)
9:
  s_waitcnt vmcnt(10)
  buffer_load_dwordx4 v5, s[24:27], s52 offen offset:2048 nt lds
  s_add_u32 m0, s53, 13184
  s_cbranch_vccnz 9f
  s_waitcnt vmcnt(6)
9:
  s_waitcnt vmcnt(9)
  buffer_load_dwordx4 v5, s[24:27], s52 offen offset:128 nt lds
  s_add_u32 m0, s53, 29696
  s_nop 0
  buffer_load_dwordx4 v18, s[36:39], s98 offen lds
  s_addk_i32 s98, 4608
  s_add_u32 m0, s53, 13184
  s_cbranch_vccnz 9f
  s_waitcnt vmcnt(6)
9:
  s_waitcnt vmcnt(10)
  buffer_load_dwordx4 v5, s[24:27], s52 offen offset:2176 nt lds
  s_xor_b32 s52, s52, 0x54000
  ds_read_b64_tr_b16 v[164:165], v15 offset:4096
  ds_read_b64_tr_b16 v[166:167], v15 offset:6144
  ds_read_b64_tr_b16 v[168:169], v16 offset:4096
  ds_read_b64_tr_b16 v[170:171], v16 offset:6144
  ds_read_b64_tr_b16 v[172:173], v17 offset:4096
  ds_read_b64_tr_b16 v[174:175], v17 offset:6144
  ds_read_b64_tr_b16 v[160:161], v14 offset:4096
  ds_read_b64_tr_b16 v[162:163], v14 offset:6144
  s_add_u32 m0, s53, 16384
  s_cbranch_vccnz 9f
  s_waitcnt vmcnt(5)
9:
  s_waitcnt vmcnt(10)
  buffer_load_dwordx4 v5, s[24:27], s52 offen nt lds
  s_add_u32 s91, s91, 1
  s_and_b32 s60, s91, 3
  s_cmp_eq_u32 s60, s3
  s_cbranch_scc0 1f
  v_mov_b32 v252, s91
  s_mov_b64 exec, 1
  buffer_store_dword v252, off, s[40:43], s94 offset:1280
  s_mov_b64 exec, -1
1:
  s_barrier
  buffer_load_dword v246, v254, s[40:43], s95 offen offset:1280 sc1
  s_addk_i32 s97, 512
  s_add_u32 s96, s96, 30
  s_and_b32 s96, s96, 0x11f
  s_cmp_eq_u32 s96, 0
  s_cbranch_scc0 1f
  s_add_u32 s60, s97, s95
  s_mov_b32 exec_hi, 0
  buffer_store_dword v253, v254, s[40:43], s60 offen sc1
  s_mov_b32 exec_hi, -1
1:
  s_waitcnt lgkmcnt(0)
  v_mfma_f32_32x32x16_bf16 v[80:95], v[164:167], a[132:135], v[80:95]
  v_mfma_f32_32x32x16_bf16 v[96:111], v[168:171], a[132:135], v[96:111]
  v_mfma_f32_32x32x16_bf16 v[112:127], v[172:175], a[132:135], v[112:127]
  v_mfma_f32_32x32x16_bf16 v[64:79], v[160:163], a[132:135], v[64:79]
  s_cbranch_vccnz 9f
  s_waitcnt vmcnt(6)
9:
  s_waitcnt vmcnt(11)
  buffer_load_dwordx4 v5, s[24:27], s52 offen offset:2048 nt lds
  s_nop 5
  v_pk_mul_f32 v[80:81], v[80:81], v[22:23] op_sel_hi:[1,0]
  v_pk_mul_f32 v[82:83], v[82:83], v[22:23] op_sel_hi:[1,0]
  v_pk_mul_f32 v[84:85], v[84:85], v[22:23] op_sel_hi:[1,0]
  v_pk_mul_f32 v[86:87], v[86:87], v[22:23] op_sel_hi:[1,0]
  v_pk_mul_f32 v[88:89], v[88:89], v[22:23] op_sel_hi:[1,0]
  v_pk_mul_f32 v[90:91], v[90:91], v[22:23] op_sel_hi:[1,0]
  v_pk_mul_f32 v[92:93], v[92:93], v[22:23] op_sel_hi:[1,0]
  v_pk_mul_f32 v[94:95], v[94:95], v[22:23] op_sel_hi:[1,0]
  v_pk_mul_f32 v[96:97], v[96:97], v[22:23] op_sel_hi:[1,0]
  v_pk_mul_f32 v[98:99], v[98:99], v[22:23] op_sel_hi:[1,0]
  v_pk_mul_f32 v[100:101], v[100:101], v[22:23] op_sel_hi:[1,0]
  v_pk_mul_f32 v[102:103], v[102:103], v[22:23] op_sel_hi:[1,0]
  v_pk_mul_f32 v[104:105], v[104:105], v[22:23] op_sel_hi:[1,0]
  v_pk_mul_f32 v[106:107], v[106:107], v[22:23] op_sel_hi:[1,0]
  v_pk_mul_f32 v[108:109], v[108:109], v[22:23] op_sel_hi:[1,0]
  v_pk_mul_f32 v[110:111], v[110:111], v[22:23] op_sel_hi:[1,0]
  s_add_u32 m0, s53, 17280
  s_cbranch_vccnz 9f
  s_waitcnt vmcnt(6)
9:
  s_waitcnt vmcnt(10)
  buffer_load_dwordx4 v5, s[24:27], s52 offen offset:128 nt lds
  s_cmp_eq_u32 s96, 1
  s_cbranch_scc0 1f
  buffer_load_dword v250, v249, s[40:43], s97 offen sc1
1:
  s_add_u32 m0, s53, 30720
  s_nop 0
  buffer_load_dwordx4 v18, s[36:39], s98 offen lds
  s_addk_i32 s98, 4608
  v_pk_mul_f32 v[112:113], v[112:113], v[22:23] op_sel_hi:[1,0]
  v_pk_mul_f32 v[114:115], v[114:115], v[22:23] op_sel_hi:[1,0]
  v_pk_mul_f32 v[116:117], v[116:117], v[22:23] op_sel_hi:[1,0]
  v_pk_mul_f32 v[118:119], v[118:119], v[22:23] op_sel_hi:[1,0]
  v_pk_mul_f32 v[120:121], v[120:121], v[22:23] op_sel_hi:[1,0]
  v_pk_mul_f32 v[122:123], v[122:123], v[22:23] op_sel_hi:[1,0]
  v_pk_mul_f32 v[124:125], v[124:125], v[22:23] op_sel_hi:[1,0]
  v_pk_mul_f32 v[126:127], v[126:127], v[22:23] op_sel_hi:[1,0]
  v_pk_mul_f32 v[64:65], v[64:65], v[22:23] op_sel_hi:[1,0]
  v_pk_mul_f32 v[66:67], v[66:67], v[22:23] op_sel_hi:[1,0]
  v_pk_mul_f32 v[68:69], v[68:69], v[22:23] op_sel_hi:[1,0]
  v_pk_mul_f32 v[70:71], v[70:71], v[22:23] op_sel_hi:[1,0]
  v_pk_mul_f32 v[72:73], v[72:73], v[22:23] op_sel_hi:[1,0]
  v_pk_mul_f32 v[74:75], v[74:75], v[22:23] op_sel_hi:[1,0]
  v_pk_mul_f32 v[76:77], v[76:77], v[22:23] op_sel_hi:[1,0]
  v_pk_mul_f32 v[78:79], v[78:79], v[22:23] op_sel_hi:[1,0]
  s_add_u32 m0, s53, 17280
  s_cbranch_vccnz 9f
  s_waitcnt vmcnt(7)
9:
  s_waitcnt vmcnt(10)
  buffer_load_dwordx4 v5, s[24:27], s52 offen offset:2176 nt lds
  s_xor_b32 s52, s52, 16384
  ds_read_b32 v22, v231 offset:2304
  ds_read_b64_tr_b16 v[148:149], v15 offset:8192
  ds_read_b64_tr_b16 v[150:151], v15 offset:10240
  ds_read_b64_tr_b16 v[152:153], v16 offset:8192
  ds_read_b64_tr_b16 v[154:155], v16 offset:10240
  ds_read_b64_tr_b16 v[156:157], v17 offset:8192
  ds_read_b64_tr_b16 v[158:159], v17 offset:10240
  ds_read_b64_tr_b16 v[144:145], v14 offset:8192
  ds_read_b64_tr_b16 v[146:147], v14 offset:10240
  s_add_u32 m0, s53, 20480
  s_cbranch_vccnz 9f
  s_waitcnt vmcnt(6)
9:
  s_waitcnt vmcnt(10)
  buffer_load_dwordx4 v5, s[24:27], s52 offen nt lds
  s_barrier
  s_waitcnt lgkmcnt(0)
  v_mfma_f32_32x32x16_bf16 v[80:95], v[148:151], a[136:139], v[80:95]
  v_mfma_f32_32x32x16_bf16 v[96:111], v[152:155], a[136:139], v[96:111]
  v_mfma_f32_32x32x16_bf16 v[112:127], v[156:159], a[136:139], v[112:127]
  v_mfma_f32_32x32x16_bf16 v[64:79], v[144:147], a[136:139], v[64:79]
  s_cbranch_vccnz 9f
  s_waitcnt vmcnt(6)
9:
  s_waitcnt vmcnt(10)
  buffer_load_dwordx4 v5, s[24:27], s52 offen offset:2048 nt lds
  s_add_u32 m0, s53, 21376
  s_cbranch_vccnz 9f
  s_waitcnt vmcnt(5)
9:
  s_waitcnt vmcnt(10)
  buffer_load_dwordx4 v5, s[24:27], s52 offen offset:128 nt lds
  s_add_u32 m0, s53, 31744
  s_nop 0
  buffer_load_dwordx4 v18, s[36:39], s98 offen lds
  s_add_u32 m0, s53, 21376
  s_cbranch_vccnz 9f
  s_waitcnt vmcnt(6)
9:
  s_waitcnt vmcnt(10)
  buffer_load_dwordx4 v5, s[24:27], s52 offen offset:2176 nt lds
  s_xor_b32 s52, s52, 0x14000
  ds_read_b64_tr_b16 v[164:165], v15 offset:12288
  ds_read_b64_tr_b16 v[166:167], v15 offset:14336
  ds_read_b64_tr_b16 v[168:169], v16 offset:12288
  ds_read_b64_tr_b16 v[170:171], v16 offset:14336
  ds_read_b64_tr_b16 v[172:173], v17 offset:12288
  ds_read_b64_tr_b16 v[174:175], v17 offset:14336
  ds_read_b64_tr_b16 v[160:161], v14 offset:12288
  ds_read_b64_tr_b16 v[162:163], v14 offset:14336
  s_mov_b32 m0, s53
  s_cbranch_vccnz 9f
  s_waitcnt vmcnt(5)
9:
  s_waitcnt vmcnt(10)
  buffer_load_dwordx4 v5, s[24:27], s52 offen nt lds
  s_barrier
  ds_read_b64_tr_b16 a[96:97], v20
  ds_read_b64_tr_b16 a[100:101], v20 offset:32
  ds_read_b64_tr_b16 a[104:105], v243
  ds_read_b64_tr_b16 a[108:109], v243 offset:32
  ds_read_b64_tr_b16 a[112:113], v244
  ds_read_b64_tr_b16 a[116:117], v244 offset:32
  ds_read_b64_tr_b16 a[120:121], v245
  s_waitcnt lgkmcnt(14)
  ds_read_b64_tr_b16 a[124:125], v245 offset:32
  s_waitcnt lgkmcnt(8)
  v_mfma_f32_32x32x16_bf16 v[80:95], v[164:167], a[140:143], v[80:95]
  v_mfma_f32_32x32x16_bf16 v[96:111], v[168:171], a[140:143], v[96:111]
  v_mfma_f32_32x32x16_bf16 v[112:127], v[172:175], a[140:143], v[112:127]
  v_mfma_f32_32x32x16_bf16 v[64:79], v[160:163], a[140:143], v[64:79]
  s_cbranch_vccnz 9f
  s_waitcnt vmcnt(5)
9:
  s_waitcnt vmcnt(9)
  buffer_load_dwordx4 v5, s[24:27], s52 offen offset:2048 nt lds
  v_add_u32 v248, v248, v247
  v_cmp_le_i32 s[92:93], v248, v246
  s_nop 0
  s_bcnt1_i32_b64 s60, s[92:93]
  s_cmp_ge_u32 s60, 33
  s_cselect_b64 vcc, -1, 0
  s_waitcnt lgkmcnt(0)
  s_lshl_b32 s62, s3, 1
  s_xor_b32 s62, s62, 12
  s_mul_i32 s62, s62, 18432
  s_add_u32 s62, s62, s66
  s_add_u32 m0, s53, 24576
  s_nop 0
  buffer_load_dwordx4 v18, s[36:39], s62 offen lds
  s_addk_i32 s62, 4608
  v_pk_mul_f32 v[80:81], v[80:81], v[22:23] op_sel_hi:[1,0]
  v_pk_mul_f32 v[82:83], v[82:83], v[22:23] op_sel_hi:[1,0]
  v_pk_mul_f32 v[84:85], v[84:85], v[22:23] op_sel_hi:[1,0]
  v_pk_mul_f32 v[86:87], v[86:87], v[22:23] op_sel_hi:[1,0]
  v_pk_mul_f32 v[88:89], v[88:89], v[22:23] op_sel_hi:[1,0]
  v_pk_mul_f32 v[90:91], v[90:91], v[22:23] op_sel_hi:[1,0]
  v_pk_mul_f32 v[92:93], v[92:93], v[22:23] op_sel_hi:[1,0]
  v_pk_mul_f32 v[94:95], v[94:95], v[22:23] op_sel_hi:[1,0]
  v_pk_mul_f32 v[96:97], v[96:97], v[22:23] op_sel_hi:[1,0]
  v_pk_mul_f32 v[98:99], v[98:99], v[22:23] op_sel_hi:[1,0]
  v_pk_mul_f32 v[100:101], v[100:101], v[22:23] op_sel_hi:[1,0]
  v_pk_mul_f32 v[102:103], v[102:103], v[22:23] op_sel_hi:[1,0]
  v_pk_mul_f32 v[104:105], v[104:105], v[22:23] op_sel_hi:[1,0]
  v_pk_mul_f32 v[106:107], v[106:107], v[22:23] op_sel_hi:[1,0]
  v_pk_mul_f32 v[108:109], v[108:109], v[22:23] op_sel_hi:[1,0]
  v_pk_mul_f32 v[110:111], v[110:111], v[22:23] op_sel_hi:[1,0]
  s_add_u32 m0, s53, 896
  s_cbranch_vccnz 9f
  s_waitcnt vmcnt(6)
9:
  s_waitcnt vmcnt(10)
  buffer_load_dwordx4 v5, s[24:27], s52 offen offset:128 nt lds
  v_pk_mul_f32 v[112:113], v[112:113], v[22:23] op_sel_hi:[1,0]
  v_pk_mul_f32 v[114:115], v[114:115], v[22:23] op_sel_hi:[1,0]
  v_pk_mul_f32 v[116:117], v[116:117], v[22:23] op_sel_hi:[1,0]
  v_pk_mul_f32 v[118:119], v[118:119], v[22:23] op_sel_hi:[1,0]
  v_pk_mul_f32 v[120:121], v[120:121], v[22:23] op_sel_hi:[1,0]
  v_pk_mul_f32 v[122:123], v[122:123], v[22:23] op_sel_hi:[1,0]
  v_pk_mul_f32 v[124:125], v[124:125], v[22:23] op_sel_hi:[1,0]
  v_pk_mul_f32 v[126:127], v[126:127], v[22:23] op_sel_hi:[1,0]
  v_pk_mul_f32 v[64:65], v[64:65], v[22:23] op_sel_hi:[1,0]
  v_pk_mul_f32 v[66:67], v[66:67], v[22:23] op_sel_hi:[1,0]
  v_pk_mul_f32 v[68:69], v[68:69], v[22:23] op_sel_hi:[1,0]
  v_pk_mul_f32 v[70:71], v[70:71], v[22:23] op_sel_hi:[1,0]
  v_pk_mul_f32 v[72:73], v[72:73], v[22:23] op_sel_hi:[1,0]
  v_pk_mul_f32 v[74:75], v[74:75], v[22:23] op_sel_hi:[1,0]
  v_pk_mul_f32 v[76:77], v[76:77], v[22:23] op_sel_hi:[1,0]
  v_pk_mul_f32 v[78:79], v[78:79], v[22:23] op_sel_hi:[1,0]
  s_cbranch_vccnz 9f
  s_waitcnt vmcnt(6)
9:
  s_waitcnt vmcnt(9)
  buffer_load_dwordx4 v5, s[24:27], s52 offen offset:2176 nt lds
  s_xor_b32 s52, s52, 16384
  s_cmp_eq_u32 s96, 1
  s_cbranch_scc0 1f
  v_cmp_lt_i32 s[92:93], 0, v250
  s_nop 0
  s_bcnt1_i32_b32 s60, s92
  v_mov_b32 v250, s60
  s_mov_b64 exec, 1
  buffer_store_dword v250, off, s[40:43], s95 offset:512
  buffer_store_dword v250, off, s[40:43], s95 offset:768
  buffer_store_dword v250, off, s[40:43], s95 offset:1792
  s_mov_b64 exec, -1
1:
  ds_read_b32 v22, v231 offset:2432
  ds_read_b64_tr_b16 v[148:149], v15 offset:16384
  ds_read_b64_tr_b16 v[150:151], v15 offset:18432
  ds_read_b64_tr_b16 v[152:153], v16 offset:16384
  ds_read_b64_tr_b16 v[154:155], v16 offset:18432
  ds_read_b64_tr_b16 v[156:157], v17 offset:16384
  ds_read_b64_tr_b16 v[158:159], v17 offset:18432
  ds_read_b64_tr_b16 v[144:145], v14 offset:16384
  ds_read_b64_tr_b16 v[146:147], v14 offset:18432
  s_add_u32 m0, s53, 4096
  s_cbranch_vccnz 9f
  s_waitcnt vmcnt(5)
9:
  s_waitcnt vmcnt(9)
  buffer_load_dwordx4 v5, s[24:27], s52 offen nt lds
  s_barrier
  s_waitcnt lgkmcnt(0)
  v_mfma_f32_32x32x16_bf16 v[80:95], v[148:151], a[144:147], v[80:95]
  v_mfma_f32_32x32x16_bf16 v[96:111], v[152:155], a[144:147], v[96:111]
  v_mfma_f32_32x32x16_bf16 v[112:127], v[156:159], a[144:147], v[112:127]
  v_mfma_f32_32x32x16_bf16 v[64:79], v[144:147], a[144:147], v[64:79]
  s_cbranch_vccnz 9f
  s_waitcnt vmcnt(5)
9:
  s_waitcnt vmcnt(9)
  buffer_load_dwordx4 v5, s[24:27], s52 offen offset:2048 nt lds
  s_add_u32 m0, s53, 25600
  s_nop 0
  buffer_load_dwordx4 v18, s[36:39], s62 offen lds
  s_addk_i32 s62, 4608
  s_add_u32 m0, s53, 4992
  s_cbranch_vccnz 9f
  s_waitcnt vmcnt(6)
9:
  s_waitcnt vmcnt(10)
  buffer_load_dwordx4 v5, s[24:27], s52 offen offset:128 nt lds
  s_cbranch_vccnz 9f
  s_waitcnt vmcnt(5)
9:
  s_waitcnt vmcnt(9)
  buffer_load_dwordx4 v5, s[24:27], s52 offen offset:2176 nt lds
  s_xor_b32 s52, s52, 0xd4000
  ds_read_b64_tr_b16 v[164:165], v15 offset:20480
  ds_read_b64_tr_b16 v[166:167], v15 offset:22528
  ds_read_b64_tr_b16 v[168:169], v16 offset:20480
  ds_read_b64_tr_b16 v[170:171], v16 offset:22528
  ds_read_b64_tr_b16 v[172:173], v17 offset:20480
  ds_read_b64_tr_b16 v[174:175], v17 offset:22528
  ds_read_b64_tr_b16 v[160:161], v14 offset:20480
  ds_read_b64_tr_b16 v[162:163], v14 offset:22528
  s_add_u32 m0, s53, 8192
  s_cbranch_vccnz 9f
  s_waitcnt vmcnt(5)
9:
  s_waitcnt vmcnt(9)
  buffer_load_dwordx4 v5, s[24:27], s52 offen nt lds
  s_add_u32 s91, s91, 1
  s_and_b32 s60, s91, 3
  s_cmp_eq_u32 s60, s3
  s_cbranch_scc0 1f
  v_mov_b32 v252, s91
  s_mov_b64 exec, 1
  buffer_store_dword v252, off, s[40:43], s94
  s_mov_b64 exec, -1
1:
  s_barrier
  buffer_load_dword v255, v254, s[40:43], s95 offen sc1
  s_addk_i32 s97, 512
  s_add_u32 s96, s96, 30
  s_and_b32 s96, s96, 0x11f
  s_cmp_eq_u32 s96, 0
  s_cbranch_scc0 1f
  s_add_u32 s60, s97, s95
  s_mov_b32 exec_hi, 0
  buffer_store_dword v253, v254, s[40:43], s60 offen sc1
  s_mov_b32 exec_hi, -1
1:
  s_waitcnt lgkmcnt(0)
  v_mfma_f32_32x32x16_bf16 v[80:95], v[164:167], a[148:151], v[80:95]
  v_mfma_f32_32x32x16_bf16 v[96:111], v[168:171], a[148:151], v[96:111]
  v_mfma_f32_32x32x16_bf16 v[112:127], v[172:175], a[148:151], v[112:127]
  v_mfma_f32_32x32x16_bf16 v[64:79], v[160:163], a[148:151], v[64:79]
  s_cbranch_vccnz 9f
  s_waitcnt vmcnt(6)
9:
  s_waitcnt vmcnt(10)
  buffer_load_dwordx4 v5, s[24:27], s52 offen offset:2048 nt lds
  s_add_u32 m0, s53, 26624
  s_nop 0
  buffer_load_dwordx4 v18, s[36:39], s62 offen lds
  s_addk_i32 s62, 4608
  s_nop 1
  v_pk_mul_f32 v[80:81], v[80:81], v[22:23] op_sel_hi:[1,0]
  v_pk_mul_f32 v[82:83], v[82:83], v[22:23] op_sel_hi:[1,0]
  v_pk_mul_f32 v[84:85], v[84:85], v[22:23] op_sel_hi:[1,0]
  v_pk_mul_f32 v[86:87], v[86:87], v[22:23] op_sel_hi:[1,0]
  v_pk_mul_f32 v[88:89], v[88:89], v[22:23] op_sel_hi:[1,0]
  v_pk_mul_f32 v[90:91], v[90:91], v[22:23] op_sel_hi:[1,0]
  v_pk_mul_f32 v[92:93], v[92:93], v[22:23] op_sel_hi:[1,0]
  v_pk_mul_f32 v[94:95], v[94:95], v[22:23] op_sel_hi:[1,0]
  v_pk_mul_f32 v[96:97], v[96:97], v[22:23] op_sel_hi:[1,0]
  v_pk_mul_f32 v[98:99], v[98:99], v[22:23] op_sel_hi:[1,0]
  v_pk_mul_f32 v[100:101], v[100:101], v[22:23] op_sel_hi:[1,0]
  v_pk_mul_f32 v[102:103], v[102:103], v[22:23] op_sel_hi:[1,0]
  v_pk_mul_f32 v[104:105], v[104:105], v[22:23] op_sel_hi:[1,0]
  v_pk_mul_f32 v[106:107], v[106:107], v[22:23] op_sel_hi:[1,0]
  v_pk_mul_f32 v[108:109], v[108:109], v[22:23] op_sel_hi:[1,0]
  v_pk_mul_f32 v[110:111], v[110:111], v[22:23] op_sel_hi:[1,0]
  s_add_u32 m0, s53, 9088
  s_cbranch_vccnz 9f
  s_waitcnt vmcnt(7)
9:
  s_waitcnt vmcnt(10)
  buffer_load_dwordx4 v5, s[24:27], s52 offen offset:128 nt lds
  s_cmp_eq_u32 s96, 1
  s_cbranch_scc0 1f
  buffer_load_dword v250, v249, s[40:43], s97 offen sc1
1:
  v_pk_mul_f32 v[112:113], v[112:113], v[22:23] op_sel_hi:[1,0]
  v_pk_mul_f32 v[114:115], v[114:115], v[22:23] op_sel_hi:[1,0]
  v_pk_mul_f32 v[116:117], v[116:117], v[22:23] op_sel_hi:[1,0]
  v_pk_mul_f32 v[118:119], v[118:119], v[22:23] op_sel_hi:[1,0]
  v_pk_mul_f32 v[120:121], v[120:121], v[22:23] op_sel_hi:[1,0]
  v_pk_mul_f32 v[122:123], v[122:123], v[22:23] op_sel_hi:[1,0]
  v_pk_mul_f32 v[124:125], v[124:125], v[22:23] op_sel_hi:[1,0]
  v_pk_mul_f32 v[126:127], v[126:127], v[22:23] op_sel_hi:[1,0]
  v_pk_mul_f32 v[64:65], v[64:65], v[22:23] op_sel_hi:[1,0]
  v_pk_mul_f32 v[66:67], v[66:67], v[22:23] op_sel_hi:[1,0]
  v_pk_mul_f32 v[68:69], v[68:69], v[22:23] op_sel_hi:[1,0]
  v_pk_mul_f32 v[70:71], v[70:71], v[22:23] op_sel_hi:[1,0]
  v_pk_mul_f32 v[72:73], v[72:73], v[22:23] op_sel_hi:[1,0]
  v_pk_mul_f32 v[74:75], v[74:75], v[22:23] op_sel_hi:[1,0]
  v_pk_mul_f32 v[76:77], v[76:77], v[22:23] op_sel_hi:[1,0]
  v_pk_mul_f32 v[78:79], v[78:79], v[22:23] op_sel_hi:[1,0]
  s_cbranch_vccnz 9f
  s_waitcnt vmcnt(6)
9:
  s_waitcnt vmcnt(10)
  buffer_load_dwordx4 v5, s[24:27], s52 offen offset:2176 nt lds
  s_xor_b32 s52, s52, 16384
  ds_read_b32 v22, v231 offset:2560
  ds_read_b64_tr_b16 v[148:149], v15
  ds_read_b64_tr_b16 v[150:151], v15 offset:2048
  ds_read_b64_tr_b16 v[152:153], v16
  ds_read_b64_tr_b16 v[154:155], v16 offset:2048
  ds_read_b64_tr_b16 v[156:157], v17
  ds_read_b64_tr_b16 v[158:159], v17 offset:2048
  ds_read_b64_tr_b16 v[144:145], v14
  ds_read_b64_tr_b16 v[146:147], v14 offset:2048
  s_add_u32 m0, s53, 12288
  s_cbranch_vccnz 9f
  s_waitcnt vmcnt(6)
9:
  s_waitcnt vmcnt(10)
  buffer_load_dwordx4 v5, s[24:27], s52 offen nt lds
  s_barrier
  s_waitcnt lgkmcnt(0)
  v_mfma_f32_32x32x16_bf16 v[80:95], v[148:151], a[152:155], v[80:95]
  v_mfma_f32_32x32x16_bf16 v[96:111], v[152:155], a[152:155], v[96:111]
  v_mfma_f32_32x32x16_bf16 v[112:127], v[156:159], a[152:155], v[112:127]
  v_mfma_f32_32x32x16_bf16 v[64:79], v[144:147], a[152:155], v[64:79]
  s_cbranch_vccnz 9f
  s_waitcnt vmcnt(6)
9:
  s_waitcnt vmcnt(10)
  buffer_load_dwordx4 v5, s[24:27], s52 offen offset:2048 nt lds
  ds_read_b64_tr_b16 a[98:99], v20 offset:4096
  ds_read_b64_tr_b16 a[102:103], v20 offset:4128
  ds_read_b64_tr_b16 a[106:107], v243 offset:4096
  ds_read_b64_tr_b16 a[110:111], v243 offset:4128
  ds_read_b64_tr_b16 a[114:115], v244 offset:4096
  ds_read_b64_tr_b16 a[118:119], v244 offset:4128
  ds_read_b64_tr_b16 a[122:123], v245 offset:4096
  ds_read_b64_tr_b16 a[126:127], v245 offset:4128
  s_add_u32 m0, s53, 27648
  s_nop 0
  buffer_load_dwordx4 v18, s[36:39], s62 offen lds
  s_add_u32 m0, s53, 13184
  s_cbranch_vccnz 9f
  s_waitcnt vmcnt(6)
9:
  s_waitcnt vmcnt(10)
  buffer_load_dwordx4 v5, s[24:27], s52 offen offset:128 nt lds
  s_waitcnt lgkmcnt(0)
  s_lshl_b32 s98, s3, 1
  s_xor_b32 s98, s98, 13
  s_mul_i32 s98, s98, 18432
  s_add_u32 s98, s98, s66
  s_add_u32 m0, s53, 28672
  s_nop 0
  buffer_load_dwordx4 v18, s[36:39], s98 offen lds
  s_addk_i32 s98, 4608
  s_add_u32 m0, s53, 13184
  s_cbranch_vccnz 9f
  s_waitcnt vmcnt(6)
9:
  s_waitcnt vmcnt(11)
  buffer_load_dwordx4 v5, s[24:27], s52 offen offset:2176 nt lds
  s_xor_b32 s52, s52, 0x14000
  ds_read_b64_tr_b16 v[164:165], v15 offset:4096
  ds_read_b64_tr_b16 v[166:167], v15 offset:6144
  ds_read_b64_tr_b16 v[168:169], v16 offset:4096
  ds_read_b64_tr_b16 v[170:171], v16 offset:6144
  ds_read_b64_tr_b16 v[172:173], v17 offset:4096
  ds_read_b64_tr_b16 v[174:175], v17 offset:6144
  ds_read_b64_tr_b16 v[160:161], v14 offset:4096
  ds_read_b64_tr_b16 v[162:163], v14 offset:6144
  s_add_u32 m0, s53, 16384
  s_cbranch_vccnz 9f
  s_waitcnt vmcnt(6)
9:
  s_waitcnt vmcnt(11)
  buffer_load_dwordx4 v5, s[24:27], s52 offen nt lds
  s_barrier
  s_waitcnt lgkmcnt(0)
  v_mfma_f32_32x32x16_bf16 v[80:95], v[164:167], a[156:159], v[80:95]
  v_mfma_f32_32x32x16_bf16 v[96:111], v[168:171], a[156:159], v[96:111]
  v_mfma_f32_32x32x16_bf16 v[112:127], v[172:175], a[156:159], v[112:127]
  v_mfma_f32_32x32x16_bf16 v[64:79], v[160:163], a[156:159], v[64:79]
  s_cbranch_vccnz 9f
  s_waitcnt vmcnt(6)
9:
  s_waitcnt vmcnt(10)
  buffer_load_dwordx4 v5, s[24:27], s52 offen offset:2048 nt lds
  v_add_u32 v248, v248, v247
  v_cmp_le_i32 s[92:93], v248, v255
  s_nop 0
  s_bcnt1_i32_b64 s60, s[92:93]
  s_cmp_ge_u32 s60, 33
  s_cselect_b64 vcc, -1, 0
  v_pk_mul_f32 v[80:81], v[80:81], v[22:23] op_sel_hi:[1,0]
  v_pk_mul_f32 v[82:83], v[82:83], v[22:23] op_sel_hi:[1,0]
  v_pk_mul_f32 v[84:85], v[84:85], v[22:23] op_sel_hi:[1,0]
  v_pk_mul_f32 v[86:87], v[86:87], v[22:23] op_sel_hi:[1,0]
  v_pk_mul_f32 v[88:89], v[88:89], v[22:23] op_sel_hi:[1,0]
  v_pk_mul_f32 v[90:91], v[90:91], v[22:23] op_sel_hi:[1,0]
  v_pk_mul_f32 v[92:93], v[92:93], v[22:23] op_sel_hi:[1,0]
  v_pk_mul_f32 v[94:95], v[94:95], v[22:23] op_sel_hi:[1,0]
  v_pk_mul_f32 v[96:97], v[96:97], v[22:23] op_sel_hi:[1,0]
  v_pk_mul_f32 v[98:99], v[98:99], v[22:23] op_sel_hi:[1,0]
  v_pk_mul_f32 v[100:101], v[100:101], v[22:23] op_sel_hi:[1,0]
  v_pk_mul_f32 v[102:103], v[102:103], v[22:23] op_sel_hi:[1,0]
  v_pk_mul_f32 v[104:105], v[104:105], v[22:23] op_sel_hi:[1,0]
  v_pk_mul_f32 v[106:107], v[106:107], v[22:23] op_sel_hi:[1,0]
  v_pk_mul_f32 v[108:109], v[108:109], v[22:23] op_sel_hi:[1,0]
  v_pk_mul_f32 v[110:111], v[110:111], v[22:23] op_sel_hi:[1,0]
  s_add_u32 m0, s53, 17280
  s_cbranch_vccnz 9f
  s_waitcnt vmcnt(6)
9:
  s_waitcnt vmcnt(9)
  buffer_load_dwordx4 v5, s[24:27], s52 offen offset:128 nt lds
  s_add_u32 m0, s53, 29696
  s_nop 0
  buffer_load_dwordx4 v18, s[36:39], s98 offen lds
  s_addk_i32 s98, 4608
  v_pk_mul_f32 v[112:113], v[112:113], v[22:23] op_sel_hi:[1,0]
  v_pk_mul_f32 v[114:115], v[114:115], v[22:23] op_sel_hi:[1,0]
  v_pk_mul_f32 v[116:117], v[116:117], v[22:23] op_sel_hi:[1,0]
  v_pk_mul_f32 v[118:119], v[118:119], v[22:23] op_sel_hi:[1,0]
  v_pk_mul_f32 v[120:121], v[120:121], v[22:23] op_sel_hi:[1,0]
  v_pk_mul_f32 v[122:123], v[122:123], v[22:23] op_sel_hi:[1,0]
  v_pk_mul_f32 v[124:125], v[124:125], v[22:23] op_sel_hi:[1,0]
  v_pk_mul_f32 v[126:127], v[126:127], v[22:23] op_sel_hi:[1,0]
  v_pk_mul_f32 v[64:65], v[64:65], v[22:23] op_sel_hi:[1,0]
  v_pk_mul_f32 v[66:67], v[66:67], v[22:23] op_sel_hi:[1,0]
  v_pk_mul_f32 v[68:69], v[68:69], v[22:23] op_sel_hi:[1,0]
  v_pk_mul_f32 v[70:71], v[70:71], v[22:23] op_sel_hi:[1,0]
  v_pk_mul_f32 v[72:73], v[72:73], v[22:23] op_sel_hi:[1,0]
  v_pk_mul_f32 v[74:75], v[74:75], v[22:23] op_sel_hi:[1,0]
  v_pk_mul_f32 v[76:77], v[76:77], v[22:23] op_sel_hi:[1,0]
  v_pk_mul_f32 v[78:79], v[78:79], v[22:23] op_sel_hi:[1,0]
  s_add_u32 m0, s53, 17280
  s_cbranch_vccnz 9f
  s_waitcnt vmcnt(6)
9:
  s_waitcnt vmcnt(10)
  buffer_load_dwordx4 v5, s[24:27], s52 offen offset:2176 nt lds
  s_xor_b32 s52, s52, 16384
  s_cmp_eq_u32 s96, 1
  s_cbranch_scc0 1f
  v_cmp_lt_i32 s[92:93], 0, v250
  s_nop 0
  s_bcnt1_i32_b32 s60, s92
  v_mov_b32 v250, s60
  s_mov_b64 exec, 1
  buffer_store_dword v250, off, s[40:43], s95 offset:512
  buffer_store_dword v250, off, s[40:43], s95 offset:768
  buffer_store_dword v250, off, s[40:43], s95 offset:1792
  s_mov_b64 exec, -1
1:
  ds_read_b32 v22, v231 offset:2688
  ds_read_b64_tr_b16 v[148:149], v15 offset:8192
  ds_read_b64_tr_b16 v[150:151], v15 offset:10240
  ds_read_b64_tr_b16 v[152:153], v16 offset:8192
  ds_read_b64_tr_b16 v[154:155], v16 offset:10240
  ds_read_b64_tr_b16 v[156:157], v17 offset:8192
  ds_read_b64_tr_b16 v[158:159], v17 offset:10240
  ds_read_b64_tr_b16 v[144:145], v14 offset:8192
  ds_read_b64_tr_b16 v[146:147], v14 offset:10240
  s_add_u32 m0, s53, 20480
  s_cbranch_vccnz 9f
  s_waitcnt vmcnt(5)
9:
  s_waitcnt vmcnt(10)
  buffer_load_dwordx4 v5, s[24:27], s52 offen nt lds
  s_barrier
  s_waitcnt lgkmcnt(0)
  v_mfma_f32_32x32x16_bf16 v[80:95], v[148:151], a[160:163], v[80:95]
  v_mfma_f32_32x32x16_bf16 v[96:111], v[152:155], a[160:163], v[96:111]
  v_mfma_f32_32x32x16_bf16 v[112:127], v[156:159], a[160:163], v[112:127]
  v_mfma_f32_32x32x16_bf16 v[64:79], v[144:147], a[160:163], v[64:79]
  s_cbranch_vccnz 9f
  s_waitcnt vmcnt(5)
9:
  s_waitcnt vmcnt(10)
  buffer_load_dwordx4 v5, s[24:27], s52 offen offset:2048 nt lds
  s_add_u32 m0, s53, 21376
  s_cbranch_vccnz 9f
  s_waitcnt vmcnt(5)
9:
  s_waitcnt vmcnt(9)
  buffer_load_dwordx4 v5, s[24:27], s52 offen offset:128 nt lds
  s_add_u32 m0, s53, 30720
  s_nop 0
  buffer_load_dwordx4 v18, s[36:39], s98 offen lds
  s_addk_i32 s98, 4608
  s_add_u32 m0, s53, 21376
  s_cbranch_vccnz 9f
  s_waitcnt vmcnt(6)
9:
  s_waitcnt vmcnt(9)
  buffer_load_dwordx4 v5, s[24:27], s52 offen offset:2176 nt lds
  s_xor_b32 s52, s52, 0x54000
  ds_read_b64_tr_b16 v[164:165], v15 offset:12288
  ds_read_b64_tr_b16 v[166:167], v15 offset:14336
  ds_read_b64_tr_b16 v[168:169], v16 offset:12288
  ds_read_b64_tr_b16 v[170:171], v16 offset:14336
  ds_read_b64_tr_b16 v[172:173], v17 offset:12288
  ds_read_b64_tr_b16 v[174:175], v17 offset:14336
  ds_read_b64_tr_b16 v[160:161], v14 offset:12288
  ds_read_b64_tr_b16 v[162:163], v14 offset:14336
  s_mov_b32 m0, s53
  s_cbranch_vccnz 9f
  s_waitcnt vmcnt(5)
9:
  s_waitcnt vmcnt(9)
  buffer_load_dwordx4 v5, s[24:27], s52 offen nt lds
  s_add_u32 s91, s91, 1
  s_and_b32 s60, s91, 3
  s_cmp_eq_u32 s60, s3
  s_cbranch_scc0 1f
  v_mov_b32 v252, s91
  s_mov_b64 exec, 1
  buffer_store_dword v252, off, s[40:43], s94 offset:256
  s_mov_b64 exec, -1
1:
  s_barrier
  buffer_load_dword v251, v254, s[40:43], s95 offen offset:256 sc1
  s_addk_i32 s97, 512
  s_add_u32 s96, s96, 30
  s_and_b32 s96, s96, 0x11f
  s_cmp_eq_u32 s96, 0
  s_cbranch_scc0 1f
  s_add_u32 s60, s97, s95
  s_mov_b32 exec_hi, 0
  buffer_store_dword v253, v254, s[40:43], s60 offen sc1
  s_mov_b32 exec_hi, -1
1:
  s_waitcnt lgkmcnt(0)
  v_mfma_f32_32x32x16_bf16 v[80:95], v[164:167], a[164:167], v[80:95]
  v_mfma_f32_32x32x16_bf16 v[96:111], v[168:171], a[164:167], v[96:111]
  v_mfma_f32_32x32x16_bf16 v[112:127], v[172:175], a[164:167], v[112:127]
  v_mfma_f32_32x32x16_bf16 v[64:79], v[160:163], a[164:167], v[64:79]
  s_cbranch_vccnz 9f
  s_waitcnt vmcnt(6)
9:
  s_waitcnt vmcnt(10)
  buffer_load_dwordx4 v5, s[24:27], s52 offen offset:2048 nt lds
  s_nop 5
  v_pk_mul_f32 v[80:81], v[80:81], v[22:23] op_sel_hi:[1,0]
  v_pk_mul_f32 v[82:83], v[82:83], v[22:23] op_sel_hi:[1,0]
  v_pk_mul_f32 v[84:85], v[84:85], v[22:23] op_sel_hi:[1,0]
  v_pk_mul_f32 v[86:87], v[86:87], v[22:23] op_sel_hi:[1,0]
  v_pk_mul_f32 v[88:89], v[88:89], v[22:23] op_sel_hi:[1,0]
  v_pk_mul_f32 v[90:91], v[90:91], v[22:23] op_sel_hi:[1,0]
  v_pk_mul_f32 v[92:93], v[92:93], v[22:23] op_sel_hi:[1,0]
  v_pk_mul_f32 v[94:95], v[94:95], v[22:23] op_sel_hi:[1,0]
  v_pk_mul_f32 v[96:97], v[96:97], v[22:23] op_sel_hi:[1,0]
  v_pk_mul_f32 v[98:99], v[98:99], v[22:23] op_sel_hi:[1,0]
  v_pk_mul_f32 v[100:101], v[100:101], v[22:23] op_sel_hi:[1,0]
  v_pk_mul_f32 v[102:103], v[102:103], v[22:23] op_sel_hi:[1,0]
  v_pk_mul_f32 v[104:105], v[104:105], v[22:23] op_sel_hi:[1,0]
  v_pk_mul_f32 v[106:107], v[106:107], v[22:23] op_sel_hi:[1,0]
  v_pk_mul_f32 v[108:109], v[108:109], v[22:23] op_sel_hi:[1,0]
  v_pk_mul_f32 v[110:111], v[110:111], v[22:23] op_sel_hi:[1,0]
  s_add_u32 m0, s53, 896
  s_cbranch_vccnz 9f
  s_waitcnt vmcnt(6)
9:
  s_waitcnt vmcnt(10)
  buffer_load_dwordx4 v5, s[24:27], s52 offen offset:128 nt lds
  s_cmp_eq_u32 s96, 1
  s_cbranch_scc0 1f
  buffer_load_dword v250, v249, s[40:43], s97 offen sc1
1:
  s_add_u32 m0, s53, 31744
  s_nop 0
  buffer_load_dwordx4 v18, s[36:39], s98 offen lds
  v_pk_mul_f32 v[112:113], v[112:113], v[22:23] op_sel_hi:[1,0]
  v_pk_mul_f32 v[114:115], v[114:115], v[22:23] op_sel_hi:[1,0]
  v_pk_mul_f32 v[116:117], v[116:117], v[22:23] op_sel_hi:[1,0]
  v_pk_mul_f32 v[118:119], v[118:119], v[22:23] op_sel_hi:[1,0]
  v_pk_mul_f32 v[120:121], v[120:121], v[22:23] op_sel_hi:[1,0]
  v_pk_mul_f32 v[122:123], v[122:123], v[22:23] op_sel_hi:[1,0]
  v_pk_mul_f32 v[124:125], v[124:125], v[22:23] op_sel_hi:[1,0]
  v_pk_mul_f32 v[126:127], v[126:127], v[22:23] op_sel_hi:[1,0]
  v_pk_mul_f32 v[64:65], v[64:65], v[22:23] op_sel_hi:[1,0]
  v_pk_mul_f32 v[66:67], v[66:67], v[22:23] op_sel_hi:[1,0]
  v_pk_mul_f32 v[68:69], v[68:69], v[22:23] op_sel_hi:[1,0]
  v_pk_mul_f32 v[70:71], v[70:71], v[22:23] op_sel_hi:[1,0]
  v_pk_mul_f32 v[72:73], v[72:73], v[22:23] op_sel_hi:[1,0]
  v_pk_mul_f32 v[74:75], v[74:75], v[22:23] op_sel_hi:[1,0]
  v_pk_mul_f32 v[76:77], v[76:77], v[22:23] op_sel_hi:[1,0]
  v_pk_mul_f32 v[78:79], v[78:79], v[22:23] op_sel_hi:[1,0]
  s_add_u32 m0, s53, 896
  s_cbranch_vccnz 9f
  s_waitcnt vmcnt(7)
9:
  s_waitcnt vmcnt(10)
  buffer_load_dwordx4 v5, s[24:27], s52 offen offset:2176 nt lds
  s_xor_b32 s52, s52, 16384
  ds_read_b32 v22, v231 offset:2816
  ds_read_b64_tr_b16 v[148:149], v15 offset:16384
  ds_read_b64_tr_b16 v[150:151], v15 offset:18432
  ds_read_b64_tr_b16 v[152:153], v16 offset:16384
  ds_read_b64_tr_b16 v[154:155], v16 offset:18432
  ds_read_b64_tr_b16 v[156:157], v17 offset:16384
  ds_read_b64_tr_b16 v[158:159], v17 offset:18432
  ds_read_b64_tr_b16 v[144:145], v14 offset:16384
  ds_read_b64_tr_b16 v[146:147], v14 offset:18432
  s_add_u32 m0, s53, 4096
  s_cbranch_vccnz 9f
  s_waitcnt vmcnt(6)
9:
  s_waitcnt vmcnt(10)
  buffer_load_dwordx4 v5, s[24:27], s52 offen nt lds
  s_barrier
  ds_read_b64_tr_b16 a[128:129], v20
  ds_read_b64_tr_b16 a[132:133], v20 offset:32
  ds_read_b64_tr_b16 a[136:137], v243
  ds_read_b64_tr_b16 a[140:141], v243 offset:32
  ds_read_b64_tr_b16 a[144:145], v244
  ds_read_b64_tr_b16 a[148:149], v244 offset:32
  s_waitcnt lgkmcnt(14)
  ds_read_b64_tr_b16 a[152:153], v245
  s_waitcnt lgkmcnt(14)
  ds_read_b64_tr_b16 a[156:157], v245 offset:32
  s_waitcnt lgkmcnt(8)
  v_mfma_f32_32x32x16_bf16 v[80:95], v[148:151], a[168:171], v[80:95]
  v_mfma_f32_32x32x16_bf16 v[96:111], v[152:155], a[168:171], v[96:111]
  v_mfma_f32_32x32x16_bf16 v[112:127], v[156:159], a[168:171], v[112:127]
  v_mfma_f32_32x32x16_bf16 v[64:79], v[144:147], a[168:171], v[64:79]
  s_cbranch_vccnz 9f
  s_waitcnt vmcnt(6)
9:
  s_waitcnt vmcnt(10)
  buffer_load_dwordx4 v5, s[24:27], s52 offen offset:2048 nt lds
  s_waitcnt lgkmcnt(0)
  s_lshl_b32 s62, s3, 1
  s_xor_b32 s62, s62, 14
  s_mul_i32 s62, s62, 18432
  s_add_u32 s62, s62, s66
  s_add_u32 m0, s53, 24576
  s_nop 0
  buffer_load_dwordx4 v18, s[36:39], s62 offen lds
  s_addk_i32 s62, 4608
  s_add_u32 m0, s53, 4992
  s_cbranch_vccnz 9f
  s_waitcnt vmcnt(6)
9:
  s_waitcnt vmcnt(11)
  buffer_load_dwordx4 v5, s[24:27], s52 offen offset:128 nt lds
  s_cbranch_vccnz 9f
  s_waitcnt vmcnt(6)
9:
  s_waitcnt vmcnt(10)
  buffer_load_dwordx4 v5, s[24:27], s52 offen offset:2176 nt lds
  s_xor_b32 s52, s52, 0x14000
  ds_read_b64_tr_b16 v[164:165], v15 offset:20480
  ds_read_b64_tr_b16 v[166:167], v15 offset:22528
  ds_read_b64_tr_b16 v[168:169], v16 offset:20480
  ds_read_b64_tr_b16 v[170:171], v16 offset:22528
  ds_read_b64_tr_b16 v[172:173], v17 offset:20480
  ds_read_b64_tr_b16 v[174:175], v17 offset:22528
  ds_read_b64_tr_b16 v[160:161], v14 offset:20480
  ds_read_b64_tr_b16 v[162:163], v14 offset:22528
  s_add_u32 m0, s53, 8192
  s_cbranch_vccnz 9f
  s_waitcnt vmcnt(5)
9:
  s_waitcnt vmcnt(10)
  buffer_load_dwordx4 v5, s[24:27], s52 offen nt lds
  s_barrier
  s_waitcnt lgkmcnt(0)
  v_mfma_f32_32x32x16_bf16 v[80:95], v[164:167], a[172:175], v[80:95]
  v_mfma_f32_32x32x16_bf16 v[96:111], v[168:171], a[172:175], v[96:111]
  v_mfma_f32_32x32x16_bf16 v[112:127], v[172:175], a[172:175], v[112:127]
  v_mfma_f32_32x32x16_bf16 v[64:79], v[160:163], a[172:175], v[64:79]
  s_cbranch_vccnz 9f
  s_waitcnt vmcnt(5)
9:
  s_waitcnt vmcnt(9)
  buffer_load_dwordx4 v5, s[24:27], s52 offen offset:2048 nt lds
  v_add_u32 v248, v248, v247
  v_cmp_le_i32 s[92:93], v248, v251
  s_nop 0
  s_bcnt1_i32_b64 s60, s[92:93]
  s_cmp_ge_u32 s60, 33
  s_cselect_b64 vcc, -1, 0
  s_add_u32 m0, s53, 25600
  s_nop 0
  buffer_load_dwordx4 v18, s[36:39], s62 offen lds
  s_addk_i32 s62, 4608
  v_pk_mul_f32 v[80:81], v[80:81], v[22:23] op_sel_hi:[1,0]
  v_pk_mul_f32 v[82:83], v[82:83], v[22:23] op_sel_hi:[1,0]
  v_pk_mul_f32 v[84:85], v[84:85], v[22:23] op_sel_hi:[1,0]
  v_pk_mul_f32 v[86:87], v[86:87], v[22:23] op_sel_hi:[1,0]
  v_pk_mul_f32 v[88:89], v[88:89], v[22:23] op_sel_hi:[1,0]
  v_pk_mul_f32 v[90:91], v[90:91], v[22:23] op_sel_hi:[1,0]
  v_pk_mul_f32 v[92:93], v[92:93], v[22:23] op_sel_hi:[1,0]
  v_pk_mul_f32 v[94:95], v[94:95], v[22:23] op_sel_hi:[1,0]
  v_pk_mul_f32 v[96:97], v[96:97], v[22:23] op_sel_hi:[1,0]
  v_pk_mul_f32 v[98:99], v[98:99], v[22:23] op_sel_hi:[1,0]
  v_pk_mul_f32 v[100:101], v[100:101], v[22:23] op_sel_hi:[1,0]
  v_pk_mul_f32 v[102:103], v[102:103], v[22:23] op_sel_hi:[1,0]
  v_pk_mul_f32 v[104:105], v[104:105], v[22:23] op_sel_hi:[1,0]
  v_pk_mul_f32 v[106:107], v[106:107], v[22:23] op_sel_hi:[1,0]
  v_pk_mul_f32 v[108:109], v[108:109], v[22:23] op_sel_hi:[1,0]
  v_pk_mul_f32 v[110:111], v[110:111], v[22:23] op_sel_hi:[1,0]
  s_add_u32 m0, s53, 9088
  s_cbranch_vccnz 9f
  s_waitcnt vmcnt(6)
9:
  s_waitcnt vmcnt(10)
  buffer_load_dwordx4 v5, s[24:27], s52 offen offset:128 nt lds
  v_pk_mul_f32 v[112:113], v[112:113], v[22:23] op_sel_hi:[1,0]
  v_pk_mul_f32 v[114:115], v[114:115], v[22:23] op_sel_hi:[1,0]
  v_pk_mul_f32 v[116:117], v[116:117], v[22:23] op_sel_hi:[1,0]
  v_pk_mul_f32 v[118:119], v[118:119], v[22:23] op_sel_hi:[1,0]
  v_pk_mul_f32 v[120:121], v[120:121], v[22:23] op_sel_hi:[1,0]
  v_pk_mul_f32 v[122:123], v[122:123], v[22:23] op_sel_hi:[1,0]
  v_pk_mul_f32 v[124:125], v[124:125], v[22:23] op_sel_hi:[1,0]
  v_pk_mul_f32 v[126:127], v[126:127], v[22:23] op_sel_hi:[1,0]
  v_pk_mul_f32 v[64:65], v[64:65], v[22:23] op_sel_hi:[1,0]
  v_pk_mul_f32 v[66:67], v[66:67], v[22:23] op_sel_hi:[1,0]
  v_pk_mul_f32 v[68:69], v[68:69], v[22:23] op_sel_hi:[1,0]
  v_pk_mul_f32 v[70:71], v[70:71], v[22:23] op_sel_hi:[1,0]
  v_pk_mul_f32 v[72:73], v[72:73], v[22:23] op_sel_hi:[1,0]
  v_pk_mul_f32 v[74:75], v[74:75], v[22:23] op_sel_hi:[1,0]
  v_pk_mul_f32 v[76:77], v[76:77], v[22:23] op_sel_hi:[1,0]
  v_pk_mul_f32 v[78:79], v[78:79], v[22:23] op_sel_hi:[1,0]
  s_cbranch_vccnz 9f
  s_waitcnt vmcnt(5)
9:
  s_waitcnt vmcnt(9)
  buffer_load_dwordx4 v5, s[24:27], s52 offen offset:2176 nt lds
  s_xor_b32 s52, s52, 16384
  s_cmp_eq_u32 s96, 1
  s_cbranch_scc0 1f
  v_cmp_lt_i32 s[92:93], 0, v250
  s_nop 0
  s_bcnt1_i32_b32 s60, s92
  v_mov_b32 v250, s60
  s_mov_b64 exec, 1
  buffer_store_dword v250, off, s[40:43], s95 offset:512
  buffer_store_dword v250, off, s[40:43], s95 offset:768
  buffer_store_dword v250, off, s[40:43], s95 offset:1792
  s_mov_b64 exec, -1
1:
  ds_read_b32 v22, v231 offset:2944
  ds_read_b64_tr_b16 v[148:149], v15
  ds_read_b64_tr_b16 v[150:151], v15 offset:2048
  ds_read_b64_tr_b16 v[152:153], v16
  ds_read_b64_tr_b16 v[154:155], v16 offset:2048
  ds_read_b64_tr_b16 v[156:157], v17
  ds_read_b64_tr_b16 v[158:159], v17 offset:2048
  ds_read_b64_tr_b16 v[144:145], v14
  ds_read_b64_tr_b16 v[146:147], v14 offset:2048
  s_add_u32 m0, s53, 12288
  s_cbranch_vccnz 9f
  s_waitcnt vmcnt(5)
9:
  s_waitcnt vmcnt(9)
  buffer_load_dwordx4 v5, s[24:27], s52 offen nt lds
  s_barrier
  s_waitcnt lgkmcnt(0)
  v_mfma_f32_32x32x16_bf16 v[80:95], v[148:151], a[176:179], v[80:95]
  v_mfma_f32_32x32x16_bf16 v[96:111], v[152:155], a[176:179], v[96:111]
  v_mfma_f32_32x32x16_bf16 v[112:127], v[156:159], a[176:179], v[112:127]
  v_mfma_f32_32x32x16_bf16 v[64:79], v[144:147], a[176:179], v[64:79]
  s_cbranch_vccnz 9f
  s_waitcnt vmcnt(5)
9:
  s_waitcnt vmcnt(9)
  buffer_load_dwordx4 v5, s[24:27], s52 offen offset:2048 nt lds
  s_add_u32 m0, s53, 26624
  s_nop 0
  buffer_load_dwordx4 v18, s[36:39], s62 offen lds
  s_addk_i32 s62, 4608
  s_add_u32 m0, s53, 13184
  s_cbranch_vccnz 9f
  s_waitcnt vmcnt(6)
9:
  s_waitcnt vmcnt(9)
  buffer_load_dwordx4 v5, s[24:27], s52 offen offset:128 nt lds
  s_cbranch_vccnz 9f
  s_waitcnt vmcnt(5)
9:
  s_waitcnt vmcnt(9)
  buffer_load_dwordx4 v5, s[24:27], s52 offen offset:2176 nt lds
  s_xor_b32 s52, s52, 0x1d4000
  ds_read_b64_tr_b16 v[164:165], v15 offset:4096
  ds_read_b64_tr_b16 v[166:167], v15 offset:6144
  ds_read_b64_tr_b16 v[168:169], v16 offset:4096
  ds_read_b64_tr_b16 v[170:171], v16 offset:6144
  ds_read_b64_tr_b16 v[172:173], v17 offset:4096
  ds_read_b64_tr_b16 v[174:175], v17 offset:6144
  ds_read_b64_tr_b16 v[160:161], v14 offset:4096
  ds_read_b64_tr_b16 v[162:163], v14 offset:6144
  s_add_u32 m0, s53, 16384
  s_cbranch_vccnz 9f
  s_waitcnt vmcnt(5)
9:
  s_waitcnt vmcnt(9)
  buffer_load_dwordx4 v5, s[24:27], s52 offen nt lds
  s_add_u32 s91, s91, 1
  s_and_b32 s60, s91, 3
  s_cmp_eq_u32 s60, s3
  s_cbranch_scc0 1f
  v_mov_b32 v252, s91
  s_mov_b64 exec, 1
  buffer_store_dword v252, off, s[40:43], s94 offset:1280
  s_mov_b64 exec, -1
1:
  s_barrier
  buffer_load_dword v246, v254, s[40:43], s95 offen offset:1280 sc1
  s_addk_i32 s97, 512
  s_add_u32 s96, s96, 30
  s_and_b32 s96, s96, 0x11f
  s_cmp_eq_u32 s96, 0
  s_cbranch_scc0 1f
  s_add_u32 s60, s97, s95
  s_mov_b32 exec_hi, 0
  buffer_store_dword v253, v254, s[40:43], s60 offen sc1
  s_mov_b32 exec_hi, -1
1:
  s_waitcnt lgkmcnt(0)
  v_mfma_f32_32x32x16_bf16 v[80:95], v[164:167], a[180:183], v[80:95]
  v_mfma_f32_32x32x16_bf16 v[96:111], v[168:171], a[180:183], v[96:111]
  v_mfma_f32_32x32x16_bf16 v[112:127], v[172:175], a[180:183], v[112:127]
  v_mfma_f32_32x32x16_bf16 v[64:79], v[160:163], a[180:183], v[64:79]
  s_cbranch_vccnz 9f
  s_waitcnt vmcnt(6)
9:
  s_waitcnt vmcnt(10)
  buffer_load_dwordx4 v5, s[24:27], s52 offen offset:2048 nt lds
  ds_read_b64_tr_b16 a[130:131], v20 offset:4096
  ds_read_b64_tr_b16 a[134:135], v20 offset:4128
  ds_read_b64_tr_b16 a[138:139], v243 offset:4096
  ds_read_b64_tr_b16 a[142:143], v243 offset:4128
  ds_read_b64_tr_b16 a[146:147], v244 offset:4096
  ds_read_b64_tr_b16 a[150:151], v244 offset:4128
  ds_read_b64_tr_b16 a[154:155], v245 offset:4096
  ds_read_b64_tr_b16 a[158:159], v245 offset:4128
  s_add_u32 m0, s53, 27648
  s_nop 0
  buffer_load_dwordx4 v18, s[36:39], s62 offen lds
  v_pk_mul_f32 v[80:81], v[80:81], v[22:23] op_sel_hi:[1,0]
  v_pk_mul_f32 v[82:83], v[82:83], v[22:23] op_sel_hi:[1,0]
  v_pk_mul_f32 v[84:85], v[84:85], v[22:23] op_sel_hi:[1,0]
  v_pk_mul_f32 v[86:87], v[86:87], v[22:23] op_sel_hi:[1,0]
  v_pk_mul_f32 v[88:89], v[88:89], v[22:23] op_sel_hi:[1,0]
  v_pk_mul_f32 v[90:91], v[90:91], v[22:23] op_sel_hi:[1,0]
  v_pk_mul_f32 v[92:93], v[92:93], v[22:23] op_sel_hi:[1,0]
  v_pk_mul_f32 v[94:95], v[94:95], v[22:23] op_sel_hi:[1,0]
  v_pk_mul_f32 v[96:97], v[96:97], v[22:23] op_sel_hi:[1,0]
  v_pk_mul_f32 v[98:99], v[98:99], v[22:23] op_sel_hi:[1,0]
  v_pk_mul_f32 v[100:101], v[100:101], v[22:23] op_sel_hi:[1,0]
  v_pk_mul_f32 v[102:103], v[102:103], v[22:23] op_sel_hi:[1,0]
  v_pk_mul_f32 v[104:105], v[104:105], v[22:23] op_sel_hi:[1,0]
  v_pk_mul_f32 v[106:107], v[106:107], v[22:23] op_sel_hi:[1,0]
  v_pk_mul_f32 v[108:109], v[108:109], v[22:23] op_sel_hi:[1,0]
  v_pk_mul_f32 v[110:111], v[110:111], v[22:23] op_sel_hi:[1,0]
  s_add_u32 m0, s53, 17280
  s_cbranch_vccnz 9f
  s_waitcnt vmcnt(7)
9:
  s_waitcnt vmcnt(10)
  buffer_load_dwordx4 v5, s[24:27], s52 offen offset:128 nt lds
  s_cmp_eq_u32 s96, 1
  s_cbranch_scc0 1f
  buffer_load_dword v250, v249, s[40:43], s97 offen sc1
1:
  s_waitcnt lgkmcnt(0)
  s_lshl_b32 s98, s3, 1
  s_xor_b32 s98, s98, 15
  s_mul_i32 s98, s98, 18432
  s_add_u32 s98, s98, s66
  s_add_u32 m0, s53, 28672
  s_nop 0
  buffer_load_dwordx4 v18, s[36:39], s98 offen lds
  s_addk_i32 s98, 4608
  v_pk_mul_f32 v[112:113], v[112:113], v[22:23] op_sel_hi:[1,0]
  v_pk_mul_f32 v[114:115], v[114:115], v[22:23] op_sel_hi:[1,0]
  v_pk_mul_f32 v[116:117], v[116:117], v[22:23] op_sel_hi:[1,0]
  v_pk_mul_f32 v[118:119], v[118:119], v[22:23] op_sel_hi:[1,0]
  v_pk_mul_f32 v[120:121], v[120:121], v[22:23] op_sel_hi:[1,0]
  v_pk_mul_f32 v[122:123], v[122:123], v[22:23] op_sel_hi:[1,0]
  v_pk_mul_f32 v[124:125], v[124:125], v[22:23] op_sel_hi:[1,0]
  v_pk_mul_f32 v[126:127], v[126:127], v[22:23] op_sel_hi:[1,0]
  v_pk_mul_f32 v[64:65], v[64:65], v[22:23] op_sel_hi:[1,0]
  v_pk_mul_f32 v[66:67], v[66:67], v[22:23] op_sel_hi:[1,0]
  v_pk_mul_f32 v[68:69], v[68:69], v[22:23] op_sel_hi:[1,0]
  v_pk_mul_f32 v[70:71], v[70:71], v[22:23] op_sel_hi:[1,0]
  v_pk_mul_f32 v[72:73], v[72:73], v[22:23] op_sel_hi:[1,0]
  v_pk_mul_f32 v[74:75], v[74:75], v[22:23] op_sel_hi:[1,0]
  v_pk_mul_f32 v[76:77], v[76:77], v[22:23] op_sel_hi:[1,0]
  v_pk_mul_f32 v[78:79], v[78:79], v[22:23] op_sel_hi:[1,0]
  s_add_u32 m0, s53, 17280
  s_cbranch_vccnz 9f
  s_waitcnt vmcnt(7)
9:
  s_waitcnt vmcnt(11)
  buffer_load_dwordx4 v5, s[24:27], s52 offen offset:2176 nt lds
  s_xor_b32 s52, s52, 16384
  ds_read_b32 v22, v231 offset:3072
  ds_read_b64_tr_b16 v[148:149], v15 offset:8192
  ds_read_b64_tr_b16 v[150:151], v15 offset:10240
  ds_read_b64_tr_b16 v[152:153], v16 offset:8192
  ds_read_b64_tr_b16 v[154:155], v16 offset:10240
  ds_read_b64_tr_b16 v[156:157], v17 offset:8192
  ds_read_b64_tr_b16 v[158:159], v17 offset:10240
  ds_read_b64_tr_b16 v[144:145], v14 offset:8192
  ds_read_b64_tr_b16 v[146:147], v14 offset:10240
  s_add_u32 m0, s53, 20480
  s_cbranch_vccnz 9f
  s_waitcnt vmcnt(7)
9:
  s_waitcnt vmcnt(11)
  buffer_load_dwordx4 v5, s[24:27], s52 offen nt lds
  s_add_u32 s91, s91, 1
  s_and_b32 s60, s91, 3
  s_cmp_eq_u32 s60, s3
  s_cbranch_scc0 1f
  v_mov_b32 v252, s91
  s_mov_b64 exec, 1
  buffer_store_dword v252, off, s[40:43], s94
  s_mov_b64 exec, -1
1:
  s_barrier
  buffer_load_dword v255, v254, s[40:43], s95 offen sc1
  s_waitcnt lgkmcnt(0)
  v_mfma_f32_32x32x16_bf16 v[80:95], v[148:151], a[184:187], v[80:95]
  v_mfma_f32_32x32x16_bf16 v[96:111], v[152:155], a[184:187], v[96:111]
  v_mfma_f32_32x32x16_bf16 v[112:127], v[156:159], a[184:187], v[112:127]
  v_mfma_f32_32x32x16_bf16 v[64:79], v[144:147], a[184:187], v[64:79]
  s_cbranch_vccnz 9f
  s_waitcnt vmcnt(8)
9:
  s_waitcnt vmcnt(12)
  buffer_load_dwordx4 v5, s[24:27], s52 offen offset:2048 nt lds
  s_add_u32 m0, s53, 21376
  s_cbranch_vccnz 9f
  s_waitcnt vmcnt(7)
9:
  s_waitcnt vmcnt(11)
  buffer_load_dwordx4 v5, s[24:27], s52 offen offset:128 nt lds
  s_add_u32 m0, s53, 29696
  s_nop 0
  buffer_load_dwordx4 v18, s[36:39], s98 offen lds
  s_addk_i32 s98, 4608
  s_add_u32 m0, s53, 21376
  s_cbranch_vccnz 9f
  s_waitcnt vmcnt(7)
9:
  s_waitcnt vmcnt(12)
  buffer_load_dwordx4 v5, s[24:27], s52 offen offset:2176 nt lds
  s_xor_b32 s52, s52, 0x14000
  ds_read_b64_tr_b16 v[164:165], v15 offset:12288
  ds_read_b64_tr_b16 v[166:167], v15 offset:14336
  ds_read_b64_tr_b16 v[168:169], v16 offset:12288
  ds_read_b64_tr_b16 v[170:171], v16 offset:14336
  ds_read_b64_tr_b16 v[172:173], v17 offset:12288
  ds_read_b64_tr_b16 v[174:175], v17 offset:14336
  ds_read_b64_tr_b16 v[160:161], v14 offset:12288
  ds_read_b64_tr_b16 v[162:163], v14 offset:14336
  s_mov_b32 m0, s53
  s_cbranch_vccnz 9f
  s_waitcnt vmcnt(6)
9:
  s_waitcnt vmcnt(12)
  buffer_load_dwordx4 v5, s[24:27], s52 offen nt lds
  s_add_u32 s91, s91, 1
  s_and_b32 s60, s91, 3
  s_cmp_eq_u32 s60, s3
  s_cbranch_scc0 1f
  v_mov_b32 v252, s91
  s_mov_b64 exec, 1
  buffer_store_dword v252, off, s[40:43], s94 offset:256
  s_mov_b64 exec, -1
1:
  s_barrier
  buffer_load_dword v251, v254, s[40:43], s95 offen offset:256 sc1
  s_waitcnt lgkmcnt(0)
  v_mfma_f32_32x32x16_bf16 v[80:95], v[164:167], a[188:191], v[80:95]
  v_mfma_f32_32x32x16_bf16 v[96:111], v[168:171], a[188:191], v[96:111]
  v_mfma_f32_32x32x16_bf16 v[112:127], v[172:175], a[188:191], v[112:127]
  v_mfma_f32_32x32x16_bf16 v[64:79], v[160:163], a[188:191], v[64:79]
  s_cbranch_vccnz 9f
  s_waitcnt vmcnt(7)
9:
  s_waitcnt vmcnt(12)
  buffer_load_dwordx4 v5, s[24:27], s52 offen offset:2048 nt lds
  v_add_u32 v248, v248, v247
  v_cmp_le_i32 s[92:93], v248, v246
  s_nop 0
  s_bcnt1_i32_b64 s60, s[92:93]
  s_cmp_ge_u32 s60, 33
  s_cselect_b64 vcc, -1, 0
  v_pk_mul_f32 v[80:81], v[80:81], v[22:23] op_sel_hi:[1,0]
  v_pk_mul_f32 v[82:83], v[82:83], v[22:23] op_sel_hi:[1,0]
  v_pk_mul_f32 v[84:85], v[84:85], v[22:23] op_sel_hi:[1,0]
  v_pk_mul_f32 v[86:87], v[86:87], v[22:23] op_sel_hi:[1,0]
  v_pk_mul_f32 v[88:89], v[88:89], v[22:23] op_sel_hi:[1,0]
  v_pk_mul_f32 v[90:91], v[90:91], v[22:23] op_sel_hi:[1,0]
  v_pk_mul_f32 v[92:93], v[92:93], v[22:23] op_sel_hi:[1,0]
  v_pk_mul_f32 v[94:95], v[94:95], v[22:23] op_sel_hi:[1,0]
  v_pk_mul_f32 v[96:97], v[96:97], v[22:23] op_sel_hi:[1,0]
  v_pk_mul_f32 v[98:99], v[98:99], v[22:23] op_sel_hi:[1,0]
  v_pk_mul_f32 v[100:101], v[100:101], v[22:23] op_sel_hi:[1,0]
  v_pk_mul_f32 v[102:103], v[102:103], v[22:23] op_sel_hi:[1,0]
  v_pk_mul_f32 v[104:105], v[104:105], v[22:23] op_sel_hi:[1,0]
  v_pk_mul_f32 v[106:107], v[106:107], v[22:23] op_sel_hi:[1,0]
  v_pk_mul_f32 v[108:109], v[108:109], v[22:23] op_sel_hi:[1,0]
  v_pk_mul_f32 v[110:111], v[110:111], v[22:23] op_sel_hi:[1,0]
  s_add_u32 m0, s53, 896
  s_cbranch_vccnz 9f
  s_waitcnt vmcnt(6)
9:
  s_waitcnt vmcnt(11)
  buffer_load_dwordx4 v5, s[24:27], s52 offen offset:128 nt lds
  s_add_u32 m0, s53, 30720
  s_nop 0
  buffer_load_dwordx4 v18, s[36:39], s98 offen lds
  s_addk_i32 s98, 4608
  v_pk_mul_f32 v[112:113], v[112:113], v[22:23] op_sel_hi:[1,0]
  v_pk_mul_f32 v[114:115], v[114:115], v[22:23] op_sel_hi:[1,0]
  v_pk_mul_f32 v[116:117], v[116:117], v[22:23] op_sel_hi:[1,0]
  v_pk_mul_f32 v[118:119], v[118:119], v[22:23] op_sel_hi:[1,0]
  v_pk_mul_f32 v[120:121], v[120:121], v[22:23] op_sel_hi:[1,0]
  v_pk_mul_f32 v[122:123], v[122:123], v[22:23] op_sel_hi:[1,0]
  v_pk_mul_f32 v[124:125], v[124:125], v[22:23] op_sel_hi:[1,0]
  v_pk_mul_f32 v[126:127], v[126:127], v[22:23] op_sel_hi:[1,0]
  v_pk_mul_f32 v[64:65], v[64:65], v[22:23] op_sel_hi:[1,0]
  v_pk_mul_f32 v[66:67], v[66:67], v[22:23] op_sel_hi:[1,0]
  v_pk_mul_f32 v[68:69], v[68:69], v[22:23] op_sel_hi:[1,0]
  v_pk_mul_f32 v[70:71], v[70:71], v[22:23] op_sel_hi:[1,0]
  v_pk_mul_f32 v[72:73], v[72:73], v[22:23] op_sel_hi:[1,0]
  v_pk_mul_f32 v[74:75], v[74:75], v[22:23] op_sel_hi:[1,0]
  v_pk_mul_f32 v[76:77], v[76:77], v[22:23] op_sel_hi:[1,0]
  v_pk_mul_f32 v[78:79], v[78:79], v[22:23] op_sel_hi:[1,0]
  s_add_u32 m0, s53, 896
  s_cbranch_vccnz 9f
  s_waitcnt vmcnt(7)
9:
  s_waitcnt vmcnt(11)
  buffer_load_dwordx4 v5, s[24:27], s52 offen offset:2176 nt lds
  s_xor_b32 s52, s52, 16384
  s_cmp_eq_u32 s96, 1
  s_cbranch_scc0 1f
  v_cmp_lt_i32 s[92:93], 0, v250
  s_nop 0
  s_bcnt1_i32_b32 s60, s92
  v_mov_b32 v250, s60
  s_mov_b64 exec, 1
  buffer_store_dword v250, off, s[40:43], s95 offset:1792
  s_mov_b64 exec, -1
1:
  ds_read_b32 v22, v231 offset:3200
  ds_read_b64_tr_b16 v[148:149], v15 offset:16384
  ds_read_b64_tr_b16 v[150:151], v15 offset:18432
  ds_read_b64_tr_b16 v[152:153], v16 offset:16384
  ds_read_b64_tr_b16 v[154:155], v16 offset:18432
  ds_read_b64_tr_b16 v[156:157], v17 offset:16384
  ds_read_b64_tr_b16 v[158:159], v17 offset:18432
  ds_read_b64_tr_b16 v[144:145], v14 offset:16384
  ds_read_b64_tr_b16 v[146:147], v14 offset:18432
  s_add_u32 m0, s53, 4096
  s_cbranch_vccnz 9f
  s_waitcnt vmcnt(6)
9:
  s_waitcnt vmcnt(11)
  buffer_load_dwordx4 v5, s[24:27], s52 offen nt lds
  s_add_u32 s91, s91, 1
  s_and_b32 s60, s91, 3
  s_cmp_eq_u32 s60, s3
  s_cbranch_scc0 1f
  v_mov_b32 v252, s91
  s_mov_b64 exec, 1
  buffer_store_dword v252, off, s[40:43], s94 offset:1280
  s_mov_b64 exec, -1
1:
  s_barrier
  buffer_load_dword v246, v254, s[40:43], s95 offen offset:1280 sc1
  s_waitcnt lgkmcnt(0)
  v_mfma_f32_32x32x16_bf16 v[80:95], v[148:151], a[192:195], v[80:95]
  v_mfma_f32_32x32x16_bf16 v[96:111], v[152:155], a[192:195], v[96:111]
  v_mfma_f32_32x32x16_bf16 v[112:127], v[156:159], a[192:195], v[112:127]
  v_mfma_f32_32x32x16_bf16 v[64:79], v[144:147], a[192:195], v[64:79]
  s_cbranch_vccnz 9f
  s_waitcnt vmcnt(7)
9:
  s_waitcnt vmcnt(11)
  buffer_load_dwordx4 v5, s[24:27], s52 offen offset:2048 nt lds
  v_add_u32 v248, v248, v247
  v_cmp_le_i32 s[92:93], v248, v255
  s_nop 0
  s_bcnt1_i32_b64 s60, s[92:93]
  s_cmp_ge_u32 s60, 33
  s_cselect_b64 vcc, -1, 0
  s_cmp_eq_u32 s96, 1
  s_cbranch_scc0 1f
  s_mov_b64 exec, 1
  buffer_store_dword v250, off, s[40:43], s95 offset:512
  s_mov_b64 exec, -1
1:
  s_add_u32 m0, s53, 4992
  s_cbranch_vccnz 9f
  s_waitcnt vmcnt(6)
9:
  s_waitcnt vmcnt(11)
  buffer_load_dwordx4 v5, s[24:27], s52 offen offset:128 nt lds
  s_add_u32 m0, s53, 31744
  s_nop 0
  buffer_load_dwordx4 v18, s[36:39], s98 offen lds
  s_add_u32 m0, s53, 4992
  s_cbranch_vccnz 9f
  s_waitcnt vmcnt(7)
9:
  s_waitcnt vmcnt(11)
  buffer_load_dwordx4 v5, s[24:27], s52 offen offset:2176 nt lds
  s_xor_b32 s52, s52, 0x54000
  ds_read_b64_tr_b16 v[164:165], v15 offset:20480
  ds_read_b64_tr_b16 v[166:167], v15 offset:22528
  ds_read_b64_tr_b16 v[168:169], v16 offset:20480
  ds_read_b64_tr_b16 v[170:171], v16 offset:22528
  ds_read_b64_tr_b16 v[172:173], v17 offset:20480
  ds_read_b64_tr_b16 v[174:175], v17 offset:22528
  ds_read_b64_tr_b16 v[160:161], v14 offset:20480
  ds_read_b64_tr_b16 v[162:163], v14 offset:22528
  s_add_u32 m0, s53, 8192
  s_cbranch_vccnz 9f
  s_waitcnt vmcnt(6)
9:
  s_waitcnt vmcnt(11)
  buffer_load_dwordx4 v5, s[24:27], s52 offen nt lds
  s_add_u32 s91, s91, 1
  s_and_b32 s60, s91, 3
  s_cmp_eq_u32 s60, s3
  s_cbranch_scc0 1f
  v_mov_b32 v252, s91
  s_mov_b64 exec, 1
  buffer_store_dword v252, off, s[40:43], s94
  s_mov_b64 exec, -1
1:
  s_barrier
  buffer_load_dword v255, v254, s[40:43], s95 offen sc1
  s_addk_i32 s97, 512
  s_add_u32 s96, s96, 30
  s_and_b32 s96, s96, 0x11f
  s_cmp_eq_u32 s96, 0
  s_cbranch_scc0 1f
  s_add_u32 s60, s97, s95
  s_mov_b32 exec_hi, 0
  buffer_store_dword v253, v254, s[40:43], s60 offen sc1
  s_mov_b32 exec_hi, -1
1:
  ds_read_b64_tr_b16 a[160:161], v20
  ds_read_b64_tr_b16 a[164:165], v20 offset:32
  ds_read_b64_tr_b16 a[168:169], v243
  ds_read_b64_tr_b16 a[172:173], v243 offset:32
  ds_read_b64_tr_b16 a[176:177], v244
  ds_read_b64_tr_b16 a[180:181], v244 offset:32
  ds_read_b64_tr_b16 a[184:185], v245
  s_waitcnt lgkmcnt(14)
  ds_read_b64_tr_b16 a[188:189], v245 offset:32
  s_waitcnt lgkmcnt(8)
  v_mfma_f32_32x32x16_bf16 v[80:95], v[164:167], a[196:199], v[80:95]
  v_mfma_f32_32x32x16_bf16 v[96:111], v[168:171], a[196:199], v[96:111]
  v_mfma_f32_32x32x16_bf16 v[112:127], v[172:175], a[196:199], v[112:127]
  v_mfma_f32_32x32x16_bf16 v[64:79], v[160:163], a[196:199], v[64:79]
  s_cbranch_vccnz 9f
  s_waitcnt vmcnt(7)
9:
  s_waitcnt vmcnt(11)
  buffer_load_dwordx4 v5, s[24:27], s52 offen offset:2048 nt lds
  v_add_u32 v248, v248, v247
  v_cmp_le_i32 s[92:93], v248, v251
  s_nop 0
  s_bcnt1_i32_b64 s60, s[92:93]
  s_cmp_ge_u32 s60, 33
  s_cselect_b64 vcc, -1, 0
  s_cmp_eq_u32 s96, 31
  s_cbranch_scc0 1f
  s_mov_b64 exec, 1
  buffer_store_dword v250, off, s[40:43], s95 offset:768
  s_mov_b64 exec, -1
1:
  v_pk_mul_f32 v[80:81], v[80:81], v[22:23] op_sel_hi:[1,0]
  v_pk_mul_f32 v[82:83], v[82:83], v[22:23] op_sel_hi:[1,0]
  v_pk_mul_f32 v[84:85], v[84:85], v[22:23] op_sel_hi:[1,0]
  v_pk_mul_f32 v[86:87], v[86:87], v[22:23] op_sel_hi:[1,0]
  v_pk_mul_f32 v[88:89], v[88:89], v[22:23] op_sel_hi:[1,0]
  v_pk_mul_f32 v[90:91], v[90:91], v[22:23] op_sel_hi:[1,0]
  v_pk_mul_f32 v[92:93], v[92:93], v[22:23] op_sel_hi:[1,0]
  v_pk_mul_f32 v[94:95], v[94:95], v[22:23] op_sel_hi:[1,0]
  v_pk_mul_f32 v[96:97], v[96:97], v[22:23] op_sel_hi:[1,0]
  v_pk_mul_f32 v[98:99], v[98:99], v[22:23] op_sel_hi:[1,0]
  v_pk_mul_f32 v[100:101], v[100:101], v[22:23] op_sel_hi:[1,0]
  v_pk_mul_f32 v[102:103], v[102:103], v[22:23] op_sel_hi:[1,0]
  v_pk_mul_f32 v[104:105], v[104:105], v[22:23] op_sel_hi:[1,0]
  v_pk_mul_f32 v[106:107], v[106:107], v[22:23] op_sel_hi:[1,0]
  v_pk_mul_f32 v[108:109], v[108:109], v[22:23] op_sel_hi:[1,0]
  v_pk_mul_f32 v[110:111], v[110:111], v[22:23] op_sel_hi:[1,0]
  s_add_u32 m0, s53, 9088
  s_cbranch_vccnz 9f
  s_waitcnt vmcnt(6)
9:
  s_waitcnt vmcnt(11)
  buffer_load_dwordx4 v5, s[24:27], s52 offen offset:128 nt lds
  s_cmp_eq_u32 s96, 1
  s_cbranch_scc0 1f
  buffer_load_dword v250, v249, s[40:43], s97 offen sc1
1:
  v_pk_mul_f32 v[112:113], v[112:113], v[22:23] op_sel_hi:[1,0]
  v_pk_mul_f32 v[114:115], v[114:115], v[22:23] op_sel_hi:[1,0]
  v_pk_mul_f32 v[116:117], v[116:117], v[22:23] op_sel_hi:[1,0]
  v_pk_mul_f32 v[118:119], v[118:119], v[22:23] op_sel_hi:[1,0]
  v_pk_mul_f32 v[120:121], v[120:121], v[22:23] op_sel_hi:[1,0]
  v_pk_mul_f32 v[122:123], v[122:123], v[22:23] op_sel_hi:[1,0]
  v_pk_mul_f32 v[124:125], v[124:125], v[22:23] op_sel_hi:[1,0]
  v_pk_mul_f32 v[126:127], v[126:127], v[22:23] op_sel_hi:[1,0]
  v_pk_mul_f32 v[64:65], v[64:65], v[22:23] op_sel_hi:[1,0]
  v_pk_mul_f32 v[66:67], v[66:67], v[22:23] op_sel_hi:[1,0]
  v_pk_mul_f32 v[68:69], v[68:69], v[22:23] op_sel_hi:[1,0]
  v_pk_mul_f32 v[70:71], v[70:71], v[22:23] op_sel_hi:[1,0]
  v_pk_mul_f32 v[72:73], v[72:73], v[22:23] op_sel_hi:[1,0]
  v_pk_mul_f32 v[74:75], v[74:75], v[22:23] op_sel_hi:[1,0]
  v_pk_mul_f32 v[76:77], v[76:77], v[22:23] op_sel_hi:[1,0]
  v_pk_mul_f32 v[78:79], v[78:79], v[22:23] op_sel_hi:[1,0]
  s_cbranch_vccnz 9f
  s_waitcnt vmcnt(6)
9:
  s_waitcnt vmcnt(10)
  buffer_load_dwordx4 v5, s[24:27], s52 offen offset:2176 nt lds
  s_xor_b32 s52, s52, 16384
  ds_read_b32 v22, v231 offset:3328
  ds_read_b64_tr_b16 v[148:149], v15
  ds_read_b64_tr_b16 v[150:151], v15 offset:2048
  ds_read_b64_tr_b16 v[152:153], v16
  ds_read_b64_tr_b16 v[154:155], v16 offset:2048
  ds_read_b64_tr_b16 v[156:157], v17
  ds_read_b64_tr_b16 v[158:159], v17 offset:2048
  s_waitcnt lgkmcnt(14)
  ds_read_b64_tr_b16 v[144:145], v14
  s_waitcnt lgkmcnt(14)
  ds_read_b64_tr_b16 v[146:147], v14 offset:2048
  s_add_u32 m0, s53, 12288
  s_cbranch_vccnz 9f
  s_waitcnt vmcnt(5)
9:
  s_waitcnt vmcnt(10)
  buffer_load_dwordx4 v5, s[24:27], s52 offen nt lds
  s_add_u32 s91, s91, 1
  s_and_b32 s60, s91, 3
  s_cmp_eq_u32 s60, s3
  s_cbranch_scc0 1f
  v_mov_b32 v252, s91
  s_mov_b64 exec, 1
  buffer_store_dword v252, off, s[40:43], s94 offset:256
  s_mov_b64 exec, -1
1:
  s_barrier
  buffer_load_dword v251, v254, s[40:43], s95 offen offset:256 sc1
  s_waitcnt lgkmcnt(0)
  v_mfma_f32_32x32x16_bf16 v[80:95], v[148:151], a[200:203], v[80:95]
  v_mfma_f32_32x32x16_bf16 v[96:111], v[152:155], a[200:203], v[96:111]
  v_mfma_f32_32x32x16_bf16 v[112:127], v[156:159], a[200:203], v[112:127]
  v_mfma_f32_32x32x16_bf16 v[64:79], v[144:147], a[200:203], v[64:79]
  s_cbranch_vccnz 9f
  s_waitcnt vmcnt(6)
9:
  s_waitcnt vmcnt(10)
  buffer_load_dwordx4 v5, s[24:27], s52 offen offset:2048 nt lds
  v_add_u32 v248, v248, v247
  v_cmp_le_i32 s[92:93], v248, v246
  s_nop 0
  s_bcnt1_i32_b64 s60, s[92:93]
  s_cmp_ge_u32 s60, 33
  s_cselect_b64 vcc, -1, 0
  s_add_u32 m0, s53, 13184
  s_cbranch_vccnz 9f
  s_waitcnt vmcnt(5)
9:
  s_waitcnt vmcnt(10)
  buffer_load_dwordx4 v5, s[24:27], s52 offen offset:128 nt lds
  s_cbranch_vccnz 9f
  s_waitcnt vmcnt(5)
9:
  s_waitcnt vmcnt(9)
  buffer_load_dwordx4 v5, s[24:27], s52 offen offset:2176 nt lds
  s_xor_b32 s52, s52, 0x14000
  ds_read_b64_tr_b16 v[164:165], v15 offset:4096
  ds_read_b64_tr_b16 v[166:167], v15 offset:6144
  ds_read_b64_tr_b16 v[168:169], v16 offset:4096
  ds_read_b64_tr_b16 v[170:171], v16 offset:6144
  ds_read_b64_tr_b16 v[172:173], v17 offset:4096
  ds_read_b64_tr_b16 v[174:175], v17 offset:6144
  ds_read_b64_tr_b16 v[160:161], v14 offset:4096
  ds_read_b64_tr_b16 v[162:163], v14 offset:6144
  s_add_u32 m0, s53, 16384
  s_cbranch_vccnz 9f
  s_waitcnt vmcnt(5)
9:
  s_waitcnt vmcnt(9)
  buffer_load_dwordx4 v5, s[24:27], s52 offen nt lds
  s_add_u32 s91, s91, 1
  s_and_b32 s60, s91, 3
  s_cmp_eq_u32 s60, s3
  s_cbranch_scc0 1f
  v_mov_b32 v252, s91
  s_mov_b64 exec, 1
  buffer_store_dword v252, off, s[40:43], s94 offset:1280
  s_mov_b64 exec, -1
1:
  s_barrier
  buffer_load_dword v246, v254, s[40:43], s95 offen offset:1280 sc1
  s_waitcnt lgkmcnt(0)
  v_mfma_f32_32x32x16_bf16 v[80:95], v[164:167], a[204:207], v[80:95]
  v_mfma_f32_32x32x16_bf16 v[96:111], v[168:171], a[204:207], v[96:111]
  v_mfma_f32_32x32x16_bf16 v[112:127], v[172:175], a[204:207], v[112:127]
  v_mfma_f32_32x32x16_bf16 v[64:79], v[160:163], a[204:207], v[64:79]
  s_cbranch_vccnz 9f
  s_waitcnt vmcnt(6)
9:
  s_waitcnt vmcnt(9)
  buffer_load_dwordx4 v5, s[24:27], s52 offen offset:2048 nt lds
  v_add_u32 v248, v248, v247
  v_cmp_le_i32 s[92:93], v248, v255
  s_nop 0
  s_bcnt1_i32_b64 s60, s[92:93]
  s_cmp_ge_u32 s60, 33
  s_cselect_b64 vcc, -1, 0
  v_pk_mul_f32 v[80:81], v[80:81], v[22:23] op_sel_hi:[1,0]
  v_pk_mul_f32 v[82:83], v[82:83], v[22:23] op_sel_hi:[1,0]
  v_pk_mul_f32 v[84:85], v[84:85], v[22:23] op_sel_hi:[1,0]
  v_pk_mul_f32 v[86:87], v[86:87], v[22:23] op_sel_hi:[1,0]
  v_pk_mul_f32 v[88:89], v[88:89], v[22:23] op_sel_hi:[1,0]
  v_pk_mul_f32 v[90:91], v[90:91], v[22:23] op_sel_hi:[1,0]
  v_pk_mul_f32 v[92:93], v[92:93], v[22:23] op_sel_hi:[1,0]
  v_pk_mul_f32 v[94:95], v[94:95], v[22:23] op_sel_hi:[1,0]
  v_pk_mul_f32 v[96:97], v[96:97], v[22:23] op_sel_hi:[1,0]
  v_pk_mul_f32 v[98:99], v[98:99], v[22:23] op_sel_hi:[1,0]
  v_pk_mul_f32 v[100:101], v[100:101], v[22:23] op_sel_hi:[1,0]
  v_pk_mul_f32 v[102:103], v[102:103], v[22:23] op_sel_hi:[1,0]
  v_pk_mul_f32 v[104:105], v[104:105], v[22:23] op_sel_hi:[1,0]
  v_pk_mul_f32 v[106:107], v[106:107], v[22:23] op_sel_hi:[1,0]
  v_pk_mul_f32 v[108:109], v[108:109], v[22:23] op_sel_hi:[1,0]
  v_pk_mul_f32 v[110:111], v[110:111], v[22:23] op_sel_hi:[1,0]
  s_add_u32 m0, s53, 17280
  s_cbranch_vccnz 9f
  s_waitcnt vmcnt(5)
9:
  s_waitcnt vmcnt(9)
  buffer_load_dwordx4 v5, s[24:27], s52 offen offset:128 nt lds
  v_pk_mul_f32 v[112:113], v[112:113], v[22:23] op_sel_hi:[1,0]
  v_pk_mul_f32 v[114:115], v[114:115], v[22:23] op_sel_hi:[1,0]
  v_pk_mul_f32 v[116:117], v[116:117], v[22:23] op_sel_hi:[1,0]
  v_pk_mul_f32 v[118:119], v[118:119], v[22:23] op_sel_hi:[1,0]
  v_pk_mul_f32 v[120:121], v[120:121], v[22:23] op_sel_hi:[1,0]
  v_pk_mul_f32 v[122:123], v[122:123], v[22:23] op_sel_hi:[1,0]
  v_pk_mul_f32 v[124:125], v[124:125], v[22:23] op_sel_hi:[1,0]
  v_pk_mul_f32 v[126:127], v[126:127], v[22:23] op_sel_hi:[1,0]
  v_pk_mul_f32 v[64:65], v[64:65], v[22:23] op_sel_hi:[1,0]
  v_pk_mul_f32 v[66:67], v[66:67], v[22:23] op_sel_hi:[1,0]
  v_pk_mul_f32 v[68:69], v[68:69], v[22:23] op_sel_hi:[1,0]
  v_pk_mul_f32 v[70:71], v[70:71], v[22:23] op_sel_hi:[1,0]
  v_pk_mul_f32 v[72:73], v[72:73], v[22:23] op_sel_hi:[1,0]
  v_pk_mul_f32 v[74:75], v[74:75], v[22:23] op_sel_hi:[1,0]
  v_pk_mul_f32 v[76:77], v[76:77], v[22:23] op_sel_hi:[1,0]
  v_pk_mul_f32 v[78:79], v[78:79], v[22:23] op_sel_hi:[1,0]
  s_cbranch_vccnz 9f
  s_waitcnt vmcnt(5)
9:
  s_waitcnt vmcnt(9)
  buffer_load_dwordx4 v5, s[24:27], s52 offen offset:2176 nt lds
  s_xor_b32 s52, s52, 16384
  s_cmp_eq_u32 s96, 1
  s_cbranch_scc0 1f
  v_cmp_lt_i32 s[92:93], 0, v250
  s_nop 0
  s_bcnt1_i32_b32 s60, s92
  v_mov_b32 v250, s60
  s_mov_b64 exec, 1
  buffer_store_dword v250, off, s[40:43], s95 offset:512
  s_mov_b64 exec, -1
1:
  ds_read_b32 v22, v231 offset:3456
  ds_read_b64_tr_b16 v[148:149], v15 offset:8192
  ds_read_b64_tr_b16 v[150:151], v15 offset:10240
  ds_read_b64_tr_b16 v[152:153], v16 offset:8192
  ds_read_b64_tr_b16 v[154:155], v16 offset:10240
  ds_read_b64_tr_b16 v[156:157], v17 offset:8192
  ds_read_b64_tr_b16 v[158:159], v17 offset:10240
  ds_read_b64_tr_b16 v[144:145], v14 offset:8192
  ds_read_b64_tr_b16 v[146:147], v14 offset:10240
  s_add_u32 m0, s53, 20480
  s_cbranch_vccnz 9f
  s_waitcnt vmcnt(5)
9:
  s_waitcnt vmcnt(9)
  buffer_load_dwordx4 v5, s[24:27], s52 offen nt lds
  s_add_u32 s91, s91, 1
  s_and_b32 s60, s91, 3
  s_cmp_eq_u32 s60, s3
  s_cbranch_scc0 1f
  v_mov_b32 v252, s91
  s_mov_b64 exec, 1
  buffer_store_dword v252, off, s[40:43], s94
  s_mov_b64 exec, -1
1:
  s_barrier
  buffer_load_dword v255, v254, s[40:43], s95 offen sc1
  s_waitcnt lgkmcnt(0)
  v_mfma_f32_32x32x16_bf16 v[80:95], v[148:151], a[208:211], v[80:95]
  v_mfma_f32_32x32x16_bf16 v[96:111], v[152:155], a[208:211], v[96:111]
  v_mfma_f32_32x32x16_bf16 v[112:127], v[156:159], a[208:211], v[112:127]
  v_mfma_f32_32x32x16_bf16 v[64:79], v[144:147], a[208:211], v[64:79]
  s_cbranch_vccnz 9f
  s_waitcnt vmcnt(6)
9:
  s_waitcnt vmcnt(9)
  buffer_load_dwordx4 v5, s[24:27], s52 offen offset:2048 nt lds
  v_add_u32 v248, v248, v247
  v_cmp_le_i32 s[92:93], v248, v251
  s_nop 0
  s_bcnt1_i32_b64 s60, s[92:93]
  s_cmp_ge_u32 s60, 33
  s_cselect_b64 vcc, -1, 0
  s_cmp_eq_u32 s96, 1
  s_cbranch_scc0 1f
  s_mov_b64 exec, 1
  buffer_store_dword v250, off, s[40:43], s95 offset:768
  s_mov_b64 exec, -1
1:
  ds_read_b64_tr_b16 a[162:163], v20 offset:4096
  ds_read_b64_tr_b16 a[166:167], v20 offset:4128
  ds_read_b64_tr_b16 a[170:171], v243 offset:4096
  ds_read_b64_tr_b16 a[174:175], v243 offset:4128
  ds_read_b64_tr_b16 a[178:179], v244 offset:4096
  ds_read_b64_tr_b16 a[182:183], v244 offset:4128
  ds_read_b64_tr_b16 a[186:187], v245 offset:4096
  ds_read_b64_tr_b16 a[190:191], v245 offset:4128
  s_add_u32 m0, s53, 21376
  s_cbranch_vccnz 9f
  s_waitcnt vmcnt(5)
9:
  s_waitcnt vmcnt(9)
  buffer_load_dwordx4 v5, s[24:27], s52 offen offset:128 nt lds
  s_cbranch_vccnz 9f
  s_waitcnt vmcnt(5)
9:
  s_waitcnt vmcnt(9)
  buffer_load_dwordx4 v5, s[24:27], s52 offen offset:2176 nt lds
  s_xor_b32 s52, s52, 0xd4000
  ds_read_b64_tr_b16 v[164:165], v15 offset:12288
  ds_read_b64_tr_b16 v[166:167], v15 offset:14336
  ds_read_b64_tr_b16 v[168:169], v16 offset:12288
  ds_read_b64_tr_b16 v[170:171], v16 offset:14336
  ds_read_b64_tr_b16 v[172:173], v17 offset:12288
  ds_read_b64_tr_b16 v[174:175], v17 offset:14336
  ds_read_b64_tr_b16 v[160:161], v14 offset:12288
  s_waitcnt lgkmcnt(14)
  ds_read_b64_tr_b16 v[162:163], v14 offset:14336
  s_mov_b32 m0, s53
  s_cbranch_vccnz 9f
  s_waitcnt vmcnt(5)
9:
  s_waitcnt vmcnt(9)
  buffer_load_dwordx4 v5, s[24:27], s52 offen nt lds
  s_add_u32 s91, s91, 1
  s_and_b32 s60, s91, 3
  s_cmp_eq_u32 s60, s3
  s_cbranch_scc0 1f
  v_mov_b32 v252, s91
  s_mov_b64 exec, 1
  buffer_store_dword v252, off, s[40:43], s94 offset:256
  s_mov_b64 exec, -1
1:
  s_barrier
  buffer_load_dword v251, v254, s[40:43], s95 offen offset:256 sc1
  s_waitcnt lgkmcnt(0)
  v_mfma_f32_32x32x16_bf16 v[80:95], v[164:167], a[212:215], v[80:95]
  v_mfma_f32_32x32x16_bf16 v[96:111], v[168:171], a[212:215], v[96:111]
  v_mfma_f32_32x32x16_bf16 v[112:127], v[172:175], a[212:215], v[112:127]
  v_mfma_f32_32x32x16_bf16 v[64:79], v[160:163], a[212:215], v[64:79]
  s_cbranch_vccnz 9f
  s_waitcnt vmcnt(6)
9:
  s_waitcnt vmcnt(9)
  buffer_load_dwordx4 v5, s[24:27], s52 offen offset:2048 nt lds
  v_add_u32 v248, v248, v247
  v_cmp_le_i32 s[92:93], v248, v246
  s_nop 0
  s_bcnt1_i32_b64 s60, s[92:93]
  s_cmp_ge_u32 s60, 33
  s_cselect_b64 vcc, -1, 0
  s_cmp_eq_u32 s96, 1
  s_cbranch_scc0 1f
  s_mov_b64 exec, 1
  buffer_store_dword v250, off, s[40:43], s95 offset:1792
  s_mov_b64 exec, -1
1:
  v_pk_mul_f32 v[80:81], v[80:81], v[22:23] op_sel_hi:[1,0]
  v_pk_mul_f32 v[82:83], v[82:83], v[22:23] op_sel_hi:[1,0]
  v_pk_mul_f32 v[84:85], v[84:85], v[22:23] op_sel_hi:[1,0]
  v_pk_mul_f32 v[86:87], v[86:87], v[22:23] op_sel_hi:[1,0]
  v_pk_mul_f32 v[88:89], v[88:89], v[22:23] op_sel_hi:[1,0]
  v_pk_mul_f32 v[90:91], v[90:91], v[22:23] op_sel_hi:[1,0]
  v_pk_mul_f32 v[92:93], v[92:93], v[22:23] op_sel_hi:[1,0]
  v_pk_mul_f32 v[94:95], v[94:95], v[22:23] op_sel_hi:[1,0]
  v_pk_mul_f32 v[96:97], v[96:97], v[22:23] op_sel_hi:[1,0]
  v_pk_mul_f32 v[98:99], v[98:99], v[22:23] op_sel_hi:[1,0]
  v_pk_mul_f32 v[100:101], v[100:101], v[22:23] op_sel_hi:[1,0]
  v_pk_mul_f32 v[102:103], v[102:103], v[22:23] op_sel_hi:[1,0]
  v_pk_mul_f32 v[104:105], v[104:105], v[22:23] op_sel_hi:[1,0]
  v_pk_mul_f32 v[106:107], v[106:107], v[22:23] op_sel_hi:[1,0]
  v_pk_mul_f32 v[108:109], v[108:109], v[22:23] op_sel_hi:[1,0]
  v_pk_mul_f32 v[110:111], v[110:111], v[22:23] op_sel_hi:[1,0]
  s_add_u32 m0, s53, 896
  s_cbranch_vccnz 9f
  s_waitcnt vmcnt(5)
9:
  s_waitcnt vmcnt(9)
  buffer_load_dwordx4 v5, s[24:27], s52 offen offset:128 nt lds
  v_pk_mul_f32 v[112:113], v[112:113], v[22:23] op_sel_hi:[1,0]
  v_pk_mul_f32 v[114:115], v[114:115], v[22:23] op_sel_hi:[1,0]
  v_pk_mul_f32 v[116:117], v[116:117], v[22:23] op_sel_hi:[1,0]
  v_pk_mul_f32 v[118:119], v[118:119], v[22:23] op_sel_hi:[1,0]
  v_pk_mul_f32 v[120:121], v[120:121], v[22:23] op_sel_hi:[1,0]
  v_pk_mul_f32 v[122:123], v[122:123], v[22:23] op_sel_hi:[1,0]
  v_pk_mul_f32 v[124:125], v[124:125], v[22:23] op_sel_hi:[1,0]
  v_pk_mul_f32 v[126:127], v[126:127], v[22:23] op_sel_hi:[1,0]
  v_pk_mul_f32 v[64:65], v[64:65], v[22:23] op_sel_hi:[1,0]
  v_pk_mul_f32 v[66:67], v[66:67], v[22:23] op_sel_hi:[1,0]
  v_pk_mul_f32 v[68:69], v[68:69], v[22:23] op_sel_hi:[1,0]
  v_pk_mul_f32 v[70:71], v[70:71], v[22:23] op_sel_hi:[1,0]
  v_pk_mul_f32 v[72:73], v[72:73], v[22:23] op_sel_hi:[1,0]
  v_pk_mul_f32 v[74:75], v[74:75], v[22:23] op_sel_hi:[1,0]
  v_pk_mul_f32 v[76:77], v[76:77], v[22:23] op_sel_hi:[1,0]
  v_pk_mul_f32 v[78:79], v[78:79], v[22:23] op_sel_hi:[1,0]
  s_cbranch_vccnz 9f
  s_waitcnt vmcnt(5)
9:
  s_waitcnt vmcnt(9)
  buffer_load_dwordx4 v5, s[24:27], s52 offen offset:2176 nt lds
  s_xor_b32 s52, s52, 16384
  ds_read_b32 v22, v231 offset:3584
  ds_read_b64_tr_b16 v[148:149], v15 offset:16384
  ds_read_b64_tr_b16 v[150:151], v15 offset:18432
  ds_read_b64_tr_b16 v[152:153], v16 offset:16384
  ds_read_b64_tr_b16 v[154:155], v16 offset:18432
  ds_read_b64_tr_b16 v[156:157], v17 offset:16384
  ds_read_b64_tr_b16 v[158:159], v17 offset:18432
  ds_read_b64_tr_b16 v[144:145], v14 offset:16384
  ds_read_b64_tr_b16 v[146:147], v14 offset:18432
  s_add_u32 m0, s53, 4096
  s_cbranch_vccnz 9f
  s_waitcnt vmcnt(5)
9:
  s_waitcnt vmcnt(9)
  buffer_load_dwordx4 v5, s[24:27], s52 offen nt lds
  s_add_u32 s91, s91, 1
  s_and_b32 s60, s91, 3
  s_cmp_eq_u32 s60, s3
  s_cbranch_scc0 1f
  v_mov_b32 v252, s91
  s_mov_b64 exec, 1
  buffer_store_dword v252, off, s[40:43], s94 offset:1280
  s_mov_b64 exec, -1
1:
  s_barrier
  buffer_load_dword v246, v254, s[40:43], s95 offen offset:1280 sc1
  s_waitcnt lgkmcnt(0)
  v_mfma_f32_32x32x16_bf16 v[80:95], v[148:151], a[216:219], v[80:95]
  v_mfma_f32_32x32x16_bf16 v[96:111], v[152:155], a[216:219], v[96:111]
  v_mfma_f32_32x32x16_bf16 v[112:127], v[156:159], a[216:219], v[112:127]
  v_mfma_f32_32x32x16_bf16 v[64:79], v[144:147], a[216:219], v[64:79]
  s_cbranch_vccnz 9f
  s_waitcnt vmcnt(6)
9:
  s_waitcnt vmcnt(9)
  buffer_load_dwordx4 v5, s[24:27], s52 offen offset:2048 nt lds
  v_add_u32 v248, v248, v247
  v_cmp_le_i32 s[92:93], v248, v255
  s_nop 0
  s_bcnt1_i32_b64 s60, s[92:93]
  s_cmp_ge_u32 s60, 33
  s_cselect_b64 vcc, -1, 0
  s_add_u32 m0, s53, 4992
  s_cbranch_vccnz 9f
  s_waitcnt vmcnt(5)
9:
  s_waitcnt vmcnt(9)
  buffer_load_dwordx4 v5, s[24:27], s52 offen offset:128 nt lds
  s_cbranch_vccnz 9f
  s_waitcnt vmcnt(5)
9:
  s_waitcnt vmcnt(9)
  buffer_load_dwordx4 v5, s[24:27], s52 offen offset:2176 nt lds
  s_xor_b32 s52, s52, 0x14000
  ds_read_b64_tr_b16 v[164:165], v15 offset:20480
  ds_read_b64_tr_b16 v[166:167], v15 offset:22528
  ds_read_b64_tr_b16 v[168:169], v16 offset:20480
  ds_read_b64_tr_b16 v[170:171], v16 offset:22528
  ds_read_b64_tr_b16 v[172:173], v17 offset:20480
  ds_read_b64_tr_b16 v[174:175], v17 offset:22528
  ds_read_b64_tr_b16 v[160:161], v14 offset:20480
  ds_read_b64_tr_b16 v[162:163], v14 offset:22528
  s_add_u32 m0, s53, 8192
  s_cbranch_vccnz 9f
  s_waitcnt vmcnt(5)
9:
  s_waitcnt vmcnt(9)
  buffer_load_dwordx4 v5, s[24:27], s52 offen nt lds
  s_add_u32 s91, s91, 1
  s_and_b32 s60, s91, 3
  s_cmp_eq_u32 s60, s3
  s_cbranch_scc0 1f
  v_mov_b32 v252, s91
  s_mov_b64 exec, 1
  buffer_store_dword v252, off, s[40:43], s94
  s_mov_b64 exec, -1
1:
  s_barrier
  buffer_load_dword v255, v254, s[40:43], s95 offen sc1
  s_waitcnt lgkmcnt(0)
  v_mfma_f32_32x32x16_bf16 v[80:95], v[164:167], a[220:223], v[80:95]
  v_mfma_f32_32x32x16_bf16 v[96:111], v[168:171], a[220:223], v[96:111]
  v_mfma_f32_32x32x16_bf16 v[112:127], v[172:175], a[220:223], v[112:127]
  v_mfma_f32_32x32x16_bf16 v[64:79], v[160:163], a[220:223], v[64:79]
  s_cbranch_vccnz 9f
  s_waitcnt vmcnt(6)
9:
  s_waitcnt vmcnt(9)
  buffer_load_dwordx4 v5, s[24:27], s52 offen offset:2048 nt lds
  v_add_u32 v248, v248, v247
  v_cmp_le_i32 s[92:93], v248, v251
  s_nop 0
  s_bcnt1_i32_b64 s60, s[92:93]
  s_cmp_ge_u32 s60, 33
  s_cselect_b64 vcc, -1, 0
  v_pk_mul_f32 v[80:81], v[80:81], v[22:23] op_sel_hi:[1,0]
  v_pk_mul_f32 v[82:83], v[82:83], v[22:23] op_sel_hi:[1,0]
  v_pk_mul_f32 v[84:85], v[84:85], v[22:23] op_sel_hi:[1,0]
  v_pk_mul_f32 v[86:87], v[86:87], v[22:23] op_sel_hi:[1,0]
  v_pk_mul_f32 v[88:89], v[88:89], v[22:23] op_sel_hi:[1,0]
  v_pk_mul_f32 v[90:91], v[90:91], v[22:23] op_sel_hi:[1,0]
  v_pk_mul_f32 v[92:93], v[92:93], v[22:23] op_sel_hi:[1,0]
  v_pk_mul_f32 v[94:95], v[94:95], v[22:23] op_sel_hi:[1,0]
  v_pk_mul_f32 v[96:97], v[96:97], v[22:23] op_sel_hi:[1,0]
  v_pk_mul_f32 v[98:99], v[98:99], v[22:23] op_sel_hi:[1,0]
  v_pk_mul_f32 v[100:101], v[100:101], v[22:23] op_sel_hi:[1,0]
  v_pk_mul_f32 v[102:103], v[102:103], v[22:23] op_sel_hi:[1,0]
  v_pk_mul_f32 v[104:105], v[104:105], v[22:23] op_sel_hi:[1,0]
  v_pk_mul_f32 v[106:107], v[106:107], v[22:23] op_sel_hi:[1,0]
  v_pk_mul_f32 v[108:109], v[108:109], v[22:23] op_sel_hi:[1,0]
  v_pk_mul_f32 v[110:111], v[110:111], v[22:23] op_sel_hi:[1,0]
  s_add_u32 m0, s53, 9088
  s_cbranch_vccnz 9f
  s_waitcnt vmcnt(5)
9:
  s_waitcnt vmcnt(9)
  buffer_load_dwordx4 v5, s[24:27], s52 offen offset:128 nt lds
  v_pk_mul_f32 v[112:113], v[112:113], v[22:23] op_sel_hi:[1,0]
  v_pk_mul_f32 v[114:115], v[114:115], v[22:23] op_sel_hi:[1,0]
  v_pk_mul_f32 v[116:117], v[116:117], v[22:23] op_sel_hi:[1,0]
  v_pk_mul_f32 v[118:119], v[118:119], v[22:23] op_sel_hi:[1,0]
  v_pk_mul_f32 v[120:121], v[120:121], v[22:23] op_sel_hi:[1,0]
  v_pk_mul_f32 v[122:123], v[122:123], v[22:23] op_sel_hi:[1,0]
  v_pk_mul_f32 v[124:125], v[124:125], v[22:23] op_sel_hi:[1,0]
  v_pk_mul_f32 v[126:127], v[126:127], v[22:23] op_sel_hi:[1,0]
  v_pk_mul_f32 v[64:65], v[64:65], v[22:23] op_sel_hi:[1,0]
  v_pk_mul_f32 v[66:67], v[66:67], v[22:23] op_sel_hi:[1,0]
  v_pk_mul_f32 v[68:69], v[68:69], v[22:23] op_sel_hi:[1,0]
  v_pk_mul_f32 v[70:71], v[70:71], v[22:23] op_sel_hi:[1,0]
  v_pk_mul_f32 v[72:73], v[72:73], v[22:23] op_sel_hi:[1,0]
  v_pk_mul_f32 v[74:75], v[74:75], v[22:23] op_sel_hi:[1,0]
  v_pk_mul_f32 v[76:77], v[76:77], v[22:23] op_sel_hi:[1,0]
  v_pk_mul_f32 v[78:79], v[78:79], v[22:23] op_sel_hi:[1,0]
  s_cbranch_vccnz 9f
  s_waitcnt vmcnt(5)
9:
  s_waitcnt vmcnt(9)
  buffer_load_dwordx4 v5, s[24:27], s52 offen offset:2176 nt lds
  s_xor_b32 s52, s52, 16384
  ds_read_b32 v22, v231 offset:3712
  ds_read_b64_tr_b16 v[148:149], v15
  ds_read_b64_tr_b16 v[150:151], v15 offset:2048
  ds_read_b64_tr_b16 v[152:153], v16
  ds_read_b64_tr_b16 v[154:155], v16 offset:2048
  ds_read_b64_tr_b16 v[156:157], v17
  ds_read_b64_tr_b16 v[158:159], v17 offset:2048
  ds_read_b64_tr_b16 v[144:145], v14
  ds_read_b64_tr_b16 v[146:147], v14 offset:2048
  s_add_u32 m0, s53, 12288
  s_cbranch_vccnz 9f
  s_waitcnt vmcnt(5)
9:
  s_waitcnt vmcnt(9)
  buffer_load_dwordx4 v5, s[24:27], s52 offen nt lds
  s_add_u32 s91, s91, 1
  s_and_b32 s60, s91, 3
  s_cmp_eq_u32 s60, s3
  s_cbranch_scc0 1f
  v_mov_b32 v252, s91
  s_mov_b64 exec, 1
  buffer_store_dword v252, off, s[40:43], s94 offset:256
  s_mov_b64 exec, -1
1:
  s_barrier
  buffer_load_dword v251, v254, s[40:43], s95 offen offset:256 sc1
  s_waitcnt lgkmcnt(0)
  v_mfma_f32_32x32x16_bf16 v[80:95], v[148:151], a[224:227], v[80:95]
  v_mfma_f32_32x32x16_bf16 v[96:111], v[152:155], a[224:227], v[96:111]
  v_mfma_f32_32x32x16_bf16 v[112:127], v[156:159], a[224:227], v[112:127]
  v_mfma_f32_32x32x16_bf16 v[64:79], v[144:147], a[224:227], v[64:79]
  s_cbranch_vccnz 9f
  s_waitcnt vmcnt(6)
9:
  s_waitcnt vmcnt(9)
  buffer_load_dwordx4 v5, s[24:27], s52 offen offset:2048 nt lds
  v_add_u32 v248, v248, v247
  v_cmp_le_i32 s[92:93], v248, v246
  s_nop 0
  s_bcnt1_i32_b64 s60, s[92:93]
  s_cmp_ge_u32 s60, 33
  s_cselect_b64 vcc, -1, 0
  s_barrier
  ds_read_b128 a[192:195], v238 offset:4096
  ds_read_b128 a[196:199], v238 offset:5120
  ds_read_b128 a[200:203], v239 offset:4096
  ds_read_b128 a[204:207], v239 offset:5120
  ds_read_b128 a[208:211], v240 offset:4096
  ds_read_b128 a[212:215], v240 offset:5120
  ds_read_b128 a[216:219], v241 offset:4096
  ds_read_b128 a[220:223], v241 offset:5120
  v_lshlrev_b32 v229, 3, v0
  v_add_u32 v229, 4096, v229
  v_and_b32 v26, 3, v0
  v_and_b32 v242, 60, v0
  v_lshl_add_u32 v242, v26, 6, v242
  v_add_u32 v234, s53, v228
  v_xor_b32 v235, 32768, v234
  v_xor_b32 v236, 65536, v234
  v_xor_b32 v237, 98304, v234
  s_mul_i32 s60, s50, 18432
  s_mul_i32 s61, s3, 4608
  s_mul_i32 s67, s49, 655360
  s_add_u32 s67, s67, s60
  s_add_u32 s67, s67, s61
  s_add_u32 m0, s53, 13184
  s_cbranch_vccnz 9f
  s_waitcnt vmcnt(5)
9:
  s_waitcnt vmcnt(9)
  buffer_load_dwordx4 v5, s[24:27], s52 offen offset:128 nt lds
  s_cbranch_vccnz 9f
  s_waitcnt vmcnt(5)
9:
  s_waitcnt vmcnt(9)
  buffer_load_dwordx4 v5, s[24:27], s52 offen offset:2176 nt lds
  s_xor_b32 s52, s52, 0x54000
  ds_read_b64_tr_b16 v[164:165], v15 offset:4096
  ds_read_b64_tr_b16 v[166:167], v15 offset:6144
  ds_read_b64_tr_b16 v[168:169], v16 offset:4096
  ds_read_b64_tr_b16 v[170:171], v16 offset:6144
  ds_read_b64_tr_b16 v[172:173], v17 offset:4096
  ds_read_b64_tr_b16 v[174:175], v17 offset:6144
  ds_read_b64_tr_b16 v[160:161], v14 offset:4096
  s_waitcnt lgkmcnt(14)
  ds_read_b64_tr_b16 v[162:163], v14 offset:6144
  s_add_u32 m0, s53, 16384
  s_cbranch_vccnz 9f
  s_waitcnt vmcnt(5)
9:
  s_waitcnt vmcnt(9)
  buffer_load_dwordx4 v5, s[24:27], s52 offen nt lds
  s_add_u32 s91, s91, 1
  s_and_b32 s60, s91, 3
  s_cmp_eq_u32 s60, s3
  s_cbranch_scc0 1f
  v_mov_b32 v252, s91
  s_mov_b64 exec, 1
  buffer_store_dword v252, off, s[40:43], s94 offset:1280
  s_mov_b64 exec, -1
1:
  s_barrier
  buffer_load_dword v246, v254, s[40:43], s95 offen offset:1280 sc1
  s_waitcnt lgkmcnt(0)
  v_mfma_f32_32x32x16_bf16 v[80:95], v[164:167], a[228:231], v[80:95]
  v_mfma_f32_32x32x16_bf16 v[96:111], v[168:171], a[228:231], v[96:111]
  v_mfma_f32_32x32x16_bf16 v[112:127], v[172:175], a[228:231], v[112:127]
  v_mfma_f32_32x32x16_bf16 v[64:79], v[160:163], a[228:231], v[64:79]
  s_cbranch_vccnz 9f
  s_waitcnt vmcnt(6)
9:
  s_waitcnt vmcnt(9)
  buffer_load_dwordx4 v5, s[24:27], s52 offen offset:2048 nt lds
  v_add_u32 v248, v248, v247
  v_cmp_le_i32 s[92:93], v248, v255
  s_nop 0
  s_bcnt1_i32_b64 s60, s[92:93]
  s_cmp_ge_u32 s60, 33
  s_cselect_b64 vcc, -1, 0
  v_pk_mul_f32 v[80:81], v[80:81], v[22:23] op_sel_hi:[1,0]
  v_pk_mul_f32 v[82:83], v[82:83], v[22:23] op_sel_hi:[1,0]
  v_pk_mul_f32 v[84:85], v[84:85], v[22:23] op_sel_hi:[1,0]
  v_pk_mul_f32 v[86:87], v[86:87], v[22:23] op_sel_hi:[1,0]
  v_pk_mul_f32 v[88:89], v[88:89], v[22:23] op_sel_hi:[1,0]
  v_pk_mul_f32 v[90:91], v[90:91], v[22:23] op_sel_hi:[1,0]
  v_pk_mul_f32 v[92:93], v[92:93], v[22:23] op_sel_hi:[1,0]
  v_pk_mul_f32 v[94:95], v[94:95], v[22:23] op_sel_hi:[1,0]
  v_pk_mul_f32 v[96:97], v[96:97], v[22:23] op_sel_hi:[1,0]
  v_pk_mul_f32 v[98:99], v[98:99], v[22:23] op_sel_hi:[1,0]
  v_pk_mul_f32 v[100:101], v[100:101], v[22:23] op_sel_hi:[1,0]
  v_pk_mul_f32 v[102:103], v[102:103], v[22:23] op_sel_hi:[1,0]
  v_pk_mul_f32 v[104:105], v[104:105], v[22:23] op_sel_hi:[1,0]
  v_pk_mul_f32 v[106:107], v[106:107], v[22:23] op_sel_hi:[1,0]
  v_pk_mul_f32 v[108:109], v[108:109], v[22:23] op_sel_hi:[1,0]
  v_pk_mul_f32 v[110:111], v[110:111], v[22:23] op_sel_hi:[1,0]
  s_add_u32 m0, s53, 17280
  s_cbranch_vccnz 9f
  s_waitcnt vmcnt(5)
9:
  s_waitcnt vmcnt(9)
  buffer_load_dwordx4 v5, s[24:27], s52 offen offset:128 nt lds
  v_pk_mul_f32 v[112:113], v[112:113], v[22:23] op_sel_hi:[1,0]
  v_pk_mul_f32 v[114:115], v[114:115], v[22:23] op_sel_hi:[1,0]
  v_pk_mul_f32 v[116:117], v[116:117], v[22:23] op_sel_hi:[1,0]
  v_pk_mul_f32 v[118:119], v[118:119], v[22:23] op_sel_hi:[1,0]
  v_pk_mul_f32 v[120:121], v[120:121], v[22:23] op_sel_hi:[1,0]
  v_pk_mul_f32 v[122:123], v[122:123], v[22:23] op_sel_hi:[1,0]
  v_pk_mul_f32 v[124:125], v[124:125], v[22:23] op_sel_hi:[1,0]
  v_pk_mul_f32 v[126:127], v[126:127], v[22:23] op_sel_hi:[1,0]
  v_pk_mul_f32 v[64:65], v[64:65], v[22:23] op_sel_hi:[1,0]
  v_pk_mul_f32 v[66:67], v[66:67], v[22:23] op_sel_hi:[1,0]
  v_pk_mul_f32 v[68:69], v[68:69], v[22:23] op_sel_hi:[1,0]
  v_pk_mul_f32 v[70:71], v[70:71], v[22:23] op_sel_hi:[1,0]
  v_pk_mul_f32 v[72:73], v[72:73], v[22:23] op_sel_hi:[1,0]
  v_pk_mul_f32 v[74:75], v[74:75], v[22:23] op_sel_hi:[1,0]
  v_pk_mul_f32 v[76:77], v[76:77], v[22:23] op_sel_hi:[1,0]
  v_pk_mul_f32 v[78:79], v[78:79], v[22:23] op_sel_hi:[1,0]
  s_cbranch_vccnz 9f
  s_waitcnt vmcnt(5)
9:
  s_waitcnt vmcnt(9)
  buffer_load_dwordx4 v5, s[24:27], s52 offen offset:2176 nt lds
  s_xor_b32 s52, s52, 16384
  ds_read_b32 v22, v231 offset:3840
  ds_read_b64_tr_b16 v[148:149], v15 offset:8192
  ds_read_b64_tr_b16 v[150:151], v15 offset:10240
  ds_read_b64_tr_b16 v[152:153], v16 offset:8192
  ds_read_b64_tr_b16 v[154:155], v16 offset:10240
  ds_read_b64_tr_b16 v[156:157], v17 offset:8192
  ds_read_b64_tr_b16 v[158:159], v17 offset:10240
  ds_read_b64_tr_b16 v[144:145], v14 offset:8192
  ds_read_b64_tr_b16 v[146:147], v14 offset:10240
  s_add_u32 m0, s53, 20480
  s_cbranch_vccnz 9f
  s_waitcnt vmcnt(5)
9:
  s_waitcnt vmcnt(9)
  buffer_load_dwordx4 v5, s[24:27], s52 offen nt lds
  s_add_u32 s91, s91, 1
  s_and_b32 s60, s91, 3
  s_cmp_eq_u32 s60, s3
  s_cbranch_scc0 1f
  v_mov_b32 v252, s91
  s_mov_b64 exec, 1
  buffer_store_dword v252, off, s[40:43], s94
  s_mov_b64 exec, -1
1:
  s_barrier
  buffer_load_dword v255, v254, s[40:43], s95 offen sc1
  s_waitcnt lgkmcnt(0)
  v_mfma_f32_32x32x16_bf16 v[80:95], v[148:151], a[232:235], v[80:95]
  v_mfma_f32_32x32x16_bf16 v[96:111], v[152:155], a[232:235], v[96:111]
  v_mfma_f32_32x32x16_bf16 v[112:127], v[156:159], a[232:235], v[112:127]
  v_mfma_f32_32x32x16_bf16 v[64:79], v[144:147], a[232:235], v[64:79]
  s_cbranch_vccnz 9f
  s_waitcnt vmcnt(6)
9:
  s_waitcnt vmcnt(9)
  buffer_load_dwordx4 v5, s[24:27], s52 offen offset:2048 nt lds
  v_add_u32 v248, v248, v247
  v_cmp_le_i32 s[92:93], v248, v251
  s_nop 0
  s_bcnt1_i32_b64 s60, s[92:93]
  s_cmp_ge_u32 s60, 33
  s_cselect_b64 vcc, -1, 0
  s_add_u32 m0, s53, 21376
  s_cbranch_vccnz 9f
  s_waitcnt vmcnt(5)
9:
  s_waitcnt vmcnt(9)
  buffer_load_dwordx4 v5, s[24:27], s52 offen offset:128 nt lds
  s_cbranch_vccnz 9f
  s_waitcnt vmcnt(5)
9:
  s_waitcnt vmcnt(9)
  buffer_load_dwordx4 v5, s[24:27], s52 offen offset:2176 nt lds
  s_xor_b32 s52, s52, 0x14000
  ds_read_b64_tr_b16 v[164:165], v15 offset:12288
  ds_read_b64_tr_b16 v[166:167], v15 offset:14336
  ds_read_b64_tr_b16 v[168:169], v16 offset:12288
  ds_read_b64_tr_b16 v[170:171], v16 offset:14336
  ds_read_b64_tr_b16 v[172:173], v17 offset:12288
  ds_read_b64_tr_b16 v[174:175], v17 offset:14336
  ds_read_b64_tr_b16 v[160:161], v14 offset:12288
  ds_read_b64_tr_b16 v[162:163], v14 offset:14336
  s_mov_b32 m0, s53
  s_cbranch_vccnz 9f
  s_waitcnt vmcnt(5)
9:
  s_waitcnt vmcnt(9)
  buffer_load_dwordx4 v5, s[24:27], s52 offen nt lds
  s_waitcnt lgkmcnt(0)
  v_mfma_f32_32x32x16_bf16 v[80:95], v[164:167], a[236:239], v[80:95]
  v_mfma_f32_32x32x16_bf16 v[96:111], v[168:171], a[236:239], v[96:111]
  v_mfma_f32_32x32x16_bf16 v[112:127], v[172:175], a[236:239], v[112:127]
  v_mfma_f32_32x32x16_bf16 v[64:79], v[160:163], a[236:239], v[64:79]
  s_cbranch_vccnz 9f
  s_waitcnt vmcnt(5)
9:
  s_waitcnt vmcnt(8)
  buffer_load_dwordx4 v5, s[24:27], s52 offen offset:2048 nt lds
  v_add_u32 v248, v248, v247
  v_cmp_le_i32 s[92:93], v248, v246
  s_nop 0
  s_bcnt1_i32_b64 s60, s[92:93]
  s_cmp_ge_u32 s60, 33
  s_cselect_b64 vcc, -1, 0
  v_pk_mul_f32 v[80:81], v[80:81], v[22:23] op_sel_hi:[1,0]
  v_pk_mul_f32 v[82:83], v[82:83], v[22:23] op_sel_hi:[1,0]
  v_pk_mul_f32 v[84:85], v[84:85], v[22:23] op_sel_hi:[1,0]
  v_pk_mul_f32 v[86:87], v[86:87], v[22:23] op_sel_hi:[1,0]
  v_pk_mul_f32 v[88:89], v[88:89], v[22:23] op_sel_hi:[1,0]
  v_pk_mul_f32 v[90:91], v[90:91], v[22:23] op_sel_hi:[1,0]
  v_pk_mul_f32 v[92:93], v[92:93], v[22:23] op_sel_hi:[1,0]
  v_pk_mul_f32 v[94:95], v[94:95], v[22:23] op_sel_hi:[1,0]
  v_pk_mul_f32 v[96:97], v[96:97], v[22:23] op_sel_hi:[1,0]
  v_pk_mul_f32 v[98:99], v[98:99], v[22:23] op_sel_hi:[1,0]
  v_pk_mul_f32 v[100:101], v[100:101], v[22:23] op_sel_hi:[1,0]
  v_pk_mul_f32 v[102:103], v[102:103], v[22:23] op_sel_hi:[1,0]
  v_pk_mul_f32 v[104:105], v[104:105], v[22:23] op_sel_hi:[1,0]
  v_pk_mul_f32 v[106:107], v[106:107], v[22:23] op_sel_hi:[1,0]
  v_pk_mul_f32 v[108:109], v[108:109], v[22:23] op_sel_hi:[1,0]
  v_pk_mul_f32 v[110:111], v[110:111], v[22:23] op_sel_hi:[1,0]
  s_add_u32 m0, s53, 896
  s_cbranch_vccnz 9f
  s_waitcnt vmcnt(4)
9:
  s_waitcnt vmcnt(8)
  buffer_load_dwordx4 v5, s[24:27], s52 offen offset:128 nt lds
  v_pk_mul_f32 v[112:113], v[112:113], v[22:23] op_sel_hi:[1,0]
  v_pk_mul_f32 v[114:115], v[114:115], v[22:23] op_sel_hi:[1,0]
  v_pk_mul_f32 v[116:117], v[116:117], v[22:23] op_sel_hi:[1,0]
  v_pk_mul_f32 v[118:119], v[118:119], v[22:23] op_sel_hi:[1,0]
  v_pk_mul_f32 v[120:121], v[120:121], v[22:23] op_sel_hi:[1,0]
  v_pk_mul_f32 v[122:123], v[122:123], v[22:23] op_sel_hi:[1,0]
  v_pk_mul_f32 v[124:125], v[124:125], v[22:23] op_sel_hi:[1,0]
  v_pk_mul_f32 v[126:127], v[126:127], v[22:23] op_sel_hi:[1,0]
  v_pk_mul_f32 v[64:65], v[64:65], v[22:23] op_sel_hi:[1,0]
  v_pk_mul_f32 v[66:67], v[66:67], v[22:23] op_sel_hi:[1,0]
  v_pk_mul_f32 v[68:69], v[68:69], v[22:23] op_sel_hi:[1,0]
  v_pk_mul_f32 v[70:71], v[70:71], v[22:23] op_sel_hi:[1,0]
  v_pk_mul_f32 v[72:73], v[72:73], v[22:23] op_sel_hi:[1,0]
  v_pk_mul_f32 v[74:75], v[74:75], v[22:23] op_sel_hi:[1,0]
  v_pk_mul_f32 v[76:77], v[76:77], v[22:23] op_sel_hi:[1,0]
  v_pk_mul_f32 v[78:79], v[78:79], v[22:23] op_sel_hi:[1,0]
  s_cbranch_vccnz 9f
  s_waitcnt vmcnt(4)
9:
  s_waitcnt vmcnt(8)
  buffer_load_dwordx4 v5, s[24:27], s52 offen offset:2176 nt lds
  s_xor_b32 s52, s52, 16384
  ds_read_b64_tr_b16 v[148:149], v15 offset:16384
  ds_read_b64_tr_b16 v[150:151], v15 offset:18432
  ds_read_b64_tr_b16 v[152:153], v16 offset:16384
  ds_read_b64_tr_b16 v[154:155], v16 offset:18432
  ds_read_b64_tr_b16 v[156:157], v17 offset:16384
  ds_read_b64_tr_b16 v[158:159], v17 offset:18432
  ds_read_b64_tr_b16 v[144:145], v14 offset:16384
  ds_read_b64_tr_b16 v[146:147], v14 offset:18432
  s_add_u32 m0, s53, 4096
  s_cbranch_vccnz 9f
  s_waitcnt vmcnt(4)
9:
  s_waitcnt vmcnt(8)
  buffer_load_dwordx4 v5, s[24:27], s52 offen nt lds
  s_waitcnt lgkmcnt(0)
  v_mfma_f32_32x32x16_bf16 v[80:95], v[148:151], a[240:243], v[80:95]
  v_mfma_f32_32x32x16_bf16 v[96:111], v[152:155], a[240:243], v[96:111]
  v_mfma_f32_32x32x16_bf16 v[112:127], v[156:159], a[240:243], v[112:127]
  v_mfma_f32_32x32x16_bf16 v[64:79], v[144:147], a[240:243], v[64:79]
  s_cbranch_vccnz 9f
  s_waitcnt vmcnt(4)
9:
  s_waitcnt vmcnt(7)
  buffer_load_dwordx4 v5, s[24:27], s52 offen offset:2048 nt lds
  v_add_u32 v248, v248, v247
  v_cmp_le_i32 s[92:93], v248, v255
  s_nop 0
  s_bcnt1_i32_b64 s60, s[92:93]
  s_cmp_ge_u32 s60, 33
  s_cselect_b64 vcc, -1, 0
  s_branch L_fin
.p2align 12
L_fin:
  s_add_u32 m0, s53, 4992
  s_cbranch_vccnz 9f
  s_waitcnt vmcnt(4)
9:
  s_waitcnt vmcnt(7)
  buffer_load_dwordx4 v5, s[24:27], s52 offen offset:128 nt lds
  s_cbranch_vccnz 9f
  s_waitcnt vmcnt(4)
9:
  s_waitcnt vmcnt(7)
  buffer_load_dwordx4 v5, s[24:27], s52 offen offset:2176 nt lds
  ds_read_b64_tr_b16 v[164:165], v15 offset:20480
  ds_read_b64_tr_b16 v[166:167], v15 offset:22528
  ds_read_b64_tr_b16 v[168:169], v16 offset:20480
  ds_read_b64_tr_b16 v[170:171], v16 offset:22528
  ds_read_b64_tr_b16 v[172:173], v17 offset:20480
  ds_read_b64_tr_b16 v[174:175], v17 offset:22528
  ds_read_b64_tr_b16 v[160:161], v14 offset:20480
  ds_read_b64_tr_b16 v[162:163], v14 offset:22528
  s_waitcnt lgkmcnt(0)
  v_mfma_f32_32x32x16_bf16 v[80:95], v[164:167], a[244:247], v[80:95]
  v_mfma_f32_32x32x16_bf16 v[96:111], v[168:171], a[244:247], v[96:111]
  v_mfma_f32_32x32x16_bf16 v[112:127], v[172:175], a[244:247], v[112:127]
  v_mfma_f32_32x32x16_bf16 v[64:79], v[160:163], a[244:247], v[64:79]
  s_nop 8
  v_pk_mul_f32 v[80:81], v[80:81], v[224:225] op_sel_hi:[1,0]
  v_pk_mul_f32 v[82:83], v[82:83], v[224:225] op_sel_hi:[1,0]
  v_pk_mul_f32 v[84:85], v[84:85], v[224:225] op_sel_hi:[1,0]
  v_pk_mul_f32 v[86:87], v[86:87], v[224:225] op_sel_hi:[1,0]
  v_pk_mul_f32 v[88:89], v[88:89], v[224:225] op_sel_hi:[1,0]
  v_pk_mul_f32 v[90:91], v[90:91], v[224:225] op_sel_hi:[1,0]
  v_pk_mul_f32 v[92:93], v[92:93], v[224:225] op_sel_hi:[1,0]
  v_pk_mul_f32 v[94:95], v[94:95], v[224:225] op_sel_hi:[1,0]
  v_pk_mul_f32 v[96:97], v[96:97], v[224:225] op_sel_hi:[1,0]
  v_pk_mul_f32 v[98:99], v[98:99], v[224:225] op_sel_hi:[1,0]
  v_pk_mul_f32 v[100:101], v[100:101], v[224:225] op_sel_hi:[1,0]
  v_pk_mul_f32 v[102:103], v[102:103], v[224:225] op_sel_hi:[1,0]
  v_pk_mul_f32 v[104:105], v[104:105], v[224:225] op_sel_hi:[1,0]
  v_pk_mul_f32 v[106:107], v[106:107], v[224:225] op_sel_hi:[1,0]
  v_pk_mul_f32 v[108:109], v[108:109], v[224:225] op_sel_hi:[1,0]
  v_pk_mul_f32 v[110:111], v[110:111], v[224:225] op_sel_hi:[1,0]
  v_pk_mul_f32 v[112:113], v[112:113], v[224:225] op_sel_hi:[1,0]
  v_pk_mul_f32 v[114:115], v[114:115], v[224:225] op_sel_hi:[1,0]
  v_pk_mul_f32 v[116:117], v[116:117], v[224:225] op_sel_hi:[1,0]
  v_pk_mul_f32 v[118:119], v[118:119], v[224:225] op_sel_hi:[1,0]
  v_pk_mul_f32 v[120:121], v[120:121], v[224:225] op_sel_hi:[1,0]
  v_pk_mul_f32 v[122:123], v[122:123], v[224:225] op_sel_hi:[1,0]
  v_pk_mul_f32 v[124:125], v[124:125], v[224:225] op_sel_hi:[1,0]
  v_pk_mul_f32 v[126:127], v[126:127], v[224:225] op_sel_hi:[1,0]
  v_pk_mul_f32 v[64:65], v[64:65], v[224:225] op_sel_hi:[1,0]
  v_pk_mul_f32 v[66:67], v[66:67], v[224:225] op_sel_hi:[1,0]
  v_pk_mul_f32 v[68:69], v[68:69], v[224:225] op_sel_hi:[1,0]
  v_pk_mul_f32 v[70:71], v[70:71], v[224:225] op_sel_hi:[1,0]
  v_pk_mul_f32 v[72:73], v[72:73], v[224:225] op_sel_hi:[1,0]
  v_pk_mul_f32 v[74:75], v[74:75], v[224:225] op_sel_hi:[1,0]
  v_pk_mul_f32 v[76:77], v[76:77], v[224:225] op_sel_hi:[1,0]
  v_pk_mul_f32 v[78:79], v[78:79], v[224:225] op_sel_hi:[1,0]
  ds_write_b128 v234, v[80:83] offset:8192
  ds_write_b128 v234, v[84:87] offset:9216
  ds_write_b128 v234, v[88:91] offset:10240
  ds_write_b128 v234, v[92:95] offset:11264
  v_xor_b32 v15, 32768, v14
  ds_write_b128 v234, v[96:99] offset:12288
  ds_write_b128 v234, v[100:103] offset:13312
  ds_write_b128 v234, v[104:107] offset:14336
  ds_write_b128 v234, v[108:111] offset:15360
  v_xor_b32 v16, 65536, v14
  ds_write_b128 v234, v[112:115] offset:16384
  ds_write_b128 v234, v[116:119] offset:17408
  ds_write_b128 v234, v[120:123] offset:18432
  ds_write_b128 v234, v[124:127] offset:19456
  v_xor_b32 v17, 98304, v14
  s_waitcnt vmcnt(4)
  s_waitcnt lgkmcnt(0)
  s_barrier
  ds_read_b128 v[80:83], v235 offset:8192
  ds_read_b128 v[84:87], v235 offset:9216
  ds_read_b128 v[88:91], v235 offset:10240
  ds_read_b128 v[92:95], v235 offset:11264
  ds_read_b128 v[96:99], v236 offset:12288
  ds_read_b128 v[100:103], v236 offset:13312
  ds_read_b128 v[104:107], v236 offset:14336
  ds_read_b128 v[108:111], v236 offset:15360
  ds_read_b128 v[112:115], v237 offset:16384
  ds_read_b128 v[116:119], v237 offset:17408
  ds_read_b128 v[120:123], v237 offset:18432
  ds_read_b128 v[124:127], v237 offset:19456
  s_waitcnt lgkmcnt(11)
  v_pk_add_f32 v[64:65], v[64:65], v[80:81]
  v_pk_add_f32 v[66:67], v[66:67], v[82:83]
  s_waitcnt lgkmcnt(10)
  v_pk_add_f32 v[68:69], v[68:69], v[84:85]
  v_pk_add_f32 v[70:71], v[70:71], v[86:87]
  s_waitcnt lgkmcnt(9)
  v_pk_add_f32 v[72:73], v[72:73], v[88:89]
  v_pk_add_f32 v[74:75], v[74:75], v[90:91]
  s_waitcnt lgkmcnt(8)
  v_pk_add_f32 v[76:77], v[76:77], v[92:93]
  v_pk_add_f32 v[78:79], v[78:79], v[94:95]
  s_waitcnt lgkmcnt(7)
  v_pk_add_f32 v[64:65], v[64:65], v[96:97]
  v_pk_add_f32 v[66:67], v[66:67], v[98:99]
  s_waitcnt lgkmcnt(6)
  v_pk_add_f32 v[68:69], v[68:69], v[100:101]
  v_pk_add_f32 v[70:71], v[70:71], v[102:103]
  s_waitcnt lgkmcnt(5)
  v_pk_add_f32 v[72:73], v[72:73], v[104:105]
  v_pk_add_f32 v[74:75], v[74:75], v[106:107]
  s_waitcnt lgkmcnt(4)
  v_pk_add_f32 v[76:77], v[76:77], v[108:109]
  v_pk_add_f32 v[78:79], v[78:79], v[110:111]
  ds_read_b64_tr_b16 v[144:145], v14
  ds_read_b64_tr_b16 v[146:147], v14 offset:2048
  ds_read_b64_tr_b16 v[148:149], v15
  ds_read_b64_tr_b16 v[150:151], v15 offset:2048
  ds_read_b64_tr_b16 v[152:153], v16
  ds_read_b64_tr_b16 v[154:155], v16 offset:2048
  ds_read_b64_tr_b16 v[156:157], v17
  ds_read_b64_tr_b16 v[158:159], v17 offset:2048
  s_waitcnt lgkmcnt(11)
  v_pk_add_f32 v[64:65], v[64:65], v[112:113]
  v_pk_add_f32 v[66:67], v[66:67], v[114:115]
  s_waitcnt lgkmcnt(10)
  v_pk_add_f32 v[68:69], v[68:69], v[116:117]
  v_pk_add_f32 v[70:71], v[70:71], v[118:119]
  s_waitcnt lgkmcnt(9)
  v_pk_add_f32 v[72:73], v[72:73], v[120:121]
  v_pk_add_f32 v[74:75], v[74:75], v[122:123]
  s_waitcnt lgkmcnt(8)
  v_pk_add_f32 v[76:77], v[76:77], v[124:125]
  v_pk_add_f32 v[78:79], v[78:79], v[126:127]
  s_nop 0
  s_waitcnt lgkmcnt(6)
  v_mfma_f32_32x32x16_bf16 v[64:79], v[144:147], a[192:195], v[64:79]
  s_waitcnt lgkmcnt(4)
  v_mfma_f32_32x32x16_bf16 v[64:79], v[148:151], a[200:203], v[64:79]
  s_waitcnt lgkmcnt(2)
  v_mfma_f32_32x32x16_bf16 v[64:79], v[152:155], a[208:211], v[64:79]
  s_waitcnt lgkmcnt(0)
  v_mfma_f32_32x32x16_bf16 v[64:79], v[156:159], a[216:219], v[64:79]
  s_waitcnt vmcnt(0)
  s_barrier
  ds_read_b64_tr_b16 v[160:161], v14 offset:4096
  ds_read_b64_tr_b16 v[162:163], v14 offset:6144
  ds_read_b64_tr_b16 v[164:165], v15 offset:4096
  ds_read_b64_tr_b16 v[166:167], v15 offset:6144
  ds_read_b64_tr_b16 v[168:169], v16 offset:4096
  ds_read_b64_tr_b16 v[170:171], v16 offset:6144
  ds_read_b64_tr_b16 v[172:173], v17 offset:4096
  ds_read_b64_tr_b16 v[174:175], v17 offset:6144
  s_waitcnt lgkmcnt(6)
  v_mfma_f32_32x32x16_bf16 v[64:79], v[160:163], a[196:199], v[64:79]
  s_waitcnt lgkmcnt(4)
  v_mfma_f32_32x32x16_bf16 v[64:79], v[164:167], a[204:207], v[64:79]
  s_waitcnt lgkmcnt(2)
  v_mfma_f32_32x32x16_bf16 v[64:79], v[168:171], a[212:215], v[64:79]
  s_waitcnt lgkmcnt(0)
  v_mfma_f32_32x32x16_bf16 v[64:79], v[172:175], a[220:223], v[64:79]
  s_nop 11
  v_cvt_pk_bf16_f32 v144, v64, v65
  v_cvt_pk_bf16_f32 v145, v66, v67
  v_cvt_pk_bf16_f32 v146, v72, v73
  v_cvt_pk_bf16_f32 v147, v74, v75
  v_cvt_pk_bf16_f32 v148, v68, v69
  v_cvt_pk_bf16_f32 v149, v70, v71
  v_cvt_pk_bf16_f32 v150, v76, v77
  v_cvt_pk_bf16_f32 v151, v78, v79
  v_permlane32_swap_b32 v144, v148
  v_permlane32_swap_b32 v145, v149
  v_permlane32_swap_b32 v146, v150
  v_permlane32_swap_b32 v147, v151
  v_permlane16_swap_b32 v144, v148
  v_permlane16_swap_b32 v145, v149
  v_permlane16_swap_b32 v146, v150
  v_permlane16_swap_b32 v147, v151
  ds_write_b128 v238, v[144:147]
  ds_write_b128 v238, v[148:151] offset:1024
  v_mfma_f32_16x16x32_bf16 v[112:115], v[192:195], v[144:147], 0
  v_mfma_f32_16x16x32_bf16 v[80:83], v[32:35], v[144:147], 0
  v_mfma_f32_16x16x32_bf16 v[84:87], v[36:39], v[144:147], 0
  v_mfma_f32_16x16x32_bf16 v[88:91], v[40:43], v[144:147], 0
  v_mfma_f32_16x16x32_bf16 v[92:95], v[44:47], v[144:147], 0
  v_mfma_f32_16x16x32_bf16 v[96:99], v[48:51], v[144:147], 0
  s_waitcnt lgkmcnt(0)
  s_barrier
  ds_read_b128 a[228:231], v239
  v_mfma_f32_16x16x32_bf16 v[100:103], v[52:55], v[144:147], 0
  ds_read_b128 a[232:235], v240
  v_mfma_f32_16x16x32_bf16 v[104:107], v[56:59], v[144:147], 0
  ds_read_b128 a[236:239], v241
  v_mfma_f32_16x16x32_bf16 v[108:111], v[60:63], v[144:147], 0
  ds_read_b128 a[244:247], v239 offset:1024
  v_mfma_f32_16x16x32_bf16 v[112:115], v[208:211], v[148:151], v[112:115]
  ds_read_b128 a[248:251], v240 offset:1024
  v_mfma_f32_16x16x32_bf16 v[80:83], a[64:67], v[148:151], v[80:83]
  ds_read_b128 a[252:255], v241 offset:1024
  v_mfma_f32_16x16x32_bf16 v[84:87], a[68:71], v[148:151], v[84:87]
  v_mfma_f32_16x16x32_bf16 v[88:91], a[72:75], v[148:151], v[88:91]
  v_mfma_f32_16x16x32_bf16 v[92:95], a[76:79], v[148:151], v[92:95]
  v_mfma_f32_16x16x32_bf16 v[96:99], a[80:83], v[148:151], v[96:99]
  v_mfma_f32_16x16x32_bf16 v[100:103], a[84:87], v[148:151], v[100:103]
  v_mfma_f32_16x16x32_bf16 v[104:107], a[88:91], v[148:151], v[104:107]
  v_mfma_f32_16x16x32_bf16 v[108:111], a[92:95], v[148:151], v[108:111]
  s_waitcnt lgkmcnt(5)
  v_mfma_f32_16x16x32_bf16 v[112:115], v[196:199], a[228:231], v[112:115]
  s_waitcnt lgkmcnt(4)
  v_mfma_f32_16x16x32_bf16 v[112:115], v[200:203], a[232:235], v[112:115]
  s_waitcnt lgkmcnt(3)
  v_mfma_f32_16x16x32_bf16 v[112:115], v[204:207], a[236:239], v[112:115]
  s_waitcnt lgkmcnt(2)
  v_mfma_f32_16x16x32_bf16 v[112:115], v[212:215], a[244:247], v[112:115]
  s_waitcnt lgkmcnt(1)
  v_mfma_f32_16x16x32_bf16 v[112:115], v[216:219], a[248:251], v[112:115]
  s_waitcnt lgkmcnt(0)
  v_mfma_f32_16x16x32_bf16 v[112:115], v[220:223], a[252:255], v[112:115]
  v_mfma_f32_16x16x32_bf16 v[80:83], v[128:131], a[228:231], v[80:83]
  v_mfma_f32_16x16x32_bf16 v[84:87], v[132:135], a[228:231], v[84:87]
  v_mfma_f32_16x16x32_bf16 v[80:83], a[0:3], a[232:235], v[80:83]
  v_mfma_f32_16x16x32_bf16 v[84:87], a[4:7], a[232:235], v[84:87]
  v_mfma_f32_16x16x32_bf16 v[80:83], a[32:35], a[236:239], v[80:83]
  v_mfma_f32_16x16x32_bf16 v[84:87], a[36:39], a[236:239], v[84:87]
  v_mfma_f32_16x16x32_bf16 v[80:83], a[96:99], a[244:247], v[80:83]
  v_mfma_f32_16x16x32_bf16 v[84:87], a[100:103], a[244:247], v[84:87]
  v_cvt_pk_bf16_f32 v168, v112, v113
  v_mfma_f32_16x16x32_bf16 v[80:83], a[128:131], a[248:251], v[80:83]
  v_cvt_pk_bf16_f32 v169, v114, v115
  v_mfma_f32_16x16x32_bf16 v[84:87], a[132:135], a[248:251], v[84:87]
  ds_bpermute_b32 v170, v242, v168
  v_mfma_f32_16x16x32_bf16 v[80:83], a[160:163], a[252:255], v[80:83]
  ds_bpermute_b32 v171, v242, v169
  v_mfma_f32_16x16x32_bf16 v[84:87], a[164:167], a[252:255], v[84:87]
  v_mfma_f32_16x16x32_bf16 v[88:91], v[136:139], a[228:231], v[88:91]
  v_mfma_f32_16x16x32_bf16 v[92:95], v[140:143], a[228:231], v[92:95]
  v_mfma_f32_16x16x32_bf16 v[88:91], a[8:11], a[232:235], v[88:91]
  v_mfma_f32_16x16x32_bf16 v[92:95], a[12:15], a[232:235], v[92:95]
  v_mfma_f32_16x16x32_bf16 v[88:91], a[40:43], a[236:239], v[88:91]
  s_waitcnt lgkmcnt(0)
  buffer_store_dwordx2 v[170:171], v229, s[40:43], s67 offen sc1
  v_mfma_f32_16x16x32_bf16 v[92:95], a[44:47], a[236:239], v[92:95]
  v_mfma_f32_16x16x32_bf16 v[88:91], a[104:107], a[244:247], v[88:91]
  v_cvt_pk_bf16_f32 v152, v80, v81
  v_mfma_f32_16x16x32_bf16 v[92:95], a[108:111], a[244:247], v[92:95]
  v_cvt_pk_bf16_f32 v153, v82, v83
  v_mfma_f32_16x16x32_bf16 v[88:91], a[136:139], a[248:251], v[88:91]
  v_cvt_pk_bf16_f32 v154, v84, v85
  v_mfma_f32_16x16x32_bf16 v[92:95], a[140:143], a[248:251], v[92:95]
  v_cvt_pk_bf16_f32 v155, v86, v87
  v_mfma_f32_16x16x32_bf16 v[88:91], a[168:171], a[252:255], v[88:91]
  buffer_store_dwordx4 v[152:155], v228, s[40:43], s67 offen sc1
  v_mfma_f32_16x16x32_bf16 v[92:95], a[172:175], a[252:255], v[92:95]
  v_mfma_f32_16x16x32_bf16 v[96:99], v[176:179], a[228:231], v[96:99]
  v_mfma_f32_16x16x32_bf16 v[100:103], v[180:183], a[228:231], v[100:103]
  v_mfma_f32_16x16x32_bf16 v[96:99], a[16:19], a[232:235], v[96:99]
  v_mfma_f32_16x16x32_bf16 v[100:103], a[20:23], a[232:235], v[100:103]
  v_mfma_f32_16x16x32_bf16 v[96:99], a[48:51], a[236:239], v[96:99]
  v_mfma_f32_16x16x32_bf16 v[100:103], a[52:55], a[236:239], v[100:103]
  v_mfma_f32_16x16x32_bf16 v[96:99], a[112:115], a[244:247], v[96:99]
  v_cvt_pk_bf16_f32 v156, v88, v89
  v_mfma_f32_16x16x32_bf16 v[100:103], a[116:119], a[244:247], v[100:103]
  v_cvt_pk_bf16_f32 v157, v90, v91
  v_mfma_f32_16x16x32_bf16 v[96:99], a[144:147], a[248:251], v[96:99]
  v_cvt_pk_bf16_f32 v158, v92, v93
  v_mfma_f32_16x16x32_bf16 v[100:103], a[148:151], a[248:251], v[100:103]
  v_cvt_pk_bf16_f32 v159, v94, v95
  v_mfma_f32_16x16x32_bf16 v[96:99], a[176:179], a[252:255], v[96:99]
  buffer_store_dwordx4 v[156:159], v228, s[40:43], s67 offen offset:1024 sc1
  v_mfma_f32_16x16x32_bf16 v[100:103], a[180:183], a[252:255], v[100:103]
  v_mfma_f32_16x16x32_bf16 v[104:107], v[184:187], a[228:231], v[104:107]
  v_mfma_f32_16x16x32_bf16 v[108:111], v[188:191], a[228:231], v[108:111]
  v_mfma_f32_16x16x32_bf16 v[104:107], a[24:27], a[232:235], v[104:107]
  v_mfma_f32_16x16x32_bf16 v[108:111], a[28:31], a[232:235], v[108:111]
  v_mfma_f32_16x16x32_bf16 v[104:107], a[56:59], a[236:239], v[104:107]
  v_mfma_f32_16x16x32_bf16 v[108:111], a[60:63], a[236:239], v[108:111]
  v_mfma_f32_16x16x32_bf16 v[104:107], a[120:123], a[244:247], v[104:107]
  v_cvt_pk_bf16_f32 v160, v96, v97
  v_mfma_f32_16x16x32_bf16 v[108:111], a[124:127], a[244:247], v[108:111]
  v_cvt_pk_bf16_f32 v161, v98, v99
  v_mfma_f32_16x16x32_bf16 v[104:107], a[152:155], a[248:251], v[104:107]
  v_cvt_pk_bf16_f32 v162, v100, v101
  v_mfma_f32_16x16x32_bf16 v[108:111], a[156:159], a[248:251], v[108:111]
  v_cvt_pk_bf16_f32 v163, v102, v103
  v_mfma_f32_16x16x32_bf16 v[104:107], a[184:187], a[252:255], v[104:107]
  buffer_store_dwordx4 v[160:163], v228, s[40:43], s67 offen offset:2048 sc1
  v_mfma_f32_16x16x32_bf16 v[108:111], a[188:191], a[252:255], v[108:111]
  s_nop 5
  v_cvt_pk_bf16_f32 v164, v104, v105
  v_cvt_pk_bf16_f32 v165, v106, v107
  v_cvt_pk_bf16_f32 v166, v108, v109
  v_cvt_pk_bf16_f32 v167, v110, v111
  buffer_store_dwordx4 v[164:167], v228, s[40:43], s67 offen offset:3072 sc1
  v_mov_b32 v119, 0x40000000
  v_lshlrev_b32 v116, 11, v0
  v_cmp_gt_u32 vcc, 8, v0
  s_lshl_b32 s99, s49, 14
  s_lshl2_add_u32 s99, s50, s99
  v_cndmask_b32 v116, v119, v116, vcc
  s_add_u32 s99, s99, 5243136
  v_add_u32 v124, 0x100, v230
  s_bfe_u32 s60, s50, 0x20003
  s_lshl_b32 s60, s60, 9
  s_add_u32 s99, s99, s60
  v_bfe_u32 v26, v0, 3, 2
  v_lshl_add_u32 v124, v26, 9, v124
  s_andn2_b32 s65, s65, 1536
  v_cmp_gt_u32 vcc, 32, v0
  v_lshrrev_b32 v30, 4, v0
  v_and_b32 v31, 15, v0
  s_lshr_b32 s52, s50, 1
  s_and_b32 s51, s50, 1
  s_mul_i32 s62, s49, 655360
  s_mul_i32 s68, s49, 18432
  v_mul_u32_u24 v117, 18176, v30
  v_add_u32 v117, v117, v228
  s_cmp_eq_u32 s3, 2
  s_cbranch_scc1 1f
  s_lshr_b32 s60, s50, 3
  s_add_u32 s60, s60, s50
  s_lshl1_add_u32 s60, s60, s3
  s_lshl_b32 s60, s60, 8
  s_add_u32 s62, s62, s60
  s_lshl2_add_u32 s60, s52, s51
  s_lshl1_add_u32 s60, s60, s3
  s_lshl3_add_u32 s68, s60, s68
  v_mul_u32_u24 v118, 1152, v31
  v_lshl_add_u32 v118, v30, 5, v118
  s_mov_b64 s[92:93], -1
  s_branch 2f
1:
  s_bfe_u32 s51, s50, 0x10002
  s_lshr_b32 s52, s50, 3
  s_and_b32 s60, s50, 3
  s_lshl2_add_u32 s52, s52, s60
  s_mul_i32 s60, s51, 9216
  s_add_u32 s62, s62, s60
  s_lshl_b32 s60, s52, 5
  s_addk_i32 s60, 4096
  s_add_u32 s62, s62, s60
  v_lshrrev_b32 v26, 1, v31
  v_mul_u32_u24 v26, 4576, v26
  v_add_u32 v117, v117, v26
  s_mul_i32 s60, s52, 1152
  s_add_u32 s68, s68, s60
  s_lshl_b32 s60, s51, 6
  s_addk_i32 s60, 1024
  s_add_u32 s68, s68, s60
  v_lshlrev_b32 v118, 4, v31
  v_lshl_add_u32 v118, v30, 3, v118
  s_mov_b32 s92, 0x000f000f
  s_mov_b32 s93, 0x000f000f
2:
  v_cndmask_b32 v118, v119, v118, vcc
  v_cndmask_b32 v118, v119, v118, s[92:93]
  v_and_b32 v26, 1, v0
  v_lshlrev_b32 v26, 4, v26
  v_mov_b32 v27, 0x3f80
  v_lshlrev_b32 v26, v26, v27
  v_lshrrev_b32 v27, 1, v31
  v_cmp_eq_u32 vcc, 0, v27
  s_nop 1
  v_cndmask_b32 v120, 0, v26, vcc
  v_cmp_eq_u32 vcc, 1, v27
  s_nop 1
  v_cndmask_b32 v121, 0, v26, vcc
  v_cmp_eq_u32 vcc, 2, v27
  s_nop 1
  v_cndmask_b32 v122, 0, v26, vcc
  v_cmp_eq_u32 vcc, 3, v27
  s_nop 1
  v_cndmask_b32 v123, 0, v26, vcc
  s_mov_b32 s69, 0x200000
  s_cmp_eq_u32 s3, 3
  s_waitcnt vmcnt(0)
  s_barrier
  s_cbranch_scc0 1f
  buffer_store_dword v253, v116, s[40:43], s99 offen sc1
  s_endpgm
1:
  s_cmp_lg_u32 s3, 0
  s_cbranch_scc1 2f
1:
  buffer_load_dword v26, v124, s[40:43], s65 offen sc1
  s_sub_u32 s69, s69, 1
  s_cmp_eq_u32 s69, 0
  s_cbranch_scc1 3f
  s_waitcnt vmcnt(0)
  v_cmp_ne_u32 vcc, 1, v26
  s_cbranch_vccnz 1b
3:
2:
  s_barrier
  s_mov_b64 exec, s[92:93]
  buffer_load_dwordx4 v[64:67], v117, s[40:43], s62 offen sc1
  s_add_u32 s62, s62, 73728
  buffer_load_dwordx4 v[68:71], v117, s[40:43], s62 offen sc1
  s_add_u32 s62, s62, 73728
  buffer_load_dwordx4 v[72:75], v117, s[40:43], s62 offen sc1
  s_add_u32 s62, s62, 73728
  buffer_load_dwordx4 v[76:79], v117, s[40:43], s62 offen sc1
  s_add_u32 s62, s62, 73728
  buffer_load_dwordx4 v[80:83], v117, s[40:43], s62 offen sc1
  s_add_u32 s62, s62, 73728
  buffer_load_dwordx4 v[84:87], v117, s[40:43], s62 offen sc1
  s_add_u32 s62, s62, 73728
  buffer_load_dwordx4 v[88:91], v117, s[40:43], s62 offen sc1
  s_add_u32 s62, s62, 73728
  buffer_load_dwordx4 v[92:95], v117, s[40:43], s62 offen sc1
  s_mov_b64 exec, -1
  s_waitcnt vmcnt(7)
  v_mfma_f32_16x16x32_bf16 v[96:99], v[120:123], v[64:67], 0
  s_waitcnt vmcnt(6)
  v_mfma_f32_16x16x32_bf16 v[96:99], v[120:123], v[68:71], v[96:99]
  s_waitcnt vmcnt(5)
  v_mfma_f32_16x16x32_bf16 v[96:99], v[120:123], v[72:75], v[96:99]
  s_waitcnt vmcnt(4)
  v_mfma_f32_16x16x32_bf16 v[96:99], v[120:123], v[76:79], v[96:99]
  s_waitcnt vmcnt(3)
  v_mfma_f32_16x16x32_bf16 v[96:99], v[120:123], v[80:83], v[96:99]
  s_waitcnt vmcnt(2)
  v_mfma_f32_16x16x32_bf16 v[96:99], v[120:123], v[84:87], v[96:99]
  s_waitcnt vmcnt(1)
  v_mfma_f32_16x16x32_bf16 v[96:99], v[120:123], v[88:91], v[96:99]
  s_waitcnt vmcnt(0)
  v_mfma_f32_16x16x32_bf16 v[96:99], v[120:123], v[92:95], v[96:99]
  s_nop 7
  v_cvt_pk_bf16_f32 v100, v96, v97
  v_cvt_pk_bf16_f32 v101, v98, v99
  buffer_store_dwordx2 v[100:101], v118, s[44:47], s68 offen
L_end:
  s_endpgm
.section .rodata,"a"
.p2align 6
.amdhsa_kernel standalone__gqa_block_cached__sampling_kernel
  .amdhsa_next_free_vgpr 512
  .amdhsa_next_free_sgpr 102
  .amdhsa_accum_offset 256
  .amdhsa_group_segment_fixed_size 0
  .amdhsa_kernarg_size 64
  .amdhsa_user_sgpr_count 2
  .amdhsa_user_sgpr_kernarg_segment_ptr 1
  .amdhsa_system_sgpr_workgroup_id_x 1
.end_amdhsa_kernel
```
